```python
import torch

def _softmax(x, axis=-1):
    return torch.softmax(x, dim=axis)
def _gelu(x):
    return torch.nn.functional.gelu(x, approximate="tanh")
def _silu(x):
    return torch.nn.functional.silu(x)
def _sigmoid(x):
    return torch.sigmoid(x)
def _layernorm(x, axis=-1, eps=1e-5):
    m = x.mean(dim=axis, keepdim=True)
    v = x.var(dim=axis, keepdim=True, unbiased=False)
    return (x - m) / torch.sqrt(v + eps)
def _scatter_add(tgt, idx, src, axis=0):
    return tgt.clone().index_add_(axis, idx, src)
def _segment_sum(src, seg, n):
    out = torch.zeros((n,) + src.shape[1:], dtype=src.dtype)
    return out.index_add_(0, seg, src)
def _pad(x, pw):
    flat = tuple(v for pair in reversed(pw) for v in pair)
    return torch.nn.functional.pad(x, flat)

kernel_name = 'concat_heads__mha_block_cached__mha_block_cached__near_ridge'

def setup_inputs():

    _w = (lambda a: (lambda t: t.to(torch.bfloat16) if t.is_floating_point() else t)(torch.as_tensor(a)))
    def _A_setup():
        B, Sq, D = 8, 240, 1024
        H, Sk, Dh = 32, 1024, 128
        return {
            "x": _w((lambda *s: torch.randn(*s, dtype=torch.bfloat16) * 0.8)(B, Sq, D)),
            "k_cache": _w((lambda *s: torch.randn(*s, dtype=torch.bfloat16) * 0.8)(B, H, Sk, Dh)),
            "v_cache": _w((lambda *s: torch.randn(*s, dtype=torch.bfloat16) * 0.05)(B, H, Sk, Dh)),
            "wq": _w((lambda *s: torch.randn(*s, dtype=torch.bfloat16) * 0.8)(D, H * Dh) * (D ** -0.5)),
            "wo": _w((lambda *s: torch.randn(*s, dtype=torch.bfloat16) * 0.05)(H * Dh, D) * ((H * Dh) ** -0.5)),
        }
    _A_in = _A_setup()

    def _B_setup():
        B, Sq, D = 8, 240, 1024
        H, Sk, Dh = 32, 1024, 128
        return {
            "x": _w((lambda *s: torch.randn(*s, dtype=torch.bfloat16) * 0.8)(B, Sq, D)),
            "k_cache": _w((lambda *s: torch.randn(*s, dtype=torch.bfloat16) * 0.8)(B, H, Sk, Dh)),
            "v_cache": _w((lambda *s: torch.randn(*s, dtype=torch.bfloat16) * 0.05)(B, H, Sk, Dh)),
            "wq": _w((lambda *s: torch.randn(*s, dtype=torch.bfloat16) * 0.8)(D, H * Dh) * (D ** -0.5)),
            "wo": _w((lambda *s: torch.randn(*s, dtype=torch.bfloat16) * 0.05)(H * Dh, D) * ((H * Dh) ** -0.5)),
        }
    _B_in = _B_setup()

    return {
        "A_x": _A_in["x"],
        "A_k_cache": _A_in["k_cache"],
        "A_v_cache": _A_in["v_cache"],
        "A_wq": _A_in["wq"],
        "A_wo": _A_in["wo"],
        "B_x": _B_in["x"],
        "B_k_cache": _B_in["k_cache"],
        "B_v_cache": _B_in["v_cache"],
        "B_wq": _B_in["wq"],
        "B_wo": _B_in["wo"],
    }

def reference(A_x, A_k_cache, A_v_cache, A_wq, A_wo, B_x, B_k_cache, B_v_cache, B_wq, B_wo):
    def _A_ref(x, k_cache, v_cache, wq, wo):
        B, Sq, D = x.shape
        H, Dh = 32, 128
        q = (lambda x, *d: x.permute(*d))((x @ wq).reshape(B, Sq, H, Dh), 0, 2, 1, 3)
        scores = torch.einsum("bhqd,bhkd->bhqk", q, k_cache) * (Dh ** -0.5)
        p = _softmax(scores, axis=-1)
        o = torch.einsum("bhqk,bhkd->bhqd", p, v_cache)
        return (lambda x, *d: x.permute(*d))(o, 0, 2, 1, 3).reshape(B, Sq, H * Dh) @ wo

    def _B_ref(x, k_cache, v_cache, wq, wo):
        B, Sq, D = x.shape
        H, Dh = 32, 128
        q = (lambda x, *d: x.permute(*d))((x @ wq).reshape(B, Sq, H, Dh), 0, 2, 1, 3)
        scores = torch.einsum("bhqd,bhkd->bhqk", q, k_cache) * (Dh ** -0.5)
        p = _softmax(scores, axis=-1)
        o = torch.einsum("bhqk,bhkd->bhqd", p, v_cache)
        return (lambda x, *d: x.permute(*d))(o, 0, 2, 1, 3).reshape(B, Sq, H * Dh) @ wo

    a = _A_ref(A_x, A_k_cache, A_v_cache, A_wq, A_wo)
    b = _B_ref(B_x, B_k_cache, B_v_cache, B_wq, B_wo)
    return torch.concatenate([a, b], axis=-1)
```

```asm
; @launch kernel=mha_kernel grid=(256,1,1) block=(256,1,1) lds=163840
.amdgcn_target "amdgcn-amd-amdhsa--gfx950"
.text
.globl mha_kernel
.p2align 8
.type mha_kernel,@function
mha_kernel:
  s_cmp_ge_u32 s2, 256
  s_cbranch_scc1 L1_end
  s_load_dwordx4 s[52:55], s[0:1], 0
  s_load_dwordx4 s[56:59], s[0:1], 16
  s_load_dwordx4 s[60:63], s[0:1], 40
  s_load_dwordx4 s[64:67], s[0:1], 56
  s_load_dwordx2 s[68:69], s[0:1], 96
  s_load_dwordx2 s[70:71], s[0:1], 88
  s_load_dwordx2 s[100:101], s[0:1], 80
  s_load_dwordx2 s[96:97], s[0:1], 32
  s_load_dwordx2 s[98:99], s[0:1], 72
  s_getpc_b64 s[72:73]
CP_base:
  s_mov_b32 s74, 32768
  s_mov_b32 s75, 0x20000
  v_lshrrev_b32 v1, 6, v0
  v_and_b32 v2, 63, v0
  v_readfirstlane_b32 s24, v1
  s_and_b32 s34, s2, 7
  s_lshr_b32 s35, s2, 3
  s_lshr_b32 s36, s34, 2
  s_and_b32 s37, s35, 7
  s_and_b32 s38, s34, 3
  s_lshl_b32 s38, s38, 2
  s_lshr_b32 s39, s35, 3
  s_add_u32 s38, s38, s39
  s_lshl_b32 s28, s24, 13
  s_lshl_b32 s29, s24, 11
  s_mov_b32 s32, 0x3e0293ee
  s_mov_b32 s33, 0x3e0293ee
  v_and_b32 v3, 31, v2
  v_lshrrev_b32 v4, 5, v2
  v_lshrrev_b32 v5, 4, v2
  v_and_b32 v6, 15, v2
  v_and_b32 v30, 3, v2
  v_lshrrev_b32 v56, 3, v2
  v_lshl_add_u32 v56, v1, 6, v56
  v_lshlrev_b32 v56, 11, v56
  v_and_b32 v57, 7, v2
  v_add_u32 v58, 0, v5
  v_and_b32 v58, 7, v58
  v_xor_b32 v58, v58, v57
  v_lshl_add_u32 v58, v58, 4, v56
  v_add_u32 v40, 0x0, v58
  v_add_u32 v58, 4, v5
  v_and_b32 v58, 7, v58
  v_xor_b32 v58, v58, v57
  v_lshl_add_u32 v58, v58, 4, v56
  v_add_u32 v41, 0x3c00, v58
  v_add_u32 v58, 8, v5
  v_and_b32 v58, 7, v58
  v_xor_b32 v58, v58, v57
  v_lshl_add_u32 v58, v58, 4, v56
  v_add_u32 v42, 0x7800, v58
  v_add_u32 v58, 12, v5
  v_and_b32 v58, 7, v58
  v_xor_b32 v58, v58, v57
  v_lshl_add_u32 v58, v58, 4, v56
  v_add_u32 v43, 0xb400, v58
  v_add_u32 v58, 16, v5
  v_and_b32 v58, 7, v58
  v_xor_b32 v58, v58, v57
  v_lshl_add_u32 v58, v58, 4, v56
  v_add_u32 v44, 0x10000, v58
  v_add_u32 v58, 20, v5
  v_and_b32 v58, 7, v58
  v_xor_b32 v58, v58, v57
  v_lshl_add_u32 v58, v58, 4, v56
  v_add_u32 v45, 0x13c00, v58
  v_add_u32 v58, 24, v5
  v_and_b32 v58, 7, v58
  v_xor_b32 v58, v58, v57
  v_lshl_add_u32 v58, v58, 4, v56
  v_add_u32 v46, 0x17800, v58
  v_add_u32 v58, 28, v5
  v_and_b32 v58, 7, v58
  v_xor_b32 v58, v58, v57
  v_lshl_add_u32 v58, v58, 4, v56
  v_add_u32 v47, 0x1b400, v58
  v_lshl_add_u32 v56, v1, 4, v4
  v_lshlrev_b32 v56, 13, v56
  v_and_b32 v57, 1, v2
  v_lshl_add_u32 v56, v57, 4, v56
  v_lshrrev_b32 v57, 1, v3
  v_add_u32 v58, 0, v4
  v_xor_b32 v58, v58, v57
  v_lshl_add_u32 v58, v58, 5, v56
  v_add_u32 v48, 0x0, v58
  v_add_u32 v58, 2, v4
  v_xor_b32 v58, v58, v57
  v_lshl_add_u32 v58, v58, 5, v56
  v_add_u32 v49, 0x3c00, v58
  v_add_u32 v58, 0, v4
  v_xor_b32 v58, v58, v57
  v_lshl_add_u32 v58, v58, 5, v56
  v_add_u32 v50, 0x7800, v58
  v_add_u32 v58, 2, v4
  v_xor_b32 v58, v58, v57
  v_lshl_add_u32 v58, v58, 5, v56
  v_add_u32 v51, 0xb400, v58
  v_add_u32 v58, 4, v4
  v_xor_b32 v58, v58, v57
  v_lshl_add_u32 v58, v58, 5, v56
  v_add_u32 v52, 0x10000, v58
  v_add_u32 v58, 6, v4
  v_xor_b32 v58, v58, v57
  v_lshl_add_u32 v58, v58, 5, v56
  v_add_u32 v53, 0x13c00, v58
  v_add_u32 v58, 4, v4
  v_xor_b32 v58, v58, v57
  v_lshl_add_u32 v58, v58, 5, v56
  v_add_u32 v54, 0x17800, v58
  v_add_u32 v58, 6, v4
  v_xor_b32 v58, v58, v57
  v_lshl_add_u32 v58, v58, 5, v56
  v_add_u32 v55, 0x1b400, v58
  s_waitcnt lgkmcnt(0)
  s_cmp_eq_u32 s36, 0
  s_cselect_b32 s4, s52, s60
  s_cselect_b32 s5, s53, s61
  s_cselect_b32 s8, s58, s66
  s_cselect_b32 s9, s59, s67
  s_mul_i32 s40, s37, 491520
  s_add_u32 s4, s4, s40
  s_addc_u32 s5, s5, 0
  s_mov_b32 s6, 491520
  s_mov_b32 s7, 0x20000
  s_lshl_b32 s40, s38, 9
  s_add_u32 s8, s8, s40
  s_addc_u32 s9, s9, 0
  s_sub_u32 s10, 0x800000, s40
  s_mov_b32 s11, 0x20000
  s_mov_b32 s25, 0
  s_mov_b32 s26, 0
  s_mov_b32 s50, 0
  s_mov_b32 s51, 0x0
  s_add_u32 m0, s28, 0x0
  s_nop 0
  buffer_load_dwordx4 v40, s[4:7], s25 offen offset:0 lds
  buffer_load_dwordx4 v41, s[4:7], s25 offen offset:1024 lds
  buffer_load_dwordx4 v42, s[4:7], s25 offen offset:2048 lds
  buffer_load_dwordx4 v43, s[4:7], s25 offen offset:3072 lds
  s_add_u32 m0, s28, 0x10000
  s_nop 0
  buffer_load_dwordx4 v48, s[8:11], s26 offen offset:0 lds
  buffer_load_dwordx4 v49, s[8:11], s26 offen offset:1024 lds
  buffer_load_dwordx4 v50, s[8:11], s26 offen offset:2048 lds
  buffer_load_dwordx4 v51, s[8:11], s26 offen offset:3072 lds
  s_add_u32 m0, s28, 0x1000
  s_nop 0
  buffer_load_dwordx4 v44, s[4:7], s25 offen offset:0 lds
  buffer_load_dwordx4 v45, s[4:7], s25 offen offset:1024 lds
  buffer_load_dwordx4 v46, s[4:7], s25 offen offset:2048 lds
  buffer_load_dwordx4 v47, s[4:7], s25 offen offset:3072 lds
  s_add_u32 m0, s28, 0x11000
  s_nop 0
  buffer_load_dwordx4 v52, s[8:11], s26 offen offset:0 lds
  buffer_load_dwordx4 v53, s[8:11], s26 offen offset:1024 lds
  buffer_load_dwordx4 v54, s[8:11], s26 offen offset:2048 lds
  buffer_load_dwordx4 v55, s[8:11], s26 offen offset:3072 lds
  s_mov_b32 s25, 128
  s_mov_b32 s26, 0x80000
  s_add_u32 m0, s28, 0x8000
  s_nop 0
  buffer_load_dwordx4 v40, s[4:7], s25 offen offset:0 lds
  buffer_load_dwordx4 v41, s[4:7], s25 offen offset:1024 lds
  buffer_load_dwordx4 v42, s[4:7], s25 offen offset:2048 lds
  buffer_load_dwordx4 v43, s[4:7], s25 offen offset:3072 lds
  s_add_u32 m0, s28, 0x18000
  s_nop 0
  buffer_load_dwordx4 v48, s[8:11], s26 offen offset:0 lds
  v_lshlrev_b32 v7, 13, v1
  v_lshl_add_u32 v7, v6, 7, v7
  v_lshrrev_b32 v29, 1, v6
  v_add_u32 v30, 0, v5
  v_xor_b32 v30, v30, v29
  v_lshl_add_u32 v25, v30, 4, v7
  v_add_u32 v30, 4, v5
  v_xor_b32 v30, v30, v29
  v_lshl_add_u32 v26, v30, 4, v7
  v_lshrrev_b32 v29, 2, v6
  v_and_b32 v30, 3, v2
  v_lshl_add_u32 v56, v5, 3, v29
  v_lshlrev_b32 v56, 9, v56
  v_lshl_add_u32 v56, v30, 3, v56
  v_add_u32 v56, 0x10000, v56
  v_and_b32 v57, 1, v5
  v_lshl_add_u32 v57, v57, 2, v29
  v_xor_b32 v58, 0, v57
  v_lshl_add_u32 v32, v58, 5, v56
  v_xor_b32 v58, 1, v57
  v_lshl_add_u32 v33, v58, 5, v56
  v_xor_b32 v58, 2, v57
  v_lshl_add_u32 v34, v58, 5, v56
  v_xor_b32 v58, 3, v57
  v_lshl_add_u32 v35, v58, 5, v56
  v_xor_b32 v58, 4, v57
  v_lshl_add_u32 v36, v58, 5, v56
  v_xor_b32 v58, 5, v57
  v_lshl_add_u32 v37, v58, 5, v56
  v_xor_b32 v58, 6, v57
  v_lshl_add_u32 v38, v58, 5, v56
  v_xor_b32 v58, 7, v57
  v_lshl_add_u32 v39, v58, 5, v56
  v_lshrrev_b32 v29, 2, v6
  v_and_b32 v30, 3, v2
  v_and_b32 v31, 1, v5
  v_lshlrev_b32 v31, 5, v31
  v_and_b32 v56, 1, v30
  v_lshl_add_u32 v31, v56, 4, v31
  v_lshrrev_b32 v56, 1, v30
  v_lshl_add_u32 v31, v56, 3, v31
  v_lshl_add_u32 v57, v4, 2, v29
  v_lshl_add_u32 v57, v57, 8, v31
  v_add_u32 v57, 0x10000, v57
  v_xor_b32 v58, 0, v29
  v_lshl_add_u32 v16, v58, 6, v57
  v_xor_b32 v58, 1, v29
  v_lshl_add_u32 v17, v58, 6, v57
  v_xor_b32 v58, 2, v29
  v_lshl_add_u32 v18, v58, 6, v57
  v_xor_b32 v58, 3, v29
  v_lshl_add_u32 v19, v58, 6, v57
  v_lshlrev_b32 v56, 8, v3
  v_add_u32 v58, 0, v4
  v_xor_b32 v58, v58, v6
  v_lshl_add_u32 v8, v58, 4, v56
  v_add_u32 v58, 2, v4
  v_xor_b32 v58, v58, v6
  v_lshl_add_u32 v9, v58, 4, v56
  v_add_u32 v58, 4, v4
  v_xor_b32 v58, v58, v6
  v_lshl_add_u32 v10, v58, 4, v56
  v_add_u32 v58, 6, v4
  v_xor_b32 v58, v58, v6
  v_lshl_add_u32 v11, v58, 4, v56
  v_add_u32 v58, 8, v4
  v_xor_b32 v58, v58, v6
  v_lshl_add_u32 v12, v58, 4, v56
  v_add_u32 v58, 10, v4
  v_xor_b32 v58, v58, v6
  v_lshl_add_u32 v13, v58, 4, v56
  v_add_u32 v58, 12, v4
  v_xor_b32 v58, v58, v6
  v_lshl_add_u32 v14, v58, 4, v56
  v_add_u32 v58, 14, v4
  v_xor_b32 v58, v58, v6
  v_lshl_add_u32 v15, v58, 4, v56
  v_lshl_add_u32 v56, v1, 3, v5
  v_lshlrev_b32 v56, 8, v56
  v_and_b32 v57, 1, v1
  v_lshl_add_u32 v57, v57, 3, v5
  v_xor_b32 v58, v57, v6
  v_lshl_add_u32 v20, v58, 4, v56
  v_add_u32 v57, 4, v57
  v_xor_b32 v58, v57, v6
  v_lshl_add_u32 v21, v58, 4, v56
  v_lshlrev_b32 v57, 2, v5
  v_xor_b32 v58, v57, v6
  v_lshl_add_u32 v22, v58, 4, v56
  v_and_b32 v56, 1, v5
  v_lshlrev_b32 v56, 17, v56
  v_lshl_add_u32 v56, v4, 8, v56
  v_lshl_add_u32 v23, v6, 4, v56
  v_add_u32 v24, 0x40000, v23
  s_lshl_b32 s40, s39, 6
  v_lshl_add_u32 v56, v1, 4, v2
  v_add_u32 v56, s40, v56
  v_lshlrev_b32 v56, 11, v56
  v_mov_b32 v57, 0x7ff00000
  v_cmp_gt_u32 vcc, 16, v2
  s_nop 1
  v_cndmask_b32 v29, v57, v56, vcc
  s_lshl_b32 s40, s37, 3
  v_lshrrev_b32 v56, 2, v2
  v_lshl_add_u32 v56, v1, 1, v56
  v_add_u32 v56, s40, v56
  v_lshlrev_b32 v56, 13, v56
  v_and_b32 v58, 3, v2
  v_lshl_add_u32 v56, v58, 7, v56
  v_cmp_gt_u32 vcc, 8, v2
  s_nop 1
  v_cndmask_b32 v30, v57, v56, vcc
  s_lshl_b32 s40, s38, 3
  s_add_u32 s40, s40, s37
  s_lshl_b32 s40, s40, 16
  v_lshlrev_b32 v57, 7, v2
  v_lshl_add_u32 v57, v1, 14, v57
  v_add_u32 v57, s40, v57
  v_mov_b32 v58, 0x7ff00000
  v_cmp_gt_u32 vcc, 16, v2
  s_nop 1
  v_cndmask_b32 v56, v58, v57, vcc
  v_and_b32 v57, 6, v2
  v_cmp_eq_u32 vcc, 2, v57
  s_nop 1
  v_cndmask_b32 v56, v56, v58, vcc
  v_mul_u32_u24 v57, 8, v1
  v_add_u32 v57, v57, v2
  v_lshlrev_b32 v57, 7, v57
  v_mov_b32 v58, 0x7ff00000
  v_cmp_gt_u32 vcc, 8, v2
  s_nop 1
  v_cndmask_b32 v64, v58, v57, vcc
  s_cmp_eq_u32 s36, 0
  s_cselect_b32 s92, s96, s98
  s_cselect_b32 s93, s97, s99
  s_mov_b32 s94, 0x800000
  s_mov_b32 s95, 0x20000
  s_cselect_b32 s12, s54, s62
  s_cselect_b32 s13, s55, s63
  s_cselect_b32 s16, s56, s64
  s_cselect_b32 s17, s57, s65
  s_lshl_b32 s40, s37, 5
  s_lshl_b32 s41, s38, 1
  s_add_u32 s40, s40, s41
  s_lshl_b32 s40, s40, 18
  s_add_u32 s12, s12, s40
  s_addc_u32 s13, s13, 0
  s_add_u32 s16, s16, s40
  s_addc_u32 s17, s17, 0
  s_mov_b32 s47, 0x80000
  s_mov_b32 s48, 0
  s_mov_b32 s14, 0x80000
  s_mov_b32 s15, 0x20000
  s_mov_b32 s18, 0x80000
  s_mov_b32 s19, 0x20000
  s_mul_i32 s40, s36, 15728640
  s_mul_i32 s41, s37, 15
  s_lshl_b32 s42, s24, 2
  s_add_u32 s41, s41, s42
  s_lshl_b32 s41, s41, 17
  s_add_u32 s40, s40, s41
  s_lshl_b32 s41, s38, 12
  s_add_u32 s40, s40, s41
  s_add_u32 s20, s68, s40
  s_addc_u32 s21, s69, 0
  s_sub_u32 s42, 15, s42
  s_min_u32 s42, s42, 4
  s_lshl_b32 s22, s42, 17
  s_mov_b32 s23, 0x20000
  s_mov_b64 s[64:65], s[72:73]
  s_mov_b32 s66, CP_end-CP_base
  s_mov_b32 s67, 0x20000
  s_lshl_b32 s40, s35, 2
  s_add_u32 s40, s40, s24
  s_lshl_b32 s40, s40, 8
  v_and_b32 v0, 1, v2
  v_lshlrev_b32 v0, 7, v0
  v_add_u32 v0, s40, v0
  v_add_u32 v3, CP_q14-CP_base, v0
  s_mov_b32 s49, 128
  buffer_load_dword v59, v29, s[4:7], s49 offen
  s_mov_b32 s49, 0x80000
  buffer_load_dword v59, v30, s[8:11], s49 offen
  s_mov_b32 s49, 256
  buffer_load_dword v59, v29, s[4:7], s49 offen
  s_mov_b32 s49, 0x100000
  buffer_load_dword v59, v30, s[8:11], s49 offen
  s_min_u32 s41, s35, 29
  s_and_b32 s40, s34, 3
  s_mul_i32 s40, s40, 30
  s_add_u32 s40, s40, s41
  s_lshr_b32 s41, s40, 3
  s_and_b32 s42, s40, 7
  s_lshl_b32 s90, s24, 12
  s_mov_b32 s72, s70
  s_mov_b32 s73, s71
  s_mov_b32 s74, 256
  s_mov_b32 s75, 0x20000
  s_lshl_b32 s43, s42, 8
  s_add_u32 s80, s92, s43
  s_addc_u32 s81, s93, 0
  s_sub_u32 s82, 0x800000, s43
  s_mov_b32 s83, 0x20000
  s_lshr_b32 s44, s42, 2
  s_lshl_b32 s45, s36, 1
  s_add_u32 s44, s44, s45
  s_lshl_b32 s44, s44, 9
  s_sub_u32 s46, 0x800000, s44
  s_add_u32 s44, s44, 0x2000000
  s_add_u32 s44, s68, s44
  s_addc_u32 s45, s69, 0
  s_and_b32 s39, s42, 3
  s_cmp_eq_u32 s39, 1
  s_cselect_b32 s80, s44, s80
  s_cselect_b32 s81, s45, s81
  s_cselect_b32 s82, s46, s82
  s_and_b32 s44, s34, 3
  s_lshl_b32 s44, s44, 4
  s_lshr_b32 s45, s35, 1
  s_add_u32 s44, s44, s45
  s_lshl_b32 s44, s44, 2
  s_add_u32 s44, s44, s24
  s_lshl_b32 s44, s44, 15
  s_and_b32 s45, s35, 1
  s_lshl_b32 s46, s45, 10
  s_add_u32 s44, s44, s46
  s_add_u32 s3, s44, 256
  s_lshl_b32 s44, s36, 10
  s_lshl_b32 s45, s45, 9
  s_sub_u32 s44, s44, s45
  s_add_u32 s44, s44, 0x1ffff00
  s_add_u32 s0, s68, s44
  s_addc_u32 s1, s69, 0
  s_lshl_b32 s38, s41, 7
  s_lshl_b32 s39, s24, 5
  s_add_u32 s38, s38, s39
  s_lshl_b32 s39, s38, 12
  s_add_u32 s39, s39, s43
  s_lshl_b32 s43, s36, 11
  s_add_u32 s39, s39, s43
  s_add_u32 s84, s100, s39
  s_addc_u32 s85, s101, 0
  s_mov_b32 s86, 0x20000
  s_mov_b32 s87, 0x20000
  s_mul_i32 s39, s36, 15728640
  s_lshl_b32 s43, s38, 13
  s_add_u32 s39, s39, s43
  s_add_u32 s76, s68, s39
  s_addc_u32 s77, s69, 0
  s_mov_b32 s78, 0x40000
  s_mov_b32 s79, 0x20000
  s_mul_i32 s39, s38, 2185
  s_lshr_b32 s39, s39, 19
  s_lshl_b32 s39, s39, 4
  s_add_u32 s38, s38, 31
  s_mul_i32 s38, s38, 2185
  s_lshr_b32 s38, s38, 19
  s_lshl_b32 s38, s38, 4
  s_lshl_b32 s43, s36, 7
  s_add_u32 s96, s39, s43
  s_add_u32 s97, s38, s43
  s_mov_b32 s98, -1
  s_mov_b32 s99, 0
  s_lshl_b32 s42, s37, 4
  s_add_u32 s41, s42, s43
  s_cmp_lt_u32 s35, 30
  s_cselect_b32 s38, 1, 0
  s_cmp_eq_u32 s24, 0
  s_cselect_b32 s39, 0, 99
  s_cselect_b32 s40, 0, 99
  s_mov_b32 s37, s82
  s_mov_b32 s36, 0x40000
  v_mov_b32 v60, 0
  v_mov_b32 v61, 0
  v_mov_b32 v62, 0
  v_mov_b32 v63, 0
  s_nop 1
  v_mfma_f32_32x32x16_bf16 v[128:143], v[60:63], v[60:63], 0
  v_mfma_f32_32x32x16_bf16 v[144:159], v[60:63], v[60:63], 0
  v_mfma_f32_32x32x16_bf16 v[160:175], v[60:63], v[60:63], 0
  v_mfma_f32_32x32x16_bf16 v[176:191], v[60:63], v[60:63], 0
  v_mfma_f32_32x32x16_bf16 v[192:207], v[60:63], v[60:63], 0
  v_mfma_f32_32x32x16_bf16 v[208:223], v[60:63], v[60:63], 0
  v_mfma_f32_32x32x16_bf16 v[224:239], v[60:63], v[60:63], 0
  v_mfma_f32_32x32x16_bf16 v[240:255], v[60:63], v[60:63], 0
  v_mfma_f32_32x32x16_bf16 a[0:15], v[60:63], v[60:63], 0
  v_mfma_f32_32x32x16_bf16 a[16:31], v[60:63], v[60:63], 0
  v_mfma_f32_32x32x16_bf16 a[32:47], v[60:63], v[60:63], 0
  v_mfma_f32_32x32x16_bf16 a[48:63], v[60:63], v[60:63], 0
  v_mfma_f32_32x32x16_bf16 a[64:79], v[60:63], v[60:63], 0
  v_mfma_f32_32x32x16_bf16 a[80:95], v[60:63], v[60:63], 0
  v_mfma_f32_32x32x16_bf16 a[96:111], v[60:63], v[60:63], 0
  v_mfma_f32_32x32x16_bf16 a[112:127], v[60:63], v[60:63], 0
  s_waitcnt vmcnt(9)
  s_barrier
  ds_read_b64_tr_b16 a[192:193], v32 offset:0
  ds_read_b64_tr_b16 a[194:195], v32 offset:2048
  ds_read_b128 a[128:131], v25 offset:0
  ds_read_b128 a[132:135], v25 offset:2048
  ds_read_b128 a[136:139], v25 offset:4096
  ds_read_b128 a[140:143], v25 offset:6144
  ds_read_b64_tr_b16 a[196:197], v33 offset:0
  ds_read_b64_tr_b16 a[198:199], v33 offset:2048
  ds_read_b64_tr_b16 a[200:201], v34 offset:0
  ds_read_b64_tr_b16 a[202:203], v34 offset:2048
  ds_read_b64_tr_b16 a[204:205], v35 offset:0
  ds_read_b64_tr_b16 a[206:207], v35 offset:2048
  ds_read_b64_tr_b16 a[208:209], v36 offset:0
  ds_read_b64_tr_b16 a[210:211], v36 offset:2048
  ds_read_b64_tr_b16 a[212:213], v37 offset:0
  ds_read_b64_tr_b16 a[214:215], v37 offset:2048
  s_waitcnt lgkmcnt(0)
  s_mov_b32 s30, 0
L1_q:
  s_waitcnt lgkmcnt(8)
  v_mfma_f32_16x16x32_bf16 v[128:131], a[192:195], a[128:131], v[128:131]
  ds_read_b64_tr_b16 a[216:217], v38 offset:0
  v_mfma_f32_16x16x32_bf16 v[132:135], a[192:195], a[132:135], v[132:135]
  ds_read_b64_tr_b16 a[218:219], v38 offset:2048
  v_mfma_f32_16x16x32_bf16 v[136:139], a[192:195], a[136:139], v[136:139]
  buffer_load_dwordx4 v49, s[8:11], s26 offen offset:1024 lds
  v_mfma_f32_16x16x32_bf16 v[140:143], a[192:195], a[140:143], v[140:143]
  ds_read_b128 a[144:147], v26 offset:0
  v_mfma_f32_16x16x32_bf16 v[144:147], a[196:199], a[128:131], v[144:147]
  v_mfma_f32_16x16x32_bf16 v[148:151], a[196:199], a[132:135], v[148:151]
  ds_read_b128 a[148:151], v26 offset:2048
  v_mfma_f32_16x16x32_bf16 v[152:155], a[196:199], a[136:139], v[152:155]
  ds_read_b128 a[152:155], v26 offset:4096
  v_mfma_f32_16x16x32_bf16 v[156:159], a[196:199], a[140:143], v[156:159]
  buffer_load_dwordx4 v50, s[8:11], s26 offen offset:2048 lds
  s_waitcnt lgkmcnt(9)
  v_mfma_f32_16x16x32_bf16 v[160:163], a[200:203], a[128:131], v[160:163]
  ds_read_b128 a[156:159], v26 offset:6144
  v_mfma_f32_16x16x32_bf16 v[164:167], a[200:203], a[132:135], v[164:167]
  v_mfma_f32_16x16x32_bf16 v[168:171], a[200:203], a[136:139], v[168:171]
  ds_read_b64_tr_b16 a[220:221], v39 offset:0
  v_mfma_f32_16x16x32_bf16 v[172:175], a[200:203], a[140:143], v[172:175]
  ds_read_b64_tr_b16 a[222:223], v39 offset:2048
  v_mfma_f32_16x16x32_bf16 v[176:179], a[204:207], a[128:131], v[176:179]
  buffer_load_dwordx4 v51, s[8:11], s26 offen offset:3072 lds
  v_mfma_f32_16x16x32_bf16 v[180:183], a[204:207], a[132:135], v[180:183]
  ds_read_b64_tr_b16 a[224:225], v32 offset:16384
  v_mfma_f32_16x16x32_bf16 v[184:187], a[204:207], a[136:139], v[184:187]
  v_mfma_f32_16x16x32_bf16 v[188:191], a[204:207], a[140:143], v[188:191]
  ds_read_b64_tr_b16 a[226:227], v32 offset:18432
  s_add_u32 m0, s28, 0x9000
  s_waitcnt lgkmcnt(10)
  v_mfma_f32_16x16x32_bf16 v[192:195], a[208:211], a[128:131], v[192:195]
  buffer_load_dwordx4 v44, s[4:7], s25 offen offset:0 lds
  v_mfma_f32_16x16x32_bf16 v[196:199], a[208:211], a[132:135], v[196:199]
  ds_read_b64_tr_b16 a[228:229], v33 offset:16384
  v_mfma_f32_16x16x32_bf16 v[200:203], a[208:211], a[136:139], v[200:203]
  ds_read_b64_tr_b16 a[230:231], v33 offset:18432
  v_mfma_f32_16x16x32_bf16 v[204:207], a[208:211], a[140:143], v[204:207]
  v_mfma_f32_16x16x32_bf16 v[208:211], a[212:215], a[128:131], v[208:211]
  ds_read_b64_tr_b16 a[232:233], v34 offset:16384
  v_mfma_f32_16x16x32_bf16 v[212:215], a[212:215], a[132:135], v[212:215]
  buffer_load_dwordx4 v45, s[4:7], s25 offen offset:1024 lds
  v_mfma_f32_16x16x32_bf16 v[216:219], a[212:215], a[136:139], v[216:219]
  ds_read_b64_tr_b16 a[234:235], v34 offset:18432
  v_mfma_f32_16x16x32_bf16 v[220:223], a[212:215], a[140:143], v[220:223]
  ds_read_b64_tr_b16 a[236:237], v35 offset:16384
  s_waitcnt lgkmcnt(7)
  v_mfma_f32_16x16x32_bf16 v[224:227], a[216:219], a[128:131], v[224:227]
  buffer_load_dwordx4 v46, s[4:7], s25 offen offset:2048 lds
  v_mfma_f32_16x16x32_bf16 v[228:231], a[216:219], a[132:135], v[228:231]
  ds_read_b64_tr_b16 a[238:239], v35 offset:18432
  v_mfma_f32_16x16x32_bf16 v[232:235], a[216:219], a[136:139], v[232:235]
  v_mfma_f32_16x16x32_bf16 v[236:239], a[216:219], a[140:143], v[236:239]
  ds_read_b64_tr_b16 a[240:241], v36 offset:16384
  v_mfma_f32_16x16x32_bf16 v[240:243], a[220:223], a[128:131], v[240:243]
  ds_read_b64_tr_b16 a[242:243], v36 offset:18432
  v_mfma_f32_16x16x32_bf16 v[244:247], a[220:223], a[132:135], v[244:247]
  buffer_load_dwordx4 v47, s[4:7], s25 offen offset:3072 lds
  v_mfma_f32_16x16x32_bf16 v[248:251], a[220:223], a[136:139], v[248:251]
  ds_read_b64_tr_b16 a[244:245], v37 offset:16384
  v_mfma_f32_16x16x32_bf16 v[252:255], a[220:223], a[140:143], v[252:255]
  s_waitcnt lgkmcnt(7)
  v_mfma_f32_16x16x32_bf16 v[128:131], a[224:227], a[144:147], v[128:131]
  ds_read_b64_tr_b16 a[246:247], v37 offset:18432
  s_add_u32 m0, s28, 0x19000
  v_mfma_f32_16x16x32_bf16 v[132:135], a[224:227], a[148:151], v[132:135]
  buffer_load_dwordx4 v52, s[8:11], s26 offen offset:0 lds
  v_mfma_f32_16x16x32_bf16 v[136:139], a[224:227], a[152:155], v[136:139]
  ds_read_b64_tr_b16 a[248:249], v38 offset:16384
  v_mfma_f32_16x16x32_bf16 v[140:143], a[224:227], a[156:159], v[140:143]
  ds_read_b64_tr_b16 a[250:251], v38 offset:18432
  v_mfma_f32_16x16x32_bf16 v[144:147], a[228:231], a[144:147], v[144:147]
  buffer_load_dwordx4 v53, s[8:11], s26 offen offset:1024 lds
  v_mfma_f32_16x16x32_bf16 v[148:151], a[228:231], a[148:151], v[148:151]
  ds_read_b64_tr_b16 a[252:253], v39 offset:16384
  v_mfma_f32_16x16x32_bf16 v[152:155], a[228:231], a[152:155], v[152:155]
  v_mfma_f32_16x16x32_bf16 v[156:159], a[228:231], a[156:159], v[156:159]
  ds_read_b64_tr_b16 a[254:255], v39 offset:18432
  s_waitcnt lgkmcnt(8)
  v_mfma_f32_16x16x32_bf16 v[160:163], a[232:235], a[144:147], v[160:163]
  ds_read_b64_tr_b16 a[192:193], v32 offset:256
  v_mfma_f32_16x16x32_bf16 v[164:167], a[232:235], a[148:151], v[164:167]
  buffer_load_dwordx4 v54, s[8:11], s26 offen offset:2048 lds
  v_mfma_f32_16x16x32_bf16 v[168:171], a[232:235], a[152:155], v[168:171]
  ds_read_b64_tr_b16 a[194:195], v32 offset:2304
  v_mfma_f32_16x16x32_bf16 v[172:175], a[232:235], a[156:159], v[172:175]
  v_mfma_f32_16x16x32_bf16 v[176:179], a[236:239], a[144:147], v[176:179]
  ds_read_b64_tr_b16 a[196:197], v33 offset:256
  v_mfma_f32_16x16x32_bf16 v[180:183], a[236:239], a[148:151], v[180:183]
  ds_read_b64_tr_b16 a[198:199], v33 offset:2304
  v_mfma_f32_16x16x32_bf16 v[184:187], a[236:239], a[152:155], v[184:187]
  buffer_load_dwordx4 v55, s[8:11], s26 offen offset:3072 lds
  v_mfma_f32_16x16x32_bf16 v[188:191], a[236:239], a[156:159], v[188:191]
  ds_read_b64_tr_b16 a[200:201], v34 offset:256
  s_waitcnt lgkmcnt(9)
  v_mfma_f32_16x16x32_bf16 v[192:195], a[240:243], a[144:147], v[192:195]
  v_mfma_f32_16x16x32_bf16 v[196:199], a[240:243], a[148:151], v[196:199]
  ds_read_b64_tr_b16 a[202:203], v34 offset:2304
  v_mfma_f32_16x16x32_bf16 v[200:203], a[240:243], a[152:155], v[200:203]
  v_mfma_f32_16x16x32_bf16 v[204:207], a[240:243], a[156:159], v[204:207]
  ds_read_b64_tr_b16 a[204:205], v35 offset:256
  v_mfma_f32_16x16x32_bf16 v[208:211], a[244:247], a[144:147], v[208:211]
  ds_read_b64_tr_b16 a[206:207], v35 offset:2304
  s_add_u32 s49, s25, 256
  v_mfma_f32_16x16x32_bf16 v[212:215], a[244:247], a[148:151], v[212:215]
  v_mfma_f32_16x16x32_bf16 v[216:219], a[244:247], a[152:155], v[216:219]
  ds_read_b64_tr_b16 a[208:209], v36 offset:256
  s_min_u32 s49, s49, 1920
  v_mfma_f32_16x16x32_bf16 v[220:223], a[244:247], a[156:159], v[220:223]
  s_waitcnt lgkmcnt(9)
  v_mfma_f32_16x16x32_bf16 v[224:227], a[248:251], a[144:147], v[224:227]
  ds_read_b64_tr_b16 a[210:211], v36 offset:2304
  buffer_load_dword v59, v29, s[4:7], s49 offen
  v_mfma_f32_16x16x32_bf16 v[228:231], a[248:251], a[148:151], v[228:231]
  ds_read_b64_tr_b16 a[212:213], v37 offset:256
  v_mfma_f32_16x16x32_bf16 v[232:235], a[248:251], a[152:155], v[232:235]
  s_lshl_b32 s49, s49, 12
  v_mfma_f32_16x16x32_bf16 v[236:239], a[248:251], a[156:159], v[236:239]
  ds_read_b64_tr_b16 a[214:215], v37 offset:2304
  v_mfma_f32_16x16x32_bf16 v[240:243], a[252:255], a[144:147], v[240:243]
  buffer_load_dword v59, v30, s[8:11], s49 offen
  v_mfma_f32_16x16x32_bf16 v[244:247], a[252:255], a[148:151], v[244:247]
  ds_read_b64_tr_b16 a[216:217], v38 offset:256
  v_mfma_f32_16x16x32_bf16 v[248:251], a[252:255], a[152:155], v[248:251]
  ds_read_b64_tr_b16 a[218:219], v38 offset:2304
  v_mfma_f32_16x16x32_bf16 v[252:255], a[252:255], a[156:159], v[252:255]
  s_waitcnt lgkmcnt(10)
  v_mfma_f32_16x16x32_bf16 a[0:3], a[192:195], a[128:131], a[0:3]
  ds_read_b64_tr_b16 a[220:221], v39 offset:256
  buffer_load_dword v59, v56, s[92:95], s50 offen
  v_mfma_f32_16x16x32_bf16 a[4:7], a[192:195], a[132:135], a[4:7]
  v_mfma_f32_16x16x32_bf16 a[16:19], a[192:195], a[136:139], a[16:19]
  ds_read_b64_tr_b16 a[222:223], v39 offset:2304
  s_add_u32 s50, s50, 0x800
  v_mfma_f32_16x16x32_bf16 a[20:23], a[192:195], a[140:143], a[20:23]
  v_mfma_f32_16x16x32_bf16 a[8:11], a[196:199], a[128:131], a[8:11]
  ds_read_b64_tr_b16 a[224:225], v32 offset:16640
  v_mfma_f32_16x16x32_bf16 a[12:15], a[196:199], a[132:135], a[12:15]
  ds_read_b64_tr_b16 a[226:227], v32 offset:18688
  v_mfma_f32_16x16x32_bf16 a[24:27], a[196:199], a[136:139], a[24:27]
  buffer_load_dword v59, v64, s[12:15], s51 offen
  v_mfma_f32_16x16x32_bf16 a[28:31], a[196:199], a[140:143], a[28:31]
  ds_read_b64_tr_b16 a[228:229], v33 offset:16640
  s_waitcnt lgkmcnt(11)
  v_mfma_f32_16x16x32_bf16 a[32:35], a[200:203], a[128:131], a[32:35]
  v_mfma_f32_16x16x32_bf16 a[36:39], a[200:203], a[132:135], a[36:39]
  ds_read_b64_tr_b16 a[230:231], v33 offset:18688
  v_mfma_f32_16x16x32_bf16 a[48:51], a[200:203], a[136:139], a[48:51]
  ds_read_b64_tr_b16 a[232:233], v34 offset:16640
  v_mfma_f32_16x16x32_bf16 a[52:55], a[200:203], a[140:143], a[52:55]
  v_mfma_f32_16x16x32_bf16 a[40:43], a[204:207], a[128:131], a[40:43]
  ds_read_b64_tr_b16 a[234:235], v34 offset:18688
  v_mfma_f32_16x16x32_bf16 a[44:47], a[204:207], a[132:135], a[44:47]
  v_mfma_f32_16x16x32_bf16 a[56:59], a[204:207], a[136:139], a[56:59]
  ds_read_b64_tr_b16 a[236:237], v35 offset:16640
  v_mfma_f32_16x16x32_bf16 a[60:63], a[204:207], a[140:143], a[60:63]
  ds_read_b64_tr_b16 a[238:239], v35 offset:18688
  s_waitcnt lgkmcnt(12)
  v_mfma_f32_16x16x32_bf16 a[64:67], a[208:211], a[128:131], a[64:67]
  v_mfma_f32_16x16x32_bf16 a[68:71], a[208:211], a[132:135], a[68:71]
  ds_read_b64_tr_b16 a[240:241], v36 offset:16640
  v_mfma_f32_16x16x32_bf16 a[80:83], a[208:211], a[136:139], a[80:83]
  v_mfma_f32_16x16x32_bf16 a[84:87], a[208:211], a[140:143], a[84:87]
  ds_read_b64_tr_b16 a[242:243], v36 offset:18688
  v_mfma_f32_16x16x32_bf16 a[72:75], a[212:215], a[128:131], a[72:75]
  v_mfma_f32_16x16x32_bf16 a[76:79], a[212:215], a[132:135], a[76:79]
  ds_read_b64_tr_b16 a[244:245], v37 offset:16640
  v_mfma_f32_16x16x32_bf16 a[88:91], a[212:215], a[136:139], a[88:91]
  ds_read_b64_tr_b16 a[246:247], v37 offset:18688
  v_mfma_f32_16x16x32_bf16 a[92:95], a[212:215], a[140:143], a[92:95]
  s_waitcnt lgkmcnt(12)
  v_mfma_f32_16x16x32_bf16 a[96:99], a[216:219], a[128:131], a[96:99]
  ds_read_b64_tr_b16 a[248:249], v38 offset:16640
  v_mfma_f32_16x16x32_bf16 a[100:103], a[216:219], a[132:135], a[100:103]
  v_mfma_f32_16x16x32_bf16 a[112:115], a[216:219], a[136:139], a[112:115]
  ds_read_b64_tr_b16 a[250:251], v38 offset:18688
  v_mfma_f32_16x16x32_bf16 a[116:119], a[216:219], a[140:143], a[116:119]
  ds_read_b64_tr_b16 a[252:253], v39 offset:16640
  v_mfma_f32_16x16x32_bf16 a[104:107], a[220:223], a[128:131], a[104:107]
  v_mfma_f32_16x16x32_bf16 a[108:111], a[220:223], a[132:135], a[108:111]
  ds_read_b64_tr_b16 a[254:255], v39 offset:18688
  v_mfma_f32_16x16x32_bf16 a[120:123], a[220:223], a[136:139], a[120:123]
  v_mfma_f32_16x16x32_bf16 a[124:127], a[220:223], a[140:143], a[124:127]
  s_waitcnt lgkmcnt(12)
  v_mfma_f32_16x16x32_bf16 a[0:3], a[224:227], a[144:147], a[0:3]
  v_mfma_f32_16x16x32_bf16 a[4:7], a[224:227], a[148:151], a[4:7]
  v_mfma_f32_16x16x32_bf16 a[16:19], a[224:227], a[152:155], a[16:19]
  v_mfma_f32_16x16x32_bf16 a[20:23], a[224:227], a[156:159], a[20:23]
  v_mfma_f32_16x16x32_bf16 a[8:11], a[228:231], a[144:147], a[8:11]
  v_mfma_f32_16x16x32_bf16 a[12:15], a[228:231], a[148:151], a[12:15]
  v_mfma_f32_16x16x32_bf16 a[24:27], a[228:231], a[152:155], a[24:27]
  v_mfma_f32_16x16x32_bf16 a[28:31], a[228:231], a[156:159], a[28:31]
  s_waitcnt lgkmcnt(8)
  v_mfma_f32_16x16x32_bf16 a[32:35], a[232:235], a[144:147], a[32:35]
  s_waitcnt vmcnt(4) lgkmcnt(0)
  s_barrier
  v_mfma_f32_16x16x32_bf16 a[36:39], a[232:235], a[148:151], a[36:39]
  ds_read_b64_tr_b16 a[192:193], v32 offset:32768
  s_add_u32 s25, s25, 128
  v_mfma_f32_16x16x32_bf16 a[48:51], a[232:235], a[152:155], a[48:51]
  ds_read_b64_tr_b16 a[194:195], v32 offset:34816
  v_mfma_f32_16x16x32_bf16 a[52:55], a[232:235], a[156:159], a[52:55]
  ds_read_b128 a[160:163], v25 offset:32768
  v_mfma_f32_16x16x32_bf16 a[40:43], a[236:239], a[144:147], a[40:43]
  ds_read_b128 a[164:167], v25 offset:34816
  v_mfma_f32_16x16x32_bf16 a[44:47], a[236:239], a[148:151], a[44:47]
  ds_read_b128 a[168:171], v25 offset:36864
  v_mfma_f32_16x16x32_bf16 a[56:59], a[236:239], a[152:155], a[56:59]
  ds_read_b128 a[172:175], v25 offset:38912
  s_add_u32 m0, s28, 0x0
  v_mfma_f32_16x16x32_bf16 a[60:63], a[236:239], a[156:159], a[60:63]
  buffer_load_dwordx4 v40, s[4:7], s25 offen offset:0 lds
  s_waitcnt lgkmcnt(10)
  v_mfma_f32_16x16x32_bf16 a[64:67], a[240:243], a[144:147], a[64:67]
  ds_read_b64_tr_b16 a[196:197], v33 offset:32768
  s_add_u32 s26, s26, 0x80000
  v_mfma_f32_16x16x32_bf16 a[68:71], a[240:243], a[148:151], a[68:71]
  ds_read_b64_tr_b16 a[198:199], v33 offset:34816
  v_mfma_f32_16x16x32_bf16 a[80:83], a[240:243], a[152:155], a[80:83]
  buffer_load_dwordx4 v41, s[4:7], s25 offen offset:1024 lds
  v_mfma_f32_16x16x32_bf16 a[84:87], a[240:243], a[156:159], a[84:87]
  ds_read_b64_tr_b16 a[200:201], v34 offset:32768
  v_mfma_f32_16x16x32_bf16 a[72:75], a[244:247], a[144:147], a[72:75]
  ds_read_b64_tr_b16 a[202:203], v34 offset:34816
  v_mfma_f32_16x16x32_bf16 a[76:79], a[244:247], a[148:151], a[76:79]
  buffer_load_dwordx4 v42, s[4:7], s25 offen offset:2048 lds
  v_mfma_f32_16x16x32_bf16 a[88:91], a[244:247], a[152:155], a[88:91]
  ds_read_b64_tr_b16 a[204:205], v35 offset:32768
  v_mfma_f32_16x16x32_bf16 a[92:95], a[244:247], a[156:159], a[92:95]
  ds_read_b64_tr_b16 a[206:207], v35 offset:34816
  s_waitcnt lgkmcnt(12)
  v_mfma_f32_16x16x32_bf16 a[96:99], a[248:251], a[144:147], a[96:99]
  buffer_load_dwordx4 v43, s[4:7], s25 offen offset:3072 lds
  v_mfma_f32_16x16x32_bf16 a[100:103], a[248:251], a[148:151], a[100:103]
  ds_read_b64_tr_b16 a[208:209], v36 offset:32768
  v_mfma_f32_16x16x32_bf16 a[112:115], a[248:251], a[152:155], a[112:115]
  ds_read_b64_tr_b16 a[210:211], v36 offset:34816
  s_add_u32 m0, s28, 0x10000
  v_mfma_f32_16x16x32_bf16 a[116:119], a[248:251], a[156:159], a[116:119]
  buffer_load_dwordx4 v48, s[8:11], s26 offen offset:0 lds
  v_mfma_f32_16x16x32_bf16 a[104:107], a[252:255], a[144:147], a[104:107]
  ds_read_b64_tr_b16 a[212:213], v37 offset:32768
  v_mfma_f32_16x16x32_bf16 a[108:111], a[252:255], a[148:151], a[108:111]
  ds_read_b64_tr_b16 a[214:215], v37 offset:34816
  v_mfma_f32_16x16x32_bf16 a[120:123], a[252:255], a[152:155], a[120:123]
  v_mfma_f32_16x16x32_bf16 a[124:127], a[252:255], a[156:159], a[124:127]
  s_waitcnt lgkmcnt(8)
  v_mfma_f32_16x16x32_bf16 v[128:131], a[192:195], a[160:163], v[128:131]
  ds_read_b64_tr_b16 a[216:217], v38 offset:32768
  v_mfma_f32_16x16x32_bf16 v[132:135], a[192:195], a[164:167], v[132:135]
  ds_read_b64_tr_b16 a[218:219], v38 offset:34816
  v_mfma_f32_16x16x32_bf16 v[136:139], a[192:195], a[168:171], v[136:139]
  buffer_load_dwordx4 v49, s[8:11], s26 offen offset:1024 lds
  v_mfma_f32_16x16x32_bf16 v[140:143], a[192:195], a[172:175], v[140:143]
  ds_read_b128 a[176:179], v26 offset:32768
  v_mfma_f32_16x16x32_bf16 v[144:147], a[196:199], a[160:163], v[144:147]
  v_mfma_f32_16x16x32_bf16 v[148:151], a[196:199], a[164:167], v[148:151]
  ds_read_b128 a[180:183], v26 offset:34816
  v_mfma_f32_16x16x32_bf16 v[152:155], a[196:199], a[168:171], v[152:155]
  ds_read_b128 a[184:187], v26 offset:36864
  v_mfma_f32_16x16x32_bf16 v[156:159], a[196:199], a[172:175], v[156:159]
  buffer_load_dwordx4 v50, s[8:11], s26 offen offset:2048 lds
  s_waitcnt lgkmcnt(9)
  v_mfma_f32_16x16x32_bf16 v[160:163], a[200:203], a[160:163], v[160:163]
  ds_read_b128 a[188:191], v26 offset:38912
  v_mfma_f32_16x16x32_bf16 v[164:167], a[200:203], a[164:167], v[164:167]
  v_mfma_f32_16x16x32_bf16 v[168:171], a[200:203], a[168:171], v[168:171]
  ds_read_b64_tr_b16 a[220:221], v39 offset:32768
  v_mfma_f32_16x16x32_bf16 v[172:175], a[200:203], a[172:175], v[172:175]
  ds_read_b64_tr_b16 a[222:223], v39 offset:34816
  v_mfma_f32_16x16x32_bf16 v[176:179], a[204:207], a[160:163], v[176:179]
  buffer_load_dwordx4 v51, s[8:11], s26 offen offset:3072 lds
  v_mfma_f32_16x16x32_bf16 v[180:183], a[204:207], a[164:167], v[180:183]
  ds_read_b64_tr_b16 a[224:225], v32 offset:49152
  v_mfma_f32_16x16x32_bf16 v[184:187], a[204:207], a[168:171], v[184:187]
  v_mfma_f32_16x16x32_bf16 v[188:191], a[204:207], a[172:175], v[188:191]
  ds_read_b64_tr_b16 a[226:227], v32 offset:51200
  s_add_u32 m0, s28, 0x1000
  s_waitcnt lgkmcnt(10)
  v_mfma_f32_16x16x32_bf16 v[192:195], a[208:211], a[160:163], v[192:195]
  buffer_load_dwordx4 v44, s[4:7], s25 offen offset:0 lds
  v_mfma_f32_16x16x32_bf16 v[196:199], a[208:211], a[164:167], v[196:199]
  ds_read_b64_tr_b16 a[228:229], v33 offset:49152
  v_mfma_f32_16x16x32_bf16 v[200:203], a[208:211], a[168:171], v[200:203]
  ds_read_b64_tr_b16 a[230:231], v33 offset:51200
  v_mfma_f32_16x16x32_bf16 v[204:207], a[208:211], a[172:175], v[204:207]
  v_mfma_f32_16x16x32_bf16 v[208:211], a[212:215], a[160:163], v[208:211]
  ds_read_b64_tr_b16 a[232:233], v34 offset:49152
  v_mfma_f32_16x16x32_bf16 v[212:215], a[212:215], a[164:167], v[212:215]
  buffer_load_dwordx4 v45, s[4:7], s25 offen offset:1024 lds
  v_mfma_f32_16x16x32_bf16 v[216:219], a[212:215], a[168:171], v[216:219]
  ds_read_b64_tr_b16 a[234:235], v34 offset:51200
  v_mfma_f32_16x16x32_bf16 v[220:223], a[212:215], a[172:175], v[220:223]
  ds_read_b64_tr_b16 a[236:237], v35 offset:49152
  s_waitcnt lgkmcnt(7)
  v_mfma_f32_16x16x32_bf16 v[224:227], a[216:219], a[160:163], v[224:227]
  buffer_load_dwordx4 v46, s[4:7], s25 offen offset:2048 lds
  v_mfma_f32_16x16x32_bf16 v[228:231], a[216:219], a[164:167], v[228:231]
  ds_read_b64_tr_b16 a[238:239], v35 offset:51200
  v_mfma_f32_16x16x32_bf16 v[232:235], a[216:219], a[168:171], v[232:235]
  v_mfma_f32_16x16x32_bf16 v[236:239], a[216:219], a[172:175], v[236:239]
  ds_read_b64_tr_b16 a[240:241], v36 offset:49152
  v_mfma_f32_16x16x32_bf16 v[240:243], a[220:223], a[160:163], v[240:243]
  ds_read_b64_tr_b16 a[242:243], v36 offset:51200
  v_mfma_f32_16x16x32_bf16 v[244:247], a[220:223], a[164:167], v[244:247]
  buffer_load_dwordx4 v47, s[4:7], s25 offen offset:3072 lds
  v_mfma_f32_16x16x32_bf16 v[248:251], a[220:223], a[168:171], v[248:251]
  ds_read_b64_tr_b16 a[244:245], v37 offset:49152
  v_mfma_f32_16x16x32_bf16 v[252:255], a[220:223], a[172:175], v[252:255]
  s_waitcnt lgkmcnt(7)
  v_mfma_f32_16x16x32_bf16 v[128:131], a[224:227], a[176:179], v[128:131]
  ds_read_b64_tr_b16 a[246:247], v37 offset:51200
  s_add_u32 m0, s28, 0x11000
  v_mfma_f32_16x16x32_bf16 v[132:135], a[224:227], a[180:183], v[132:135]
  buffer_load_dwordx4 v52, s[8:11], s26 offen offset:0 lds
  v_mfma_f32_16x16x32_bf16 v[136:139], a[224:227], a[184:187], v[136:139]
  ds_read_b64_tr_b16 a[248:249], v38 offset:49152
  v_mfma_f32_16x16x32_bf16 v[140:143], a[224:227], a[188:191], v[140:143]
  ds_read_b64_tr_b16 a[250:251], v38 offset:51200
  v_mfma_f32_16x16x32_bf16 v[144:147], a[228:231], a[176:179], v[144:147]
  buffer_load_dwordx4 v53, s[8:11], s26 offen offset:1024 lds
  v_mfma_f32_16x16x32_bf16 v[148:151], a[228:231], a[180:183], v[148:151]
  ds_read_b64_tr_b16 a[252:253], v39 offset:49152
  v_mfma_f32_16x16x32_bf16 v[152:155], a[228:231], a[184:187], v[152:155]
  v_mfma_f32_16x16x32_bf16 v[156:159], a[228:231], a[188:191], v[156:159]
  ds_read_b64_tr_b16 a[254:255], v39 offset:51200
  s_waitcnt lgkmcnt(8)
  v_mfma_f32_16x16x32_bf16 v[160:163], a[232:235], a[176:179], v[160:163]
  ds_read_b64_tr_b16 a[192:193], v32 offset:33024
  v_mfma_f32_16x16x32_bf16 v[164:167], a[232:235], a[180:183], v[164:167]
  buffer_load_dwordx4 v54, s[8:11], s26 offen offset:2048 lds
  v_mfma_f32_16x16x32_bf16 v[168:171], a[232:235], a[184:187], v[168:171]
  ds_read_b64_tr_b16 a[194:195], v32 offset:35072
  v_mfma_f32_16x16x32_bf16 v[172:175], a[232:235], a[188:191], v[172:175]
  v_mfma_f32_16x16x32_bf16 v[176:179], a[236:239], a[176:179], v[176:179]
  ds_read_b64_tr_b16 a[196:197], v33 offset:33024
  v_mfma_f32_16x16x32_bf16 v[180:183], a[236:239], a[180:183], v[180:183]
  ds_read_b64_tr_b16 a[198:199], v33 offset:35072
  v_mfma_f32_16x16x32_bf16 v[184:187], a[236:239], a[184:187], v[184:187]
  buffer_load_dwordx4 v55, s[8:11], s26 offen offset:3072 lds
  v_mfma_f32_16x16x32_bf16 v[188:191], a[236:239], a[188:191], v[188:191]
  ds_read_b64_tr_b16 a[200:201], v34 offset:33024
  s_waitcnt lgkmcnt(9)
  v_mfma_f32_16x16x32_bf16 v[192:195], a[240:243], a[176:179], v[192:195]
  v_mfma_f32_16x16x32_bf16 v[196:199], a[240:243], a[180:183], v[196:199]
  ds_read_b64_tr_b16 a[202:203], v34 offset:35072
  v_mfma_f32_16x16x32_bf16 v[200:203], a[240:243], a[184:187], v[200:203]
  v_mfma_f32_16x16x32_bf16 v[204:207], a[240:243], a[188:191], v[204:207]
  ds_read_b64_tr_b16 a[204:205], v35 offset:33024
  v_mfma_f32_16x16x32_bf16 v[208:211], a[244:247], a[176:179], v[208:211]
  ds_read_b64_tr_b16 a[206:207], v35 offset:35072
  s_add_u32 s49, s25, 256
  v_mfma_f32_16x16x32_bf16 v[212:215], a[244:247], a[180:183], v[212:215]
  v_mfma_f32_16x16x32_bf16 v[216:219], a[244:247], a[184:187], v[216:219]
  ds_read_b64_tr_b16 a[208:209], v36 offset:33024
  s_min_u32 s49, s49, 1920
  v_mfma_f32_16x16x32_bf16 v[220:223], a[244:247], a[188:191], v[220:223]
  s_waitcnt lgkmcnt(9)
  v_mfma_f32_16x16x32_bf16 v[224:227], a[248:251], a[176:179], v[224:227]
  ds_read_b64_tr_b16 a[210:211], v36 offset:35072
  buffer_load_dword v59, v29, s[4:7], s49 offen
  v_mfma_f32_16x16x32_bf16 v[228:231], a[248:251], a[180:183], v[228:231]
  ds_read_b64_tr_b16 a[212:213], v37 offset:33024
  v_mfma_f32_16x16x32_bf16 v[232:235], a[248:251], a[184:187], v[232:235]
  s_lshl_b32 s49, s49, 12
  v_mfma_f32_16x16x32_bf16 v[236:239], a[248:251], a[188:191], v[236:239]
  ds_read_b64_tr_b16 a[214:215], v37 offset:35072
  v_mfma_f32_16x16x32_bf16 v[240:243], a[252:255], a[176:179], v[240:243]
  buffer_load_dword v59, v30, s[8:11], s49 offen
  v_mfma_f32_16x16x32_bf16 v[244:247], a[252:255], a[180:183], v[244:247]
  ds_read_b64_tr_b16 a[216:217], v38 offset:33024
  v_mfma_f32_16x16x32_bf16 v[248:251], a[252:255], a[184:187], v[248:251]
  ds_read_b64_tr_b16 a[218:219], v38 offset:35072
  v_mfma_f32_16x16x32_bf16 v[252:255], a[252:255], a[188:191], v[252:255]
  s_waitcnt lgkmcnt(10)
  v_mfma_f32_16x16x32_bf16 a[0:3], a[192:195], a[160:163], a[0:3]
  ds_read_b64_tr_b16 a[220:221], v39 offset:33024
  buffer_load_dword v59, v3, s[64:67], 0 offen
  v_mfma_f32_16x16x32_bf16 a[4:7], a[192:195], a[164:167], a[4:7]
  v_mfma_f32_16x16x32_bf16 a[16:19], a[192:195], a[168:171], a[16:19]
  ds_read_b64_tr_b16 a[222:223], v39 offset:35072
  v_mfma_f32_16x16x32_bf16 a[20:23], a[192:195], a[172:175], a[20:23]
  v_mfma_f32_16x16x32_bf16 a[8:11], a[196:199], a[160:163], a[8:11]
  ds_read_b64_tr_b16 a[224:225], v32 offset:49408
  v_mfma_f32_16x16x32_bf16 a[12:15], a[196:199], a[164:167], a[12:15]
  ds_read_b64_tr_b16 a[226:227], v32 offset:51456
  v_mfma_f32_16x16x32_bf16 a[24:27], a[196:199], a[168:171], a[24:27]
  buffer_load_dword v59, v64, s[16:19], s51 offen
  v_mfma_f32_16x16x32_bf16 a[28:31], a[196:199], a[172:175], a[28:31]
  ds_read_b64_tr_b16 a[228:229], v33 offset:49408
  s_waitcnt lgkmcnt(11)
  v_mfma_f32_16x16x32_bf16 a[32:35], a[200:203], a[160:163], a[32:35]
  s_add_u32 s51, s51, 0x1000
  v_mfma_f32_16x16x32_bf16 a[36:39], a[200:203], a[164:167], a[36:39]
  ds_read_b64_tr_b16 a[230:231], v33 offset:51456
  v_mfma_f32_16x16x32_bf16 a[48:51], a[200:203], a[168:171], a[48:51]
  ds_read_b64_tr_b16 a[232:233], v34 offset:49408
  v_mfma_f32_16x16x32_bf16 a[52:55], a[200:203], a[172:175], a[52:55]
  v_mfma_f32_16x16x32_bf16 a[40:43], a[204:207], a[160:163], a[40:43]
  ds_read_b64_tr_b16 a[234:235], v34 offset:51456
  v_mfma_f32_16x16x32_bf16 a[44:47], a[204:207], a[164:167], a[44:47]
  v_mfma_f32_16x16x32_bf16 a[56:59], a[204:207], a[168:171], a[56:59]
  ds_read_b64_tr_b16 a[236:237], v35 offset:49408
  v_mfma_f32_16x16x32_bf16 a[60:63], a[204:207], a[172:175], a[60:63]
  ds_read_b64_tr_b16 a[238:239], v35 offset:51456
  s_waitcnt lgkmcnt(12)
  v_mfma_f32_16x16x32_bf16 a[64:67], a[208:211], a[160:163], a[64:67]
  v_mfma_f32_16x16x32_bf16 a[68:71], a[208:211], a[164:167], a[68:71]
  ds_read_b64_tr_b16 a[240:241], v36 offset:49408
  v_mfma_f32_16x16x32_bf16 a[80:83], a[208:211], a[168:171], a[80:83]
  v_mfma_f32_16x16x32_bf16 a[84:87], a[208:211], a[172:175], a[84:87]
  ds_read_b64_tr_b16 a[242:243], v36 offset:51456
  v_mfma_f32_16x16x32_bf16 a[72:75], a[212:215], a[160:163], a[72:75]
  v_mfma_f32_16x16x32_bf16 a[76:79], a[212:215], a[164:167], a[76:79]
  ds_read_b64_tr_b16 a[244:245], v37 offset:49408
  v_mfma_f32_16x16x32_bf16 a[88:91], a[212:215], a[168:171], a[88:91]
  ds_read_b64_tr_b16 a[246:247], v37 offset:51456
  v_mfma_f32_16x16x32_bf16 a[92:95], a[212:215], a[172:175], a[92:95]
  s_waitcnt lgkmcnt(12)
  v_mfma_f32_16x16x32_bf16 a[96:99], a[216:219], a[160:163], a[96:99]
  ds_read_b64_tr_b16 a[248:249], v38 offset:49408
  v_mfma_f32_16x16x32_bf16 a[100:103], a[216:219], a[164:167], a[100:103]
  v_mfma_f32_16x16x32_bf16 a[112:115], a[216:219], a[168:171], a[112:115]
  ds_read_b64_tr_b16 a[250:251], v38 offset:51456
  v_mfma_f32_16x16x32_bf16 a[116:119], a[216:219], a[172:175], a[116:119]
  ds_read_b64_tr_b16 a[252:253], v39 offset:49408
  v_mfma_f32_16x16x32_bf16 a[104:107], a[220:223], a[160:163], a[104:107]
  v_mfma_f32_16x16x32_bf16 a[108:111], a[220:223], a[164:167], a[108:111]
  ds_read_b64_tr_b16 a[254:255], v39 offset:51456
  v_mfma_f32_16x16x32_bf16 a[120:123], a[220:223], a[168:171], a[120:123]
  v_mfma_f32_16x16x32_bf16 a[124:127], a[220:223], a[172:175], a[124:127]
  s_waitcnt lgkmcnt(12)
  v_mfma_f32_16x16x32_bf16 a[0:3], a[224:227], a[176:179], a[0:3]
  v_mfma_f32_16x16x32_bf16 a[4:7], a[224:227], a[180:183], a[4:7]
  v_mfma_f32_16x16x32_bf16 a[16:19], a[224:227], a[184:187], a[16:19]
  v_mfma_f32_16x16x32_bf16 a[20:23], a[224:227], a[188:191], a[20:23]
  v_mfma_f32_16x16x32_bf16 a[8:11], a[228:231], a[176:179], a[8:11]
  v_mfma_f32_16x16x32_bf16 a[12:15], a[228:231], a[180:183], a[12:15]
  v_mfma_f32_16x16x32_bf16 a[24:27], a[228:231], a[184:187], a[24:27]
  v_mfma_f32_16x16x32_bf16 a[28:31], a[228:231], a[188:191], a[28:31]
  s_waitcnt lgkmcnt(8)
  v_mfma_f32_16x16x32_bf16 a[32:35], a[232:235], a[176:179], a[32:35]
  s_waitcnt vmcnt(4) lgkmcnt(0)
  s_barrier
  v_mfma_f32_16x16x32_bf16 a[36:39], a[232:235], a[180:183], a[36:39]
  ds_read_b64_tr_b16 a[192:193], v32 offset:0
  s_add_u32 s25, s25, 128
  v_mfma_f32_16x16x32_bf16 a[48:51], a[232:235], a[184:187], a[48:51]
  ds_read_b64_tr_b16 a[194:195], v32 offset:2048
  v_mfma_f32_16x16x32_bf16 a[52:55], a[232:235], a[188:191], a[52:55]
  ds_read_b128 a[128:131], v25 offset:0
  v_mfma_f32_16x16x32_bf16 a[40:43], a[236:239], a[176:179], a[40:43]
  ds_read_b128 a[132:135], v25 offset:2048
  v_mfma_f32_16x16x32_bf16 a[44:47], a[236:239], a[180:183], a[44:47]
  ds_read_b128 a[136:139], v25 offset:4096
  v_mfma_f32_16x16x32_bf16 a[56:59], a[236:239], a[184:187], a[56:59]
  ds_read_b128 a[140:143], v25 offset:6144
  s_add_u32 m0, s28, 0x8000
  v_mfma_f32_16x16x32_bf16 a[60:63], a[236:239], a[188:191], a[60:63]
  buffer_load_dwordx4 v40, s[4:7], s25 offen offset:0 lds
  s_waitcnt lgkmcnt(10)
  v_mfma_f32_16x16x32_bf16 a[64:67], a[240:243], a[176:179], a[64:67]
  ds_read_b64_tr_b16 a[196:197], v33 offset:0
  s_add_u32 s26, s26, 0x80000
  v_mfma_f32_16x16x32_bf16 a[68:71], a[240:243], a[180:183], a[68:71]
  ds_read_b64_tr_b16 a[198:199], v33 offset:2048
  v_mfma_f32_16x16x32_bf16 a[80:83], a[240:243], a[184:187], a[80:83]
  buffer_load_dwordx4 v41, s[4:7], s25 offen offset:1024 lds
  v_mfma_f32_16x16x32_bf16 a[84:87], a[240:243], a[188:191], a[84:87]
  ds_read_b64_tr_b16 a[200:201], v34 offset:0
  v_mfma_f32_16x16x32_bf16 a[72:75], a[244:247], a[176:179], a[72:75]
  ds_read_b64_tr_b16 a[202:203], v34 offset:2048
  v_mfma_f32_16x16x32_bf16 a[76:79], a[244:247], a[180:183], a[76:79]
  buffer_load_dwordx4 v42, s[4:7], s25 offen offset:2048 lds
  v_mfma_f32_16x16x32_bf16 a[88:91], a[244:247], a[184:187], a[88:91]
  ds_read_b64_tr_b16 a[204:205], v35 offset:0
  v_mfma_f32_16x16x32_bf16 a[92:95], a[244:247], a[188:191], a[92:95]
  ds_read_b64_tr_b16 a[206:207], v35 offset:2048
  s_waitcnt lgkmcnt(12)
  v_mfma_f32_16x16x32_bf16 a[96:99], a[248:251], a[176:179], a[96:99]
  buffer_load_dwordx4 v43, s[4:7], s25 offen offset:3072 lds
  v_mfma_f32_16x16x32_bf16 a[100:103], a[248:251], a[180:183], a[100:103]
  ds_read_b64_tr_b16 a[208:209], v36 offset:0
  v_mfma_f32_16x16x32_bf16 a[112:115], a[248:251], a[184:187], a[112:115]
  ds_read_b64_tr_b16 a[210:211], v36 offset:2048
  s_add_u32 m0, s28, 0x18000
  v_mfma_f32_16x16x32_bf16 a[116:119], a[248:251], a[188:191], a[116:119]
  buffer_load_dwordx4 v48, s[8:11], s26 offen offset:0 lds
  v_mfma_f32_16x16x32_bf16 a[104:107], a[252:255], a[176:179], a[104:107]
  ds_read_b64_tr_b16 a[212:213], v37 offset:0
  v_mfma_f32_16x16x32_bf16 a[108:111], a[252:255], a[180:183], a[108:111]
  ds_read_b64_tr_b16 a[214:215], v37 offset:2048
  s_add_u32 s30, s30, 1
  v_mfma_f32_16x16x32_bf16 a[120:123], a[252:255], a[184:187], a[120:123]
  v_mfma_f32_16x16x32_bf16 a[124:127], a[252:255], a[188:191], a[124:127]
  s_cmp_lt_u32 s30, 7
  s_cbranch_scc1 L1_q
CP_q14:
  s_waitcnt lgkmcnt(8)
  v_mfma_f32_16x16x32_bf16 v[128:131], a[192:195], a[128:131], v[128:131]
  ds_read_b64_tr_b16 a[216:217], v38 offset:0
  v_mfma_f32_16x16x32_bf16 v[132:135], a[192:195], a[132:135], v[132:135]
  ds_read_b64_tr_b16 a[218:219], v38 offset:2048
  v_mfma_f32_16x16x32_bf16 v[136:139], a[192:195], a[136:139], v[136:139]
  buffer_load_dwordx4 v49, s[8:11], s26 offen offset:1024 lds
  v_mfma_f32_16x16x32_bf16 v[140:143], a[192:195], a[140:143], v[140:143]
  ds_read_b128 a[144:147], v26 offset:0
  v_mfma_f32_16x16x32_bf16 v[144:147], a[196:199], a[128:131], v[144:147]
  v_mfma_f32_16x16x32_bf16 v[148:151], a[196:199], a[132:135], v[148:151]
  ds_read_b128 a[148:151], v26 offset:2048
  v_mfma_f32_16x16x32_bf16 v[152:155], a[196:199], a[136:139], v[152:155]
  ds_read_b128 a[152:155], v26 offset:4096
  v_mfma_f32_16x16x32_bf16 v[156:159], a[196:199], a[140:143], v[156:159]
  buffer_load_dwordx4 v50, s[8:11], s26 offen offset:2048 lds
  s_waitcnt lgkmcnt(9)
  v_mfma_f32_16x16x32_bf16 v[160:163], a[200:203], a[128:131], v[160:163]
  ds_read_b128 a[156:159], v26 offset:6144
  v_mfma_f32_16x16x32_bf16 v[164:167], a[200:203], a[132:135], v[164:167]
  v_mfma_f32_16x16x32_bf16 v[168:171], a[200:203], a[136:139], v[168:171]
  ds_read_b64_tr_b16 a[220:221], v39 offset:0
  v_mfma_f32_16x16x32_bf16 v[172:175], a[200:203], a[140:143], v[172:175]
  ds_read_b64_tr_b16 a[222:223], v39 offset:2048
  v_mfma_f32_16x16x32_bf16 v[176:179], a[204:207], a[128:131], v[176:179]
  buffer_load_dwordx4 v51, s[8:11], s26 offen offset:3072 lds
  v_mfma_f32_16x16x32_bf16 v[180:183], a[204:207], a[132:135], v[180:183]
  ds_read_b64_tr_b16 a[224:225], v32 offset:16384
  v_mfma_f32_16x16x32_bf16 v[184:187], a[204:207], a[136:139], v[184:187]
  v_mfma_f32_16x16x32_bf16 v[188:191], a[204:207], a[140:143], v[188:191]
  ds_read_b64_tr_b16 a[226:227], v32 offset:18432
  s_add_u32 m0, s28, 0x9000
  s_waitcnt lgkmcnt(10)
  v_mfma_f32_16x16x32_bf16 v[192:195], a[208:211], a[128:131], v[192:195]
  buffer_load_dwordx4 v44, s[4:7], s25 offen offset:0 lds
  v_mfma_f32_16x16x32_bf16 v[196:199], a[208:211], a[132:135], v[196:199]
  ds_read_b64_tr_b16 a[228:229], v33 offset:16384
  v_mfma_f32_16x16x32_bf16 v[200:203], a[208:211], a[136:139], v[200:203]
  ds_read_b64_tr_b16 a[230:231], v33 offset:18432
  v_mfma_f32_16x16x32_bf16 v[204:207], a[208:211], a[140:143], v[204:207]
  v_mfma_f32_16x16x32_bf16 v[208:211], a[212:215], a[128:131], v[208:211]
  ds_read_b64_tr_b16 a[232:233], v34 offset:16384
  v_mfma_f32_16x16x32_bf16 v[212:215], a[212:215], a[132:135], v[212:215]
  buffer_load_dwordx4 v45, s[4:7], s25 offen offset:1024 lds
  v_mfma_f32_16x16x32_bf16 v[216:219], a[212:215], a[136:139], v[216:219]
  ds_read_b64_tr_b16 a[234:235], v34 offset:18432
  v_mfma_f32_16x16x32_bf16 v[220:223], a[212:215], a[140:143], v[220:223]
  ds_read_b64_tr_b16 a[236:237], v35 offset:16384
  s_waitcnt lgkmcnt(7)
  v_mfma_f32_16x16x32_bf16 v[224:227], a[216:219], a[128:131], v[224:227]
  buffer_load_dwordx4 v46, s[4:7], s25 offen offset:2048 lds
  v_mfma_f32_16x16x32_bf16 v[228:231], a[216:219], a[132:135], v[228:231]
  ds_read_b64_tr_b16 a[238:239], v35 offset:18432
  v_mfma_f32_16x16x32_bf16 v[232:235], a[216:219], a[136:139], v[232:235]
  v_mfma_f32_16x16x32_bf16 v[236:239], a[216:219], a[140:143], v[236:239]
  ds_read_b64_tr_b16 a[240:241], v36 offset:16384
  v_mfma_f32_16x16x32_bf16 v[240:243], a[220:223], a[128:131], v[240:243]
  ds_read_b64_tr_b16 a[242:243], v36 offset:18432
  v_mfma_f32_16x16x32_bf16 v[244:247], a[220:223], a[132:135], v[244:247]
  buffer_load_dwordx4 v47, s[4:7], s25 offen offset:3072 lds
  v_mfma_f32_16x16x32_bf16 v[248:251], a[220:223], a[136:139], v[248:251]
  ds_read_b64_tr_b16 a[244:245], v37 offset:16384
  v_mfma_f32_16x16x32_bf16 v[252:255], a[220:223], a[140:143], v[252:255]
  s_waitcnt lgkmcnt(7)
  v_mfma_f32_16x16x32_bf16 v[128:131], a[224:227], a[144:147], v[128:131]
  ds_read_b64_tr_b16 a[246:247], v37 offset:18432
  s_add_u32 m0, s28, 0x19000
  v_mfma_f32_16x16x32_bf16 v[132:135], a[224:227], a[148:151], v[132:135]
  buffer_load_dwordx4 v52, s[8:11], s26 offen offset:0 lds
  v_mfma_f32_16x16x32_bf16 v[136:139], a[224:227], a[152:155], v[136:139]
  ds_read_b64_tr_b16 a[248:249], v38 offset:16384
  v_mfma_f32_16x16x32_bf16 v[140:143], a[224:227], a[156:159], v[140:143]
  ds_read_b64_tr_b16 a[250:251], v38 offset:18432
  v_mfma_f32_16x16x32_bf16 v[144:147], a[228:231], a[144:147], v[144:147]
  buffer_load_dwordx4 v53, s[8:11], s26 offen offset:1024 lds
  v_mfma_f32_16x16x32_bf16 v[148:151], a[228:231], a[148:151], v[148:151]
  ds_read_b64_tr_b16 a[252:253], v39 offset:16384
  v_mfma_f32_16x16x32_bf16 v[152:155], a[228:231], a[152:155], v[152:155]
  v_mfma_f32_16x16x32_bf16 v[156:159], a[228:231], a[156:159], v[156:159]
  ds_read_b64_tr_b16 a[254:255], v39 offset:18432
  s_waitcnt lgkmcnt(8)
  v_mfma_f32_16x16x32_bf16 v[160:163], a[232:235], a[144:147], v[160:163]
  ds_read_b64_tr_b16 a[192:193], v32 offset:256
  v_mfma_f32_16x16x32_bf16 v[164:167], a[232:235], a[148:151], v[164:167]
  buffer_load_dwordx4 v54, s[8:11], s26 offen offset:2048 lds
  v_mfma_f32_16x16x32_bf16 v[168:171], a[232:235], a[152:155], v[168:171]
  ds_read_b64_tr_b16 a[194:195], v32 offset:2304
  v_mfma_f32_16x16x32_bf16 v[172:175], a[232:235], a[156:159], v[172:175]
  v_mfma_f32_16x16x32_bf16 v[176:179], a[236:239], a[144:147], v[176:179]
  ds_read_b64_tr_b16 a[196:197], v33 offset:256
  v_mfma_f32_16x16x32_bf16 v[180:183], a[236:239], a[148:151], v[180:183]
  ds_read_b64_tr_b16 a[198:199], v33 offset:2304
  v_mfma_f32_16x16x32_bf16 v[184:187], a[236:239], a[152:155], v[184:187]
  buffer_load_dwordx4 v55, s[8:11], s26 offen offset:3072 lds
  v_mfma_f32_16x16x32_bf16 v[188:191], a[236:239], a[156:159], v[188:191]
  ds_read_b64_tr_b16 a[200:201], v34 offset:256
  s_waitcnt lgkmcnt(9)
  v_mfma_f32_16x16x32_bf16 v[192:195], a[240:243], a[144:147], v[192:195]
  v_mfma_f32_16x16x32_bf16 v[196:199], a[240:243], a[148:151], v[196:199]
  ds_read_b64_tr_b16 a[202:203], v34 offset:2304
  v_mfma_f32_16x16x32_bf16 v[200:203], a[240:243], a[152:155], v[200:203]
  v_mfma_f32_16x16x32_bf16 v[204:207], a[240:243], a[156:159], v[204:207]
  ds_read_b64_tr_b16 a[204:205], v35 offset:256
  v_mfma_f32_16x16x32_bf16 v[208:211], a[244:247], a[144:147], v[208:211]
  ds_read_b64_tr_b16 a[206:207], v35 offset:2304
  v_mfma_f32_16x16x32_bf16 v[212:215], a[244:247], a[148:151], v[212:215]
  v_mfma_f32_16x16x32_bf16 v[216:219], a[244:247], a[152:155], v[216:219]
  ds_read_b64_tr_b16 a[208:209], v36 offset:256
  v_mfma_f32_16x16x32_bf16 v[220:223], a[244:247], a[156:159], v[220:223]
  s_waitcnt lgkmcnt(9)
  v_mfma_f32_16x16x32_bf16 v[224:227], a[248:251], a[144:147], v[224:227]
  ds_read_b64_tr_b16 a[210:211], v36 offset:2304
  v_mfma_f32_16x16x32_bf16 v[228:231], a[248:251], a[148:151], v[228:231]
  ds_read_b64_tr_b16 a[212:213], v37 offset:256
  v_mfma_f32_16x16x32_bf16 v[232:235], a[248:251], a[152:155], v[232:235]
  v_mfma_f32_16x16x32_bf16 v[236:239], a[248:251], a[156:159], v[236:239]
  ds_read_b64_tr_b16 a[214:215], v37 offset:2304
  v_mfma_f32_16x16x32_bf16 v[240:243], a[252:255], a[144:147], v[240:243]
  v_mfma_f32_16x16x32_bf16 v[244:247], a[252:255], a[148:151], v[244:247]
  ds_read_b64_tr_b16 a[216:217], v38 offset:256
  v_mfma_f32_16x16x32_bf16 v[248:251], a[252:255], a[152:155], v[248:251]
  ds_read_b64_tr_b16 a[218:219], v38 offset:2304
  v_mfma_f32_16x16x32_bf16 v[252:255], a[252:255], a[156:159], v[252:255]
  s_waitcnt lgkmcnt(10)
  v_mfma_f32_16x16x32_bf16 a[0:3], a[192:195], a[128:131], a[0:3]
  ds_read_b64_tr_b16 a[220:221], v39 offset:256
  buffer_load_dword v59, v56, s[92:95], s50 offen
  v_mfma_f32_16x16x32_bf16 a[4:7], a[192:195], a[132:135], a[4:7]
  v_mfma_f32_16x16x32_bf16 a[16:19], a[192:195], a[136:139], a[16:19]
  ds_read_b64_tr_b16 a[222:223], v39 offset:2304
  s_add_u32 s50, s50, 0x800
  v_mfma_f32_16x16x32_bf16 a[20:23], a[192:195], a[140:143], a[20:23]
  v_mfma_f32_16x16x32_bf16 a[8:11], a[196:199], a[128:131], a[8:11]
  ds_read_b64_tr_b16 a[224:225], v32 offset:16640
  v_mfma_f32_16x16x32_bf16 a[12:15], a[196:199], a[132:135], a[12:15]
  ds_read_b64_tr_b16 a[226:227], v32 offset:18688
  v_mfma_f32_16x16x32_bf16 a[24:27], a[196:199], a[136:139], a[24:27]
  v_mfma_f32_16x16x32_bf16 a[28:31], a[196:199], a[140:143], a[28:31]
  ds_read_b64_tr_b16 a[228:229], v33 offset:16640
  s_waitcnt lgkmcnt(11)
  v_mfma_f32_16x16x32_bf16 a[32:35], a[200:203], a[128:131], a[32:35]
  v_mfma_f32_16x16x32_bf16 a[36:39], a[200:203], a[132:135], a[36:39]
  ds_read_b64_tr_b16 a[230:231], v33 offset:18688
  v_mfma_f32_16x16x32_bf16 a[48:51], a[200:203], a[136:139], a[48:51]
  ds_read_b64_tr_b16 a[232:233], v34 offset:16640
  v_mfma_f32_16x16x32_bf16 a[52:55], a[200:203], a[140:143], a[52:55]
  v_mfma_f32_16x16x32_bf16 a[40:43], a[204:207], a[128:131], a[40:43]
  ds_read_b64_tr_b16 a[234:235], v34 offset:18688
  v_mfma_f32_16x16x32_bf16 a[44:47], a[204:207], a[132:135], a[44:47]
  v_mfma_f32_16x16x32_bf16 a[56:59], a[204:207], a[136:139], a[56:59]
  ds_read_b64_tr_b16 a[236:237], v35 offset:16640
  v_mfma_f32_16x16x32_bf16 a[60:63], a[204:207], a[140:143], a[60:63]
  ds_read_b64_tr_b16 a[238:239], v35 offset:18688
  s_waitcnt lgkmcnt(12)
  v_mfma_f32_16x16x32_bf16 a[64:67], a[208:211], a[128:131], a[64:67]
  v_mfma_f32_16x16x32_bf16 a[68:71], a[208:211], a[132:135], a[68:71]
  ds_read_b64_tr_b16 a[240:241], v36 offset:16640
  v_mfma_f32_16x16x32_bf16 a[80:83], a[208:211], a[136:139], a[80:83]
  v_mfma_f32_16x16x32_bf16 a[84:87], a[208:211], a[140:143], a[84:87]
  ds_read_b64_tr_b16 a[242:243], v36 offset:18688
  v_mfma_f32_16x16x32_bf16 a[72:75], a[212:215], a[128:131], a[72:75]
  v_mfma_f32_16x16x32_bf16 a[76:79], a[212:215], a[132:135], a[76:79]
  ds_read_b64_tr_b16 a[244:245], v37 offset:16640
  v_mfma_f32_16x16x32_bf16 a[88:91], a[212:215], a[136:139], a[88:91]
  ds_read_b64_tr_b16 a[246:247], v37 offset:18688
  v_mfma_f32_16x16x32_bf16 a[92:95], a[212:215], a[140:143], a[92:95]
  s_waitcnt lgkmcnt(12)
  v_mfma_f32_16x16x32_bf16 a[96:99], a[216:219], a[128:131], a[96:99]
  ds_read_b64_tr_b16 a[248:249], v38 offset:16640
  v_mfma_f32_16x16x32_bf16 a[100:103], a[216:219], a[132:135], a[100:103]
  v_mfma_f32_16x16x32_bf16 a[112:115], a[216:219], a[136:139], a[112:115]
  ds_read_b64_tr_b16 a[250:251], v38 offset:18688
  v_mfma_f32_16x16x32_bf16 a[116:119], a[216:219], a[140:143], a[116:119]
  ds_read_b64_tr_b16 a[252:253], v39 offset:16640
  v_mfma_f32_16x16x32_bf16 a[104:107], a[220:223], a[128:131], a[104:107]
  v_mfma_f32_16x16x32_bf16 a[108:111], a[220:223], a[132:135], a[108:111]
  ds_read_b64_tr_b16 a[254:255], v39 offset:18688
  v_mfma_f32_16x16x32_bf16 a[120:123], a[220:223], a[136:139], a[120:123]
  v_mfma_f32_16x16x32_bf16 a[124:127], a[220:223], a[140:143], a[124:127]
  s_waitcnt lgkmcnt(12)
  v_mfma_f32_16x16x32_bf16 a[0:3], a[224:227], a[144:147], a[0:3]
  v_mfma_f32_16x16x32_bf16 a[4:7], a[224:227], a[148:151], a[4:7]
  v_mfma_f32_16x16x32_bf16 a[16:19], a[224:227], a[152:155], a[16:19]
  v_mfma_f32_16x16x32_bf16 a[20:23], a[224:227], a[156:159], a[20:23]
  v_mfma_f32_16x16x32_bf16 a[8:11], a[228:231], a[144:147], a[8:11]
  v_mfma_f32_16x16x32_bf16 a[12:15], a[228:231], a[148:151], a[12:15]
  v_mfma_f32_16x16x32_bf16 a[24:27], a[228:231], a[152:155], a[24:27]
  v_mfma_f32_16x16x32_bf16 a[28:31], a[228:231], a[156:159], a[28:31]
  s_waitcnt lgkmcnt(8)
  v_mfma_f32_16x16x32_bf16 a[32:35], a[232:235], a[144:147], a[32:35]
  s_waitcnt vmcnt(1) lgkmcnt(0)
  s_barrier
  v_mfma_f32_16x16x32_bf16 a[36:39], a[232:235], a[148:151], a[36:39]
  ds_read_b64_tr_b16 a[192:193], v32 offset:32768
  s_add_u32 s25, s25, 128
  v_mfma_f32_16x16x32_bf16 a[48:51], a[232:235], a[152:155], a[48:51]
  ds_read_b64_tr_b16 a[194:195], v32 offset:34816
  v_mfma_f32_16x16x32_bf16 a[52:55], a[232:235], a[156:159], a[52:55]
  ds_read_b128 a[160:163], v25 offset:32768
  v_mfma_f32_16x16x32_bf16 a[40:43], a[236:239], a[144:147], a[40:43]
  ds_read_b128 a[164:167], v25 offset:34816
  v_mfma_f32_16x16x32_bf16 a[44:47], a[236:239], a[148:151], a[44:47]
  ds_read_b128 a[168:171], v25 offset:36864
  v_mfma_f32_16x16x32_bf16 a[56:59], a[236:239], a[152:155], a[56:59]
  ds_read_b128 a[172:175], v25 offset:38912
  s_mov_b32 s34, 0x0
  s_add_u32 m0, s29, 0x0
  v_mfma_f32_16x16x32_bf16 a[60:63], a[236:239], a[156:159], a[60:63]
  buffer_load_dwordx4 v20, s[12:15], s34 offen offset:0 nt lds
  s_waitcnt lgkmcnt(10)
  v_mfma_f32_16x16x32_bf16 a[64:67], a[240:243], a[144:147], a[64:67]
  ds_read_b64_tr_b16 a[196:197], v33 offset:32768
  s_add_u32 s26, s26, 0x80000
  v_mfma_f32_16x16x32_bf16 a[68:71], a[240:243], a[148:151], a[68:71]
  ds_read_b64_tr_b16 a[198:199], v33 offset:34816
  v_mfma_f32_16x16x32_bf16 a[80:83], a[240:243], a[152:155], a[80:83]
  buffer_load_dwordx4 v21, s[12:15], s34 offen offset:1024 nt lds
  v_mfma_f32_16x16x32_bf16 a[84:87], a[240:243], a[156:159], a[84:87]
  ds_read_b64_tr_b16 a[200:201], v34 offset:32768
  v_mfma_f32_16x16x32_bf16 a[72:75], a[244:247], a[144:147], a[72:75]
  ds_read_b64_tr_b16 a[202:203], v34 offset:34816
  s_mov_b32 s34, 0x2000
  s_add_u32 m0, s29, 0x2000
  v_mfma_f32_16x16x32_bf16 a[76:79], a[244:247], a[148:151], a[76:79]
  buffer_load_dwordx4 v20, s[12:15], s34 offen offset:0 nt lds
  v_mfma_f32_16x16x32_bf16 a[88:91], a[244:247], a[152:155], a[88:91]
  ds_read_b64_tr_b16 a[204:205], v35 offset:32768
  v_mfma_f32_16x16x32_bf16 a[92:95], a[244:247], a[156:159], a[92:95]
  ds_read_b64_tr_b16 a[206:207], v35 offset:34816
  s_waitcnt lgkmcnt(12)
  v_mfma_f32_16x16x32_bf16 a[96:99], a[248:251], a[144:147], a[96:99]
  buffer_load_dwordx4 v21, s[12:15], s34 offen offset:1024 nt lds
  v_mfma_f32_16x16x32_bf16 a[100:103], a[248:251], a[148:151], a[100:103]
  ds_read_b64_tr_b16 a[208:209], v36 offset:32768
  v_mfma_f32_16x16x32_bf16 a[112:115], a[248:251], a[152:155], a[112:115]
  ds_read_b64_tr_b16 a[210:211], v36 offset:34816
  s_mov_b32 s34, 0x0
  s_add_u32 m0, s29, 0x10000
  v_mfma_f32_16x16x32_bf16 a[116:119], a[248:251], a[156:159], a[116:119]
  buffer_load_dwordx4 v22, s[16:19], s34 offen offset:0 nt lds
  v_mfma_f32_16x16x32_bf16 a[104:107], a[252:255], a[144:147], a[104:107]
  ds_read_b64_tr_b16 a[212:213], v37 offset:32768
  v_mfma_f32_16x16x32_bf16 a[108:111], a[252:255], a[148:151], a[108:111]
  ds_read_b64_tr_b16 a[214:215], v37 offset:34816
  v_mfma_f32_16x16x32_bf16 a[120:123], a[252:255], a[152:155], a[120:123]
  v_mfma_f32_16x16x32_bf16 a[124:127], a[252:255], a[156:159], a[124:127]
  s_waitcnt lgkmcnt(8)
  v_mfma_f32_16x16x32_bf16 v[128:131], a[192:195], a[160:163], v[128:131]
  ds_read_b64_tr_b16 a[216:217], v38 offset:32768
  v_mfma_f32_16x16x32_bf16 v[132:135], a[192:195], a[164:167], v[132:135]
  ds_read_b64_tr_b16 a[218:219], v38 offset:34816
  v_mfma_f32_16x16x32_bf16 v[136:139], a[192:195], a[168:171], v[136:139]
  buffer_load_dwordx4 v22, s[16:19], s34 offen offset:1024 nt lds
  v_mfma_f32_16x16x32_bf16 v[140:143], a[192:195], a[172:175], v[140:143]
  ds_read_b128 a[176:179], v26 offset:32768
  v_mfma_f32_16x16x32_bf16 v[144:147], a[196:199], a[160:163], v[144:147]
  v_mfma_f32_16x16x32_bf16 v[148:151], a[196:199], a[164:167], v[148:151]
  ds_read_b128 a[180:183], v26 offset:34816
  v_mfma_f32_16x16x32_bf16 v[152:155], a[196:199], a[168:171], v[152:155]
  ds_read_b128 a[184:187], v26 offset:36864
  s_mov_b32 s34, 0x2000
  s_add_u32 m0, s29, 0x12000
  v_mfma_f32_16x16x32_bf16 v[156:159], a[196:199], a[172:175], v[156:159]
  buffer_load_dwordx4 v22, s[16:19], s34 offen offset:0 nt lds
  s_waitcnt lgkmcnt(9)
  v_mfma_f32_16x16x32_bf16 v[160:163], a[200:203], a[160:163], v[160:163]
  ds_read_b128 a[188:191], v26 offset:38912
  v_mfma_f32_16x16x32_bf16 v[164:167], a[200:203], a[164:167], v[164:167]
  v_mfma_f32_16x16x32_bf16 v[168:171], a[200:203], a[168:171], v[168:171]
  ds_read_b64_tr_b16 a[220:221], v39 offset:32768
  v_mfma_f32_16x16x32_bf16 v[172:175], a[200:203], a[172:175], v[172:175]
  ds_read_b64_tr_b16 a[222:223], v39 offset:34816
  v_mfma_f32_16x16x32_bf16 v[176:179], a[204:207], a[160:163], v[176:179]
  buffer_load_dwordx4 v22, s[16:19], s34 offen offset:1024 nt lds
  v_mfma_f32_16x16x32_bf16 v[180:183], a[204:207], a[164:167], v[180:183]
  ds_read_b64_tr_b16 a[224:225], v32 offset:49152
  v_mfma_f32_16x16x32_bf16 v[184:187], a[204:207], a[168:171], v[184:187]
  v_mfma_f32_16x16x32_bf16 v[188:191], a[204:207], a[172:175], v[188:191]
  ds_read_b64_tr_b16 a[226:227], v32 offset:51200
  s_mov_b32 s34, 0x4000
  s_add_u32 m0, s29, 0x4000
  s_waitcnt lgkmcnt(10)
  v_mfma_f32_16x16x32_bf16 v[192:195], a[208:211], a[160:163], v[192:195]
  buffer_load_dwordx4 v20, s[12:15], s34 offen offset:0 nt lds
  v_mfma_f32_16x16x32_bf16 v[196:199], a[208:211], a[164:167], v[196:199]
  ds_read_b64_tr_b16 a[228:229], v33 offset:49152
  v_mfma_f32_16x16x32_bf16 v[200:203], a[208:211], a[168:171], v[200:203]
  ds_read_b64_tr_b16 a[230:231], v33 offset:51200
  v_mfma_f32_16x16x32_bf16 v[204:207], a[208:211], a[172:175], v[204:207]
  v_mfma_f32_16x16x32_bf16 v[208:211], a[212:215], a[160:163], v[208:211]
  ds_read_b64_tr_b16 a[232:233], v34 offset:49152
  v_mfma_f32_16x16x32_bf16 v[212:215], a[212:215], a[164:167], v[212:215]
  buffer_load_dwordx4 v21, s[12:15], s34 offen offset:1024 nt lds
  v_mfma_f32_16x16x32_bf16 v[216:219], a[212:215], a[168:171], v[216:219]
  ds_read_b64_tr_b16 a[234:235], v34 offset:51200
  v_mfma_f32_16x16x32_bf16 v[220:223], a[212:215], a[172:175], v[220:223]
  ds_read_b64_tr_b16 a[236:237], v35 offset:49152
  s_mov_b32 s34, 0x6000
  s_add_u32 m0, s29, 0x6000
  s_waitcnt lgkmcnt(7)
  v_mfma_f32_16x16x32_bf16 v[224:227], a[216:219], a[160:163], v[224:227]
  buffer_load_dwordx4 v20, s[12:15], s34 offen offset:0 nt lds
  v_mfma_f32_16x16x32_bf16 v[228:231], a[216:219], a[164:167], v[228:231]
  ds_read_b64_tr_b16 a[238:239], v35 offset:51200
  v_mfma_f32_16x16x32_bf16 v[232:235], a[216:219], a[168:171], v[232:235]
  v_mfma_f32_16x16x32_bf16 v[236:239], a[216:219], a[172:175], v[236:239]
  ds_read_b64_tr_b16 a[240:241], v36 offset:49152
  v_mfma_f32_16x16x32_bf16 v[240:243], a[220:223], a[160:163], v[240:243]
  ds_read_b64_tr_b16 a[242:243], v36 offset:51200
  v_mfma_f32_16x16x32_bf16 v[244:247], a[220:223], a[164:167], v[244:247]
  buffer_load_dwordx4 v21, s[12:15], s34 offen offset:1024 nt lds
  v_mfma_f32_16x16x32_bf16 v[248:251], a[220:223], a[168:171], v[248:251]
  ds_read_b64_tr_b16 a[244:245], v37 offset:49152
  v_mfma_f32_16x16x32_bf16 v[252:255], a[220:223], a[172:175], v[252:255]
  s_waitcnt lgkmcnt(7)
  v_mfma_f32_16x16x32_bf16 v[128:131], a[224:227], a[176:179], v[128:131]
  ds_read_b64_tr_b16 a[246:247], v37 offset:51200
  s_mov_b32 s34, 0x4000
  s_add_u32 m0, s29, 0x14000
  v_mfma_f32_16x16x32_bf16 v[132:135], a[224:227], a[180:183], v[132:135]
  buffer_load_dwordx4 v22, s[16:19], s34 offen offset:0 nt lds
  v_mfma_f32_16x16x32_bf16 v[136:139], a[224:227], a[184:187], v[136:139]
  ds_read_b64_tr_b16 a[248:249], v38 offset:49152
  v_mfma_f32_16x16x32_bf16 v[140:143], a[224:227], a[188:191], v[140:143]
  ds_read_b64_tr_b16 a[250:251], v38 offset:51200
  v_mfma_f32_16x16x32_bf16 v[144:147], a[228:231], a[176:179], v[144:147]
  buffer_load_dwordx4 v22, s[16:19], s34 offen offset:1024 nt lds
  v_mfma_f32_16x16x32_bf16 v[148:151], a[228:231], a[180:183], v[148:151]
  ds_read_b64_tr_b16 a[252:253], v39 offset:49152
  v_mfma_f32_16x16x32_bf16 v[152:155], a[228:231], a[184:187], v[152:155]
  v_mfma_f32_16x16x32_bf16 v[156:159], a[228:231], a[188:191], v[156:159]
  ds_read_b64_tr_b16 a[254:255], v39 offset:51200
  s_waitcnt lgkmcnt(8)
  v_mfma_f32_16x16x32_bf16 v[160:163], a[232:235], a[176:179], v[160:163]
  ds_read_b64_tr_b16 a[192:193], v32 offset:33024
  s_mov_b32 s34, 0x6000
  s_add_u32 m0, s29, 0x16000
  v_mfma_f32_16x16x32_bf16 v[164:167], a[232:235], a[180:183], v[164:167]
  buffer_load_dwordx4 v22, s[16:19], s34 offen offset:0 nt lds
  v_mfma_f32_16x16x32_bf16 v[168:171], a[232:235], a[184:187], v[168:171]
  ds_read_b64_tr_b16 a[194:195], v32 offset:35072
  v_mfma_f32_16x16x32_bf16 v[172:175], a[232:235], a[188:191], v[172:175]
  v_mfma_f32_16x16x32_bf16 v[176:179], a[236:239], a[176:179], v[176:179]
  ds_read_b64_tr_b16 a[196:197], v33 offset:33024
  v_mfma_f32_16x16x32_bf16 v[180:183], a[236:239], a[180:183], v[180:183]
  ds_read_b64_tr_b16 a[198:199], v33 offset:35072
  v_mfma_f32_16x16x32_bf16 v[184:187], a[236:239], a[184:187], v[184:187]
  buffer_load_dwordx4 v22, s[16:19], s34 offen offset:1024 nt lds
  v_mfma_f32_16x16x32_bf16 v[188:191], a[236:239], a[188:191], v[188:191]
  ds_read_b64_tr_b16 a[200:201], v34 offset:33024
  s_waitcnt lgkmcnt(9)
  v_mfma_f32_16x16x32_bf16 v[192:195], a[240:243], a[176:179], v[192:195]
  v_mfma_f32_16x16x32_bf16 v[196:199], a[240:243], a[180:183], v[196:199]
  ds_read_b64_tr_b16 a[202:203], v34 offset:35072
  v_mfma_f32_16x16x32_bf16 v[200:203], a[240:243], a[184:187], v[200:203]
  v_mfma_f32_16x16x32_bf16 v[204:207], a[240:243], a[188:191], v[204:207]
  ds_read_b64_tr_b16 a[204:205], v35 offset:33024
  v_mfma_f32_16x16x32_bf16 v[208:211], a[244:247], a[176:179], v[208:211]
  ds_read_b64_tr_b16 a[206:207], v35 offset:35072
  v_mfma_f32_16x16x32_bf16 v[212:215], a[244:247], a[180:183], v[212:215]
  v_mfma_f32_16x16x32_bf16 v[216:219], a[244:247], a[184:187], v[216:219]
  ds_read_b64_tr_b16 a[208:209], v36 offset:33024
  v_mfma_f32_16x16x32_bf16 v[220:223], a[244:247], a[188:191], v[220:223]
  s_waitcnt lgkmcnt(9)
  v_mfma_f32_16x16x32_bf16 v[224:227], a[248:251], a[176:179], v[224:227]
  ds_read_b64_tr_b16 a[210:211], v36 offset:35072
  v_mfma_f32_16x16x32_bf16 v[228:231], a[248:251], a[180:183], v[228:231]
  ds_read_b64_tr_b16 a[212:213], v37 offset:33024
  v_mfma_f32_16x16x32_bf16 v[232:235], a[248:251], a[184:187], v[232:235]
  v_mfma_f32_16x16x32_bf16 v[236:239], a[248:251], a[188:191], v[236:239]
  ds_read_b64_tr_b16 a[214:215], v37 offset:35072
  v_mfma_f32_16x16x32_bf16 v[240:243], a[252:255], a[176:179], v[240:243]
  v_mfma_f32_16x16x32_bf16 v[244:247], a[252:255], a[180:183], v[244:247]
  ds_read_b64_tr_b16 a[216:217], v38 offset:33024
  v_mfma_f32_16x16x32_bf16 v[248:251], a[252:255], a[184:187], v[248:251]
  ds_read_b64_tr_b16 a[218:219], v38 offset:35072
  v_mfma_f32_16x16x32_bf16 v[252:255], a[252:255], a[188:191], v[252:255]
  s_waitcnt lgkmcnt(10)
  v_mfma_f32_16x16x32_bf16 a[0:3], a[192:195], a[160:163], a[0:3]
  ds_read_b64_tr_b16 a[220:221], v39 offset:33024
  v_mfma_f32_16x16x32_bf16 a[4:7], a[192:195], a[164:167], a[4:7]
  v_mfma_f32_16x16x32_bf16 a[16:19], a[192:195], a[168:171], a[16:19]
  ds_read_b64_tr_b16 a[222:223], v39 offset:35072
  v_mfma_f32_16x16x32_bf16 a[20:23], a[192:195], a[172:175], a[20:23]
  v_mfma_f32_16x16x32_bf16 a[8:11], a[196:199], a[160:163], a[8:11]
  ds_read_b64_tr_b16 a[224:225], v32 offset:49408
  v_mfma_f32_16x16x32_bf16 a[12:15], a[196:199], a[164:167], a[12:15]
  ds_read_b64_tr_b16 a[226:227], v32 offset:51456
  v_mfma_f32_16x16x32_bf16 a[24:27], a[196:199], a[168:171], a[24:27]
  v_mfma_f32_16x16x32_bf16 a[28:31], a[196:199], a[172:175], a[28:31]
  ds_read_b64_tr_b16 a[228:229], v33 offset:49408
  s_waitcnt lgkmcnt(11)
  v_mfma_f32_16x16x32_bf16 a[32:35], a[200:203], a[160:163], a[32:35]
  v_mfma_f32_16x16x32_bf16 a[36:39], a[200:203], a[164:167], a[36:39]
  ds_read_b64_tr_b16 a[230:231], v33 offset:51456
  v_mfma_f32_16x16x32_bf16 a[48:51], a[200:203], a[168:171], a[48:51]
  ds_read_b64_tr_b16 a[232:233], v34 offset:49408
  v_mfma_f32_16x16x32_bf16 a[52:55], a[200:203], a[172:175], a[52:55]
  v_mfma_f32_16x16x32_bf16 a[40:43], a[204:207], a[160:163], a[40:43]
  ds_read_b64_tr_b16 a[234:235], v34 offset:51456
  v_mfma_f32_16x16x32_bf16 a[44:47], a[204:207], a[164:167], a[44:47]
  v_mfma_f32_16x16x32_bf16 a[56:59], a[204:207], a[168:171], a[56:59]
  ds_read_b64_tr_b16 a[236:237], v35 offset:49408
  v_mfma_f32_16x16x32_bf16 a[60:63], a[204:207], a[172:175], a[60:63]
  ds_read_b64_tr_b16 a[238:239], v35 offset:51456
  s_waitcnt lgkmcnt(12)
  v_mfma_f32_16x16x32_bf16 a[64:67], a[208:211], a[160:163], a[64:67]
  v_mfma_f32_16x16x32_bf16 a[68:71], a[208:211], a[164:167], a[68:71]
  ds_read_b64_tr_b16 a[240:241], v36 offset:49408
  v_mfma_f32_16x16x32_bf16 a[80:83], a[208:211], a[168:171], a[80:83]
  v_mfma_f32_16x16x32_bf16 a[84:87], a[208:211], a[172:175], a[84:87]
  ds_read_b64_tr_b16 a[242:243], v36 offset:51456
  v_mfma_f32_16x16x32_bf16 a[72:75], a[212:215], a[160:163], a[72:75]
  v_mfma_f32_16x16x32_bf16 a[76:79], a[212:215], a[164:167], a[76:79]
  ds_read_b64_tr_b16 a[244:245], v37 offset:49408
  v_mfma_f32_16x16x32_bf16 a[88:91], a[212:215], a[168:171], a[88:91]
  ds_read_b64_tr_b16 a[246:247], v37 offset:51456
  v_mfma_f32_16x16x32_bf16 a[92:95], a[212:215], a[172:175], a[92:95]
  s_waitcnt lgkmcnt(12)
  v_mfma_f32_16x16x32_bf16 a[96:99], a[216:219], a[160:163], a[96:99]
  ds_read_b64_tr_b16 a[248:249], v38 offset:49408
  v_mfma_f32_16x16x32_bf16 a[100:103], a[216:219], a[164:167], a[100:103]
  v_mfma_f32_16x16x32_bf16 a[112:115], a[216:219], a[168:171], a[112:115]
  ds_read_b64_tr_b16 a[250:251], v38 offset:51456
  v_mfma_f32_16x16x32_bf16 a[116:119], a[216:219], a[172:175], a[116:119]
  ds_read_b64_tr_b16 a[252:253], v39 offset:49408
  v_mfma_f32_16x16x32_bf16 a[104:107], a[220:223], a[160:163], a[104:107]
  v_mfma_f32_16x16x32_bf16 a[108:111], a[220:223], a[164:167], a[108:111]
  ds_read_b64_tr_b16 a[254:255], v39 offset:51456
  v_mfma_f32_16x16x32_bf16 a[120:123], a[220:223], a[168:171], a[120:123]
  v_mfma_f32_16x16x32_bf16 a[124:127], a[220:223], a[172:175], a[124:127]
  s_waitcnt lgkmcnt(12)
  v_mfma_f32_16x16x32_bf16 a[0:3], a[224:227], a[176:179], a[0:3]
  v_mfma_f32_16x16x32_bf16 a[4:7], a[224:227], a[180:183], a[4:7]
  v_mfma_f32_16x16x32_bf16 a[16:19], a[224:227], a[184:187], a[16:19]
  v_mfma_f32_16x16x32_bf16 a[20:23], a[224:227], a[188:191], a[20:23]
  v_mfma_f32_16x16x32_bf16 a[8:11], a[228:231], a[176:179], a[8:11]
  v_mfma_f32_16x16x32_bf16 a[12:15], a[228:231], a[180:183], a[12:15]
  v_mfma_f32_16x16x32_bf16 a[24:27], a[228:231], a[184:187], a[24:27]
  v_mfma_f32_16x16x32_bf16 a[28:31], a[228:231], a[188:191], a[28:31]
  s_waitcnt lgkmcnt(8)
  v_mfma_f32_16x16x32_bf16 a[32:35], a[232:235], a[176:179], a[32:35]
  s_waitcnt vmcnt(12) lgkmcnt(0)
  s_barrier
  v_mfma_f32_16x16x32_bf16 a[36:39], a[232:235], a[180:183], a[36:39]
  ds_read_b128 a[192:195], v8 offset:0
  s_add_u32 s25, s25, 128
  v_mfma_f32_16x16x32_bf16 a[48:51], a[232:235], a[184:187], a[48:51]
  v_mfma_f32_16x16x32_bf16 a[52:55], a[232:235], a[188:191], a[52:55]
  v_mfma_f32_16x16x32_bf16 a[40:43], a[236:239], a[176:179], a[40:43]
  ds_read_b128 a[196:199], v9 offset:0
  v_mfma_f32_16x16x32_bf16 a[44:47], a[236:239], a[180:183], a[44:47]
  v_mfma_f32_16x16x32_bf16 a[56:59], a[236:239], a[184:187], a[56:59]
  s_mov_b32 s34, 0x8000
  s_add_u32 m0, s29, 0x8000
  v_mfma_f32_16x16x32_bf16 a[60:63], a[236:239], a[188:191], a[60:63]
  ds_read_b128 a[200:203], v10 offset:0
  buffer_load_dwordx4 v20, s[12:15], s34 offen offset:0 nt lds
  s_waitcnt lgkmcnt(7)
  v_mfma_f32_16x16x32_bf16 a[64:67], a[240:243], a[176:179], a[64:67]
  s_add_u32 s26, s26, 0x80000
  v_mfma_f32_16x16x32_bf16 a[68:71], a[240:243], a[180:183], a[68:71]
  v_mfma_f32_16x16x32_bf16 a[80:83], a[240:243], a[184:187], a[80:83]
  ds_read_b128 a[204:207], v11 offset:0
  buffer_load_dwordx4 v21, s[12:15], s34 offen offset:1024 nt lds
  v_mfma_f32_16x16x32_bf16 a[84:87], a[240:243], a[188:191], a[84:87]
  v_mfma_f32_16x16x32_bf16 a[72:75], a[244:247], a[176:179], a[72:75]
  s_mov_b32 s34, 0xa000
  s_add_u32 m0, s29, 0xa000
  v_mfma_f32_16x16x32_bf16 a[76:79], a[244:247], a[180:183], a[76:79]
  ds_read_b128 a[208:211], v12 offset:0
  buffer_load_dwordx4 v20, s[12:15], s34 offen offset:0 nt lds
  v_mfma_f32_16x16x32_bf16 a[88:91], a[244:247], a[184:187], a[88:91]
  v_mfma_f32_16x16x32_bf16 a[92:95], a[244:247], a[188:191], a[92:95]
  s_waitcnt lgkmcnt(5)
  v_mfma_f32_16x16x32_bf16 a[96:99], a[248:251], a[176:179], a[96:99]
  ds_read_b128 a[212:215], v13 offset:0
  buffer_load_dwordx4 v21, s[12:15], s34 offen offset:1024 nt lds
  v_mfma_f32_16x16x32_bf16 a[100:103], a[248:251], a[180:183], a[100:103]
  v_mfma_f32_16x16x32_bf16 a[112:115], a[248:251], a[184:187], a[112:115]
  s_mov_b32 s34, 0x8000
  s_add_u32 m0, s29, 0x18000
  v_mfma_f32_16x16x32_bf16 a[116:119], a[248:251], a[188:191], a[116:119]
  ds_read_b128 a[216:219], v14 offset:0
  buffer_load_dwordx4 v22, s[16:19], s34 offen offset:0 nt lds
  v_mfma_f32_16x16x32_bf16 a[104:107], a[252:255], a[176:179], a[104:107]
  v_mfma_f32_16x16x32_bf16 a[108:111], a[252:255], a[180:183], a[108:111]
  v_mfma_f32_16x16x32_bf16 a[120:123], a[252:255], a[184:187], a[120:123]
  v_mfma_f32_16x16x32_bf16 a[124:127], a[252:255], a[188:191], a[124:127]
  buffer_load_dwordx4 v22, s[16:19], s34 offen offset:1024 nt lds
  s_add_u32 s12, s12, 0x2000
  s_addc_u32 s13, s13, 0
  s_mov_b32 s14, 0x7e000
  s_mov_b32 s46, 0x10000
  s_and_b32 s9, s41, 0x80
  s_mov_b32 s4, s0
  s_mov_b32 s5, s1
  s_mov_b32 s6, 0x800000
  s_mov_b32 s7, 0x20000
  s_mov_b32 s8, s3
  s_mov_b32 s27, 0x8000
  ds_read_b128 a[220:223], v15 offset:0
  v_pk_mul_f32 v[160:161], v[160:161], s[32:33]
  v_pk_mul_f32 v[162:163], v[162:163], s[32:33]
  v_pk_mul_f32 v[164:165], v[164:165], s[32:33]
  v_pk_mul_f32 v[166:167], v[166:167], s[32:33]
  v_cvt_pk_bf16_f32 v72, v160, v161
  v_cvt_pk_bf16_f32 v74, v164, v165
  v_cvt_pk_bf16_f32 v73, v162, v163
  v_cvt_pk_bf16_f32 v75, v166, v167
  v_pk_mul_f32 v[168:169], v[168:169], s[32:33]
  v_pk_mul_f32 v[170:171], v[170:171], s[32:33]
  v_pk_mul_f32 v[172:173], v[172:173], s[32:33]
  v_pk_mul_f32 v[174:175], v[174:175], s[32:33]
  v_cvt_pk_bf16_f32 v104, v168, v169
  v_cvt_pk_bf16_f32 v106, v172, v173
  v_cvt_pk_bf16_f32 v105, v170, v171
  v_cvt_pk_bf16_f32 v107, v174, v175
  v_permlane16_swap_b32 v72, v74
  v_permlane16_swap_b32 v73, v75
  v_permlane16_swap_b32 v104, v106
  v_permlane16_swap_b32 v105, v107
  v_mfma_f32_32x32x16_bf16 v[160:175], v[60:63], v[60:63], 0
  v_pk_mul_f32 v[128:129], v[128:129], s[32:33]
  v_pk_mul_f32 v[130:131], v[130:131], s[32:33]
  v_pk_mul_f32 v[132:133], v[132:133], s[32:33]
  v_pk_mul_f32 v[134:135], v[134:135], s[32:33]
  v_cvt_pk_bf16_f32 v64, v128, v129
  v_cvt_pk_bf16_f32 v66, v132, v133
  v_cvt_pk_bf16_f32 v65, v130, v131
  v_cvt_pk_bf16_f32 v67, v134, v135
  v_pk_mul_f32 v[136:137], v[136:137], s[32:33]
  v_pk_mul_f32 v[138:139], v[138:139], s[32:33]
  v_pk_mul_f32 v[140:141], v[140:141], s[32:33]
  v_pk_mul_f32 v[142:143], v[142:143], s[32:33]
  v_cvt_pk_bf16_f32 v96, v136, v137
  v_cvt_pk_bf16_f32 v98, v140, v141
  v_cvt_pk_bf16_f32 v97, v138, v139
  v_cvt_pk_bf16_f32 v99, v142, v143
  v_permlane16_swap_b32 v64, v66
  v_permlane16_swap_b32 v65, v67
  v_permlane16_swap_b32 v96, v98
  v_permlane16_swap_b32 v97, v99
  v_pk_mul_f32 v[144:145], v[144:145], s[32:33]
  v_pk_mul_f32 v[146:147], v[146:147], s[32:33]
  v_pk_mul_f32 v[148:149], v[148:149], s[32:33]
  v_pk_mul_f32 v[150:151], v[150:151], s[32:33]
  v_cvt_pk_bf16_f32 v68, v144, v145
  v_cvt_pk_bf16_f32 v70, v148, v149
  v_cvt_pk_bf16_f32 v69, v146, v147
  v_cvt_pk_bf16_f32 v71, v150, v151
  v_pk_mul_f32 v[152:153], v[152:153], s[32:33]
  v_pk_mul_f32 v[154:155], v[154:155], s[32:33]
  v_pk_mul_f32 v[156:157], v[156:157], s[32:33]
  v_pk_mul_f32 v[158:159], v[158:159], s[32:33]
  v_cvt_pk_bf16_f32 v100, v152, v153
  v_cvt_pk_bf16_f32 v102, v156, v157
  v_cvt_pk_bf16_f32 v101, v154, v155
  v_cvt_pk_bf16_f32 v103, v158, v159
  v_permlane16_swap_b32 v68, v70
  v_permlane16_swap_b32 v69, v71
  v_permlane16_swap_b32 v100, v102
  v_permlane16_swap_b32 v101, v103
  v_pk_mul_f32 v[176:177], v[176:177], s[32:33]
  v_pk_mul_f32 v[178:179], v[178:179], s[32:33]
  v_pk_mul_f32 v[180:181], v[180:181], s[32:33]
  v_pk_mul_f32 v[182:183], v[182:183], s[32:33]
  v_cvt_pk_bf16_f32 v76, v176, v177
  v_cvt_pk_bf16_f32 v78, v180, v181
  v_cvt_pk_bf16_f32 v77, v178, v179
  v_cvt_pk_bf16_f32 v79, v182, v183
  v_pk_mul_f32 v[184:185], v[184:185], s[32:33]
  v_pk_mul_f32 v[186:187], v[186:187], s[32:33]
  v_pk_mul_f32 v[188:189], v[188:189], s[32:33]
  v_pk_mul_f32 v[190:191], v[190:191], s[32:33]
  v_cvt_pk_bf16_f32 v108, v184, v185
  v_cvt_pk_bf16_f32 v110, v188, v189
  v_cvt_pk_bf16_f32 v109, v186, v187
  v_cvt_pk_bf16_f32 v111, v190, v191
  v_permlane16_swap_b32 v76, v78
  v_permlane16_swap_b32 v77, v79
  v_permlane16_swap_b32 v108, v110
  v_permlane16_swap_b32 v109, v111
  v_pk_mul_f32 v[192:193], v[192:193], s[32:33]
  v_pk_mul_f32 v[194:195], v[194:195], s[32:33]
  v_pk_mul_f32 v[196:197], v[196:197], s[32:33]
  v_pk_mul_f32 v[198:199], v[198:199], s[32:33]
  v_cvt_pk_bf16_f32 v80, v192, v193
  v_cvt_pk_bf16_f32 v82, v196, v197
  v_cvt_pk_bf16_f32 v81, v194, v195
  v_cvt_pk_bf16_f32 v83, v198, v199
  v_pk_mul_f32 v[200:201], v[200:201], s[32:33]
  v_pk_mul_f32 v[202:203], v[202:203], s[32:33]
  v_pk_mul_f32 v[204:205], v[204:205], s[32:33]
  v_pk_mul_f32 v[206:207], v[206:207], s[32:33]
  v_cvt_pk_bf16_f32 v112, v200, v201
  v_cvt_pk_bf16_f32 v114, v204, v205
  v_cvt_pk_bf16_f32 v113, v202, v203
  v_cvt_pk_bf16_f32 v115, v206, v207
  v_permlane16_swap_b32 v80, v82
  v_permlane16_swap_b32 v81, v83
  v_permlane16_swap_b32 v112, v114
  v_permlane16_swap_b32 v113, v115
  v_pk_mul_f32 v[208:209], v[208:209], s[32:33]
  v_pk_mul_f32 v[210:211], v[210:211], s[32:33]
  v_pk_mul_f32 v[212:213], v[212:213], s[32:33]
  v_pk_mul_f32 v[214:215], v[214:215], s[32:33]
  v_cvt_pk_bf16_f32 v84, v208, v209
  v_cvt_pk_bf16_f32 v86, v212, v213
  v_cvt_pk_bf16_f32 v85, v210, v211
  v_cvt_pk_bf16_f32 v87, v214, v215
  v_pk_mul_f32 v[216:217], v[216:217], s[32:33]
  v_pk_mul_f32 v[218:219], v[218:219], s[32:33]
  v_pk_mul_f32 v[220:221], v[220:221], s[32:33]
  v_pk_mul_f32 v[222:223], v[222:223], s[32:33]
  v_cvt_pk_bf16_f32 v116, v216, v217
  v_cvt_pk_bf16_f32 v118, v220, v221
  v_cvt_pk_bf16_f32 v117, v218, v219
  v_cvt_pk_bf16_f32 v119, v222, v223
  v_permlane16_swap_b32 v84, v86
  v_permlane16_swap_b32 v85, v87
  v_permlane16_swap_b32 v116, v118
  v_permlane16_swap_b32 v117, v119
  v_pk_mul_f32 v[224:225], v[224:225], s[32:33]
  v_pk_mul_f32 v[226:227], v[226:227], s[32:33]
  v_pk_mul_f32 v[228:229], v[228:229], s[32:33]
  v_pk_mul_f32 v[230:231], v[230:231], s[32:33]
  v_cvt_pk_bf16_f32 v88, v224, v225
  v_cvt_pk_bf16_f32 v90, v228, v229
  v_cvt_pk_bf16_f32 v89, v226, v227
  v_cvt_pk_bf16_f32 v91, v230, v231
  v_pk_mul_f32 v[232:233], v[232:233], s[32:33]
  v_pk_mul_f32 v[234:235], v[234:235], s[32:33]
  v_pk_mul_f32 v[236:237], v[236:237], s[32:33]
  v_pk_mul_f32 v[238:239], v[238:239], s[32:33]
  v_cvt_pk_bf16_f32 v120, v232, v233
  v_cvt_pk_bf16_f32 v122, v236, v237
  v_cvt_pk_bf16_f32 v121, v234, v235
  v_cvt_pk_bf16_f32 v123, v238, v239
  v_permlane16_swap_b32 v88, v90
  v_permlane16_swap_b32 v89, v91
  v_permlane16_swap_b32 v120, v122
  v_permlane16_swap_b32 v121, v123
  v_pk_mul_f32 v[240:241], v[240:241], s[32:33]
  v_pk_mul_f32 v[242:243], v[242:243], s[32:33]
  v_pk_mul_f32 v[244:245], v[244:245], s[32:33]
  v_pk_mul_f32 v[246:247], v[246:247], s[32:33]
  v_cvt_pk_bf16_f32 v92, v240, v241
  v_cvt_pk_bf16_f32 v94, v244, v245
  v_cvt_pk_bf16_f32 v93, v242, v243
  v_cvt_pk_bf16_f32 v95, v246, v247
  v_pk_mul_f32 v[248:249], v[248:249], s[32:33]
  v_pk_mul_f32 v[250:251], v[250:251], s[32:33]
  v_pk_mul_f32 v[252:253], v[252:253], s[32:33]
  v_pk_mul_f32 v[254:255], v[254:255], s[32:33]
  v_cvt_pk_bf16_f32 v124, v248, v249
  v_cvt_pk_bf16_f32 v126, v252, v253
  v_cvt_pk_bf16_f32 v125, v250, v251
  v_cvt_pk_bf16_f32 v127, v254, v255
  v_permlane16_swap_b32 v92, v94
  v_permlane16_swap_b32 v93, v95
  v_permlane16_swap_b32 v124, v126
  v_permlane16_swap_b32 v125, v127
  s_cmp_eq_u32 s24, 3
  s_cselect_b32 s50, 0xffff, -1
  s_mov_b32 s51, s50
  v_mov_b32 v217, 0xf149f2ca
  v_cndmask_b32 v216, v217, 0, s[50:51]
  s_waitcnt vmcnt(16)
  s_barrier
  s_waitcnt lgkmcnt(0)
  v_mfma_f32_32x32x16_bf16 v[128:143], a[192:195], v[64:67], 0
  v_mov_b32 v176, v216
  v_mov_b32 v177, v216
  v_mov_b32 v178, v216
  v_accvgpr_read_b32 v3, a0
  v_accvgpr_read_b32 v4, a1
  v_accvgpr_read_b32 v29, a2
  v_mfma_f32_32x32x16_bf16 v[128:143], a[196:199], v[68:71], v[128:143]
  ds_read_b64_tr_b16 a[224:225], v16 offset:0
  ds_read_b64_tr_b16 a[226:227], v16 offset:2048
  v_mov_b32 v179, v216
  v_mov_b32 v180, v216
  v_accvgpr_read_b32 v30, a3
  v_mul_f32 v3, s32, v3
  v_mfma_f32_32x32x16_bf16 v[128:143], a[200:203], v[72:75], v[128:143]
  ds_read_b64_tr_b16 a[228:229], v17 offset:0
  ds_read_b64_tr_b16 a[230:231], v17 offset:2048
  v_mov_b32 v181, v216
  v_mov_b32 v182, v216
  v_mul_f32 v4, s32, v4
  v_mul_f32 v29, s32, v29
  v_mfma_f32_32x32x16_bf16 v[128:143], a[204:207], v[76:79], v[128:143]
  ds_read_b64_tr_b16 a[232:233], v18 offset:0
  ds_read_b64_tr_b16 a[234:235], v18 offset:2048
  v_mov_b32 v183, v216
  v_mov_b32 v184, v216
  v_mov_b32 v185, v216
  v_mul_f32 v30, s32, v30
  v_mfma_f32_32x32x16_bf16 v[128:143], a[208:211], v[80:83], v[128:143]
  ds_read_b64_tr_b16 a[236:237], v19 offset:0
  ds_read_b64_tr_b16 a[238:239], v19 offset:2048
  v_mov_b32 v186, v216
  v_mov_b32 v187, v216
  v_cvt_pk_bf16_f32 v3, v3, v4
  v_cvt_pk_bf16_f32 v4, v29, v30
  v_mfma_f32_32x32x16_bf16 v[128:143], a[212:215], v[84:87], v[128:143]
  ds_read_b64_tr_b16 a[240:241], v16 offset:4096
  ds_read_b64_tr_b16 a[242:243], v16 offset:6144
  v_mov_b32 v188, v216
  v_mov_b32 v189, v216
  v_accvgpr_read_b32 v29, a4
  v_accvgpr_read_b32 v30, a5
  v_mfma_f32_32x32x16_bf16 v[128:143], a[216:219], v[88:91], v[128:143]
  v_mov_b32 v190, v216
  v_mov_b32 v191, v216
  v_mul_f32 v29, s32, v29
  v_mul_f32 v30, s32, v30
  v_cvt_pk_bf16_f32 v29, v29, v30
  v_mfma_f32_32x32x16_bf16 v[128:143], a[220:223], v[92:95], v[128:143]
  v_permlane16_swap_b32 v3, v29
  v_accvgpr_write_b32 a0, v3
  v_accvgpr_write_b32 a2, v29
  v_accvgpr_read_b32 v29, a6
  v_accvgpr_read_b32 v30, a7
  v_mfma_f32_32x32x16_bf16 v[144:159], a[192:195], v[96:99], v[176:191]
  v_mul_f32 v29, s32, v29
  v_mul_f32 v30, s32, v30
  v_cvt_pk_bf16_f32 v30, v29, v30
  v_mfma_f32_32x32x16_bf16 v[144:159], a[196:199], v[100:103], v[144:159]
  ds_read_b128 a[192:195], v8 offset:8192
  v_permlane16_swap_b32 v4, v30
  v_accvgpr_write_b32 a1, v4
  v_accvgpr_write_b32 a3, v30
  v_accvgpr_read_b32 v3, a8
  v_mfma_f32_32x32x16_bf16 v[144:159], a[200:203], v[104:107], v[144:159]
  ds_read_b128 a[196:199], v9 offset:8192
  v_exp_f32 v208, v128
  v_accvgpr_read_b32 v4, a9
  v_accvgpr_read_b32 v29, a10
  v_accvgpr_read_b32 v30, a11
  v_mfma_f32_32x32x16_bf16 v[144:159], a[204:207], v[108:111], v[144:159]
  ds_read_b128 a[200:203], v10 offset:8192
  v_exp_f32 v209, v129
  v_mul_f32 v3, s32, v3
  v_mul_f32 v4, s32, v4
  v_mul_f32 v29, s32, v29
  v_mfma_f32_32x32x16_bf16 v[144:159], a[208:211], v[112:115], v[144:159]
  ds_read_b128 a[204:207], v11 offset:8192
  v_exp_f32 v210, v130
  v_add_f32 v27, v208, v209
  v_cvt_pk_bf16_f32 v192, v208, v209
  v_mul_f32 v30, s32, v30
  v_mfma_f32_32x32x16_bf16 v[144:159], a[212:215], v[116:119], v[144:159]
  ds_read_b128 a[208:211], v12 offset:8192
  v_exp_f32 v211, v131
  v_add_f32 v27, v27, v210
  v_cvt_pk_bf16_f32 v3, v3, v4
  v_cvt_pk_bf16_f32 v4, v29, v30
  v_mfma_f32_32x32x16_bf16 v[144:159], a[216:219], v[120:123], v[144:159]
  ds_read_b128 a[212:215], v13 offset:8192
  v_exp_f32 v212, v132
  v_add_f32 v27, v27, v211
  v_cvt_pk_bf16_f32 v193, v210, v211
  v_accvgpr_read_b32 v29, a12
  v_mfma_f32_32x32x16_bf16 v[144:159], a[220:223], v[124:127], v[144:159]
  ds_read_b128 a[216:219], v14 offset:8192
  v_exp_f32 v213, v133
  v_add_f32 v27, v27, v212
  v_accvgpr_read_b32 v30, a13
  v_mul_f32 v29, s32, v29
  v_exp_f32 v214, v134
  v_add_f32 v27, v27, v213
  v_cvt_pk_bf16_f32 v194, v212, v213
  v_exp_f32 v215, v135
  v_add_f32 v27, v27, v214
  ds_read_b128 a[220:223], v15 offset:8192
  v_exp_f32 v208, v136
  v_add_f32 v27, v27, v215
  v_cvt_pk_bf16_f32 v195, v214, v215
  v_exp_f32 v209, v137
  v_add_f32 v27, v27, v208
  v_exp_f32 v210, v138
  v_add_f32 v27, v27, v209
  v_cvt_pk_bf16_f32 v196, v208, v209
  v_exp_f32 v211, v139
  v_add_f32 v27, v27, v210
  v_exp_f32 v212, v140
  v_add_f32 v27, v27, v211
  v_cvt_pk_bf16_f32 v197, v210, v211
  v_exp_f32 v213, v141
  v_add_f32 v27, v27, v212
  v_exp_f32 v214, v142
  v_add_f32 v27, v27, v213
  v_cvt_pk_bf16_f32 v198, v212, v213
  v_exp_f32 v215, v143
  v_add_f32 v27, v27, v214
  v_add_f32 v27, v27, v215
  v_cvt_pk_bf16_f32 v199, v214, v215
  v_subrev_u32 v7, 0x37800000, v27
  v_cmp_lt_u32 vcc, 0x10000000, v7
  v_exp_f32 v216, v144
  v_exp_f32 v217, v145
  s_cbranch_vccnz L1_cam
L1_ram:
  v_mov_b32 v25, v27
  v_exp_f32 v218, v146
  v_add_f32 v28, v216, v217
  v_cvt_pk_bf16_f32 v200, v216, v217
  v_exp_f32 v219, v147
  v_add_f32 v28, v28, v218
  v_exp_f32 v220, v148
  v_add_f32 v28, v28, v219
  v_cvt_pk_bf16_f32 v201, v218, v219
  v_exp_f32 v221, v149
  v_add_f32 v28, v28, v220
  s_waitcnt lgkmcnt(0)
  v_mfma_f32_32x32x16_bf16 v[128:143], a[192:195], v[64:67], v[160:175]
  v_exp_f32 v222, v150
  v_add_f32 v28, v28, v221
  v_cvt_pk_bf16_f32 v202, v220, v221
  v_mul_f32 v30, s32, v30
  v_cvt_pk_bf16_f32 v29, v29, v30
  v_mfma_f32_32x32x16_bf16 v[128:143], a[196:199], v[68:71], v[128:143]
  ds_read_b64_tr_b16 a[244:245], v17 offset:4096
  ds_read_b64_tr_b16 a[246:247], v17 offset:6144
  v_exp_f32 v223, v151
  v_add_f32 v28, v28, v222
  v_mfma_f32_32x32x16_bf16 v[128:143], a[200:203], v[72:75], v[128:143]
  ds_read_b64_tr_b16 a[248:249], v18 offset:4096
  s_add_u32 s27, s27, 0x2000
  v_exp_f32 v216, v152
  v_add_f32 v28, v28, v223
  v_cvt_pk_bf16_f32 v203, v222, v223
  v_mfma_f32_32x32x16_bf16 v[128:143], a[204:207], v[76:79], v[128:143]
  ds_read_b64_tr_b16 a[250:251], v18 offset:6144
  ds_read_b64_tr_b16 a[252:253], v19 offset:4096
  v_exp_f32 v217, v153
  v_add_f32 v28, v28, v216
  v_mfma_f32_32x32x16_bf16 v[128:143], a[208:211], v[80:83], v[128:143]
  ds_read_b64_tr_b16 a[254:255], v19 offset:6144
  v_exp_f32 v218, v154
  v_add_f32 v28, v28, v217
  v_cvt_pk_bf16_f32 v204, v216, v217
  v_mfma_f32_32x32x16_bf16 v[128:143], a[212:215], v[84:87], v[128:143]
  v_exp_f32 v219, v155
  v_add_f32 v28, v28, v218
  v_permlane16_swap_b32 v3, v29
  v_accvgpr_write_b32 a4, v3
  v_mfma_f32_32x32x16_bf16 v[128:143], a[216:219], v[88:91], v[128:143]
  v_exp_f32 v220, v156
  v_add_f32 v28, v28, v219
  v_cvt_pk_bf16_f32 v205, v218, v219
  v_accvgpr_write_b32 a6, v29
  v_accvgpr_read_b32 v29, a14
  v_mfma_f32_32x32x16_bf16 v[128:143], a[220:223], v[92:95], v[128:143]
  v_exp_f32 v221, v157
  v_add_f32 v28, v28, v220
  v_accvgpr_read_b32 v30, a15
  v_mul_f32 v29, s32, v29
  v_mul_f32 v30, s32, v30
  s_waitcnt lgkmcnt(0)
  v_mfma_f32_32x32x16_bf16 v[224:239], a[224:227], v[192:195], 0
  v_exp_f32 v222, v158
  v_add_f32 v28, v28, v221
  v_cvt_pk_bf16_f32 v206, v220, v221
  v_cvt_pk_bf16_f32 v30, v29, v30
  v_mfma_f32_32x32x16_bf16 v[240:255], a[228:231], v[192:195], 0
  v_exp_f32 v223, v159
  v_add_f32 v28, v28, v222
  v_permlane16_swap_b32 v4, v30
  v_accvgpr_write_b32 a5, v4
  v_mfma_f32_32x32x16_bf16 v[32:47], a[232:235], v[192:195], 0
  v_exp_f32 v208, v128
  v_add_f32 v28, v28, v223
  v_cvt_pk_bf16_f32 v207, v222, v223
  v_accvgpr_write_b32 a7, v30
  v_accvgpr_read_b32 v3, a16
  v_mfma_f32_32x32x16_bf16 v[48:63], a[236:239], v[192:195], 0
  v_exp_f32 v209, v129
  v_subrev_u32 v7, 0x37800000, v28
  v_cmp_lt_u32 vcc, 0x10000000, v7
  s_and_b64 vcc, vcc, s[50:51]
  v_accvgpr_read_b32 v4, a17
  v_mfma_f32_32x32x16_bf16 v[224:239], a[240:243], v[196:199], v[224:239]
  s_cbranch_vccnz L1_cbJ0
L1_rbJ0:
  v_exp_f32 v210, v130
  v_add_f32 v27, v208, v209
  v_cvt_pk_bf16_f32 v192, v208, v209
  v_accvgpr_read_b32 v29, a18
  v_mfma_f32_32x32x16_bf16 v[240:255], a[244:247], v[196:199], v[240:255]
  v_exp_f32 v211, v131
  v_mov_b32 v26, v28
  v_add_f32 v27, v27, v210
  v_accvgpr_read_b32 v30, a19
  v_mul_f32 v3, s32, v3
  v_mfma_f32_32x32x16_bf16 v[32:47], a[248:251], v[196:199], v[32:47]
  v_exp_f32 v212, v132
  v_add_f32 v27, v27, v211
  v_cvt_pk_bf16_f32 v193, v210, v211
  v_mul_f32 v4, s32, v4
  v_mul_f32 v29, s32, v29
  v_mfma_f32_32x32x16_bf16 v[48:63], a[252:255], v[196:199], v[48:63]
  v_exp_f32 v213, v133
  v_add_f32 v27, v27, v212
  v_mul_f32 v30, s32, v30
  v_cvt_pk_bf16_f32 v3, v3, v4
  v_cvt_pk_bf16_f32 v4, v29, v30
  v_mfma_f32_32x32x16_bf16 v[144:159], a[192:195], v[96:99], v[176:191]
  s_waitcnt vmcnt(8)
  s_barrier
  v_exp_f32 v214, v134
  v_add_f32 v27, v27, v213
  v_cvt_pk_bf16_f32 v194, v212, v213
  v_accvgpr_read_b32 v29, a20
  v_mfma_f32_32x32x16_bf16 v[144:159], a[196:199], v[100:103], v[144:159]
  ds_read_b128 a[192:195], v8 offset:16384
  v_exp_f32 v215, v135
  v_add_f32 v27, v27, v214
  v_accvgpr_read_b32 v30, a21
  v_mul_f32 v29, s32, v29
  v_mfma_f32_32x32x16_bf16 v[144:159], a[200:203], v[104:107], v[144:159]
  ds_read_b128 a[196:199], v9 offset:16384
  v_exp_f32 v208, v136
  v_add_f32 v27, v27, v215
  v_cvt_pk_bf16_f32 v195, v214, v215
  v_mul_f32 v30, s32, v30
  v_mfma_f32_32x32x16_bf16 v[144:159], a[204:207], v[108:111], v[144:159]
  ds_read_b128 a[200:203], v10 offset:16384
  v_exp_f32 v209, v137
  v_add_f32 v27, v27, v208
  v_cvt_pk_bf16_f32 v29, v29, v30
  v_mfma_f32_32x32x16_bf16 v[144:159], a[208:211], v[112:115], v[144:159]
  ds_read_b128 a[204:207], v11 offset:16384
  v_exp_f32 v210, v138
  v_add_f32 v27, v27, v209
  v_cvt_pk_bf16_f32 v196, v208, v209
  v_mfma_f32_32x32x16_bf16 v[144:159], a[212:215], v[116:119], v[144:159]
  ds_read_b128 a[208:211], v12 offset:16384
  v_exp_f32 v211, v139
  v_add_f32 v27, v27, v210
  v_permlane16_swap_b32 v3, v29
  v_mfma_f32_32x32x16_bf16 v[144:159], a[216:219], v[120:123], v[144:159]
  ds_read_b128 a[212:215], v13 offset:16384
  v_exp_f32 v212, v140
  v_add_f32 v27, v27, v211
  v_cvt_pk_bf16_f32 v197, v210, v211
  v_accvgpr_write_b32 a8, v3
  v_mfma_f32_32x32x16_bf16 v[144:159], a[220:223], v[124:127], v[144:159]
  ds_read_b128 a[216:219], v14 offset:16384
  v_exp_f32 v213, v141
  v_add_f32 v27, v27, v212
  v_accvgpr_write_b32 a10, v29
  s_add_u32 m0, s29, 0xc000
  v_mfma_f32_32x32x16_bf16 a[128:143], a[224:227], v[200:203], 0
  ds_read_b128 a[220:223], v15 offset:16384
  buffer_load_dwordx4 v20, s[12:15], s27 offen offset:0 nt lds
  v_exp_f32 v214, v142
  v_add_f32 v27, v27, v213
  v_cvt_pk_bf16_f32 v198, v212, v213
  v_mfma_f32_32x32x16_bf16 a[144:159], a[228:231], v[200:203], 0
  ds_read_b64_tr_b16 a[224:225], v16 offset:8192
  ds_read_b64_tr_b16 a[226:227], v16 offset:10240
  v_exp_f32 v215, v143
  v_add_f32 v27, v27, v214
  v_accvgpr_read_b32 v29, a22
  v_mfma_f32_32x32x16_bf16 a[160:175], a[232:235], v[200:203], 0
  ds_read_b64_tr_b16 a[228:229], v17 offset:8192
  buffer_load_dwordx4 v21, s[12:15], s27 offen offset:1024 nt lds
  v_exp_f32 v216, v144
  v_add_f32 v27, v27, v215
  v_cvt_pk_bf16_f32 v199, v214, v215
  v_mfma_f32_32x32x16_bf16 a[176:191], a[236:239], v[200:203], 0
  ds_read_b64_tr_b16 a[230:231], v17 offset:10240
  ds_read_b64_tr_b16 a[232:233], v18 offset:8192
  v_exp_f32 v217, v145
  v_cmp_nge_f32 vcc, 0x47800000, v27
  s_add_u32 m0, s29, 0x1a000
  v_mfma_f32_32x32x16_bf16 a[128:143], a[240:243], v[204:207], a[128:143]
  ds_read_b64_tr_b16 a[234:235], v18 offset:10240
  buffer_load_dwordx4 v22, s[16:19], s27 offen offset:0 nt lds
  s_cbranch_vccnz L1_caJ0
L1_raJ0:
  v_exp_f32 v218, v146
  v_add_f32 v28, v216, v217
  v_cvt_pk_bf16_f32 v200, v216, v217
  v_mfma_f32_32x32x16_bf16 a[144:159], a[244:247], v[204:207], a[144:159]
  ds_read_b64_tr_b16 a[236:237], v19 offset:8192
  v_exp_f32 v219, v147
  v_add_f32 v28, v28, v218
  v_add_f32 v25, v25, v27
  v_accvgpr_read_b32 v30, a23
  v_mfma_f32_32x32x16_bf16 a[160:175], a[248:251], v[204:207], a[160:175]
  ds_read_b64_tr_b16 a[238:239], v19 offset:10240
  buffer_load_dwordx4 v22, s[16:19], s27 offen offset:1024 nt lds
  v_exp_f32 v220, v148
  v_add_f32 v28, v28, v219
  v_cvt_pk_bf16_f32 v201, v218, v219
  v_mfma_f32_32x32x16_bf16 a[176:191], a[252:255], v[204:207], a[176:191]
  ds_read_b64_tr_b16 a[240:241], v16 offset:12288
  ds_read_b64_tr_b16 a[242:243], v16 offset:14336
  v_exp_f32 v221, v149
  v_add_f32 v28, v28, v220
  v_mul_f32 v29, s32, v29
  s_waitcnt lgkmcnt(10)
  v_mfma_f32_32x32x16_bf16 v[128:143], a[192:195], v[64:67], v[160:175]
  v_exp_f32 v222, v150
  v_add_f32 v28, v28, v221
  v_cvt_pk_bf16_f32 v202, v220, v221
  v_mul_f32 v30, s32, v30
  v_cvt_pk_bf16_f32 v30, v29, v30
  v_mfma_f32_32x32x16_bf16 v[128:143], a[196:199], v[68:71], v[128:143]
  ds_read_b64_tr_b16 a[244:245], v17 offset:12288
  ds_read_b64_tr_b16 a[246:247], v17 offset:14336
  v_exp_f32 v223, v151
  v_add_f32 v28, v28, v222
  v_mfma_f32_32x32x16_bf16 v[128:143], a[200:203], v[72:75], v[128:143]
  ds_read_b64_tr_b16 a[248:249], v18 offset:12288
  s_add_u32 s27, s27, 0x2000
  v_exp_f32 v216, v152
  v_add_f32 v28, v28, v223
  v_cvt_pk_bf16_f32 v203, v222, v223
  v_mfma_f32_32x32x16_bf16 v[128:143], a[204:207], v[76:79], v[128:143]
  ds_read_b64_tr_b16 a[250:251], v18 offset:14336
  ds_read_b64_tr_b16 a[252:253], v19 offset:12288
  v_exp_f32 v217, v153
  v_add_f32 v28, v28, v216
  v_mfma_f32_32x32x16_bf16 v[128:143], a[208:211], v[80:83], v[128:143]
  ds_read_b64_tr_b16 a[254:255], v19 offset:14336
  v_exp_f32 v218, v154
  v_add_f32 v28, v28, v217
  v_cvt_pk_bf16_f32 v204, v216, v217
  v_mfma_f32_32x32x16_bf16 v[128:143], a[212:215], v[84:87], v[128:143]
  v_exp_f32 v219, v155
  v_add_f32 v28, v28, v218
  v_permlane16_swap_b32 v4, v30
  v_accvgpr_write_b32 a9, v4
  v_mfma_f32_32x32x16_bf16 v[128:143], a[216:219], v[88:91], v[128:143]
  v_exp_f32 v220, v156
  v_add_f32 v28, v28, v219
  v_cvt_pk_bf16_f32 v205, v218, v219
  v_accvgpr_write_b32 a11, v30
  v_accvgpr_read_b32 v3, a24
  v_mfma_f32_32x32x16_bf16 v[128:143], a[220:223], v[92:95], v[128:143]
  v_exp_f32 v221, v157
  v_add_f32 v28, v28, v220
  v_accvgpr_read_b32 v4, a25
  v_accvgpr_read_b32 v29, a26
  v_accvgpr_read_b32 v30, a27
  s_waitcnt lgkmcnt(0)
  v_mfma_f32_32x32x16_bf16 v[224:239], a[224:227], v[192:195], v[224:239]
  v_exp_f32 v222, v158
  v_add_f32 v28, v28, v221
  v_cvt_pk_bf16_f32 v206, v220, v221
  v_mul_f32 v3, s32, v3
  v_mul_f32 v4, s32, v4
  v_mfma_f32_32x32x16_bf16 v[240:255], a[228:231], v[192:195], v[240:255]
  v_exp_f32 v223, v159
  v_add_f32 v28, v28, v222
  v_mul_f32 v29, s32, v29
  v_mul_f32 v30, s32, v30
  v_cvt_pk_bf16_f32 v3, v3, v4
  v_mfma_f32_32x32x16_bf16 v[32:47], a[232:235], v[192:195], v[32:47]
  v_exp_f32 v208, v128
  v_add_f32 v28, v28, v223
  v_cvt_pk_bf16_f32 v207, v222, v223
  v_cvt_pk_bf16_f32 v4, v29, v30
  v_accvgpr_read_b32 v29, a28
  v_mfma_f32_32x32x16_bf16 v[48:63], a[236:239], v[192:195], v[48:63]
  v_exp_f32 v209, v129
  v_cmp_nge_f32 vcc, 0x47800000, v28
  v_accvgpr_read_b32 v30, a29
  v_mul_f32 v29, s32, v29
  v_mul_f32 v30, s32, v30
  v_mfma_f32_32x32x16_bf16 v[224:239], a[240:243], v[196:199], v[224:239]
  s_cbranch_vccnz L1_cbJ1
L1_rbJ1:
  v_exp_f32 v210, v130
  v_add_f32 v27, v208, v209
  v_cvt_pk_bf16_f32 v192, v208, v209
  v_cvt_pk_bf16_f32 v29, v29, v30
  v_mfma_f32_32x32x16_bf16 v[240:255], a[244:247], v[196:199], v[240:255]
  v_exp_f32 v211, v131
  v_add_f32 v26, v26, v28
  v_add_f32 v27, v27, v210
  v_permlane16_swap_b32 v3, v29
  v_mfma_f32_32x32x16_bf16 v[32:47], a[248:251], v[196:199], v[32:47]
  v_exp_f32 v212, v132
  v_add_f32 v27, v27, v211
  v_cvt_pk_bf16_f32 v193, v210, v211
  v_accvgpr_write_b32 a12, v3
  v_accvgpr_write_b32 a14, v29
  v_mfma_f32_32x32x16_bf16 v[48:63], a[252:255], v[196:199], v[48:63]
  v_exp_f32 v213, v133
  v_add_f32 v27, v27, v212
  v_accvgpr_read_b32 v29, a30
  v_accvgpr_read_b32 v30, a31
  v_mul_f32 v29, s32, v29
  v_mfma_f32_32x32x16_bf16 v[144:159], a[192:195], v[96:99], v[176:191]
  v_exp_f32 v214, v134
  v_add_f32 v27, v27, v213
  v_cvt_pk_bf16_f32 v194, v212, v213
  v_mul_f32 v30, s32, v30
  v_cvt_pk_bf16_f32 v30, v29, v30
  v_mfma_f32_32x32x16_bf16 v[144:159], a[196:199], v[100:103], v[144:159]
  ds_read_b128 a[192:195], v8 offset:24576
  v_exp_f32 v215, v135
  v_add_f32 v27, v27, v214
  v_permlane16_swap_b32 v4, v30
  v_mfma_f32_32x32x16_bf16 v[144:159], a[200:203], v[104:107], v[144:159]
  ds_read_b128 a[196:199], v9 offset:24576
  v_exp_f32 v208, v136
  v_add_f32 v27, v27, v215
  v_cvt_pk_bf16_f32 v195, v214, v215
  v_accvgpr_write_b32 a13, v4
  v_mfma_f32_32x32x16_bf16 v[144:159], a[204:207], v[108:111], v[144:159]
  ds_read_b128 a[200:203], v10 offset:24576
  v_exp_f32 v209, v137
  v_add_f32 v27, v27, v208
  v_accvgpr_write_b32 a15, v30
  v_accvgpr_read_b32 v3, a32
  v_mfma_f32_32x32x16_bf16 v[144:159], a[208:211], v[112:115], v[144:159]
  ds_read_b128 a[204:207], v11 offset:24576
  v_exp_f32 v210, v138
  v_add_f32 v27, v27, v209
  v_cvt_pk_bf16_f32 v196, v208, v209
  v_accvgpr_read_b32 v4, a33
  v_mfma_f32_32x32x16_bf16 v[144:159], a[212:215], v[116:119], v[144:159]
  ds_read_b128 a[208:211], v12 offset:24576
  v_exp_f32 v211, v139
  v_add_f32 v27, v27, v210
  v_accvgpr_read_b32 v29, a34
  v_accvgpr_read_b32 v30, a35
  v_mfma_f32_32x32x16_bf16 v[144:159], a[216:219], v[120:123], v[144:159]
  ds_read_b128 a[212:215], v13 offset:24576
  v_exp_f32 v212, v140
  v_add_f32 v27, v27, v211
  v_cvt_pk_bf16_f32 v197, v210, v211
  v_mul_f32 v3, s32, v3
  v_mfma_f32_32x32x16_bf16 v[144:159], a[220:223], v[124:127], v[144:159]
  ds_read_b128 a[216:219], v14 offset:24576
  v_exp_f32 v213, v141
  v_add_f32 v27, v27, v212
  v_mul_f32 v4, s32, v4
  s_add_u32 m0, s29, 0xe000
  v_mfma_f32_32x32x16_bf16 a[128:143], a[224:227], v[200:203], a[128:143]
  ds_read_b128 a[220:223], v15 offset:24576
  buffer_load_dwordx4 v20, s[12:15], s27 offen offset:0 nt lds
  v_exp_f32 v214, v142
  v_add_f32 v27, v27, v213
  v_cvt_pk_bf16_f32 v198, v212, v213
  v_mfma_f32_32x32x16_bf16 a[144:159], a[228:231], v[200:203], a[144:159]
  ds_read_b64_tr_b16 a[224:225], v16 offset:16384
  ds_read_b64_tr_b16 a[226:227], v16 offset:18432
  v_exp_f32 v215, v143
  v_add_f32 v27, v27, v214
  v_mul_f32 v29, s32, v29
  v_mfma_f32_32x32x16_bf16 a[160:175], a[232:235], v[200:203], a[160:175]
  ds_read_b64_tr_b16 a[228:229], v17 offset:16384
  buffer_load_dwordx4 v21, s[12:15], s27 offen offset:1024 nt lds
  v_exp_f32 v216, v144
  v_add_f32 v27, v27, v215
  v_cvt_pk_bf16_f32 v199, v214, v215
  v_mfma_f32_32x32x16_bf16 a[176:191], a[236:239], v[200:203], a[176:191]
  ds_read_b64_tr_b16 a[230:231], v17 offset:18432
  ds_read_b64_tr_b16 a[232:233], v18 offset:16384
  v_exp_f32 v217, v145
  v_cmp_nge_f32 vcc, 0x47800000, v27
  s_add_u32 m0, s29, 0x1c000
  v_mfma_f32_32x32x16_bf16 a[128:143], a[240:243], v[204:207], a[128:143]
  ds_read_b64_tr_b16 a[234:235], v18 offset:18432
  buffer_load_dwordx4 v22, s[16:19], s27 offen offset:0 nt lds
  s_cbranch_vccnz L1_caJ1
L1_raJ1:
  v_exp_f32 v218, v146
  v_add_f32 v28, v216, v217
  v_cvt_pk_bf16_f32 v200, v216, v217
  v_mfma_f32_32x32x16_bf16 a[144:159], a[244:247], v[204:207], a[144:159]
  ds_read_b64_tr_b16 a[236:237], v19 offset:16384
  v_exp_f32 v219, v147
  v_add_f32 v28, v28, v218
  v_add_f32 v25, v25, v27
  v_mul_f32 v30, s32, v30
  v_mfma_f32_32x32x16_bf16 a[160:175], a[248:251], v[204:207], a[160:175]
  ds_read_b64_tr_b16 a[238:239], v19 offset:18432
  buffer_load_dwordx4 v22, s[16:19], s27 offen offset:1024 nt lds
  v_exp_f32 v220, v148
  v_add_f32 v28, v28, v219
  v_cvt_pk_bf16_f32 v201, v218, v219
  v_mfma_f32_32x32x16_bf16 a[176:191], a[252:255], v[204:207], a[176:191]
  ds_read_b64_tr_b16 a[240:241], v16 offset:20480
  ds_read_b64_tr_b16 a[242:243], v16 offset:22528
  v_exp_f32 v221, v149
  v_add_f32 v28, v28, v220
  v_cvt_pk_bf16_f32 v3, v3, v4
  s_waitcnt lgkmcnt(10)
  v_mfma_f32_32x32x16_bf16 v[128:143], a[192:195], v[64:67], v[160:175]
  v_exp_f32 v222, v150
  v_add_f32 v28, v28, v221
  v_cvt_pk_bf16_f32 v202, v220, v221
  v_cvt_pk_bf16_f32 v4, v29, v30
  v_accvgpr_read_b32 v29, a36
  v_mfma_f32_32x32x16_bf16 v[128:143], a[196:199], v[68:71], v[128:143]
  ds_read_b64_tr_b16 a[244:245], v17 offset:20480
  ds_read_b64_tr_b16 a[246:247], v17 offset:22528
  v_exp_f32 v223, v151
  v_add_f32 v28, v28, v222
  v_accvgpr_read_b32 v30, a37
  v_mfma_f32_32x32x16_bf16 v[128:143], a[200:203], v[72:75], v[128:143]
  ds_read_b64_tr_b16 a[248:249], v18 offset:20480
  s_add_u32 s27, s27, 0x2000
  v_exp_f32 v216, v152
  v_add_f32 v28, v28, v223
  v_cvt_pk_bf16_f32 v203, v222, v223
  v_mfma_f32_32x32x16_bf16 v[128:143], a[204:207], v[76:79], v[128:143]
  ds_read_b64_tr_b16 a[250:251], v18 offset:22528
  ds_read_b64_tr_b16 a[252:253], v19 offset:20480
  v_exp_f32 v217, v153
  v_add_f32 v28, v28, v216
  v_mul_f32 v29, s32, v29
  v_mfma_f32_32x32x16_bf16 v[128:143], a[208:211], v[80:83], v[128:143]
  ds_read_b64_tr_b16 a[254:255], v19 offset:22528
  v_exp_f32 v218, v154
  v_add_f32 v28, v28, v217
  v_cvt_pk_bf16_f32 v204, v216, v217
  v_mul_f32 v30, s32, v30
  v_mfma_f32_32x32x16_bf16 v[128:143], a[212:215], v[84:87], v[128:143]
  v_exp_f32 v219, v155
  v_add_f32 v28, v28, v218
  v_cvt_pk_bf16_f32 v29, v29, v30
  v_mfma_f32_32x32x16_bf16 v[128:143], a[216:219], v[88:91], v[128:143]
  v_exp_f32 v220, v156
  v_add_f32 v28, v28, v219
  v_cvt_pk_bf16_f32 v205, v218, v219
  v_permlane16_swap_b32 v3, v29
  v_mfma_f32_32x32x16_bf16 v[128:143], a[220:223], v[92:95], v[128:143]
  v_exp_f32 v221, v157
  v_add_f32 v28, v28, v220
  v_accvgpr_write_b32 a16, v3
  v_accvgpr_write_b32 a18, v29
  v_accvgpr_read_b32 v29, a38
  s_waitcnt lgkmcnt(0)
  v_mfma_f32_32x32x16_bf16 v[224:239], a[224:227], v[192:195], v[224:239]
  v_exp_f32 v222, v158
  v_add_f32 v28, v28, v221
  v_cvt_pk_bf16_f32 v206, v220, v221
  v_accvgpr_read_b32 v30, a39
  v_mul_f32 v29, s32, v29
  v_mfma_f32_32x32x16_bf16 v[240:255], a[228:231], v[192:195], v[240:255]
  v_exp_f32 v223, v159
  v_add_f32 v28, v28, v222
  v_mul_f32 v30, s32, v30
  v_cvt_pk_bf16_f32 v30, v29, v30
  v_mfma_f32_32x32x16_bf16 v[32:47], a[232:235], v[192:195], v[32:47]
  v_exp_f32 v208, v128
  v_add_f32 v28, v28, v223
  v_cvt_pk_bf16_f32 v207, v222, v223
  v_permlane16_swap_b32 v4, v30
  v_mfma_f32_32x32x16_bf16 v[48:63], a[236:239], v[192:195], v[48:63]
  v_exp_f32 v209, v129
  v_cmp_nge_f32 vcc, 0x47800000, v28
  v_accvgpr_write_b32 a17, v4
  v_accvgpr_write_b32 a19, v30
  v_accvgpr_read_b32 v3, a40
  v_mfma_f32_32x32x16_bf16 v[224:239], a[240:243], v[196:199], v[224:239]
  s_cbranch_vccnz L1_cbJ2
L1_rbJ2:
  v_exp_f32 v210, v130
  v_add_f32 v27, v208, v209
  v_cvt_pk_bf16_f32 v192, v208, v209
  v_accvgpr_read_b32 v4, a41
  v_mfma_f32_32x32x16_bf16 v[240:255], a[244:247], v[196:199], v[240:255]
  v_exp_f32 v211, v131
  v_add_f32 v26, v26, v28
  v_add_f32 v27, v27, v210
  v_accvgpr_read_b32 v29, a42
  v_accvgpr_read_b32 v30, a43
  v_mfma_f32_32x32x16_bf16 v[32:47], a[248:251], v[196:199], v[32:47]
  v_exp_f32 v212, v132
  v_add_f32 v27, v27, v211
  v_cvt_pk_bf16_f32 v193, v210, v211
  v_mul_f32 v3, s32, v3
  v_mul_f32 v4, s32, v4
  v_mfma_f32_32x32x16_bf16 v[48:63], a[252:255], v[196:199], v[48:63]
  v_exp_f32 v213, v133
  v_add_f32 v27, v27, v212
  v_mul_f32 v29, s32, v29
  v_mul_f32 v30, s32, v30
  v_cvt_pk_bf16_f32 v3, v3, v4
  v_mfma_f32_32x32x16_bf16 v[144:159], a[192:195], v[96:99], v[176:191]
  s_waitcnt vmcnt(8)
  s_barrier
  v_exp_f32 v214, v134
  v_add_f32 v27, v27, v213
  v_cvt_pk_bf16_f32 v194, v212, v213
  v_cvt_pk_bf16_f32 v4, v29, v30
  v_mfma_f32_32x32x16_bf16 v[144:159], a[196:199], v[100:103], v[144:159]
  ds_read_b128 a[192:195], v8 offset:32768
  v_exp_f32 v215, v135
  v_add_f32 v27, v27, v214
  v_accvgpr_read_b32 v29, a44
  v_accvgpr_read_b32 v30, a45
  v_mfma_f32_32x32x16_bf16 v[144:159], a[200:203], v[104:107], v[144:159]
  ds_read_b128 a[196:199], v9 offset:32768
  v_exp_f32 v208, v136
  v_add_f32 v27, v27, v215
  v_cvt_pk_bf16_f32 v195, v214, v215
  v_mul_f32 v29, s32, v29
  v_mfma_f32_32x32x16_bf16 v[144:159], a[204:207], v[108:111], v[144:159]
  ds_read_b128 a[200:203], v10 offset:32768
  v_exp_f32 v209, v137
  v_add_f32 v27, v27, v208
  v_mul_f32 v30, s32, v30
  v_cvt_pk_bf16_f32 v29, v29, v30
  v_mfma_f32_32x32x16_bf16 v[144:159], a[208:211], v[112:115], v[144:159]
  ds_read_b128 a[204:207], v11 offset:32768
  v_exp_f32 v210, v138
  v_add_f32 v27, v27, v209
  v_cvt_pk_bf16_f32 v196, v208, v209
  v_mfma_f32_32x32x16_bf16 v[144:159], a[212:215], v[116:119], v[144:159]
  ds_read_b128 a[208:211], v12 offset:32768
  v_exp_f32 v211, v139
  v_add_f32 v27, v27, v210
  v_permlane16_swap_b32 v3, v29
  v_mfma_f32_32x32x16_bf16 v[144:159], a[216:219], v[120:123], v[144:159]
  ds_read_b128 a[212:215], v13 offset:32768
  v_exp_f32 v212, v140
  v_add_f32 v27, v27, v211
  v_cvt_pk_bf16_f32 v197, v210, v211
  v_accvgpr_write_b32 a20, v3
  v_mfma_f32_32x32x16_bf16 v[144:159], a[220:223], v[124:127], v[144:159]
  ds_read_b128 a[216:219], v14 offset:32768
  v_exp_f32 v213, v141
  v_add_f32 v27, v27, v212
  v_accvgpr_write_b32 a22, v29
  s_add_u32 m0, s29, 0x0
  v_mfma_f32_32x32x16_bf16 a[128:143], a[224:227], v[200:203], a[128:143]
  ds_read_b128 a[220:223], v15 offset:32768
  buffer_load_dwordx4 v20, s[12:15], s27 offen offset:0 nt lds
  v_exp_f32 v214, v142
  v_add_f32 v27, v27, v213
  v_cvt_pk_bf16_f32 v198, v212, v213
  v_mfma_f32_32x32x16_bf16 a[144:159], a[228:231], v[200:203], a[144:159]
  ds_read_b64_tr_b16 a[224:225], v16 offset:24576
  ds_read_b64_tr_b16 a[226:227], v16 offset:26624
  v_exp_f32 v215, v143
  v_add_f32 v27, v27, v214
  v_accvgpr_read_b32 v29, a46
  v_mfma_f32_32x32x16_bf16 a[160:175], a[232:235], v[200:203], a[160:175]
  ds_read_b64_tr_b16 a[228:229], v17 offset:24576
  buffer_load_dwordx4 v21, s[12:15], s27 offen offset:1024 nt lds
  v_exp_f32 v216, v144
  v_add_f32 v27, v27, v215
  v_cvt_pk_bf16_f32 v199, v214, v215
  v_mfma_f32_32x32x16_bf16 a[176:191], a[236:239], v[200:203], a[176:191]
  ds_read_b64_tr_b16 a[230:231], v17 offset:26624
  ds_read_b64_tr_b16 a[232:233], v18 offset:24576
  v_exp_f32 v217, v145
  v_cmp_nge_f32 vcc, 0x47800000, v27
  s_add_u32 m0, s29, 0x1e000
  v_mfma_f32_32x32x16_bf16 a[128:143], a[240:243], v[204:207], a[128:143]
  ds_read_b64_tr_b16 a[234:235], v18 offset:26624
  buffer_load_dwordx4 v22, s[16:19], s27 offen offset:0 nt lds
  s_cbranch_vccnz L1_caJ2
L1_raJ2:
  v_exp_f32 v218, v146
  v_add_f32 v28, v216, v217
  v_cvt_pk_bf16_f32 v200, v216, v217
  v_mfma_f32_32x32x16_bf16 a[144:159], a[244:247], v[204:207], a[144:159]
  ds_read_b64_tr_b16 a[236:237], v19 offset:24576
  v_exp_f32 v219, v147
  v_add_f32 v28, v28, v218
  v_add_f32 v25, v25, v27
  v_accvgpr_read_b32 v30, a47
  v_mfma_f32_32x32x16_bf16 a[160:175], a[248:251], v[204:207], a[160:175]
  ds_read_b64_tr_b16 a[238:239], v19 offset:26624
  buffer_load_dwordx4 v22, s[16:19], s27 offen offset:1024 nt lds
  v_exp_f32 v220, v148
  v_add_f32 v28, v28, v219
  v_cvt_pk_bf16_f32 v201, v218, v219
  v_mfma_f32_32x32x16_bf16 a[176:191], a[252:255], v[204:207], a[176:191]
  ds_read_b64_tr_b16 a[240:241], v16 offset:28672
  ds_read_b64_tr_b16 a[242:243], v16 offset:30720
  v_exp_f32 v221, v149
  v_add_f32 v28, v28, v220
  v_mul_f32 v29, s32, v29
  s_waitcnt lgkmcnt(10)
  v_mfma_f32_32x32x16_bf16 v[128:143], a[192:195], v[64:67], v[160:175]
  v_exp_f32 v222, v150
  v_add_f32 v28, v28, v221
  v_cvt_pk_bf16_f32 v202, v220, v221
  v_mul_f32 v30, s32, v30
  v_cvt_pk_bf16_f32 v30, v29, v30
  v_mfma_f32_32x32x16_bf16 v[128:143], a[196:199], v[68:71], v[128:143]
  ds_read_b64_tr_b16 a[244:245], v17 offset:28672
  ds_read_b64_tr_b16 a[246:247], v17 offset:30720
  v_exp_f32 v223, v151
  v_add_f32 v28, v28, v222
  v_mfma_f32_32x32x16_bf16 v[128:143], a[200:203], v[72:75], v[128:143]
  ds_read_b64_tr_b16 a[248:249], v18 offset:28672
  s_add_u32 s27, s27, 0x2000
  v_exp_f32 v216, v152
  v_add_f32 v28, v28, v223
  v_cvt_pk_bf16_f32 v203, v222, v223
  v_mfma_f32_32x32x16_bf16 v[128:143], a[204:207], v[76:79], v[128:143]
  ds_read_b64_tr_b16 a[250:251], v18 offset:30720
  ds_read_b64_tr_b16 a[252:253], v19 offset:28672
  v_exp_f32 v217, v153
  v_add_f32 v28, v28, v216
  v_mfma_f32_32x32x16_bf16 v[128:143], a[208:211], v[80:83], v[128:143]
  ds_read_b64_tr_b16 a[254:255], v19 offset:30720
  v_exp_f32 v218, v154
  v_add_f32 v28, v28, v217
  v_cvt_pk_bf16_f32 v204, v216, v217
  v_mfma_f32_32x32x16_bf16 v[128:143], a[212:215], v[84:87], v[128:143]
  v_exp_f32 v219, v155
  v_add_f32 v28, v28, v218
  v_permlane16_swap_b32 v4, v30
  v_accvgpr_write_b32 a21, v4
  v_mfma_f32_32x32x16_bf16 v[128:143], a[216:219], v[88:91], v[128:143]
  v_exp_f32 v220, v156
  v_add_f32 v28, v28, v219
  v_cvt_pk_bf16_f32 v205, v218, v219
  v_accvgpr_write_b32 a23, v30
  v_accvgpr_read_b32 v3, a48
  v_mfma_f32_32x32x16_bf16 v[128:143], a[220:223], v[92:95], v[128:143]
  v_exp_f32 v221, v157
  v_add_f32 v28, v28, v220
  v_accvgpr_read_b32 v4, a49
  v_accvgpr_read_b32 v29, a50
  v_accvgpr_read_b32 v30, a51
  s_waitcnt lgkmcnt(0)
  v_mfma_f32_32x32x16_bf16 v[224:239], a[224:227], v[192:195], v[224:239]
  v_exp_f32 v222, v158
  v_add_f32 v28, v28, v221
  v_cvt_pk_bf16_f32 v206, v220, v221
  v_mul_f32 v3, s32, v3
  v_mul_f32 v4, s32, v4
  v_mfma_f32_32x32x16_bf16 v[240:255], a[228:231], v[192:195], v[240:255]
  v_exp_f32 v223, v159
  v_add_f32 v28, v28, v222
  v_mul_f32 v29, s32, v29
  v_mul_f32 v30, s32, v30
  v_cvt_pk_bf16_f32 v3, v3, v4
  v_mfma_f32_32x32x16_bf16 v[32:47], a[232:235], v[192:195], v[32:47]
  v_exp_f32 v208, v128
  v_add_f32 v28, v28, v223
  v_cvt_pk_bf16_f32 v207, v222, v223
  v_cvt_pk_bf16_f32 v4, v29, v30
  v_accvgpr_read_b32 v29, a52
  v_mfma_f32_32x32x16_bf16 v[48:63], a[236:239], v[192:195], v[48:63]
  v_exp_f32 v209, v129
  v_cmp_nge_f32 vcc, 0x47800000, v28
  v_accvgpr_read_b32 v30, a53
  v_mul_f32 v29, s32, v29
  v_mul_f32 v30, s32, v30
  v_mfma_f32_32x32x16_bf16 v[224:239], a[240:243], v[196:199], v[224:239]
  s_cbranch_vccnz L1_cbJ3
L1_rbJ3:
  v_exp_f32 v210, v130
  v_add_f32 v27, v208, v209
  v_cvt_pk_bf16_f32 v192, v208, v209
  v_cvt_pk_bf16_f32 v29, v29, v30
  v_mfma_f32_32x32x16_bf16 v[240:255], a[244:247], v[196:199], v[240:255]
  v_exp_f32 v211, v131
  v_add_f32 v26, v26, v28
  v_add_f32 v27, v27, v210
  v_permlane16_swap_b32 v3, v29
  v_mfma_f32_32x32x16_bf16 v[32:47], a[248:251], v[196:199], v[32:47]
  v_exp_f32 v212, v132
  v_add_f32 v27, v27, v211
  v_cvt_pk_bf16_f32 v193, v210, v211
  v_accvgpr_write_b32 a24, v3
  v_accvgpr_write_b32 a26, v29
  v_mfma_f32_32x32x16_bf16 v[48:63], a[252:255], v[196:199], v[48:63]
  v_exp_f32 v213, v133
  v_add_f32 v27, v27, v212
  v_accvgpr_read_b32 v29, a54
  v_accvgpr_read_b32 v30, a55
  v_mul_f32 v29, s32, v29
  v_mfma_f32_32x32x16_bf16 v[144:159], a[192:195], v[96:99], v[176:191]
  v_exp_f32 v214, v134
  v_add_f32 v27, v27, v213
  v_cvt_pk_bf16_f32 v194, v212, v213
  v_mul_f32 v30, s32, v30
  v_cvt_pk_bf16_f32 v30, v29, v30
  v_mfma_f32_32x32x16_bf16 v[144:159], a[196:199], v[100:103], v[144:159]
  ds_read_b128 a[192:195], v8 offset:40960
  v_exp_f32 v215, v135
  v_add_f32 v27, v27, v214
  v_permlane16_swap_b32 v4, v30
  v_mfma_f32_32x32x16_bf16 v[144:159], a[200:203], v[104:107], v[144:159]
  ds_read_b128 a[196:199], v9 offset:40960
  v_exp_f32 v208, v136
  v_add_f32 v27, v27, v215
  v_cvt_pk_bf16_f32 v195, v214, v215
  v_accvgpr_write_b32 a25, v4
  v_mfma_f32_32x32x16_bf16 v[144:159], a[204:207], v[108:111], v[144:159]
  ds_read_b128 a[200:203], v10 offset:40960
  v_exp_f32 v209, v137
  v_add_f32 v27, v27, v208
  v_accvgpr_write_b32 a27, v30
  v_accvgpr_read_b32 v3, a56
  v_mfma_f32_32x32x16_bf16 v[144:159], a[208:211], v[112:115], v[144:159]
  ds_read_b128 a[204:207], v11 offset:40960
  v_exp_f32 v210, v138
  v_add_f32 v27, v27, v209
  v_cvt_pk_bf16_f32 v196, v208, v209
  v_accvgpr_read_b32 v4, a57
  v_mfma_f32_32x32x16_bf16 v[144:159], a[212:215], v[116:119], v[144:159]
  ds_read_b128 a[208:211], v12 offset:40960
  v_exp_f32 v211, v139
  v_add_f32 v27, v27, v210
  v_accvgpr_read_b32 v29, a58
  v_accvgpr_read_b32 v30, a59
  v_mfma_f32_32x32x16_bf16 v[144:159], a[216:219], v[120:123], v[144:159]
  ds_read_b128 a[212:215], v13 offset:40960
  v_exp_f32 v212, v140
  v_add_f32 v27, v27, v211
  v_cvt_pk_bf16_f32 v197, v210, v211
  v_mul_f32 v3, s32, v3
  v_mfma_f32_32x32x16_bf16 v[144:159], a[220:223], v[124:127], v[144:159]
  ds_read_b128 a[216:219], v14 offset:40960
  v_exp_f32 v213, v141
  v_add_f32 v27, v27, v212
  v_mul_f32 v4, s32, v4
  s_add_u32 m0, s29, 0x2000
  v_mfma_f32_32x32x16_bf16 a[128:143], a[224:227], v[200:203], a[128:143]
  ds_read_b128 a[220:223], v15 offset:40960
  buffer_load_dwordx4 v20, s[12:15], s27 offen offset:0 nt lds
  v_exp_f32 v214, v142
  v_add_f32 v27, v27, v213
  v_cvt_pk_bf16_f32 v198, v212, v213
  v_mfma_f32_32x32x16_bf16 a[144:159], a[228:231], v[200:203], a[144:159]
  ds_read_b64_tr_b16 a[224:225], v16 offset:32768
  ds_read_b64_tr_b16 a[226:227], v16 offset:34816
  v_exp_f32 v215, v143
  v_add_f32 v27, v27, v214
  v_mul_f32 v29, s32, v29
  v_mfma_f32_32x32x16_bf16 a[160:175], a[232:235], v[200:203], a[160:175]
  ds_read_b64_tr_b16 a[228:229], v17 offset:32768
  buffer_load_dwordx4 v21, s[12:15], s27 offen offset:1024 nt lds
  v_exp_f32 v216, v144
  v_add_f32 v27, v27, v215
  v_cvt_pk_bf16_f32 v199, v214, v215
  v_mfma_f32_32x32x16_bf16 a[176:191], a[236:239], v[200:203], a[176:191]
  ds_read_b64_tr_b16 a[230:231], v17 offset:34816
  ds_read_b64_tr_b16 a[232:233], v18 offset:32768
  v_exp_f32 v217, v145
  v_cmp_nge_f32 vcc, 0x47800000, v27
  s_add_u32 m0, s29, 0x10000
  v_mfma_f32_32x32x16_bf16 a[128:143], a[240:243], v[204:207], a[128:143]
  ds_read_b64_tr_b16 a[234:235], v18 offset:34816
  buffer_load_dwordx4 v22, s[16:19], s27 offen offset:0 nt lds
  s_cbranch_vccnz L1_caJ3
L1_raJ3:
  v_exp_f32 v218, v146
  v_add_f32 v28, v216, v217
  v_cvt_pk_bf16_f32 v200, v216, v217
  v_mfma_f32_32x32x16_bf16 a[144:159], a[244:247], v[204:207], a[144:159]
  ds_read_b64_tr_b16 a[236:237], v19 offset:32768
  v_exp_f32 v219, v147
  v_add_f32 v28, v28, v218
  v_add_f32 v25, v25, v27
  v_mul_f32 v30, s32, v30
  v_mfma_f32_32x32x16_bf16 a[160:175], a[248:251], v[204:207], a[160:175]
  ds_read_b64_tr_b16 a[238:239], v19 offset:34816
  buffer_load_dwordx4 v22, s[16:19], s27 offen offset:1024 nt lds
  v_exp_f32 v220, v148
  v_add_f32 v28, v28, v219
  v_cvt_pk_bf16_f32 v201, v218, v219
  v_mfma_f32_32x32x16_bf16 a[176:191], a[252:255], v[204:207], a[176:191]
  ds_read_b64_tr_b16 a[240:241], v16 offset:36864
  ds_read_b64_tr_b16 a[242:243], v16 offset:38912
  v_exp_f32 v221, v149
  v_add_f32 v28, v28, v220
  v_cvt_pk_bf16_f32 v3, v3, v4
  s_waitcnt lgkmcnt(10)
  v_mfma_f32_32x32x16_bf16 v[128:143], a[192:195], v[64:67], v[160:175]
  v_exp_f32 v222, v150
  v_add_f32 v28, v28, v221
  v_cvt_pk_bf16_f32 v202, v220, v221
  v_cvt_pk_bf16_f32 v4, v29, v30
  v_accvgpr_read_b32 v29, a60
  v_mfma_f32_32x32x16_bf16 v[128:143], a[196:199], v[68:71], v[128:143]
  ds_read_b64_tr_b16 a[244:245], v17 offset:36864
  ds_read_b64_tr_b16 a[246:247], v17 offset:38912
  v_exp_f32 v223, v151
  v_add_f32 v28, v28, v222
  v_accvgpr_read_b32 v30, a61
  v_mfma_f32_32x32x16_bf16 v[128:143], a[200:203], v[72:75], v[128:143]
  ds_read_b64_tr_b16 a[248:249], v18 offset:36864
  s_add_u32 s27, s27, 0x2000
  v_exp_f32 v216, v152
  v_add_f32 v28, v28, v223
  v_cvt_pk_bf16_f32 v203, v222, v223
  v_mfma_f32_32x32x16_bf16 v[128:143], a[204:207], v[76:79], v[128:143]
  ds_read_b64_tr_b16 a[250:251], v18 offset:38912
  ds_read_b64_tr_b16 a[252:253], v19 offset:36864
  v_exp_f32 v217, v153
  v_add_f32 v28, v28, v216
  v_mul_f32 v29, s32, v29
  v_mfma_f32_32x32x16_bf16 v[128:143], a[208:211], v[80:83], v[128:143]
  ds_read_b64_tr_b16 a[254:255], v19 offset:38912
  v_exp_f32 v218, v154
  v_add_f32 v28, v28, v217
  v_cvt_pk_bf16_f32 v204, v216, v217
  v_mul_f32 v30, s32, v30
  v_mfma_f32_32x32x16_bf16 v[128:143], a[212:215], v[84:87], v[128:143]
  v_exp_f32 v219, v155
  v_add_f32 v28, v28, v218
  v_cvt_pk_bf16_f32 v29, v29, v30
  v_mfma_f32_32x32x16_bf16 v[128:143], a[216:219], v[88:91], v[128:143]
  v_exp_f32 v220, v156
  v_add_f32 v28, v28, v219
  v_cvt_pk_bf16_f32 v205, v218, v219
  v_permlane16_swap_b32 v3, v29
  v_mfma_f32_32x32x16_bf16 v[128:143], a[220:223], v[92:95], v[128:143]
  v_exp_f32 v221, v157
  v_add_f32 v28, v28, v220
  v_accvgpr_write_b32 a28, v3
  v_accvgpr_write_b32 a30, v29
  v_accvgpr_read_b32 v29, a62
  s_waitcnt lgkmcnt(0)
  v_mfma_f32_32x32x16_bf16 v[224:239], a[224:227], v[192:195], v[224:239]
  v_exp_f32 v222, v158
  v_add_f32 v28, v28, v221
  v_cvt_pk_bf16_f32 v206, v220, v221
  v_accvgpr_read_b32 v30, a63
  v_mul_f32 v29, s32, v29
  v_mfma_f32_32x32x16_bf16 v[240:255], a[228:231], v[192:195], v[240:255]
  v_exp_f32 v223, v159
  v_add_f32 v28, v28, v222
  v_mul_f32 v30, s32, v30
  v_cvt_pk_bf16_f32 v30, v29, v30
  v_mfma_f32_32x32x16_bf16 v[32:47], a[232:235], v[192:195], v[32:47]
  v_exp_f32 v208, v128
  v_add_f32 v28, v28, v223
  v_cvt_pk_bf16_f32 v207, v222, v223
  v_permlane16_swap_b32 v4, v30
  v_mfma_f32_32x32x16_bf16 v[48:63], a[236:239], v[192:195], v[48:63]
  v_exp_f32 v209, v129
  v_cmp_nge_f32 vcc, 0x47800000, v28
  v_accvgpr_write_b32 a29, v4
  v_accvgpr_write_b32 a31, v30
  v_accvgpr_read_b32 v3, a64
  v_mfma_f32_32x32x16_bf16 v[224:239], a[240:243], v[196:199], v[224:239]
  s_cbranch_vccnz L1_cbJ4
L1_rbJ4:
  v_exp_f32 v210, v130
  v_add_f32 v27, v208, v209
  v_cvt_pk_bf16_f32 v192, v208, v209
  v_accvgpr_read_b32 v4, a65
  v_mfma_f32_32x32x16_bf16 v[240:255], a[244:247], v[196:199], v[240:255]
  v_exp_f32 v211, v131
  v_add_f32 v26, v26, v28
  v_add_f32 v27, v27, v210
  v_accvgpr_read_b32 v29, a66
  v_accvgpr_read_b32 v30, a67
  v_mfma_f32_32x32x16_bf16 v[32:47], a[248:251], v[196:199], v[32:47]
  v_exp_f32 v212, v132
  v_add_f32 v27, v27, v211
  v_cvt_pk_bf16_f32 v193, v210, v211
  v_mul_f32 v3, s32, v3
  v_mul_f32 v4, s32, v4
  v_mfma_f32_32x32x16_bf16 v[48:63], a[252:255], v[196:199], v[48:63]
  v_exp_f32 v213, v133
  v_add_f32 v27, v27, v212
  v_mul_f32 v29, s32, v29
  v_mul_f32 v30, s32, v30
  v_cvt_pk_bf16_f32 v3, v3, v4
  v_mfma_f32_32x32x16_bf16 v[144:159], a[192:195], v[96:99], v[176:191]
  s_waitcnt vmcnt(8)
  s_barrier
  v_exp_f32 v214, v134
  v_add_f32 v27, v27, v213
  v_cvt_pk_bf16_f32 v194, v212, v213
  v_cvt_pk_bf16_f32 v4, v29, v30
  v_mfma_f32_32x32x16_bf16 v[144:159], a[196:199], v[100:103], v[144:159]
  ds_read_b128 a[192:195], v8 offset:49152
  v_exp_f32 v215, v135
  v_add_f32 v27, v27, v214
  v_accvgpr_read_b32 v29, a68
  v_accvgpr_read_b32 v30, a69
  v_mfma_f32_32x32x16_bf16 v[144:159], a[200:203], v[104:107], v[144:159]
  ds_read_b128 a[196:199], v9 offset:49152
  v_exp_f32 v208, v136
  v_add_f32 v27, v27, v215
  v_cvt_pk_bf16_f32 v195, v214, v215
  v_mul_f32 v29, s32, v29
  v_mfma_f32_32x32x16_bf16 v[144:159], a[204:207], v[108:111], v[144:159]
  ds_read_b128 a[200:203], v10 offset:49152
  v_exp_f32 v209, v137
  v_add_f32 v27, v27, v208
  v_mul_f32 v30, s32, v30
  v_cvt_pk_bf16_f32 v29, v29, v30
  v_mfma_f32_32x32x16_bf16 v[144:159], a[208:211], v[112:115], v[144:159]
  ds_read_b128 a[204:207], v11 offset:49152
  v_exp_f32 v210, v138
  v_add_f32 v27, v27, v209
  v_cvt_pk_bf16_f32 v196, v208, v209
  v_mfma_f32_32x32x16_bf16 v[144:159], a[212:215], v[116:119], v[144:159]
  ds_read_b128 a[208:211], v12 offset:49152
  v_exp_f32 v211, v139
  v_add_f32 v27, v27, v210
  v_permlane16_swap_b32 v3, v29
  v_mfma_f32_32x32x16_bf16 v[144:159], a[216:219], v[120:123], v[144:159]
  ds_read_b128 a[212:215], v13 offset:49152
  v_exp_f32 v212, v140
  v_add_f32 v27, v27, v211
  v_cvt_pk_bf16_f32 v197, v210, v211
  v_accvgpr_write_b32 a32, v3
  v_mfma_f32_32x32x16_bf16 v[144:159], a[220:223], v[124:127], v[144:159]
  ds_read_b128 a[216:219], v14 offset:49152
  v_exp_f32 v213, v141
  v_add_f32 v27, v27, v212
  v_accvgpr_write_b32 a34, v29
  s_add_u32 m0, s29, 0x4000
  v_mfma_f32_32x32x16_bf16 a[128:143], a[224:227], v[200:203], a[128:143]
  ds_read_b128 a[220:223], v15 offset:49152
  buffer_load_dwordx4 v20, s[12:15], s27 offen offset:0 nt lds
  v_exp_f32 v214, v142
  v_add_f32 v27, v27, v213
  v_cvt_pk_bf16_f32 v198, v212, v213
  v_mfma_f32_32x32x16_bf16 a[144:159], a[228:231], v[200:203], a[144:159]
  ds_read_b64_tr_b16 a[224:225], v16 offset:40960
  ds_read_b64_tr_b16 a[226:227], v16 offset:43008
  v_exp_f32 v215, v143
  v_add_f32 v27, v27, v214
  v_accvgpr_read_b32 v29, a70
  v_mfma_f32_32x32x16_bf16 a[160:175], a[232:235], v[200:203], a[160:175]
  ds_read_b64_tr_b16 a[228:229], v17 offset:40960
  buffer_load_dwordx4 v21, s[12:15], s27 offen offset:1024 nt lds
  v_exp_f32 v216, v144
  v_add_f32 v27, v27, v215
  v_cvt_pk_bf16_f32 v199, v214, v215
  v_mfma_f32_32x32x16_bf16 a[176:191], a[236:239], v[200:203], a[176:191]
  ds_read_b64_tr_b16 a[230:231], v17 offset:43008
  ds_read_b64_tr_b16 a[232:233], v18 offset:40960
  v_exp_f32 v217, v145
  v_cmp_nge_f32 vcc, 0x47800000, v27
  s_add_u32 m0, s29, 0x12000
  v_mfma_f32_32x32x16_bf16 a[128:143], a[240:243], v[204:207], a[128:143]
  ds_read_b64_tr_b16 a[234:235], v18 offset:43008
  buffer_load_dwordx4 v22, s[16:19], s27 offen offset:0 nt lds
  s_cbranch_vccnz L1_caJ4
L1_raJ4:
  v_exp_f32 v218, v146
  v_add_f32 v28, v216, v217
  v_cvt_pk_bf16_f32 v200, v216, v217
  v_mfma_f32_32x32x16_bf16 a[144:159], a[244:247], v[204:207], a[144:159]
  ds_read_b64_tr_b16 a[236:237], v19 offset:40960
  v_exp_f32 v219, v147
  v_add_f32 v28, v28, v218
  v_add_f32 v25, v25, v27
  v_accvgpr_read_b32 v30, a71
  v_mfma_f32_32x32x16_bf16 a[160:175], a[248:251], v[204:207], a[160:175]
  ds_read_b64_tr_b16 a[238:239], v19 offset:43008
  buffer_load_dwordx4 v22, s[16:19], s27 offen offset:1024 nt lds
  v_exp_f32 v220, v148
  v_add_f32 v28, v28, v219
  v_cvt_pk_bf16_f32 v201, v218, v219
  v_mfma_f32_32x32x16_bf16 a[176:191], a[252:255], v[204:207], a[176:191]
  ds_read_b64_tr_b16 a[240:241], v16 offset:45056
  ds_read_b64_tr_b16 a[242:243], v16 offset:47104
  v_exp_f32 v221, v149
  v_add_f32 v28, v28, v220
  v_mul_f32 v29, s32, v29
  s_waitcnt lgkmcnt(10)
  v_mfma_f32_32x32x16_bf16 v[128:143], a[192:195], v[64:67], v[160:175]
  v_exp_f32 v222, v150
  v_add_f32 v28, v28, v221
  v_cvt_pk_bf16_f32 v202, v220, v221
  v_mul_f32 v30, s32, v30
  v_cvt_pk_bf16_f32 v30, v29, v30
  v_mfma_f32_32x32x16_bf16 v[128:143], a[196:199], v[68:71], v[128:143]
  ds_read_b64_tr_b16 a[244:245], v17 offset:45056
  ds_read_b64_tr_b16 a[246:247], v17 offset:47104
  v_exp_f32 v223, v151
  v_add_f32 v28, v28, v222
  v_mfma_f32_32x32x16_bf16 v[128:143], a[200:203], v[72:75], v[128:143]
  ds_read_b64_tr_b16 a[248:249], v18 offset:45056
  s_add_u32 s27, s27, 0x2000
  v_exp_f32 v216, v152
  v_add_f32 v28, v28, v223
  v_cvt_pk_bf16_f32 v203, v222, v223
  v_mfma_f32_32x32x16_bf16 v[128:143], a[204:207], v[76:79], v[128:143]
  ds_read_b64_tr_b16 a[250:251], v18 offset:47104
  ds_read_b64_tr_b16 a[252:253], v19 offset:45056
  v_exp_f32 v217, v153
  v_add_f32 v28, v28, v216
  v_mfma_f32_32x32x16_bf16 v[128:143], a[208:211], v[80:83], v[128:143]
  ds_read_b64_tr_b16 a[254:255], v19 offset:47104
  v_exp_f32 v218, v154
  v_add_f32 v28, v28, v217
  v_cvt_pk_bf16_f32 v204, v216, v217
  v_mfma_f32_32x32x16_bf16 v[128:143], a[212:215], v[84:87], v[128:143]
  v_exp_f32 v219, v155
  v_add_f32 v28, v28, v218
  v_permlane16_swap_b32 v4, v30
  v_accvgpr_write_b32 a33, v4
  v_mfma_f32_32x32x16_bf16 v[128:143], a[216:219], v[88:91], v[128:143]
  v_exp_f32 v220, v156
  v_add_f32 v28, v28, v219
  v_cvt_pk_bf16_f32 v205, v218, v219
  v_accvgpr_write_b32 a35, v30
  v_accvgpr_read_b32 v3, a72
  v_mfma_f32_32x32x16_bf16 v[128:143], a[220:223], v[92:95], v[128:143]
  v_exp_f32 v221, v157
  v_add_f32 v28, v28, v220
  v_accvgpr_read_b32 v4, a73
  v_accvgpr_read_b32 v29, a74
  v_accvgpr_read_b32 v30, a75
  s_waitcnt lgkmcnt(0)
  v_mfma_f32_32x32x16_bf16 v[224:239], a[224:227], v[192:195], v[224:239]
  v_exp_f32 v222, v158
  v_add_f32 v28, v28, v221
  v_cvt_pk_bf16_f32 v206, v220, v221
  v_mul_f32 v3, s32, v3
  v_mul_f32 v4, s32, v4
  v_mfma_f32_32x32x16_bf16 v[240:255], a[228:231], v[192:195], v[240:255]
  v_exp_f32 v223, v159
  v_add_f32 v28, v28, v222
  v_mul_f32 v29, s32, v29
  v_mul_f32 v30, s32, v30
  v_cvt_pk_bf16_f32 v3, v3, v4
  v_mfma_f32_32x32x16_bf16 v[32:47], a[232:235], v[192:195], v[32:47]
  v_exp_f32 v208, v128
  v_add_f32 v28, v28, v223
  v_cvt_pk_bf16_f32 v207, v222, v223
  v_cvt_pk_bf16_f32 v4, v29, v30
  v_accvgpr_read_b32 v29, a76
  v_mfma_f32_32x32x16_bf16 v[48:63], a[236:239], v[192:195], v[48:63]
  v_exp_f32 v209, v129
  v_cmp_nge_f32 vcc, 0x47800000, v28
  v_accvgpr_read_b32 v30, a77
  v_mul_f32 v29, s32, v29
  v_mul_f32 v30, s32, v30
  v_mfma_f32_32x32x16_bf16 v[224:239], a[240:243], v[196:199], v[224:239]
  s_cbranch_vccnz L1_cbJ5
L1_rbJ5:
  v_exp_f32 v210, v130
  v_add_f32 v27, v208, v209
  v_cvt_pk_bf16_f32 v192, v208, v209
  v_cvt_pk_bf16_f32 v29, v29, v30
  v_mfma_f32_32x32x16_bf16 v[240:255], a[244:247], v[196:199], v[240:255]
  v_exp_f32 v211, v131
  v_add_f32 v26, v26, v28
  v_add_f32 v27, v27, v210
  v_permlane16_swap_b32 v3, v29
  v_mfma_f32_32x32x16_bf16 v[32:47], a[248:251], v[196:199], v[32:47]
  v_exp_f32 v212, v132
  v_add_f32 v27, v27, v211
  v_cvt_pk_bf16_f32 v193, v210, v211
  v_accvgpr_write_b32 a36, v3
  v_accvgpr_write_b32 a38, v29
  v_mfma_f32_32x32x16_bf16 v[48:63], a[252:255], v[196:199], v[48:63]
  v_exp_f32 v213, v133
  v_add_f32 v27, v27, v212
  v_accvgpr_read_b32 v29, a78
  v_accvgpr_read_b32 v30, a79
  v_mul_f32 v29, s32, v29
  v_mfma_f32_32x32x16_bf16 v[144:159], a[192:195], v[96:99], v[176:191]
  v_exp_f32 v214, v134
  v_add_f32 v27, v27, v213
  v_cvt_pk_bf16_f32 v194, v212, v213
  v_mul_f32 v30, s32, v30
  v_cvt_pk_bf16_f32 v30, v29, v30
  v_mfma_f32_32x32x16_bf16 v[144:159], a[196:199], v[100:103], v[144:159]
  ds_read_b128 a[192:195], v8 offset:57344
  v_exp_f32 v215, v135
  v_add_f32 v27, v27, v214
  v_permlane16_swap_b32 v4, v30
  v_mfma_f32_32x32x16_bf16 v[144:159], a[200:203], v[104:107], v[144:159]
  ds_read_b128 a[196:199], v9 offset:57344
  v_exp_f32 v208, v136
  v_add_f32 v27, v27, v215
  v_cvt_pk_bf16_f32 v195, v214, v215
  v_accvgpr_write_b32 a37, v4
  v_mfma_f32_32x32x16_bf16 v[144:159], a[204:207], v[108:111], v[144:159]
  ds_read_b128 a[200:203], v10 offset:57344
  v_exp_f32 v209, v137
  v_add_f32 v27, v27, v208
  v_accvgpr_write_b32 a39, v30
  v_accvgpr_read_b32 v3, a80
  v_mfma_f32_32x32x16_bf16 v[144:159], a[208:211], v[112:115], v[144:159]
  ds_read_b128 a[204:207], v11 offset:57344
  v_exp_f32 v210, v138
  v_add_f32 v27, v27, v209
  v_cvt_pk_bf16_f32 v196, v208, v209
  v_accvgpr_read_b32 v4, a81
  v_mfma_f32_32x32x16_bf16 v[144:159], a[212:215], v[116:119], v[144:159]
  ds_read_b128 a[208:211], v12 offset:57344
  v_exp_f32 v211, v139
  v_add_f32 v27, v27, v210
  v_accvgpr_read_b32 v29, a82
  v_accvgpr_read_b32 v30, a83
  v_mfma_f32_32x32x16_bf16 v[144:159], a[216:219], v[120:123], v[144:159]
  ds_read_b128 a[212:215], v13 offset:57344
  v_exp_f32 v212, v140
  v_add_f32 v27, v27, v211
  v_cvt_pk_bf16_f32 v197, v210, v211
  v_mul_f32 v3, s32, v3
  v_mfma_f32_32x32x16_bf16 v[144:159], a[220:223], v[124:127], v[144:159]
  ds_read_b128 a[216:219], v14 offset:57344
  v_exp_f32 v213, v141
  v_add_f32 v27, v27, v212
  v_mul_f32 v4, s32, v4
  s_add_u32 m0, s29, 0x6000
  v_mfma_f32_32x32x16_bf16 a[128:143], a[224:227], v[200:203], a[128:143]
  ds_read_b128 a[220:223], v15 offset:57344
  buffer_load_dwordx4 v20, s[12:15], s27 offen offset:0 nt lds
  v_exp_f32 v214, v142
  v_add_f32 v27, v27, v213
  v_cvt_pk_bf16_f32 v198, v212, v213
  v_mfma_f32_32x32x16_bf16 a[144:159], a[228:231], v[200:203], a[144:159]
  ds_read_b64_tr_b16 a[224:225], v16 offset:49152
  ds_read_b64_tr_b16 a[226:227], v16 offset:51200
  v_exp_f32 v215, v143
  v_add_f32 v27, v27, v214
  v_mul_f32 v29, s32, v29
  v_mfma_f32_32x32x16_bf16 a[160:175], a[232:235], v[200:203], a[160:175]
  ds_read_b64_tr_b16 a[228:229], v17 offset:49152
  buffer_load_dwordx4 v21, s[12:15], s27 offen offset:1024 nt lds
  v_exp_f32 v216, v144
  v_add_f32 v27, v27, v215
  v_cvt_pk_bf16_f32 v199, v214, v215
  v_mfma_f32_32x32x16_bf16 a[176:191], a[236:239], v[200:203], a[176:191]
  ds_read_b64_tr_b16 a[230:231], v17 offset:51200
  ds_read_b64_tr_b16 a[232:233], v18 offset:49152
  v_exp_f32 v217, v145
  v_cmp_nge_f32 vcc, 0x47800000, v27
  s_add_u32 m0, s29, 0x14000
  v_mfma_f32_32x32x16_bf16 a[128:143], a[240:243], v[204:207], a[128:143]
  ds_read_b64_tr_b16 a[234:235], v18 offset:51200
  buffer_load_dwordx4 v22, s[16:19], s27 offen offset:0 nt lds
  s_cbranch_vccnz L1_caJ5
L1_raJ5:
  v_exp_f32 v218, v146
  v_add_f32 v28, v216, v217
  v_cvt_pk_bf16_f32 v200, v216, v217
  v_mfma_f32_32x32x16_bf16 a[144:159], a[244:247], v[204:207], a[144:159]
  ds_read_b64_tr_b16 a[236:237], v19 offset:49152
  v_exp_f32 v219, v147
  v_add_f32 v28, v28, v218
  v_add_f32 v25, v25, v27
  v_mul_f32 v30, s32, v30
  v_mfma_f32_32x32x16_bf16 a[160:175], a[248:251], v[204:207], a[160:175]
  ds_read_b64_tr_b16 a[238:239], v19 offset:51200
  buffer_load_dwordx4 v22, s[16:19], s27 offen offset:1024 nt lds
  v_exp_f32 v220, v148
  v_add_f32 v28, v28, v219
  v_cvt_pk_bf16_f32 v201, v218, v219
  v_mfma_f32_32x32x16_bf16 a[176:191], a[252:255], v[204:207], a[176:191]
  ds_read_b64_tr_b16 a[240:241], v16 offset:53248
  ds_read_b64_tr_b16 a[242:243], v16 offset:55296
  v_exp_f32 v221, v149
  v_add_f32 v28, v28, v220
  v_cvt_pk_bf16_f32 v3, v3, v4
  s_waitcnt lgkmcnt(10)
  v_mfma_f32_32x32x16_bf16 v[128:143], a[192:195], v[64:67], v[160:175]
  v_exp_f32 v222, v150
  v_add_f32 v28, v28, v221
  v_cvt_pk_bf16_f32 v202, v220, v221
  v_cvt_pk_bf16_f32 v4, v29, v30
  v_accvgpr_read_b32 v29, a84
  v_mfma_f32_32x32x16_bf16 v[128:143], a[196:199], v[68:71], v[128:143]
  ds_read_b64_tr_b16 a[244:245], v17 offset:53248
  ds_read_b64_tr_b16 a[246:247], v17 offset:55296
  v_exp_f32 v223, v151
  v_add_f32 v28, v28, v222
  v_accvgpr_read_b32 v30, a85
  v_mfma_f32_32x32x16_bf16 v[128:143], a[200:203], v[72:75], v[128:143]
  ds_read_b64_tr_b16 a[248:249], v18 offset:53248
  s_add_u32 s27, s27, 0x2000
  v_exp_f32 v216, v152
  v_add_f32 v28, v28, v223
  v_cvt_pk_bf16_f32 v203, v222, v223
  v_mfma_f32_32x32x16_bf16 v[128:143], a[204:207], v[76:79], v[128:143]
  ds_read_b64_tr_b16 a[250:251], v18 offset:55296
  ds_read_b64_tr_b16 a[252:253], v19 offset:53248
  v_exp_f32 v217, v153
  v_add_f32 v28, v28, v216
  v_mul_f32 v29, s32, v29
  v_mfma_f32_32x32x16_bf16 v[128:143], a[208:211], v[80:83], v[128:143]
  ds_read_b64_tr_b16 a[254:255], v19 offset:55296
  v_exp_f32 v218, v154
  v_add_f32 v28, v28, v217
  v_cvt_pk_bf16_f32 v204, v216, v217
  v_mul_f32 v30, s32, v30
  v_mfma_f32_32x32x16_bf16 v[128:143], a[212:215], v[84:87], v[128:143]
  v_exp_f32 v219, v155
  v_add_f32 v28, v28, v218
  v_cvt_pk_bf16_f32 v29, v29, v30
  v_mfma_f32_32x32x16_bf16 v[128:143], a[216:219], v[88:91], v[128:143]
  v_exp_f32 v220, v156
  v_add_f32 v28, v28, v219
  v_cvt_pk_bf16_f32 v205, v218, v219
  v_permlane16_swap_b32 v3, v29
  v_mfma_f32_32x32x16_bf16 v[128:143], a[220:223], v[92:95], v[128:143]
  v_exp_f32 v221, v157
  v_add_f32 v28, v28, v220
  v_accvgpr_write_b32 a40, v3
  v_accvgpr_write_b32 a42, v29
  v_accvgpr_read_b32 v29, a86
  s_waitcnt lgkmcnt(0)
  v_mfma_f32_32x32x16_bf16 v[224:239], a[224:227], v[192:195], v[224:239]
  v_exp_f32 v222, v158
  v_add_f32 v28, v28, v221
  v_cvt_pk_bf16_f32 v206, v220, v221
  v_accvgpr_read_b32 v30, a87
  v_mul_f32 v29, s32, v29
  v_mfma_f32_32x32x16_bf16 v[240:255], a[228:231], v[192:195], v[240:255]
  v_exp_f32 v223, v159
  v_add_f32 v28, v28, v222
  v_mul_f32 v30, s32, v30
  v_cvt_pk_bf16_f32 v30, v29, v30
  v_mfma_f32_32x32x16_bf16 v[32:47], a[232:235], v[192:195], v[32:47]
  v_exp_f32 v208, v128
  v_add_f32 v28, v28, v223
  v_cvt_pk_bf16_f32 v207, v222, v223
  v_permlane16_swap_b32 v4, v30
  v_mfma_f32_32x32x16_bf16 v[48:63], a[236:239], v[192:195], v[48:63]
  v_exp_f32 v209, v129
  v_cmp_nge_f32 vcc, 0x47800000, v28
  v_accvgpr_write_b32 a41, v4
  v_accvgpr_write_b32 a43, v30
  v_accvgpr_read_b32 v3, a88
  v_mfma_f32_32x32x16_bf16 v[224:239], a[240:243], v[196:199], v[224:239]
  s_cbranch_vccnz L1_cbJ6
L1_rbJ6:
  v_exp_f32 v210, v130
  v_add_f32 v27, v208, v209
  v_cvt_pk_bf16_f32 v192, v208, v209
  v_accvgpr_read_b32 v4, a89
  v_mfma_f32_32x32x16_bf16 v[240:255], a[244:247], v[196:199], v[240:255]
  v_exp_f32 v211, v131
  v_add_f32 v26, v26, v28
  v_add_f32 v27, v27, v210
  v_accvgpr_read_b32 v29, a90
  v_accvgpr_read_b32 v30, a91
  v_mfma_f32_32x32x16_bf16 v[32:47], a[248:251], v[196:199], v[32:47]
  v_exp_f32 v212, v132
  v_add_f32 v27, v27, v211
  v_cvt_pk_bf16_f32 v193, v210, v211
  v_mul_f32 v3, s32, v3
  v_mul_f32 v4, s32, v4
  v_mfma_f32_32x32x16_bf16 v[48:63], a[252:255], v[196:199], v[48:63]
  v_exp_f32 v213, v133
  v_add_f32 v27, v27, v212
  v_mul_f32 v29, s32, v29
  v_mul_f32 v30, s32, v30
  v_cvt_pk_bf16_f32 v3, v3, v4
  v_mfma_f32_32x32x16_bf16 v[144:159], a[192:195], v[96:99], v[176:191]
  s_waitcnt vmcnt(8)
  s_barrier
  v_exp_f32 v214, v134
  v_add_f32 v27, v27, v213
  v_cvt_pk_bf16_f32 v194, v212, v213
  v_cvt_pk_bf16_f32 v4, v29, v30
  v_mfma_f32_32x32x16_bf16 v[144:159], a[196:199], v[100:103], v[144:159]
  ds_read_b128 a[192:195], v8 offset:0
  v_exp_f32 v215, v135
  v_add_f32 v27, v27, v214
  v_accvgpr_read_b32 v29, a92
  v_accvgpr_read_b32 v30, a93
  v_mfma_f32_32x32x16_bf16 v[144:159], a[200:203], v[104:107], v[144:159]
  ds_read_b128 a[196:199], v9 offset:0
  v_exp_f32 v208, v136
  v_add_f32 v27, v27, v215
  v_cvt_pk_bf16_f32 v195, v214, v215
  v_mul_f32 v29, s32, v29
  v_mfma_f32_32x32x16_bf16 v[144:159], a[204:207], v[108:111], v[144:159]
  ds_read_b128 a[200:203], v10 offset:0
  v_exp_f32 v209, v137
  v_add_f32 v27, v27, v208
  v_mul_f32 v30, s32, v30
  v_cvt_pk_bf16_f32 v29, v29, v30
  v_mfma_f32_32x32x16_bf16 v[144:159], a[208:211], v[112:115], v[144:159]
  ds_read_b128 a[204:207], v11 offset:0
  v_exp_f32 v210, v138
  v_add_f32 v27, v27, v209
  v_cvt_pk_bf16_f32 v196, v208, v209
  v_mfma_f32_32x32x16_bf16 v[144:159], a[212:215], v[116:119], v[144:159]
  ds_read_b128 a[208:211], v12 offset:0
  v_exp_f32 v211, v139
  v_add_f32 v27, v27, v210
  v_permlane16_swap_b32 v3, v29
  v_mfma_f32_32x32x16_bf16 v[144:159], a[216:219], v[120:123], v[144:159]
  ds_read_b128 a[212:215], v13 offset:0
  v_exp_f32 v212, v140
  v_add_f32 v27, v27, v211
  v_cvt_pk_bf16_f32 v197, v210, v211
  v_accvgpr_write_b32 a44, v3
  v_mfma_f32_32x32x16_bf16 v[144:159], a[220:223], v[124:127], v[144:159]
  ds_read_b128 a[216:219], v14 offset:0
  v_exp_f32 v213, v141
  v_add_f32 v27, v27, v212
  v_accvgpr_write_b32 a46, v29
  s_add_u32 m0, s29, 0x8000
  v_mfma_f32_32x32x16_bf16 a[128:143], a[224:227], v[200:203], a[128:143]
  ds_read_b128 a[220:223], v15 offset:0
  buffer_load_dwordx4 v20, s[12:15], s27 offen offset:0 nt lds
  v_exp_f32 v214, v142
  v_add_f32 v27, v27, v213
  v_cvt_pk_bf16_f32 v198, v212, v213
  v_mfma_f32_32x32x16_bf16 a[144:159], a[228:231], v[200:203], a[144:159]
  ds_read_b64_tr_b16 a[224:225], v16 offset:57344
  ds_read_b64_tr_b16 a[226:227], v16 offset:59392
  v_exp_f32 v215, v143
  v_add_f32 v27, v27, v214
  v_accvgpr_read_b32 v29, a94
  v_mfma_f32_32x32x16_bf16 a[160:175], a[232:235], v[200:203], a[160:175]
  ds_read_b64_tr_b16 a[228:229], v17 offset:57344
  buffer_load_dwordx4 v21, s[12:15], s27 offen offset:1024 nt lds
  v_exp_f32 v216, v144
  v_add_f32 v27, v27, v215
  v_cvt_pk_bf16_f32 v199, v214, v215
  v_mfma_f32_32x32x16_bf16 a[176:191], a[236:239], v[200:203], a[176:191]
  ds_read_b64_tr_b16 a[230:231], v17 offset:59392
  ds_read_b64_tr_b16 a[232:233], v18 offset:57344
  v_exp_f32 v217, v145
  v_cmp_nge_f32 vcc, 0x47800000, v27
  s_add_u32 m0, s29, 0x16000
  v_mfma_f32_32x32x16_bf16 a[128:143], a[240:243], v[204:207], a[128:143]
  ds_read_b64_tr_b16 a[234:235], v18 offset:59392
  buffer_load_dwordx4 v22, s[16:19], s27 offen offset:0 nt lds
  s_cbranch_vccnz L1_caJ6
L1_raJ6:
  v_exp_f32 v218, v146
  v_add_f32 v28, v216, v217
  v_cvt_pk_bf16_f32 v200, v216, v217
  v_mfma_f32_32x32x16_bf16 a[144:159], a[244:247], v[204:207], a[144:159]
  ds_read_b64_tr_b16 a[236:237], v19 offset:57344
  v_exp_f32 v219, v147
  v_add_f32 v28, v28, v218
  v_add_f32 v25, v25, v27
  v_accvgpr_read_b32 v30, a95
  v_mfma_f32_32x32x16_bf16 a[160:175], a[248:251], v[204:207], a[160:175]
  ds_read_b64_tr_b16 a[238:239], v19 offset:59392
  buffer_load_dwordx4 v22, s[16:19], s27 offen offset:1024 nt lds
  v_exp_f32 v220, v148
  v_add_f32 v28, v28, v219
  v_cvt_pk_bf16_f32 v201, v218, v219
  v_mfma_f32_32x32x16_bf16 a[176:191], a[252:255], v[204:207], a[176:191]
  ds_read_b64_tr_b16 a[240:241], v16 offset:61440
  ds_read_b64_tr_b16 a[242:243], v16 offset:63488
  v_exp_f32 v221, v149
  v_add_f32 v28, v28, v220
  v_mul_f32 v29, s32, v29
  s_waitcnt lgkmcnt(10)
  v_mfma_f32_32x32x16_bf16 v[128:143], a[192:195], v[64:67], v[160:175]
  v_exp_f32 v222, v150
  v_add_f32 v28, v28, v221
  v_cvt_pk_bf16_f32 v202, v220, v221
  v_mul_f32 v30, s32, v30
  v_cvt_pk_bf16_f32 v30, v29, v30
  v_mfma_f32_32x32x16_bf16 v[128:143], a[196:199], v[68:71], v[128:143]
  ds_read_b64_tr_b16 a[244:245], v17 offset:61440
  ds_read_b64_tr_b16 a[246:247], v17 offset:63488
  v_exp_f32 v223, v151
  v_add_f32 v28, v28, v222
  v_mfma_f32_32x32x16_bf16 v[128:143], a[200:203], v[72:75], v[128:143]
  ds_read_b64_tr_b16 a[248:249], v18 offset:61440
  s_add_u32 s27, s27, 0x2000
  v_exp_f32 v216, v152
  v_add_f32 v28, v28, v223
  v_cvt_pk_bf16_f32 v203, v222, v223
  v_mfma_f32_32x32x16_bf16 v[128:143], a[204:207], v[76:79], v[128:143]
  ds_read_b64_tr_b16 a[250:251], v18 offset:63488
  ds_read_b64_tr_b16 a[252:253], v19 offset:61440
  v_exp_f32 v217, v153
  v_add_f32 v28, v28, v216
  v_mfma_f32_32x32x16_bf16 v[128:143], a[208:211], v[80:83], v[128:143]
  ds_read_b64_tr_b16 a[254:255], v19 offset:63488
  v_exp_f32 v218, v154
  v_add_f32 v28, v28, v217
  v_cvt_pk_bf16_f32 v204, v216, v217
  v_mfma_f32_32x32x16_bf16 v[128:143], a[212:215], v[84:87], v[128:143]
  v_exp_f32 v219, v155
  v_add_f32 v28, v28, v218
  v_permlane16_swap_b32 v4, v30
  v_accvgpr_write_b32 a45, v4
  v_mfma_f32_32x32x16_bf16 v[128:143], a[216:219], v[88:91], v[128:143]
  v_exp_f32 v220, v156
  v_add_f32 v28, v28, v219
  v_cvt_pk_bf16_f32 v205, v218, v219
  v_accvgpr_write_b32 a47, v30
  v_accvgpr_read_b32 v3, a96
  v_mfma_f32_32x32x16_bf16 v[128:143], a[220:223], v[92:95], v[128:143]
  v_exp_f32 v221, v157
  v_add_f32 v28, v28, v220
  v_accvgpr_read_b32 v4, a97
  v_accvgpr_read_b32 v29, a98
  v_accvgpr_read_b32 v30, a99
  s_waitcnt lgkmcnt(0)
  v_mfma_f32_32x32x16_bf16 v[224:239], a[224:227], v[192:195], v[224:239]
  v_exp_f32 v222, v158
  v_add_f32 v28, v28, v221
  v_cvt_pk_bf16_f32 v206, v220, v221
  v_mul_f32 v3, s32, v3
  v_mul_f32 v4, s32, v4
  v_mfma_f32_32x32x16_bf16 v[240:255], a[228:231], v[192:195], v[240:255]
  v_exp_f32 v223, v159
  v_add_f32 v28, v28, v222
  v_mul_f32 v29, s32, v29
  v_mul_f32 v30, s32, v30
  v_cvt_pk_bf16_f32 v3, v3, v4
  v_mfma_f32_32x32x16_bf16 v[32:47], a[232:235], v[192:195], v[32:47]
  v_exp_f32 v208, v128
  v_add_f32 v28, v28, v223
  v_cvt_pk_bf16_f32 v207, v222, v223
  v_cvt_pk_bf16_f32 v4, v29, v30
  v_accvgpr_read_b32 v29, a100
  v_mfma_f32_32x32x16_bf16 v[48:63], a[236:239], v[192:195], v[48:63]
  v_exp_f32 v209, v129
  v_cmp_nge_f32 vcc, 0x47800000, v28
  v_accvgpr_read_b32 v30, a101
  v_mul_f32 v29, s32, v29
  v_mul_f32 v30, s32, v30
  v_mfma_f32_32x32x16_bf16 v[224:239], a[240:243], v[196:199], v[224:239]
  s_cbranch_vccnz L1_cbJ7
L1_rbJ7:
  v_exp_f32 v210, v130
  v_add_f32 v27, v208, v209
  v_cvt_pk_bf16_f32 v192, v208, v209
  v_cvt_pk_bf16_f32 v29, v29, v30
  v_mfma_f32_32x32x16_bf16 v[240:255], a[244:247], v[196:199], v[240:255]
  v_exp_f32 v211, v131
  v_add_f32 v26, v26, v28
  v_add_f32 v27, v27, v210
  v_permlane16_swap_b32 v3, v29
  v_mfma_f32_32x32x16_bf16 v[32:47], a[248:251], v[196:199], v[32:47]
  v_exp_f32 v212, v132
  v_add_f32 v27, v27, v211
  v_cvt_pk_bf16_f32 v193, v210, v211
  v_accvgpr_write_b32 a48, v3
  v_accvgpr_write_b32 a50, v29
  v_mfma_f32_32x32x16_bf16 v[48:63], a[252:255], v[196:199], v[48:63]
  v_exp_f32 v213, v133
  v_add_f32 v27, v27, v212
  v_accvgpr_read_b32 v29, a102
  v_accvgpr_read_b32 v30, a103
  v_mul_f32 v29, s32, v29
  v_mfma_f32_32x32x16_bf16 v[144:159], a[192:195], v[96:99], v[176:191]
  v_exp_f32 v214, v134
  v_add_f32 v27, v27, v213
  v_cvt_pk_bf16_f32 v194, v212, v213
  v_mul_f32 v30, s32, v30
  v_cvt_pk_bf16_f32 v30, v29, v30
  v_mfma_f32_32x32x16_bf16 v[144:159], a[196:199], v[100:103], v[144:159]
  ds_read_b128 a[192:195], v8 offset:8192
  v_exp_f32 v215, v135
  v_add_f32 v27, v27, v214
  v_permlane16_swap_b32 v4, v30
  v_mfma_f32_32x32x16_bf16 v[144:159], a[200:203], v[104:107], v[144:159]
  ds_read_b128 a[196:199], v9 offset:8192
  v_exp_f32 v208, v136
  v_add_f32 v27, v27, v215
  v_cvt_pk_bf16_f32 v195, v214, v215
  v_accvgpr_write_b32 a49, v4
  v_mfma_f32_32x32x16_bf16 v[144:159], a[204:207], v[108:111], v[144:159]
  ds_read_b128 a[200:203], v10 offset:8192
  v_exp_f32 v209, v137
  v_add_f32 v27, v27, v208
  v_accvgpr_write_b32 a51, v30
  v_accvgpr_read_b32 v3, a104
  v_mfma_f32_32x32x16_bf16 v[144:159], a[208:211], v[112:115], v[144:159]
  ds_read_b128 a[204:207], v11 offset:8192
  v_exp_f32 v210, v138
  v_add_f32 v27, v27, v209
  v_cvt_pk_bf16_f32 v196, v208, v209
  v_accvgpr_read_b32 v4, a105
  v_mfma_f32_32x32x16_bf16 v[144:159], a[212:215], v[116:119], v[144:159]
  ds_read_b128 a[208:211], v12 offset:8192
  v_exp_f32 v211, v139
  v_add_f32 v27, v27, v210
  v_accvgpr_read_b32 v29, a106
  v_accvgpr_read_b32 v30, a107
  v_mfma_f32_32x32x16_bf16 v[144:159], a[216:219], v[120:123], v[144:159]
  ds_read_b128 a[212:215], v13 offset:8192
  v_exp_f32 v212, v140
  v_add_f32 v27, v27, v211
  v_cvt_pk_bf16_f32 v197, v210, v211
  v_mul_f32 v3, s32, v3
  v_mfma_f32_32x32x16_bf16 v[144:159], a[220:223], v[124:127], v[144:159]
  ds_read_b128 a[216:219], v14 offset:8192
  v_exp_f32 v213, v141
  v_add_f32 v27, v27, v212
  v_mul_f32 v4, s32, v4
  s_add_u32 m0, s29, 0xa000
  v_mfma_f32_32x32x16_bf16 a[128:143], a[224:227], v[200:203], a[128:143]
  ds_read_b128 a[220:223], v15 offset:8192
  buffer_load_dwordx4 v20, s[12:15], s27 offen offset:0 nt lds
  v_exp_f32 v214, v142
  v_add_f32 v27, v27, v213
  v_cvt_pk_bf16_f32 v198, v212, v213
  v_mfma_f32_32x32x16_bf16 a[144:159], a[228:231], v[200:203], a[144:159]
  ds_read_b64_tr_b16 a[224:225], v16 offset:0
  ds_read_b64_tr_b16 a[226:227], v16 offset:2048
  v_exp_f32 v215, v143
  v_add_f32 v27, v27, v214
  v_mul_f32 v29, s32, v29
  v_mfma_f32_32x32x16_bf16 a[160:175], a[232:235], v[200:203], a[160:175]
  ds_read_b64_tr_b16 a[228:229], v17 offset:0
  buffer_load_dwordx4 v21, s[12:15], s27 offen offset:1024 nt lds
  v_exp_f32 v216, v144
  v_add_f32 v27, v27, v215
  v_cvt_pk_bf16_f32 v199, v214, v215
  v_mfma_f32_32x32x16_bf16 a[176:191], a[236:239], v[200:203], a[176:191]
  ds_read_b64_tr_b16 a[230:231], v17 offset:2048
  ds_read_b64_tr_b16 a[232:233], v18 offset:0
  v_exp_f32 v217, v145
  v_cmp_nge_f32 vcc, 0x47800000, v27
  s_add_u32 m0, s29, 0x18000
  v_mfma_f32_32x32x16_bf16 a[128:143], a[240:243], v[204:207], a[128:143]
  ds_read_b64_tr_b16 a[234:235], v18 offset:2048
  buffer_load_dwordx4 v22, s[16:19], s27 offen offset:0 nt lds
  s_cbranch_vccnz L1_caJ7
L1_raJ7:
  v_exp_f32 v218, v146
  v_add_f32 v28, v216, v217
  v_cvt_pk_bf16_f32 v200, v216, v217
  v_mfma_f32_32x32x16_bf16 a[144:159], a[244:247], v[204:207], a[144:159]
  ds_read_b64_tr_b16 a[236:237], v19 offset:0
  v_exp_f32 v219, v147
  v_add_f32 v28, v28, v218
  v_add_f32 v25, v25, v27
  v_mul_f32 v30, s32, v30
  v_mfma_f32_32x32x16_bf16 a[160:175], a[248:251], v[204:207], a[160:175]
  ds_read_b64_tr_b16 a[238:239], v19 offset:2048
  buffer_load_dwordx4 v22, s[16:19], s27 offen offset:1024 nt lds
  v_exp_f32 v220, v148
  v_add_f32 v28, v28, v219
  v_cvt_pk_bf16_f32 v201, v218, v219
  v_mfma_f32_32x32x16_bf16 a[176:191], a[252:255], v[204:207], a[176:191]
  ds_read_b64_tr_b16 a[240:241], v16 offset:4096
  ds_read_b64_tr_b16 a[242:243], v16 offset:6144
  v_exp_f32 v221, v149
  v_add_f32 v28, v28, v220
  v_cvt_pk_bf16_f32 v3, v3, v4
  s_waitcnt lgkmcnt(10)
  v_mfma_f32_32x32x16_bf16 v[128:143], a[192:195], v[64:67], v[160:175]
  v_exp_f32 v222, v150
  v_add_f32 v28, v28, v221
  v_cvt_pk_bf16_f32 v202, v220, v221
  v_cvt_pk_bf16_f32 v4, v29, v30
  v_accvgpr_read_b32 v29, a108
  v_mfma_f32_32x32x16_bf16 v[128:143], a[196:199], v[68:71], v[128:143]
  ds_read_b64_tr_b16 a[244:245], v17 offset:4096
  ds_read_b64_tr_b16 a[246:247], v17 offset:6144
  v_exp_f32 v223, v151
  v_add_f32 v28, v28, v222
  v_accvgpr_read_b32 v30, a109
  v_mfma_f32_32x32x16_bf16 v[128:143], a[200:203], v[72:75], v[128:143]
  ds_read_b64_tr_b16 a[248:249], v18 offset:4096
  s_add_u32 s27, s27, 0x2000
  v_exp_f32 v216, v152
  v_add_f32 v28, v28, v223
  v_cvt_pk_bf16_f32 v203, v222, v223
  v_mfma_f32_32x32x16_bf16 v[128:143], a[204:207], v[76:79], v[128:143]
  ds_read_b64_tr_b16 a[250:251], v18 offset:6144
  ds_read_b64_tr_b16 a[252:253], v19 offset:4096
  v_exp_f32 v217, v153
  v_add_f32 v28, v28, v216
  v_mul_f32 v29, s32, v29
  v_mfma_f32_32x32x16_bf16 v[128:143], a[208:211], v[80:83], v[128:143]
  ds_read_b64_tr_b16 a[254:255], v19 offset:6144
  v_exp_f32 v218, v154
  v_add_f32 v28, v28, v217
  v_cvt_pk_bf16_f32 v204, v216, v217
  v_mul_f32 v30, s32, v30
  v_mfma_f32_32x32x16_bf16 v[128:143], a[212:215], v[84:87], v[128:143]
  v_exp_f32 v219, v155
  v_add_f32 v28, v28, v218
  v_cvt_pk_bf16_f32 v29, v29, v30
  v_mfma_f32_32x32x16_bf16 v[128:143], a[216:219], v[88:91], v[128:143]
  v_exp_f32 v220, v156
  v_add_f32 v28, v28, v219
  v_cvt_pk_bf16_f32 v205, v218, v219
  v_permlane16_swap_b32 v3, v29
  v_mfma_f32_32x32x16_bf16 v[128:143], a[220:223], v[92:95], v[128:143]
  v_exp_f32 v221, v157
  v_add_f32 v28, v28, v220
  v_accvgpr_write_b32 a52, v3
  v_accvgpr_write_b32 a54, v29
  v_accvgpr_read_b32 v29, a110
  s_waitcnt lgkmcnt(0)
  v_mfma_f32_32x32x16_bf16 v[224:239], a[224:227], v[192:195], v[224:239]
  v_exp_f32 v222, v158
  v_add_f32 v28, v28, v221
  v_cvt_pk_bf16_f32 v206, v220, v221
  v_accvgpr_read_b32 v30, a111
  v_mul_f32 v29, s32, v29
  v_mfma_f32_32x32x16_bf16 v[240:255], a[228:231], v[192:195], v[240:255]
  v_exp_f32 v223, v159
  v_add_f32 v28, v28, v222
  v_mul_f32 v30, s32, v30
  v_cvt_pk_bf16_f32 v30, v29, v30
  v_mfma_f32_32x32x16_bf16 v[32:47], a[232:235], v[192:195], v[32:47]
  v_exp_f32 v208, v128
  v_add_f32 v28, v28, v223
  v_cvt_pk_bf16_f32 v207, v222, v223
  v_permlane16_swap_b32 v4, v30
  v_mfma_f32_32x32x16_bf16 v[48:63], a[236:239], v[192:195], v[48:63]
  v_exp_f32 v209, v129
  v_cmp_nge_f32 vcc, 0x47800000, v28
  v_accvgpr_write_b32 a53, v4
  v_accvgpr_write_b32 a55, v30
  v_accvgpr_read_b32 v3, a112
  v_mfma_f32_32x32x16_bf16 v[224:239], a[240:243], v[196:199], v[224:239]
  s_cbranch_vccnz L1_cbJ8
L1_rbJ8:
  v_exp_f32 v210, v130
  v_add_f32 v27, v208, v209
  v_cvt_pk_bf16_f32 v192, v208, v209
  v_accvgpr_read_b32 v4, a113
  v_mfma_f32_32x32x16_bf16 v[240:255], a[244:247], v[196:199], v[240:255]
  v_exp_f32 v211, v131
  v_add_f32 v26, v26, v28
  v_add_f32 v27, v27, v210
  v_accvgpr_read_b32 v29, a114
  v_accvgpr_read_b32 v30, a115
  v_mfma_f32_32x32x16_bf16 v[32:47], a[248:251], v[196:199], v[32:47]
  v_exp_f32 v212, v132
  v_add_f32 v27, v27, v211
  v_cvt_pk_bf16_f32 v193, v210, v211
  v_mul_f32 v3, s32, v3
  v_mul_f32 v4, s32, v4
  v_mfma_f32_32x32x16_bf16 v[48:63], a[252:255], v[196:199], v[48:63]
  v_exp_f32 v213, v133
  v_add_f32 v27, v27, v212
  v_mul_f32 v29, s32, v29
  v_mul_f32 v30, s32, v30
  v_cvt_pk_bf16_f32 v3, v3, v4
  v_mfma_f32_32x32x16_bf16 v[144:159], a[192:195], v[96:99], v[176:191]
  s_waitcnt vmcnt(8)
  s_barrier
  v_exp_f32 v214, v134
  v_add_f32 v27, v27, v213
  v_cvt_pk_bf16_f32 v194, v212, v213
  v_cvt_pk_bf16_f32 v4, v29, v30
  v_mfma_f32_32x32x16_bf16 v[144:159], a[196:199], v[100:103], v[144:159]
  ds_read_b128 a[192:195], v8 offset:16384
  v_exp_f32 v215, v135
  v_add_f32 v27, v27, v214
  v_accvgpr_read_b32 v29, a116
  v_accvgpr_read_b32 v30, a117
  v_mfma_f32_32x32x16_bf16 v[144:159], a[200:203], v[104:107], v[144:159]
  ds_read_b128 a[196:199], v9 offset:16384
  v_exp_f32 v208, v136
  v_add_f32 v27, v27, v215
  v_cvt_pk_bf16_f32 v195, v214, v215
  v_mul_f32 v29, s32, v29
  v_mfma_f32_32x32x16_bf16 v[144:159], a[204:207], v[108:111], v[144:159]
  ds_read_b128 a[200:203], v10 offset:16384
  v_exp_f32 v209, v137
  v_add_f32 v27, v27, v208
  v_mul_f32 v30, s32, v30
  v_cvt_pk_bf16_f32 v29, v29, v30
  v_mfma_f32_32x32x16_bf16 v[144:159], a[208:211], v[112:115], v[144:159]
  ds_read_b128 a[204:207], v11 offset:16384
  v_exp_f32 v210, v138
  v_add_f32 v27, v27, v209
  v_cvt_pk_bf16_f32 v196, v208, v209
  v_mfma_f32_32x32x16_bf16 v[144:159], a[212:215], v[116:119], v[144:159]
  ds_read_b128 a[208:211], v12 offset:16384
  v_exp_f32 v211, v139
  v_add_f32 v27, v27, v210
  v_permlane16_swap_b32 v3, v29
  v_mfma_f32_32x32x16_bf16 v[144:159], a[216:219], v[120:123], v[144:159]
  ds_read_b128 a[212:215], v13 offset:16384
  v_exp_f32 v212, v140
  v_add_f32 v27, v27, v211
  v_cvt_pk_bf16_f32 v197, v210, v211
  v_accvgpr_write_b32 a56, v3
  v_mfma_f32_32x32x16_bf16 v[144:159], a[220:223], v[124:127], v[144:159]
  ds_read_b128 a[216:219], v14 offset:16384
  v_exp_f32 v213, v141
  v_add_f32 v27, v27, v212
  v_accvgpr_write_b32 a58, v29
  s_add_u32 m0, s29, 0xc000
  v_mfma_f32_32x32x16_bf16 a[128:143], a[224:227], v[200:203], a[128:143]
  ds_read_b128 a[220:223], v15 offset:16384
  buffer_load_dwordx4 v20, s[12:15], s27 offen offset:0 nt lds
  v_exp_f32 v214, v142
  v_add_f32 v27, v27, v213
  v_cvt_pk_bf16_f32 v198, v212, v213
  v_mfma_f32_32x32x16_bf16 a[144:159], a[228:231], v[200:203], a[144:159]
  ds_read_b64_tr_b16 a[224:225], v16 offset:8192
  ds_read_b64_tr_b16 a[226:227], v16 offset:10240
  v_exp_f32 v215, v143
  v_add_f32 v27, v27, v214
  v_accvgpr_read_b32 v29, a118
  v_mfma_f32_32x32x16_bf16 a[160:175], a[232:235], v[200:203], a[160:175]
  ds_read_b64_tr_b16 a[228:229], v17 offset:8192
  buffer_load_dwordx4 v21, s[12:15], s27 offen offset:1024 nt lds
  v_exp_f32 v216, v144
  v_add_f32 v27, v27, v215
  v_cvt_pk_bf16_f32 v199, v214, v215
  v_mfma_f32_32x32x16_bf16 a[176:191], a[236:239], v[200:203], a[176:191]
  ds_read_b64_tr_b16 a[230:231], v17 offset:10240
  ds_read_b64_tr_b16 a[232:233], v18 offset:8192
  v_exp_f32 v217, v145
  v_cmp_nge_f32 vcc, 0x47800000, v27
  s_add_u32 m0, s29, 0x1a000
  v_mfma_f32_32x32x16_bf16 a[128:143], a[240:243], v[204:207], a[128:143]
  ds_read_b64_tr_b16 a[234:235], v18 offset:10240
  buffer_load_dwordx4 v22, s[16:19], s27 offen offset:0 nt lds
  s_cbranch_vccnz L1_caJ8
L1_raJ8:
  v_exp_f32 v218, v146
  v_add_f32 v28, v216, v217
  v_cvt_pk_bf16_f32 v200, v216, v217
  v_mfma_f32_32x32x16_bf16 a[144:159], a[244:247], v[204:207], a[144:159]
  ds_read_b64_tr_b16 a[236:237], v19 offset:8192
  v_exp_f32 v219, v147
  v_add_f32 v28, v28, v218
  v_add_f32 v25, v25, v27
  v_accvgpr_read_b32 v30, a119
  v_mfma_f32_32x32x16_bf16 a[160:175], a[248:251], v[204:207], a[160:175]
  ds_read_b64_tr_b16 a[238:239], v19 offset:10240
  buffer_load_dwordx4 v22, s[16:19], s27 offen offset:1024 nt lds
  v_exp_f32 v220, v148
  v_add_f32 v28, v28, v219
  v_cvt_pk_bf16_f32 v201, v218, v219
  v_mfma_f32_32x32x16_bf16 a[176:191], a[252:255], v[204:207], a[176:191]
  ds_read_b64_tr_b16 a[240:241], v16 offset:12288
  ds_read_b64_tr_b16 a[242:243], v16 offset:14336
  v_exp_f32 v221, v149
  v_add_f32 v28, v28, v220
  v_mul_f32 v29, s32, v29
  s_waitcnt lgkmcnt(10)
  v_mfma_f32_32x32x16_bf16 v[128:143], a[192:195], v[64:67], v[160:175]
  v_exp_f32 v222, v150
  v_add_f32 v28, v28, v221
  v_cvt_pk_bf16_f32 v202, v220, v221
  v_mul_f32 v30, s32, v30
  v_cvt_pk_bf16_f32 v30, v29, v30
  v_mfma_f32_32x32x16_bf16 v[128:143], a[196:199], v[68:71], v[128:143]
  ds_read_b64_tr_b16 a[244:245], v17 offset:12288
  ds_read_b64_tr_b16 a[246:247], v17 offset:14336
  v_exp_f32 v223, v151
  v_add_f32 v28, v28, v222
  v_mfma_f32_32x32x16_bf16 v[128:143], a[200:203], v[72:75], v[128:143]
  ds_read_b64_tr_b16 a[248:249], v18 offset:12288
  s_add_u32 s27, s27, 0x2000
  v_exp_f32 v216, v152
  v_add_f32 v28, v28, v223
  v_cvt_pk_bf16_f32 v203, v222, v223
  v_mfma_f32_32x32x16_bf16 v[128:143], a[204:207], v[76:79], v[128:143]
  ds_read_b64_tr_b16 a[250:251], v18 offset:14336
  ds_read_b64_tr_b16 a[252:253], v19 offset:12288
  v_exp_f32 v217, v153
  v_add_f32 v28, v28, v216
  v_mfma_f32_32x32x16_bf16 v[128:143], a[208:211], v[80:83], v[128:143]
  ds_read_b64_tr_b16 a[254:255], v19 offset:14336
  v_exp_f32 v218, v154
  v_add_f32 v28, v28, v217
  v_cvt_pk_bf16_f32 v204, v216, v217
  v_mfma_f32_32x32x16_bf16 v[128:143], a[212:215], v[84:87], v[128:143]
  v_exp_f32 v219, v155
  v_add_f32 v28, v28, v218
  v_permlane16_swap_b32 v4, v30
  v_accvgpr_write_b32 a57, v4
  v_mfma_f32_32x32x16_bf16 v[128:143], a[216:219], v[88:91], v[128:143]
  v_exp_f32 v220, v156
  v_add_f32 v28, v28, v219
  v_cvt_pk_bf16_f32 v205, v218, v219
  v_accvgpr_write_b32 a59, v30
  v_accvgpr_read_b32 v3, a120
  v_mfma_f32_32x32x16_bf16 v[128:143], a[220:223], v[92:95], v[128:143]
  v_exp_f32 v221, v157
  v_add_f32 v28, v28, v220
  v_accvgpr_read_b32 v4, a121
  v_accvgpr_read_b32 v29, a122
  v_accvgpr_read_b32 v30, a123
  s_waitcnt lgkmcnt(0)
  v_mfma_f32_32x32x16_bf16 v[224:239], a[224:227], v[192:195], v[224:239]
  v_exp_f32 v222, v158
  v_add_f32 v28, v28, v221
  v_cvt_pk_bf16_f32 v206, v220, v221
  v_mul_f32 v3, s32, v3
  v_mul_f32 v4, s32, v4
  v_mfma_f32_32x32x16_bf16 v[240:255], a[228:231], v[192:195], v[240:255]
  v_exp_f32 v223, v159
  v_add_f32 v28, v28, v222
  v_mul_f32 v29, s32, v29
  v_mul_f32 v30, s32, v30
  v_cvt_pk_bf16_f32 v3, v3, v4
  v_mfma_f32_32x32x16_bf16 v[32:47], a[232:235], v[192:195], v[32:47]
  v_exp_f32 v208, v128
  v_add_f32 v28, v28, v223
  v_cvt_pk_bf16_f32 v207, v222, v223
  v_cvt_pk_bf16_f32 v4, v29, v30
  v_accvgpr_read_b32 v29, a124
  v_mfma_f32_32x32x16_bf16 v[48:63], a[236:239], v[192:195], v[48:63]
  v_exp_f32 v209, v129
  v_cmp_nge_f32 vcc, 0x47800000, v28
  v_accvgpr_read_b32 v30, a125
  v_mul_f32 v29, s32, v29
  v_mul_f32 v30, s32, v30
  v_mfma_f32_32x32x16_bf16 v[224:239], a[240:243], v[196:199], v[224:239]
  s_cbranch_vccnz L1_cbJ9
L1_rbJ9:
  v_exp_f32 v210, v130
  v_add_f32 v27, v208, v209
  v_cvt_pk_bf16_f32 v192, v208, v209
  v_cvt_pk_bf16_f32 v29, v29, v30
  v_mfma_f32_32x32x16_bf16 v[240:255], a[244:247], v[196:199], v[240:255]
  v_exp_f32 v211, v131
  v_add_f32 v26, v26, v28
  v_add_f32 v27, v27, v210
  v_permlane16_swap_b32 v3, v29
  v_mfma_f32_32x32x16_bf16 v[32:47], a[248:251], v[196:199], v[32:47]
  v_exp_f32 v212, v132
  v_add_f32 v27, v27, v211
  v_cvt_pk_bf16_f32 v193, v210, v211
  v_accvgpr_write_b32 a60, v3
  v_accvgpr_write_b32 a62, v29
  v_mfma_f32_32x32x16_bf16 v[48:63], a[252:255], v[196:199], v[48:63]
  v_exp_f32 v213, v133
  v_add_f32 v27, v27, v212
  v_accvgpr_read_b32 v29, a126
  v_accvgpr_read_b32 v30, a127
  v_mul_f32 v29, s32, v29
  v_mfma_f32_32x32x16_bf16 v[144:159], a[192:195], v[96:99], v[176:191]
  v_exp_f32 v214, v134
  v_add_f32 v27, v27, v213
  v_cvt_pk_bf16_f32 v194, v212, v213
  v_mul_f32 v30, s32, v30
  v_cvt_pk_bf16_f32 v30, v29, v30
  v_mfma_f32_32x32x16_bf16 v[144:159], a[196:199], v[100:103], v[144:159]
  ds_read_b128 a[192:195], v8 offset:24576
  v_exp_f32 v215, v135
  v_add_f32 v27, v27, v214
  v_permlane16_swap_b32 v4, v30
  v_mfma_f32_32x32x16_bf16 v[144:159], a[200:203], v[104:107], v[144:159]
  ds_read_b128 a[196:199], v9 offset:24576
  v_exp_f32 v208, v136
  v_add_f32 v27, v27, v215
  v_cvt_pk_bf16_f32 v195, v214, v215
  v_accvgpr_write_b32 a61, v4
  v_mfma_f32_32x32x16_bf16 v[144:159], a[204:207], v[108:111], v[144:159]
  ds_read_b128 a[200:203], v10 offset:24576
  v_exp_f32 v209, v137
  v_add_f32 v27, v27, v208
  v_accvgpr_write_b32 a63, v30
  v_mfma_f32_32x32x16_bf16 v[144:159], a[208:211], v[112:115], v[144:159]
  ds_read_b128 a[204:207], v11 offset:24576
  v_exp_f32 v210, v138
  v_add_f32 v27, v27, v209
  v_cvt_pk_bf16_f32 v196, v208, v209
  v_mfma_f32_32x32x16_bf16 v[144:159], a[212:215], v[116:119], v[144:159]
  ds_read_b128 a[208:211], v12 offset:24576
  v_exp_f32 v211, v139
  v_add_f32 v27, v27, v210
  v_mfma_f32_32x32x16_bf16 v[144:159], a[216:219], v[120:123], v[144:159]
  ds_read_b128 a[212:215], v13 offset:24576
  v_exp_f32 v212, v140
  v_add_f32 v27, v27, v211
  v_cvt_pk_bf16_f32 v197, v210, v211
  v_mfma_f32_32x32x16_bf16 v[144:159], a[220:223], v[124:127], v[144:159]
  ds_read_b128 a[216:219], v14 offset:24576
  v_exp_f32 v213, v141
  v_add_f32 v27, v27, v212
  s_add_u32 m0, s29, 0xe000
  v_mfma_f32_32x32x16_bf16 a[128:143], a[224:227], v[200:203], a[128:143]
  ds_read_b128 a[220:223], v15 offset:24576
  buffer_load_dwordx4 v20, s[12:15], s27 offen offset:0 nt lds
  v_exp_f32 v214, v142
  v_add_f32 v27, v27, v213
  v_cvt_pk_bf16_f32 v198, v212, v213
  v_mfma_f32_32x32x16_bf16 a[144:159], a[228:231], v[200:203], a[144:159]
  ds_read_b64_tr_b16 a[224:225], v16 offset:16384
  ds_read_b64_tr_b16 a[226:227], v16 offset:18432
  v_exp_f32 v215, v143
  v_add_f32 v27, v27, v214
  v_mfma_f32_32x32x16_bf16 a[160:175], a[232:235], v[200:203], a[160:175]
  ds_read_b64_tr_b16 a[228:229], v17 offset:16384
  buffer_load_dwordx4 v21, s[12:15], s27 offen offset:1024 nt lds
  v_exp_f32 v216, v144
  v_add_f32 v27, v27, v215
  v_cvt_pk_bf16_f32 v199, v214, v215
  v_mfma_f32_32x32x16_bf16 a[176:191], a[236:239], v[200:203], a[176:191]
  ds_read_b64_tr_b16 a[230:231], v17 offset:18432
  ds_read_b64_tr_b16 a[232:233], v18 offset:16384
  v_exp_f32 v217, v145
  v_cmp_nge_f32 vcc, 0x47800000, v27
  s_add_u32 m0, s29, 0x1c000
  v_mfma_f32_32x32x16_bf16 a[128:143], a[240:243], v[204:207], a[128:143]
  ds_read_b64_tr_b16 a[234:235], v18 offset:18432
  buffer_load_dwordx4 v22, s[16:19], s27 offen offset:0 nt lds
  s_cbranch_vccnz L1_caJ9
L1_raJ9:
  v_exp_f32 v218, v146
  v_add_f32 v28, v216, v217
  v_cvt_pk_bf16_f32 v200, v216, v217
  v_mfma_f32_32x32x16_bf16 a[144:159], a[244:247], v[204:207], a[144:159]
  ds_read_b64_tr_b16 a[236:237], v19 offset:16384
  v_exp_f32 v219, v147
  v_add_f32 v28, v28, v218
  v_add_f32 v25, v25, v27
  v_mfma_f32_32x32x16_bf16 a[160:175], a[248:251], v[204:207], a[160:175]
  ds_read_b64_tr_b16 a[238:239], v19 offset:18432
  buffer_load_dwordx4 v22, s[16:19], s27 offen offset:1024 nt lds
  v_exp_f32 v220, v148
  v_add_f32 v28, v28, v219
  v_cvt_pk_bf16_f32 v201, v218, v219
  v_mfma_f32_32x32x16_bf16 a[176:191], a[252:255], v[204:207], a[176:191]
  ds_read_b64_tr_b16 a[240:241], v16 offset:20480
  ds_read_b64_tr_b16 a[242:243], v16 offset:22528
  v_exp_f32 v221, v149
  v_add_f32 v28, v28, v220
  s_waitcnt lgkmcnt(10)
  v_mfma_f32_32x32x16_bf16 v[128:143], a[192:195], v[64:67], v[160:175]
  v_exp_f32 v222, v150
  v_add_f32 v28, v28, v221
  v_cvt_pk_bf16_f32 v202, v220, v221
  v_mfma_f32_32x32x16_bf16 v[128:143], a[196:199], v[68:71], v[128:143]
  ds_read_b64_tr_b16 a[244:245], v17 offset:20480
  ds_read_b64_tr_b16 a[246:247], v17 offset:22528
  v_exp_f32 v223, v151
  v_add_f32 v28, v28, v222
  v_mfma_f32_32x32x16_bf16 v[128:143], a[200:203], v[72:75], v[128:143]
  ds_read_b64_tr_b16 a[248:249], v18 offset:20480
  s_add_u32 s27, s27, 0x2000
  v_exp_f32 v216, v152
  v_add_f32 v28, v28, v223
  v_cvt_pk_bf16_f32 v203, v222, v223
  v_mfma_f32_32x32x16_bf16 v[128:143], a[204:207], v[76:79], v[128:143]
  ds_read_b64_tr_b16 a[250:251], v18 offset:22528
  ds_read_b64_tr_b16 a[252:253], v19 offset:20480
  v_exp_f32 v217, v153
  v_add_f32 v28, v28, v216
  v_mfma_f32_32x32x16_bf16 v[128:143], a[208:211], v[80:83], v[128:143]
  ds_read_b64_tr_b16 a[254:255], v19 offset:22528
  v_exp_f32 v218, v154
  v_add_f32 v28, v28, v217
  v_cvt_pk_bf16_f32 v204, v216, v217
  v_mfma_f32_32x32x16_bf16 v[128:143], a[212:215], v[84:87], v[128:143]
  v_exp_f32 v219, v155
  v_add_f32 v28, v28, v218
  v_mfma_f32_32x32x16_bf16 v[128:143], a[216:219], v[88:91], v[128:143]
  v_exp_f32 v220, v156
  v_add_f32 v28, v28, v219
  v_cvt_pk_bf16_f32 v205, v218, v219
  v_mfma_f32_32x32x16_bf16 v[128:143], a[220:223], v[92:95], v[128:143]
  v_exp_f32 v221, v157
  v_add_f32 v28, v28, v220
  s_waitcnt lgkmcnt(0)
  v_mfma_f32_32x32x16_bf16 v[224:239], a[224:227], v[192:195], v[224:239]
  v_exp_f32 v222, v158
  v_add_f32 v28, v28, v221
  v_cvt_pk_bf16_f32 v206, v220, v221
  v_mfma_f32_32x32x16_bf16 v[240:255], a[228:231], v[192:195], v[240:255]
  v_exp_f32 v223, v159
  v_add_f32 v28, v28, v222
  v_mfma_f32_32x32x16_bf16 v[32:47], a[232:235], v[192:195], v[32:47]
  v_exp_f32 v208, v128
  v_add_f32 v28, v28, v223
  v_cvt_pk_bf16_f32 v207, v222, v223
  v_mfma_f32_32x32x16_bf16 v[48:63], a[236:239], v[192:195], v[48:63]
  v_exp_f32 v209, v129
  v_cmp_nge_f32 vcc, 0x47800000, v28
  v_mfma_f32_32x32x16_bf16 v[224:239], a[240:243], v[196:199], v[224:239]
  s_cbranch_vccnz L1_cbJ10
L1_rbJ10:
  v_exp_f32 v210, v130
  v_add_f32 v27, v208, v209
  v_cvt_pk_bf16_f32 v192, v208, v209
  v_mfma_f32_32x32x16_bf16 v[240:255], a[244:247], v[196:199], v[240:255]
  v_exp_f32 v211, v131
  v_add_f32 v26, v26, v28
  v_add_f32 v27, v27, v210
  v_mfma_f32_32x32x16_bf16 v[32:47], a[248:251], v[196:199], v[32:47]
  v_exp_f32 v212, v132
  v_add_f32 v27, v27, v211
  v_cvt_pk_bf16_f32 v193, v210, v211
  v_mfma_f32_32x32x16_bf16 v[48:63], a[252:255], v[196:199], v[48:63]
  v_exp_f32 v213, v133
  v_add_f32 v27, v27, v212
  v_mfma_f32_32x32x16_bf16 v[144:159], a[192:195], v[96:99], v[176:191]
  s_waitcnt vmcnt(8)
  s_barrier
  v_exp_f32 v214, v134
  v_add_f32 v27, v27, v213
  v_cvt_pk_bf16_f32 v194, v212, v213
  v_mfma_f32_32x32x16_bf16 v[144:159], a[196:199], v[100:103], v[144:159]
  ds_read_b128 a[192:195], v8 offset:32768
  v_exp_f32 v215, v135
  v_add_f32 v27, v27, v214
  v_mfma_f32_32x32x16_bf16 v[144:159], a[200:203], v[104:107], v[144:159]
  ds_read_b128 a[196:199], v9 offset:32768
  v_exp_f32 v208, v136
  v_add_f32 v27, v27, v215
  v_cvt_pk_bf16_f32 v195, v214, v215
  v_mfma_f32_32x32x16_bf16 v[144:159], a[204:207], v[108:111], v[144:159]
  ds_read_b128 a[200:203], v10 offset:32768
  v_exp_f32 v209, v137
  v_add_f32 v27, v27, v208
  v_mfma_f32_32x32x16_bf16 v[144:159], a[208:211], v[112:115], v[144:159]
  ds_read_b128 a[204:207], v11 offset:32768
  v_exp_f32 v210, v138
  v_add_f32 v27, v27, v209
  v_cvt_pk_bf16_f32 v196, v208, v209
  v_mfma_f32_32x32x16_bf16 v[144:159], a[212:215], v[116:119], v[144:159]
  ds_read_b128 a[208:211], v12 offset:32768
  v_exp_f32 v211, v139
  v_add_f32 v27, v27, v210
  v_mfma_f32_32x32x16_bf16 v[144:159], a[216:219], v[120:123], v[144:159]
  ds_read_b128 a[212:215], v13 offset:32768
  v_exp_f32 v212, v140
  v_add_f32 v27, v27, v211
  v_cvt_pk_bf16_f32 v197, v210, v211
  v_mfma_f32_32x32x16_bf16 v[144:159], a[220:223], v[124:127], v[144:159]
  ds_read_b128 a[216:219], v14 offset:32768
  v_exp_f32 v213, v141
  v_add_f32 v27, v27, v212
  s_add_u32 m0, s29, 0x0
  v_mfma_f32_32x32x16_bf16 a[128:143], a[224:227], v[200:203], a[128:143]
  ds_read_b128 a[220:223], v15 offset:32768
  buffer_load_dwordx4 v20, s[12:15], s27 offen offset:0 nt lds
  v_exp_f32 v214, v142
  v_add_f32 v27, v27, v213
  v_cvt_pk_bf16_f32 v198, v212, v213
  v_mfma_f32_32x32x16_bf16 a[144:159], a[228:231], v[200:203], a[144:159]
  ds_read_b64_tr_b16 a[224:225], v16 offset:24576
  ds_read_b64_tr_b16 a[226:227], v16 offset:26624
  v_exp_f32 v215, v143
  v_add_f32 v27, v27, v214
  v_mfma_f32_32x32x16_bf16 a[160:175], a[232:235], v[200:203], a[160:175]
  ds_read_b64_tr_b16 a[228:229], v17 offset:24576
  buffer_load_dwordx4 v21, s[12:15], s27 offen offset:1024 nt lds
  v_exp_f32 v216, v144
  v_add_f32 v27, v27, v215
  v_cvt_pk_bf16_f32 v199, v214, v215
  v_mfma_f32_32x32x16_bf16 a[176:191], a[236:239], v[200:203], a[176:191]
  ds_read_b64_tr_b16 a[230:231], v17 offset:26624
  ds_read_b64_tr_b16 a[232:233], v18 offset:24576
  v_exp_f32 v217, v145
  v_cmp_nge_f32 vcc, 0x47800000, v27
  s_add_u32 m0, s29, 0x1e000
  v_mfma_f32_32x32x16_bf16 a[128:143], a[240:243], v[204:207], a[128:143]
  ds_read_b64_tr_b16 a[234:235], v18 offset:26624
  buffer_load_dwordx4 v22, s[16:19], s27 offen offset:0 nt lds
  s_cbranch_vccnz L1_caJ10
L1_raJ10:
  v_exp_f32 v218, v146
  v_add_f32 v28, v216, v217
  v_cvt_pk_bf16_f32 v200, v216, v217
  v_mfma_f32_32x32x16_bf16 a[144:159], a[244:247], v[204:207], a[144:159]
  ds_read_b64_tr_b16 a[236:237], v19 offset:24576
  v_exp_f32 v219, v147
  v_add_f32 v28, v28, v218
  v_add_f32 v25, v25, v27
  v_mfma_f32_32x32x16_bf16 a[160:175], a[248:251], v[204:207], a[160:175]
  ds_read_b64_tr_b16 a[238:239], v19 offset:26624
  buffer_load_dwordx4 v22, s[16:19], s27 offen offset:1024 nt lds
  v_exp_f32 v220, v148
  v_add_f32 v28, v28, v219
  v_cvt_pk_bf16_f32 v201, v218, v219
  v_mfma_f32_32x32x16_bf16 a[176:191], a[252:255], v[204:207], a[176:191]
  ds_read_b64_tr_b16 a[240:241], v16 offset:28672
  ds_read_b64_tr_b16 a[242:243], v16 offset:30720
  v_exp_f32 v221, v149
  v_add_f32 v28, v28, v220
  s_waitcnt lgkmcnt(10)
  v_mfma_f32_32x32x16_bf16 v[128:143], a[192:195], v[64:67], v[160:175]
  v_exp_f32 v222, v150
  v_add_f32 v28, v28, v221
  v_cvt_pk_bf16_f32 v202, v220, v221
  v_mfma_f32_32x32x16_bf16 v[128:143], a[196:199], v[68:71], v[128:143]
  ds_read_b64_tr_b16 a[244:245], v17 offset:28672
  ds_read_b64_tr_b16 a[246:247], v17 offset:30720
  v_exp_f32 v223, v151
  v_add_f32 v28, v28, v222
  v_mfma_f32_32x32x16_bf16 v[128:143], a[200:203], v[72:75], v[128:143]
  ds_read_b64_tr_b16 a[248:249], v18 offset:28672
  s_add_u32 s27, s27, 0x2000
  v_exp_f32 v216, v152
  v_add_f32 v28, v28, v223
  v_cvt_pk_bf16_f32 v203, v222, v223
  v_mfma_f32_32x32x16_bf16 v[128:143], a[204:207], v[76:79], v[128:143]
  ds_read_b64_tr_b16 a[250:251], v18 offset:30720
  ds_read_b64_tr_b16 a[252:253], v19 offset:28672
  v_exp_f32 v217, v153
  v_add_f32 v28, v28, v216
  v_mfma_f32_32x32x16_bf16 v[128:143], a[208:211], v[80:83], v[128:143]
  ds_read_b64_tr_b16 a[254:255], v19 offset:30720
  v_exp_f32 v218, v154
  v_add_f32 v28, v28, v217
  v_cvt_pk_bf16_f32 v204, v216, v217
  v_mfma_f32_32x32x16_bf16 v[128:143], a[212:215], v[84:87], v[128:143]
  v_exp_f32 v219, v155
  v_add_f32 v28, v28, v218
  v_mfma_f32_32x32x16_bf16 v[128:143], a[216:219], v[88:91], v[128:143]
  v_exp_f32 v220, v156
  v_add_f32 v28, v28, v219
  v_cvt_pk_bf16_f32 v205, v218, v219
  v_mfma_f32_32x32x16_bf16 v[128:143], a[220:223], v[92:95], v[128:143]
  v_exp_f32 v221, v157
  v_add_f32 v28, v28, v220
  s_waitcnt lgkmcnt(0)
  v_mfma_f32_32x32x16_bf16 v[224:239], a[224:227], v[192:195], v[224:239]
  v_exp_f32 v222, v158
  v_add_f32 v28, v28, v221
  v_cvt_pk_bf16_f32 v206, v220, v221
  v_mfma_f32_32x32x16_bf16 v[240:255], a[228:231], v[192:195], v[240:255]
  v_exp_f32 v223, v159
  v_add_f32 v28, v28, v222
  v_mfma_f32_32x32x16_bf16 v[32:47], a[232:235], v[192:195], v[32:47]
  v_exp_f32 v208, v128
  v_add_f32 v28, v28, v223
  v_cvt_pk_bf16_f32 v207, v222, v223
  v_mfma_f32_32x32x16_bf16 v[48:63], a[236:239], v[192:195], v[48:63]
  v_exp_f32 v209, v129
  v_cmp_nge_f32 vcc, 0x47800000, v28
  v_mfma_f32_32x32x16_bf16 v[224:239], a[240:243], v[196:199], v[224:239]
  s_cbranch_vccnz L1_cbJ11
L1_rbJ11:
  v_exp_f32 v210, v130
  v_add_f32 v27, v208, v209
  v_cvt_pk_bf16_f32 v192, v208, v209
  v_mfma_f32_32x32x16_bf16 v[240:255], a[244:247], v[196:199], v[240:255]
  v_exp_f32 v211, v131
  v_add_f32 v26, v26, v28
  v_add_f32 v27, v27, v210
  v_mfma_f32_32x32x16_bf16 v[32:47], a[248:251], v[196:199], v[32:47]
  v_exp_f32 v212, v132
  v_add_f32 v27, v27, v211
  v_cvt_pk_bf16_f32 v193, v210, v211
  v_mfma_f32_32x32x16_bf16 v[48:63], a[252:255], v[196:199], v[48:63]
  v_exp_f32 v213, v133
  v_add_f32 v27, v27, v212
  v_mfma_f32_32x32x16_bf16 v[144:159], a[192:195], v[96:99], v[176:191]
  v_exp_f32 v214, v134
  v_add_f32 v27, v27, v213
  v_cvt_pk_bf16_f32 v194, v212, v213
  v_mfma_f32_32x32x16_bf16 v[144:159], a[196:199], v[100:103], v[144:159]
  ds_read_b128 a[192:195], v8 offset:40960
  v_exp_f32 v215, v135
  v_add_f32 v27, v27, v214
  v_mfma_f32_32x32x16_bf16 v[144:159], a[200:203], v[104:107], v[144:159]
  ds_read_b128 a[196:199], v9 offset:40960
  v_exp_f32 v208, v136
  v_add_f32 v27, v27, v215
  v_cvt_pk_bf16_f32 v195, v214, v215
  v_mfma_f32_32x32x16_bf16 v[144:159], a[204:207], v[108:111], v[144:159]
  ds_read_b128 a[200:203], v10 offset:40960
  v_exp_f32 v209, v137
  v_add_f32 v27, v27, v208
  v_mfma_f32_32x32x16_bf16 v[144:159], a[208:211], v[112:115], v[144:159]
  ds_read_b128 a[204:207], v11 offset:40960
  v_exp_f32 v210, v138
  v_add_f32 v27, v27, v209
  v_cvt_pk_bf16_f32 v196, v208, v209
  v_mfma_f32_32x32x16_bf16 v[144:159], a[212:215], v[116:119], v[144:159]
  ds_read_b128 a[208:211], v12 offset:40960
  v_exp_f32 v211, v139
  v_add_f32 v27, v27, v210
  v_mfma_f32_32x32x16_bf16 v[144:159], a[216:219], v[120:123], v[144:159]
  ds_read_b128 a[212:215], v13 offset:40960
  v_exp_f32 v212, v140
  v_add_f32 v27, v27, v211
  v_cvt_pk_bf16_f32 v197, v210, v211
  v_mfma_f32_32x32x16_bf16 v[144:159], a[220:223], v[124:127], v[144:159]
  ds_read_b128 a[216:219], v14 offset:40960
  v_exp_f32 v213, v141
  v_add_f32 v27, v27, v212
  s_add_u32 m0, s29, 0x2000
  v_mfma_f32_32x32x16_bf16 a[128:143], a[224:227], v[200:203], a[128:143]
  ds_read_b128 a[220:223], v15 offset:40960
  buffer_load_dwordx4 v20, s[12:15], s27 offen offset:0 nt lds
  v_exp_f32 v214, v142
  v_add_f32 v27, v27, v213
  v_cvt_pk_bf16_f32 v198, v212, v213
  v_mfma_f32_32x32x16_bf16 a[144:159], a[228:231], v[200:203], a[144:159]
  ds_read_b64_tr_b16 a[224:225], v16 offset:32768
  ds_read_b64_tr_b16 a[226:227], v16 offset:34816
  v_exp_f32 v215, v143
  v_add_f32 v27, v27, v214
  v_mfma_f32_32x32x16_bf16 a[160:175], a[232:235], v[200:203], a[160:175]
  ds_read_b64_tr_b16 a[228:229], v17 offset:32768
  buffer_load_dwordx4 v21, s[12:15], s27 offen offset:1024 nt lds
  v_exp_f32 v216, v144
  v_add_f32 v27, v27, v215
  v_cvt_pk_bf16_f32 v199, v214, v215
  v_mfma_f32_32x32x16_bf16 a[176:191], a[236:239], v[200:203], a[176:191]
  ds_read_b64_tr_b16 a[230:231], v17 offset:34816
  ds_read_b64_tr_b16 a[232:233], v18 offset:32768
  v_exp_f32 v217, v145
  v_cmp_nge_f32 vcc, 0x47800000, v27
  s_add_u32 m0, s29, 0x10000
  v_mfma_f32_32x32x16_bf16 a[128:143], a[240:243], v[204:207], a[128:143]
  ds_read_b64_tr_b16 a[234:235], v18 offset:34816
  buffer_load_dwordx4 v22, s[16:19], s27 offen offset:0 nt lds
  s_cbranch_vccnz L1_caJ11
L1_raJ11:
  v_exp_f32 v218, v146
  v_add_f32 v28, v216, v217
  v_cvt_pk_bf16_f32 v200, v216, v217
  v_mfma_f32_32x32x16_bf16 a[144:159], a[244:247], v[204:207], a[144:159]
  ds_read_b64_tr_b16 a[236:237], v19 offset:32768
  v_exp_f32 v219, v147
  v_add_f32 v28, v28, v218
  v_add_f32 v25, v25, v27
  v_mfma_f32_32x32x16_bf16 a[160:175], a[248:251], v[204:207], a[160:175]
  ds_read_b64_tr_b16 a[238:239], v19 offset:34816
  buffer_load_dwordx4 v22, s[16:19], s27 offen offset:1024 nt lds
  v_exp_f32 v220, v148
  v_add_f32 v28, v28, v219
  v_cvt_pk_bf16_f32 v201, v218, v219
  v_mfma_f32_32x32x16_bf16 a[176:191], a[252:255], v[204:207], a[176:191]
  ds_read_b64_tr_b16 a[240:241], v16 offset:36864
  ds_read_b64_tr_b16 a[242:243], v16 offset:38912
  v_exp_f32 v221, v149
  v_add_f32 v28, v28, v220
  s_waitcnt lgkmcnt(10)
  v_mfma_f32_32x32x16_bf16 v[128:143], a[192:195], v[64:67], v[160:175]
  v_exp_f32 v222, v150
  v_add_f32 v28, v28, v221
  v_cvt_pk_bf16_f32 v202, v220, v221
  v_mfma_f32_32x32x16_bf16 v[128:143], a[196:199], v[68:71], v[128:143]
  ds_read_b64_tr_b16 a[244:245], v17 offset:36864
  ds_read_b64_tr_b16 a[246:247], v17 offset:38912
  v_exp_f32 v223, v151
  v_add_f32 v28, v28, v222
  v_mfma_f32_32x32x16_bf16 v[128:143], a[200:203], v[72:75], v[128:143]
  ds_read_b64_tr_b16 a[248:249], v18 offset:36864
  s_add_u32 s27, s27, 0x2000
  v_exp_f32 v216, v152
  v_add_f32 v28, v28, v223
  v_cvt_pk_bf16_f32 v203, v222, v223
  v_mfma_f32_32x32x16_bf16 v[128:143], a[204:207], v[76:79], v[128:143]
  ds_read_b64_tr_b16 a[250:251], v18 offset:38912
  ds_read_b64_tr_b16 a[252:253], v19 offset:36864
  v_exp_f32 v217, v153
  v_add_f32 v28, v28, v216
  v_mfma_f32_32x32x16_bf16 v[128:143], a[208:211], v[80:83], v[128:143]
  ds_read_b64_tr_b16 a[254:255], v19 offset:38912
  v_exp_f32 v218, v154
  v_add_f32 v28, v28, v217
  v_cvt_pk_bf16_f32 v204, v216, v217
  v_mfma_f32_32x32x16_bf16 v[128:143], a[212:215], v[84:87], v[128:143]
  v_exp_f32 v219, v155
  v_add_f32 v28, v28, v218
  v_mfma_f32_32x32x16_bf16 v[128:143], a[216:219], v[88:91], v[128:143]
  v_exp_f32 v220, v156
  v_add_f32 v28, v28, v219
  v_cvt_pk_bf16_f32 v205, v218, v219
  v_mfma_f32_32x32x16_bf16 v[128:143], a[220:223], v[92:95], v[128:143]
  v_exp_f32 v221, v157
  v_add_f32 v28, v28, v220
  s_waitcnt lgkmcnt(0)
  v_mfma_f32_32x32x16_bf16 v[224:239], a[224:227], v[192:195], v[224:239]
  v_exp_f32 v222, v158
  v_add_f32 v28, v28, v221
  v_cvt_pk_bf16_f32 v206, v220, v221
  v_mfma_f32_32x32x16_bf16 v[240:255], a[228:231], v[192:195], v[240:255]
  v_exp_f32 v223, v159
  v_add_f32 v28, v28, v222
  v_mfma_f32_32x32x16_bf16 v[32:47], a[232:235], v[192:195], v[32:47]
  v_exp_f32 v208, v128
  v_add_f32 v28, v28, v223
  v_cvt_pk_bf16_f32 v207, v222, v223
  v_mfma_f32_32x32x16_bf16 v[48:63], a[236:239], v[192:195], v[48:63]
  v_exp_f32 v209, v129
  v_cmp_nge_f32 vcc, 0x47800000, v28
  v_mfma_f32_32x32x16_bf16 v[224:239], a[240:243], v[196:199], v[224:239]
  s_cbranch_vccnz L1_cbJ12
L1_rbJ12:
  v_exp_f32 v210, v130
  v_add_f32 v27, v208, v209
  v_cvt_pk_bf16_f32 v192, v208, v209
  v_mfma_f32_32x32x16_bf16 v[240:255], a[244:247], v[196:199], v[240:255]
  v_exp_f32 v211, v131
  v_add_f32 v26, v26, v28
  v_add_f32 v27, v27, v210
  v_mfma_f32_32x32x16_bf16 v[32:47], a[248:251], v[196:199], v[32:47]
  v_exp_f32 v212, v132
  v_add_f32 v27, v27, v211
  v_cvt_pk_bf16_f32 v193, v210, v211
  v_mfma_f32_32x32x16_bf16 v[48:63], a[252:255], v[196:199], v[48:63]
  v_exp_f32 v213, v133
  v_add_f32 v27, v27, v212
  v_mfma_f32_32x32x16_bf16 v[144:159], a[192:195], v[96:99], v[176:191]
  s_waitcnt vmcnt(8)
  s_barrier
  v_exp_f32 v214, v134
  v_add_f32 v27, v27, v213
  v_cvt_pk_bf16_f32 v194, v212, v213
  v_mfma_f32_32x32x16_bf16 v[144:159], a[196:199], v[100:103], v[144:159]
  ds_read_b128 a[192:195], v8 offset:49152
  v_exp_f32 v215, v135
  v_add_f32 v27, v27, v214
  v_mfma_f32_32x32x16_bf16 v[144:159], a[200:203], v[104:107], v[144:159]
  ds_read_b128 a[196:199], v9 offset:49152
  v_exp_f32 v208, v136
  v_add_f32 v27, v27, v215
  v_cvt_pk_bf16_f32 v195, v214, v215
  v_mfma_f32_32x32x16_bf16 v[144:159], a[204:207], v[108:111], v[144:159]
  ds_read_b128 a[200:203], v10 offset:49152
  v_exp_f32 v209, v137
  v_add_f32 v27, v27, v208
  v_mfma_f32_32x32x16_bf16 v[144:159], a[208:211], v[112:115], v[144:159]
  ds_read_b128 a[204:207], v11 offset:49152
  v_exp_f32 v210, v138
  v_add_f32 v27, v27, v209
  v_cvt_pk_bf16_f32 v196, v208, v209
  v_mfma_f32_32x32x16_bf16 v[144:159], a[212:215], v[116:119], v[144:159]
  ds_read_b128 a[208:211], v12 offset:49152
  v_exp_f32 v211, v139
  v_add_f32 v27, v27, v210
  v_mfma_f32_32x32x16_bf16 v[144:159], a[216:219], v[120:123], v[144:159]
  ds_read_b128 a[212:215], v13 offset:49152
  v_exp_f32 v212, v140
  v_add_f32 v27, v27, v211
  v_cvt_pk_bf16_f32 v197, v210, v211
  v_mfma_f32_32x32x16_bf16 v[144:159], a[220:223], v[124:127], v[144:159]
  ds_read_b128 a[216:219], v14 offset:49152
  v_exp_f32 v213, v141
  v_add_f32 v27, v27, v212
  s_add_u32 m0, s29, 0x4000
  v_mfma_f32_32x32x16_bf16 a[128:143], a[224:227], v[200:203], a[128:143]
  ds_read_b128 a[220:223], v15 offset:49152
  buffer_load_dwordx4 v20, s[12:15], s27 offen offset:0 nt lds
  v_exp_f32 v214, v142
  v_add_f32 v27, v27, v213
  v_cvt_pk_bf16_f32 v198, v212, v213
  v_mfma_f32_32x32x16_bf16 a[144:159], a[228:231], v[200:203], a[144:159]
  ds_read_b64_tr_b16 a[224:225], v16 offset:40960
  ds_read_b64_tr_b16 a[226:227], v16 offset:43008
  v_exp_f32 v215, v143
  v_add_f32 v27, v27, v214
  v_mfma_f32_32x32x16_bf16 a[160:175], a[232:235], v[200:203], a[160:175]
  ds_read_b64_tr_b16 a[228:229], v17 offset:40960
  buffer_load_dwordx4 v21, s[12:15], s27 offen offset:1024 nt lds
  v_exp_f32 v216, v144
  v_add_f32 v27, v27, v215
  v_cvt_pk_bf16_f32 v199, v214, v215
  v_mfma_f32_32x32x16_bf16 a[176:191], a[236:239], v[200:203], a[176:191]
  ds_read_b64_tr_b16 a[230:231], v17 offset:43008
  ds_read_b64_tr_b16 a[232:233], v18 offset:40960
  v_exp_f32 v217, v145
  v_cmp_nge_f32 vcc, 0x47800000, v27
  s_add_u32 m0, s29, 0x12000
  v_mfma_f32_32x32x16_bf16 a[128:143], a[240:243], v[204:207], a[128:143]
  ds_read_b64_tr_b16 a[234:235], v18 offset:43008
  buffer_load_dwordx4 v22, s[16:19], s27 offen offset:0 nt lds
  s_cbranch_vccnz L1_caJ12
L1_raJ12:
  v_exp_f32 v218, v146
  v_add_f32 v28, v216, v217
  v_cvt_pk_bf16_f32 v200, v216, v217
  v_mfma_f32_32x32x16_bf16 a[144:159], a[244:247], v[204:207], a[144:159]
  ds_read_b64_tr_b16 a[236:237], v19 offset:40960
  v_exp_f32 v219, v147
  v_add_f32 v28, v28, v218
  v_add_f32 v25, v25, v27
  v_mfma_f32_32x32x16_bf16 a[160:175], a[248:251], v[204:207], a[160:175]
  ds_read_b64_tr_b16 a[238:239], v19 offset:43008
  buffer_load_dwordx4 v22, s[16:19], s27 offen offset:1024 nt lds
  v_exp_f32 v220, v148
  v_add_f32 v28, v28, v219
  v_cvt_pk_bf16_f32 v201, v218, v219
  v_mfma_f32_32x32x16_bf16 a[176:191], a[252:255], v[204:207], a[176:191]
  ds_read_b64_tr_b16 a[240:241], v16 offset:45056
  ds_read_b64_tr_b16 a[242:243], v16 offset:47104
  v_exp_f32 v221, v149
  v_add_f32 v28, v28, v220
  s_waitcnt lgkmcnt(10)
  v_mfma_f32_32x32x16_bf16 v[128:143], a[192:195], v[64:67], v[160:175]
  v_exp_f32 v222, v150
  v_add_f32 v28, v28, v221
  v_cvt_pk_bf16_f32 v202, v220, v221
  v_mfma_f32_32x32x16_bf16 v[128:143], a[196:199], v[68:71], v[128:143]
  ds_read_b64_tr_b16 a[244:245], v17 offset:45056
  ds_read_b64_tr_b16 a[246:247], v17 offset:47104
  v_exp_f32 v223, v151
  v_add_f32 v28, v28, v222
  v_mfma_f32_32x32x16_bf16 v[128:143], a[200:203], v[72:75], v[128:143]
  ds_read_b64_tr_b16 a[248:249], v18 offset:45056
  s_add_u32 s27, s27, 0x2000
  v_exp_f32 v216, v152
  v_add_f32 v28, v28, v223
  v_cvt_pk_bf16_f32 v203, v222, v223
  v_mfma_f32_32x32x16_bf16 v[128:143], a[204:207], v[76:79], v[128:143]
  ds_read_b64_tr_b16 a[250:251], v18 offset:47104
  ds_read_b64_tr_b16 a[252:253], v19 offset:45056
  v_exp_f32 v217, v153
  v_add_f32 v28, v28, v216
  v_mfma_f32_32x32x16_bf16 v[128:143], a[208:211], v[80:83], v[128:143]
  ds_read_b64_tr_b16 a[254:255], v19 offset:47104
  v_exp_f32 v218, v154
  v_add_f32 v28, v28, v217
  v_cvt_pk_bf16_f32 v204, v216, v217
  v_mfma_f32_32x32x16_bf16 v[128:143], a[212:215], v[84:87], v[128:143]
  v_exp_f32 v219, v155
  v_add_f32 v28, v28, v218
  v_mfma_f32_32x32x16_bf16 v[128:143], a[216:219], v[88:91], v[128:143]
  v_exp_f32 v220, v156
  v_add_f32 v28, v28, v219
  v_cvt_pk_bf16_f32 v205, v218, v219
  v_mfma_f32_32x32x16_bf16 v[128:143], a[220:223], v[92:95], v[128:143]
  v_exp_f32 v221, v157
  v_add_f32 v28, v28, v220
  s_waitcnt lgkmcnt(0)
  v_mfma_f32_32x32x16_bf16 v[224:239], a[224:227], v[192:195], v[224:239]
  v_exp_f32 v222, v158
  v_add_f32 v28, v28, v221
  v_cvt_pk_bf16_f32 v206, v220, v221
  v_mfma_f32_32x32x16_bf16 v[240:255], a[228:231], v[192:195], v[240:255]
  v_exp_f32 v223, v159
  v_add_f32 v28, v28, v222
  v_mfma_f32_32x32x16_bf16 v[32:47], a[232:235], v[192:195], v[32:47]
  v_exp_f32 v208, v128
  v_add_f32 v28, v28, v223
  v_cvt_pk_bf16_f32 v207, v222, v223
  v_mfma_f32_32x32x16_bf16 v[48:63], a[236:239], v[192:195], v[48:63]
  v_exp_f32 v209, v129
  v_cmp_nge_f32 vcc, 0x47800000, v28
  v_mfma_f32_32x32x16_bf16 v[224:239], a[240:243], v[196:199], v[224:239]
  s_cbranch_vccnz L1_cbJ13
L1_rbJ13:
  v_exp_f32 v210, v130
  v_add_f32 v27, v208, v209
  v_cvt_pk_bf16_f32 v192, v208, v209
  v_mfma_f32_32x32x16_bf16 v[240:255], a[244:247], v[196:199], v[240:255]
  v_exp_f32 v211, v131
  v_add_f32 v26, v26, v28
  v_add_f32 v27, v27, v210
  v_mfma_f32_32x32x16_bf16 v[32:47], a[248:251], v[196:199], v[32:47]
  v_exp_f32 v212, v132
  v_add_f32 v27, v27, v211
  v_cvt_pk_bf16_f32 v193, v210, v211
  v_mfma_f32_32x32x16_bf16 v[48:63], a[252:255], v[196:199], v[48:63]
  v_exp_f32 v213, v133
  v_add_f32 v27, v27, v212
  v_mfma_f32_32x32x16_bf16 v[144:159], a[192:195], v[96:99], v[176:191]
  v_exp_f32 v214, v134
  v_add_f32 v27, v27, v213
  v_cvt_pk_bf16_f32 v194, v212, v213
  v_mfma_f32_32x32x16_bf16 v[144:159], a[196:199], v[100:103], v[144:159]
  ds_read_b128 a[192:195], v8 offset:57344
  v_exp_f32 v215, v135
  v_add_f32 v27, v27, v214
  v_mfma_f32_32x32x16_bf16 v[144:159], a[200:203], v[104:107], v[144:159]
  ds_read_b128 a[196:199], v9 offset:57344
  v_exp_f32 v208, v136
  v_add_f32 v27, v27, v215
  v_cvt_pk_bf16_f32 v195, v214, v215
  v_mfma_f32_32x32x16_bf16 v[144:159], a[204:207], v[108:111], v[144:159]
  ds_read_b128 a[200:203], v10 offset:57344
  v_exp_f32 v209, v137
  v_add_f32 v27, v27, v208
  v_mfma_f32_32x32x16_bf16 v[144:159], a[208:211], v[112:115], v[144:159]
  ds_read_b128 a[204:207], v11 offset:57344
  v_exp_f32 v210, v138
  v_add_f32 v27, v27, v209
  v_cvt_pk_bf16_f32 v196, v208, v209
  v_mfma_f32_32x32x16_bf16 v[144:159], a[212:215], v[116:119], v[144:159]
  ds_read_b128 a[208:211], v12 offset:57344
  v_exp_f32 v211, v139
  v_add_f32 v27, v27, v210
  v_mfma_f32_32x32x16_bf16 v[144:159], a[216:219], v[120:123], v[144:159]
  ds_read_b128 a[212:215], v13 offset:57344
  v_exp_f32 v212, v140
  v_add_f32 v27, v27, v211
  v_cvt_pk_bf16_f32 v197, v210, v211
  v_mfma_f32_32x32x16_bf16 v[144:159], a[220:223], v[124:127], v[144:159]
  ds_read_b128 a[216:219], v14 offset:57344
  v_exp_f32 v213, v141
  v_add_f32 v27, v27, v212
  s_add_u32 m0, s29, 0x6000
  v_mfma_f32_32x32x16_bf16 a[128:143], a[224:227], v[200:203], a[128:143]
  ds_read_b128 a[220:223], v15 offset:57344
  buffer_load_dwordx4 v20, s[12:15], s27 offen offset:0 nt lds
  v_exp_f32 v214, v142
  v_add_f32 v27, v27, v213
  v_cvt_pk_bf16_f32 v198, v212, v213
  v_mfma_f32_32x32x16_bf16 a[144:159], a[228:231], v[200:203], a[144:159]
  ds_read_b64_tr_b16 a[224:225], v16 offset:49152
  ds_read_b64_tr_b16 a[226:227], v16 offset:51200
  v_exp_f32 v215, v143
  v_add_f32 v27, v27, v214
  v_mfma_f32_32x32x16_bf16 a[160:175], a[232:235], v[200:203], a[160:175]
  ds_read_b64_tr_b16 a[228:229], v17 offset:49152
  buffer_load_dwordx4 v21, s[12:15], s27 offen offset:1024 nt lds
  v_exp_f32 v216, v144
  v_add_f32 v27, v27, v215
  v_cvt_pk_bf16_f32 v199, v214, v215
  v_mfma_f32_32x32x16_bf16 a[176:191], a[236:239], v[200:203], a[176:191]
  ds_read_b64_tr_b16 a[230:231], v17 offset:51200
  ds_read_b64_tr_b16 a[232:233], v18 offset:49152
  v_exp_f32 v217, v145
  v_cmp_nge_f32 vcc, 0x47800000, v27
  s_add_u32 m0, s29, 0x14000
  v_mfma_f32_32x32x16_bf16 a[128:143], a[240:243], v[204:207], a[128:143]
  ds_read_b64_tr_b16 a[234:235], v18 offset:51200
  buffer_load_dwordx4 v22, s[16:19], s27 offen offset:0 nt lds
  s_cbranch_vccnz L1_caJ13
L1_raJ13:
  v_exp_f32 v218, v146
  v_add_f32 v28, v216, v217
  v_cvt_pk_bf16_f32 v200, v216, v217
  v_mfma_f32_32x32x16_bf16 a[144:159], a[244:247], v[204:207], a[144:159]
  ds_read_b64_tr_b16 a[236:237], v19 offset:49152
  v_exp_f32 v219, v147
  v_add_f32 v28, v28, v218
  v_add_f32 v25, v25, v27
  v_mfma_f32_32x32x16_bf16 a[160:175], a[248:251], v[204:207], a[160:175]
  ds_read_b64_tr_b16 a[238:239], v19 offset:51200
  buffer_load_dwordx4 v22, s[16:19], s27 offen offset:1024 nt lds
  v_exp_f32 v220, v148
  v_add_f32 v28, v28, v219
  v_cvt_pk_bf16_f32 v201, v218, v219
  v_mfma_f32_32x32x16_bf16 a[176:191], a[252:255], v[204:207], a[176:191]
  ds_read_b64_tr_b16 a[240:241], v16 offset:53248
  ds_read_b64_tr_b16 a[242:243], v16 offset:55296
  v_exp_f32 v221, v149
  v_add_f32 v28, v28, v220
  s_waitcnt lgkmcnt(10)
  v_mfma_f32_32x32x16_bf16 v[128:143], a[192:195], v[64:67], v[160:175]
  v_exp_f32 v222, v150
  v_add_f32 v28, v28, v221
  v_cvt_pk_bf16_f32 v202, v220, v221
  v_mfma_f32_32x32x16_bf16 v[128:143], a[196:199], v[68:71], v[128:143]
  ds_read_b64_tr_b16 a[244:245], v17 offset:53248
  ds_read_b64_tr_b16 a[246:247], v17 offset:55296
  v_exp_f32 v223, v151
  v_add_f32 v28, v28, v222
  v_mfma_f32_32x32x16_bf16 v[128:143], a[200:203], v[72:75], v[128:143]
  ds_read_b64_tr_b16 a[248:249], v18 offset:53248
  s_add_u32 s27, s27, 0x2000
  v_exp_f32 v216, v152
  v_add_f32 v28, v28, v223
  v_cvt_pk_bf16_f32 v203, v222, v223
  v_mfma_f32_32x32x16_bf16 v[128:143], a[204:207], v[76:79], v[128:143]
  ds_read_b64_tr_b16 a[250:251], v18 offset:55296
  ds_read_b64_tr_b16 a[252:253], v19 offset:53248
  v_exp_f32 v217, v153
  v_add_f32 v28, v28, v216
  v_mfma_f32_32x32x16_bf16 v[128:143], a[208:211], v[80:83], v[128:143]
  ds_read_b64_tr_b16 a[254:255], v19 offset:55296
  v_exp_f32 v218, v154
  v_add_f32 v28, v28, v217
  v_cvt_pk_bf16_f32 v204, v216, v217
  v_mfma_f32_32x32x16_bf16 v[128:143], a[212:215], v[84:87], v[128:143]
  v_exp_f32 v219, v155
  v_add_f32 v28, v28, v218
  v_mfma_f32_32x32x16_bf16 v[128:143], a[216:219], v[88:91], v[128:143]
  v_exp_f32 v220, v156
  v_add_f32 v28, v28, v219
  v_cvt_pk_bf16_f32 v205, v218, v219
  v_mfma_f32_32x32x16_bf16 v[128:143], a[220:223], v[92:95], v[128:143]
  v_exp_f32 v221, v157
  v_add_f32 v28, v28, v220
  s_waitcnt lgkmcnt(0)
  v_mfma_f32_32x32x16_bf16 v[224:239], a[224:227], v[192:195], v[224:239]
  v_exp_f32 v222, v158
  v_add_f32 v28, v28, v221
  v_cvt_pk_bf16_f32 v206, v220, v221
  v_mfma_f32_32x32x16_bf16 v[240:255], a[228:231], v[192:195], v[240:255]
  v_exp_f32 v223, v159
  v_add_f32 v28, v28, v222
  v_mfma_f32_32x32x16_bf16 v[32:47], a[232:235], v[192:195], v[32:47]
  v_exp_f32 v208, v128
  v_add_f32 v28, v28, v223
  v_cvt_pk_bf16_f32 v207, v222, v223
  v_mfma_f32_32x32x16_bf16 v[48:63], a[236:239], v[192:195], v[48:63]
  v_exp_f32 v209, v129
  v_cmp_nge_f32 vcc, 0x47800000, v28
  v_mfma_f32_32x32x16_bf16 v[224:239], a[240:243], v[196:199], v[224:239]
  s_cbranch_vccnz L1_cbJ14
L1_rbJ14:
  v_exp_f32 v210, v130
  v_add_f32 v27, v208, v209
  v_cvt_pk_bf16_f32 v192, v208, v209
  v_mfma_f32_32x32x16_bf16 v[240:255], a[244:247], v[196:199], v[240:255]
  v_exp_f32 v211, v131
  v_add_f32 v26, v26, v28
  v_add_f32 v27, v27, v210
  v_mfma_f32_32x32x16_bf16 v[32:47], a[248:251], v[196:199], v[32:47]
  s_mov_b32 s30, 0
  v_exp_f32 v212, v132
  v_add_f32 v27, v27, v211
  v_cvt_pk_bf16_f32 v193, v210, v211
  v_mfma_f32_32x32x16_bf16 v[48:63], a[252:255], v[196:199], v[48:63]
  v_exp_f32 v213, v133
  v_add_f32 v27, v27, v212
  v_mfma_f32_32x32x16_bf16 v[144:159], a[192:195], v[96:99], v[176:191]
  s_waitcnt vmcnt(8)
  s_barrier
  v_exp_f32 v214, v134
  v_add_f32 v27, v27, v213
  v_cvt_pk_bf16_f32 v194, v212, v213
  v_mfma_f32_32x32x16_bf16 v[144:159], a[196:199], v[100:103], v[144:159]
  ds_read_b128 a[192:195], v8 offset:0
  v_exp_f32 v215, v135
  v_add_f32 v27, v27, v214
  v_mfma_f32_32x32x16_bf16 v[144:159], a[200:203], v[104:107], v[144:159]
  ds_read_b128 a[196:199], v9 offset:0
  v_exp_f32 v208, v136
  v_add_f32 v27, v27, v215
  v_cvt_pk_bf16_f32 v195, v214, v215
  v_mfma_f32_32x32x16_bf16 v[144:159], a[204:207], v[108:111], v[144:159]
  ds_read_b128 a[200:203], v10 offset:0
  v_exp_f32 v209, v137
  v_add_f32 v27, v27, v208
  v_mfma_f32_32x32x16_bf16 v[144:159], a[208:211], v[112:115], v[144:159]
  ds_read_b128 a[204:207], v11 offset:0
  v_exp_f32 v210, v138
  v_add_f32 v27, v27, v209
  v_cvt_pk_bf16_f32 v196, v208, v209
  v_mfma_f32_32x32x16_bf16 v[144:159], a[212:215], v[116:119], v[144:159]
  ds_read_b128 a[208:211], v12 offset:0
  v_exp_f32 v211, v139
  v_add_f32 v27, v27, v210
  v_mfma_f32_32x32x16_bf16 v[144:159], a[216:219], v[120:123], v[144:159]
  ds_read_b128 a[212:215], v13 offset:0
  v_exp_f32 v212, v140
  v_add_f32 v27, v27, v211
  v_cvt_pk_bf16_f32 v197, v210, v211
  v_mfma_f32_32x32x16_bf16 v[144:159], a[220:223], v[124:127], v[144:159]
  ds_read_b128 a[216:219], v14 offset:0
  v_exp_f32 v213, v141
  v_add_f32 v27, v27, v212
  s_add_u32 m0, s29, 0x8000
  v_mfma_f32_32x32x16_bf16 a[128:143], a[224:227], v[200:203], a[128:143]
  ds_read_b128 a[220:223], v15 offset:0
  buffer_load_dwordx4 v20, s[12:15], s27 offen offset:0 nt lds
  v_exp_f32 v214, v142
  v_add_f32 v27, v27, v213
  v_cvt_pk_bf16_f32 v198, v212, v213
  v_mfma_f32_32x32x16_bf16 a[144:159], a[228:231], v[200:203], a[144:159]
  ds_read_b64_tr_b16 a[224:225], v16 offset:57344
  ds_read_b64_tr_b16 a[226:227], v16 offset:59392
  v_exp_f32 v215, v143
  v_add_f32 v27, v27, v214
  v_mfma_f32_32x32x16_bf16 a[160:175], a[232:235], v[200:203], a[160:175]
  ds_read_b64_tr_b16 a[228:229], v17 offset:57344
  buffer_load_dwordx4 v21, s[12:15], s27 offen offset:1024 nt lds
  v_exp_f32 v216, v144
  v_add_f32 v27, v27, v215
  v_cvt_pk_bf16_f32 v199, v214, v215
  v_mfma_f32_32x32x16_bf16 a[176:191], a[236:239], v[200:203], a[176:191]
  ds_read_b64_tr_b16 a[230:231], v17 offset:59392
  ds_read_b64_tr_b16 a[232:233], v18 offset:57344
  v_exp_f32 v217, v145
  v_cmp_nge_f32 vcc, 0x47800000, v27
  s_add_u32 m0, s29, 0x16000
  v_mfma_f32_32x32x16_bf16 a[128:143], a[240:243], v[204:207], a[128:143]
  ds_read_b64_tr_b16 a[234:235], v18 offset:59392
  buffer_load_dwordx4 v22, s[16:19], s27 offen offset:0 nt lds
  s_cbranch_vccnz L1_caJ14
L1_raJ14:
  v_exp_f32 v218, v146
  v_add_f32 v28, v216, v217
  v_cvt_pk_bf16_f32 v200, v216, v217
  v_mfma_f32_32x32x16_bf16 a[144:159], a[244:247], v[204:207], a[144:159]
  ds_read_b64_tr_b16 a[236:237], v19 offset:57344
  v_exp_f32 v219, v147
  v_add_f32 v28, v28, v218
  v_add_f32 v25, v25, v27
  v_mfma_f32_32x32x16_bf16 a[160:175], a[248:251], v[204:207], a[160:175]
  ds_read_b64_tr_b16 a[238:239], v19 offset:59392
  buffer_load_dwordx4 v22, s[16:19], s27 offen offset:1024 nt lds
  v_exp_f32 v220, v148
  v_add_f32 v28, v28, v219
  v_cvt_pk_bf16_f32 v201, v218, v219
  v_mfma_f32_32x32x16_bf16 a[176:191], a[252:255], v[204:207], a[176:191]
  ds_read_b64_tr_b16 a[240:241], v16 offset:61440
  ds_read_b64_tr_b16 a[242:243], v16 offset:63488
  v_exp_f32 v221, v149
  v_add_f32 v28, v28, v220
  v_lshlrev_b32 v29, 11, v5
  v_lshl_add_u32 v29, v6, 4, v29
L1_lp1:
  s_waitcnt lgkmcnt(10)
  v_mfma_f32_32x32x16_bf16 v[128:143], a[192:195], v[64:67], v[160:175]
  v_exp_f32 v222, v150
  v_add_f32 v28, v28, v221
  v_cvt_pk_bf16_f32 v202, v220, v221
  v_mfma_f32_32x32x16_bf16 v[128:143], a[196:199], v[68:71], v[128:143]
  ds_read_b64_tr_b16 a[244:245], v17 offset:61440
  ds_read_b64_tr_b16 a[246:247], v17 offset:63488
  v_exp_f32 v223, v151
  v_add_f32 v28, v28, v222
  v_mfma_f32_32x32x16_bf16 v[128:143], a[200:203], v[72:75], v[128:143]
  ds_read_b64_tr_b16 a[248:249], v18 offset:61440
  s_add_u32 s27, s27, 0x2000
  v_exp_f32 v216, v152
  v_add_f32 v28, v28, v223
  v_cvt_pk_bf16_f32 v203, v222, v223
  v_mfma_f32_32x32x16_bf16 v[128:143], a[204:207], v[76:79], v[128:143]
  ds_read_b64_tr_b16 a[250:251], v18 offset:63488
  ds_read_b64_tr_b16 a[252:253], v19 offset:61440
  v_exp_f32 v217, v153
  v_add_f32 v28, v28, v216
  v_mfma_f32_32x32x16_bf16 v[128:143], a[208:211], v[80:83], v[128:143]
  ds_read_b64_tr_b16 a[254:255], v19 offset:63488
  v_exp_f32 v218, v154
  v_add_f32 v28, v28, v217
  v_cvt_pk_bf16_f32 v204, v216, v217
  v_mfma_f32_32x32x16_bf16 v[128:143], a[212:215], v[84:87], v[128:143]
  v_exp_f32 v219, v155
  v_add_f32 v28, v28, v218
  v_mfma_f32_32x32x16_bf16 v[128:143], a[216:219], v[88:91], v[128:143]
  v_exp_f32 v220, v156
  v_add_f32 v28, v28, v219
  v_cvt_pk_bf16_f32 v205, v218, v219
  v_mfma_f32_32x32x16_bf16 v[128:143], a[220:223], v[92:95], v[128:143]
  v_exp_f32 v221, v157
  v_add_f32 v28, v28, v220
  s_waitcnt lgkmcnt(0)
  v_mfma_f32_32x32x16_bf16 v[224:239], a[224:227], v[192:195], v[224:239]
  v_exp_f32 v222, v158
  v_add_f32 v28, v28, v221
  v_cvt_pk_bf16_f32 v206, v220, v221
  v_mfma_f32_32x32x16_bf16 v[240:255], a[228:231], v[192:195], v[240:255]
  v_exp_f32 v223, v159
  v_add_f32 v28, v28, v222
  v_mfma_f32_32x32x16_bf16 v[32:47], a[232:235], v[192:195], v[32:47]
  v_exp_f32 v208, v128
  v_add_f32 v28, v28, v223
  v_cvt_pk_bf16_f32 v207, v222, v223
  v_mfma_f32_32x32x16_bf16 v[48:63], a[236:239], v[192:195], v[48:63]
  v_exp_f32 v209, v129
  v_cmp_nge_f32 vcc, 0x47800000, v28
  v_mfma_f32_32x32x16_bf16 v[224:239], a[240:243], v[196:199], v[224:239]
  s_cbranch_vccnz L1_cbp0
L1_rbp0:
  v_exp_f32 v210, v130
  v_add_f32 v27, v208, v209
  v_cvt_pk_bf16_f32 v192, v208, v209
  v_mfma_f32_32x32x16_bf16 v[240:255], a[244:247], v[196:199], v[240:255]
  v_exp_f32 v211, v131
  v_add_f32 v26, v26, v28
  v_add_f32 v27, v27, v210
  v_mfma_f32_32x32x16_bf16 v[32:47], a[248:251], v[196:199], v[32:47]
  buffer_load_dwordx4 a[64:67], v29, s[92:95], s3 offen
  v_exp_f32 v212, v132
  v_add_f32 v27, v27, v211
  v_cvt_pk_bf16_f32 v193, v210, v211
  v_mfma_f32_32x32x16_bf16 v[48:63], a[252:255], v[196:199], v[48:63]
  s_add_u32 s3, s3, 0x2000
  v_exp_f32 v213, v133
  v_add_f32 v27, v27, v212
  v_mfma_f32_32x32x16_bf16 v[144:159], a[192:195], v[96:99], v[176:191]
  v_exp_f32 v214, v134
  v_add_f32 v27, v27, v213
  v_cvt_pk_bf16_f32 v194, v212, v213
  v_mfma_f32_32x32x16_bf16 v[144:159], a[196:199], v[100:103], v[144:159]
  ds_read_b128 a[192:195], v8 offset:8192
  v_exp_f32 v215, v135
  v_add_f32 v27, v27, v214
  v_mfma_f32_32x32x16_bf16 v[144:159], a[200:203], v[104:107], v[144:159]
  ds_read_b128 a[196:199], v9 offset:8192
  v_exp_f32 v208, v136
  v_add_f32 v27, v27, v215
  v_cvt_pk_bf16_f32 v195, v214, v215
  v_mfma_f32_32x32x16_bf16 v[144:159], a[204:207], v[108:111], v[144:159]
  ds_read_b128 a[200:203], v10 offset:8192
  v_exp_f32 v209, v137
  v_add_f32 v27, v27, v208
  v_mfma_f32_32x32x16_bf16 v[144:159], a[208:211], v[112:115], v[144:159]
  ds_read_b128 a[204:207], v11 offset:8192
  v_exp_f32 v210, v138
  v_add_f32 v27, v27, v209
  v_cvt_pk_bf16_f32 v196, v208, v209
  v_mfma_f32_32x32x16_bf16 v[144:159], a[212:215], v[116:119], v[144:159]
  ds_read_b128 a[208:211], v12 offset:8192
  v_exp_f32 v211, v139
  v_add_f32 v27, v27, v210
  v_mfma_f32_32x32x16_bf16 v[144:159], a[216:219], v[120:123], v[144:159]
  ds_read_b128 a[212:215], v13 offset:8192
  v_exp_f32 v212, v140
  v_add_f32 v27, v27, v211
  v_cvt_pk_bf16_f32 v197, v210, v211
  v_mfma_f32_32x32x16_bf16 v[144:159], a[220:223], v[124:127], v[144:159]
  ds_read_b128 a[216:219], v14 offset:8192
  v_exp_f32 v213, v141
  v_add_f32 v27, v27, v212
  s_add_u32 m0, s29, 0xa000
  v_mfma_f32_32x32x16_bf16 a[128:143], a[224:227], v[200:203], a[128:143]
  ds_read_b128 a[220:223], v15 offset:8192
  buffer_load_dwordx4 v20, s[12:15], s27 offen offset:0 nt lds
  v_exp_f32 v214, v142
  v_add_f32 v27, v27, v213
  v_cvt_pk_bf16_f32 v198, v212, v213
  v_mfma_f32_32x32x16_bf16 a[144:159], a[228:231], v[200:203], a[144:159]
  ds_read_b64_tr_b16 a[224:225], v16 offset:0
  ds_read_b64_tr_b16 a[226:227], v16 offset:2048
  v_exp_f32 v215, v143
  v_add_f32 v27, v27, v214
  v_mfma_f32_32x32x16_bf16 a[160:175], a[232:235], v[200:203], a[160:175]
  ds_read_b64_tr_b16 a[228:229], v17 offset:0
  buffer_load_dwordx4 v21, s[12:15], s27 offen offset:1024 nt lds
  v_exp_f32 v216, v144
  v_add_f32 v27, v27, v215
  v_cvt_pk_bf16_f32 v199, v214, v215
  v_mfma_f32_32x32x16_bf16 a[176:191], a[236:239], v[200:203], a[176:191]
  ds_read_b64_tr_b16 a[230:231], v17 offset:2048
  ds_read_b64_tr_b16 a[232:233], v18 offset:0
  v_exp_f32 v217, v145
  v_cmp_nge_f32 vcc, 0x47800000, v27
  s_add_u32 m0, s29, 0x18000
  v_mfma_f32_32x32x16_bf16 a[128:143], a[240:243], v[204:207], a[128:143]
  ds_read_b64_tr_b16 a[234:235], v18 offset:2048
  buffer_load_dwordx4 v22, s[16:19], s27 offen offset:0 nt lds
  s_cbranch_vccnz L1_cap0
L1_rap0:
  v_exp_f32 v218, v146
  v_add_f32 v28, v216, v217
  v_cvt_pk_bf16_f32 v200, v216, v217
  v_mfma_f32_32x32x16_bf16 a[144:159], a[244:247], v[204:207], a[144:159]
  ds_read_b64_tr_b16 a[236:237], v19 offset:0
  v_exp_f32 v219, v147
  v_add_f32 v28, v28, v218
  v_add_f32 v25, v25, v27
  v_mfma_f32_32x32x16_bf16 a[160:175], a[248:251], v[204:207], a[160:175]
  ds_read_b64_tr_b16 a[238:239], v19 offset:2048
  buffer_load_dwordx4 v22, s[16:19], s27 offen offset:1024 nt lds
  v_exp_f32 v220, v148
  v_add_f32 v28, v28, v219
  v_cvt_pk_bf16_f32 v201, v218, v219
  v_mfma_f32_32x32x16_bf16 a[176:191], a[252:255], v[204:207], a[176:191]
  ds_read_b64_tr_b16 a[240:241], v16 offset:4096
  ds_read_b64_tr_b16 a[242:243], v16 offset:6144
  v_exp_f32 v221, v149
  v_add_f32 v28, v28, v220
  s_waitcnt lgkmcnt(10)
  v_mfma_f32_32x32x16_bf16 v[128:143], a[192:195], v[64:67], v[160:175]
  v_exp_f32 v222, v150
  v_add_f32 v28, v28, v221
  v_cvt_pk_bf16_f32 v202, v220, v221
  v_mfma_f32_32x32x16_bf16 v[128:143], a[196:199], v[68:71], v[128:143]
  ds_read_b64_tr_b16 a[244:245], v17 offset:4096
  ds_read_b64_tr_b16 a[246:247], v17 offset:6144
  v_exp_f32 v223, v151
  v_add_f32 v28, v28, v222
  v_mfma_f32_32x32x16_bf16 v[128:143], a[200:203], v[72:75], v[128:143]
  ds_read_b64_tr_b16 a[248:249], v18 offset:4096
  s_add_u32 s27, s27, 0x2000
  v_exp_f32 v216, v152
  v_add_f32 v28, v28, v223
  v_cvt_pk_bf16_f32 v203, v222, v223
  v_mfma_f32_32x32x16_bf16 v[128:143], a[204:207], v[76:79], v[128:143]
  ds_read_b64_tr_b16 a[250:251], v18 offset:6144
  ds_read_b64_tr_b16 a[252:253], v19 offset:4096
  buffer_load_dwordx4 a[68:71], v29, s[92:95], s3 offen
  v_exp_f32 v217, v153
  v_add_f32 v28, v28, v216
  v_mfma_f32_32x32x16_bf16 v[128:143], a[208:211], v[80:83], v[128:143]
  ds_read_b64_tr_b16 a[254:255], v19 offset:6144
  s_add_u32 s3, s3, 0x2000
  v_exp_f32 v218, v154
  v_add_f32 v28, v28, v217
  v_cvt_pk_bf16_f32 v204, v216, v217
  v_mfma_f32_32x32x16_bf16 v[128:143], a[212:215], v[84:87], v[128:143]
  v_exp_f32 v219, v155
  v_add_f32 v28, v28, v218
  v_mfma_f32_32x32x16_bf16 v[128:143], a[216:219], v[88:91], v[128:143]
  v_exp_f32 v220, v156
  v_add_f32 v28, v28, v219
  v_cvt_pk_bf16_f32 v205, v218, v219
  v_mfma_f32_32x32x16_bf16 v[128:143], a[220:223], v[92:95], v[128:143]
  v_exp_f32 v221, v157
  v_add_f32 v28, v28, v220
  s_waitcnt lgkmcnt(0)
  v_mfma_f32_32x32x16_bf16 v[224:239], a[224:227], v[192:195], v[224:239]
  v_exp_f32 v222, v158
  v_add_f32 v28, v28, v221
  v_cvt_pk_bf16_f32 v206, v220, v221
  v_mfma_f32_32x32x16_bf16 v[240:255], a[228:231], v[192:195], v[240:255]
  v_exp_f32 v223, v159
  v_add_f32 v28, v28, v222
  v_mfma_f32_32x32x16_bf16 v[32:47], a[232:235], v[192:195], v[32:47]
  v_exp_f32 v208, v128
  v_add_f32 v28, v28, v223
  v_cvt_pk_bf16_f32 v207, v222, v223
  v_mfma_f32_32x32x16_bf16 v[48:63], a[236:239], v[192:195], v[48:63]
  v_exp_f32 v209, v129
  v_cmp_nge_f32 vcc, 0x47800000, v28
  v_mfma_f32_32x32x16_bf16 v[224:239], a[240:243], v[196:199], v[224:239]
  s_cbranch_vccnz L1_cbp1
L1_rbp1:
  v_exp_f32 v210, v130
  v_add_f32 v27, v208, v209
  v_cvt_pk_bf16_f32 v192, v208, v209
  v_mfma_f32_32x32x16_bf16 v[240:255], a[244:247], v[196:199], v[240:255]
  v_exp_f32 v211, v131
  v_add_f32 v26, v26, v28
  v_add_f32 v27, v27, v210
  v_mfma_f32_32x32x16_bf16 v[32:47], a[248:251], v[196:199], v[32:47]
  v_exp_f32 v212, v132
  v_add_f32 v27, v27, v211
  v_cvt_pk_bf16_f32 v193, v210, v211
  v_mfma_f32_32x32x16_bf16 v[48:63], a[252:255], v[196:199], v[48:63]
  v_exp_f32 v213, v133
  v_add_f32 v27, v27, v212
  v_mfma_f32_32x32x16_bf16 v[144:159], a[192:195], v[96:99], v[176:191]
  s_waitcnt vmcnt(10)
  s_barrier
  v_exp_f32 v214, v134
  v_add_f32 v27, v27, v213
  v_cvt_pk_bf16_f32 v194, v212, v213
  v_mfma_f32_32x32x16_bf16 v[144:159], a[196:199], v[100:103], v[144:159]
  ds_read_b128 a[192:195], v8 offset:16384
  v_exp_f32 v215, v135
  v_add_f32 v27, v27, v214
  v_mfma_f32_32x32x16_bf16 v[144:159], a[200:203], v[104:107], v[144:159]
  ds_read_b128 a[196:199], v9 offset:16384
  v_exp_f32 v208, v136
  v_add_f32 v27, v27, v215
  v_cvt_pk_bf16_f32 v195, v214, v215
  v_mfma_f32_32x32x16_bf16 v[144:159], a[204:207], v[108:111], v[144:159]
  ds_read_b128 a[200:203], v10 offset:16384
  v_exp_f32 v209, v137
  v_add_f32 v27, v27, v208
  v_mfma_f32_32x32x16_bf16 v[144:159], a[208:211], v[112:115], v[144:159]
  ds_read_b128 a[204:207], v11 offset:16384
  v_exp_f32 v210, v138
  v_add_f32 v27, v27, v209
  v_cvt_pk_bf16_f32 v196, v208, v209
  v_mfma_f32_32x32x16_bf16 v[144:159], a[212:215], v[116:119], v[144:159]
  ds_read_b128 a[208:211], v12 offset:16384
  v_exp_f32 v211, v139
  v_add_f32 v27, v27, v210
  v_mfma_f32_32x32x16_bf16 v[144:159], a[216:219], v[120:123], v[144:159]
  ds_read_b128 a[212:215], v13 offset:16384
  v_exp_f32 v212, v140
  v_add_f32 v27, v27, v211
  v_cvt_pk_bf16_f32 v197, v210, v211
  v_mfma_f32_32x32x16_bf16 v[144:159], a[220:223], v[124:127], v[144:159]
  ds_read_b128 a[216:219], v14 offset:16384
  v_exp_f32 v213, v141
  v_add_f32 v27, v27, v212
  s_add_u32 m0, s29, 0xc000
  v_mfma_f32_32x32x16_bf16 a[128:143], a[224:227], v[200:203], a[128:143]
  ds_read_b128 a[220:223], v15 offset:16384
  buffer_load_dwordx4 v20, s[12:15], s27 offen offset:0 nt lds
  v_exp_f32 v214, v142
  v_add_f32 v27, v27, v213
  v_cvt_pk_bf16_f32 v198, v212, v213
  v_mfma_f32_32x32x16_bf16 a[144:159], a[228:231], v[200:203], a[144:159]
  ds_read_b64_tr_b16 a[224:225], v16 offset:8192
  ds_read_b64_tr_b16 a[226:227], v16 offset:10240
  v_exp_f32 v215, v143
  v_add_f32 v27, v27, v214
  v_mfma_f32_32x32x16_bf16 a[160:175], a[232:235], v[200:203], a[160:175]
  ds_read_b64_tr_b16 a[228:229], v17 offset:8192
  buffer_load_dwordx4 v21, s[12:15], s27 offen offset:1024 nt lds
  v_exp_f32 v216, v144
  v_add_f32 v27, v27, v215
  v_cvt_pk_bf16_f32 v199, v214, v215
  v_mfma_f32_32x32x16_bf16 a[176:191], a[236:239], v[200:203], a[176:191]
  ds_read_b64_tr_b16 a[230:231], v17 offset:10240
  ds_read_b64_tr_b16 a[232:233], v18 offset:8192
  v_exp_f32 v217, v145
  v_cmp_nge_f32 vcc, 0x47800000, v27
  s_add_u32 m0, s29, 0x1a000
  v_mfma_f32_32x32x16_bf16 a[128:143], a[240:243], v[204:207], a[128:143]
  ds_read_b64_tr_b16 a[234:235], v18 offset:10240
  buffer_load_dwordx4 v22, s[16:19], s27 offen offset:0 nt lds
  s_cbranch_vccnz L1_cap1
L1_rap1:
  v_exp_f32 v218, v146
  v_add_f32 v28, v216, v217
  v_cvt_pk_bf16_f32 v200, v216, v217
  v_mfma_f32_32x32x16_bf16 a[144:159], a[244:247], v[204:207], a[144:159]
  ds_read_b64_tr_b16 a[236:237], v19 offset:8192
  v_exp_f32 v219, v147
  v_add_f32 v28, v28, v218
  v_add_f32 v25, v25, v27
  v_mfma_f32_32x32x16_bf16 a[160:175], a[248:251], v[204:207], a[160:175]
  ds_read_b64_tr_b16 a[238:239], v19 offset:10240
  buffer_load_dwordx4 v22, s[16:19], s27 offen offset:1024 nt lds
  v_exp_f32 v220, v148
  v_add_f32 v28, v28, v219
  v_cvt_pk_bf16_f32 v201, v218, v219
  v_mfma_f32_32x32x16_bf16 a[176:191], a[252:255], v[204:207], a[176:191]
  ds_read_b64_tr_b16 a[240:241], v16 offset:12288
  ds_read_b64_tr_b16 a[242:243], v16 offset:14336
  v_exp_f32 v221, v149
  v_add_f32 v28, v28, v220
  s_waitcnt lgkmcnt(10)
  v_mfma_f32_32x32x16_bf16 v[128:143], a[192:195], v[64:67], v[160:175]
  v_exp_f32 v222, v150
  v_add_f32 v28, v28, v221
  v_cvt_pk_bf16_f32 v202, v220, v221
  v_mfma_f32_32x32x16_bf16 v[128:143], a[196:199], v[68:71], v[128:143]
  ds_read_b64_tr_b16 a[244:245], v17 offset:12288
  ds_read_b64_tr_b16 a[246:247], v17 offset:14336
  v_exp_f32 v223, v151
  v_add_f32 v28, v28, v222
  v_mfma_f32_32x32x16_bf16 v[128:143], a[200:203], v[72:75], v[128:143]
  ds_read_b64_tr_b16 a[248:249], v18 offset:12288
  s_add_u32 s27, s27, 0x2000
  v_exp_f32 v216, v152
  v_add_f32 v28, v28, v223
  v_cvt_pk_bf16_f32 v203, v222, v223
  v_mfma_f32_32x32x16_bf16 v[128:143], a[204:207], v[76:79], v[128:143]
  ds_read_b64_tr_b16 a[250:251], v18 offset:14336
  ds_read_b64_tr_b16 a[252:253], v19 offset:12288
  v_exp_f32 v217, v153
  v_add_f32 v28, v28, v216
  v_mfma_f32_32x32x16_bf16 v[128:143], a[208:211], v[80:83], v[128:143]
  ds_read_b64_tr_b16 a[254:255], v19 offset:14336
  v_exp_f32 v218, v154
  v_add_f32 v28, v28, v217
  v_cvt_pk_bf16_f32 v204, v216, v217
  v_mfma_f32_32x32x16_bf16 v[128:143], a[212:215], v[84:87], v[128:143]
  v_exp_f32 v219, v155
  v_add_f32 v28, v28, v218
  v_mfma_f32_32x32x16_bf16 v[128:143], a[216:219], v[88:91], v[128:143]
  v_exp_f32 v220, v156
  v_add_f32 v28, v28, v219
  v_cvt_pk_bf16_f32 v205, v218, v219
  v_mfma_f32_32x32x16_bf16 v[128:143], a[220:223], v[92:95], v[128:143]
  v_exp_f32 v221, v157
  v_add_f32 v28, v28, v220
  s_waitcnt lgkmcnt(0)
  v_mfma_f32_32x32x16_bf16 v[224:239], a[224:227], v[192:195], v[224:239]
  v_exp_f32 v222, v158
  v_add_f32 v28, v28, v221
  v_cvt_pk_bf16_f32 v206, v220, v221
  v_mfma_f32_32x32x16_bf16 v[240:255], a[228:231], v[192:195], v[240:255]
  v_exp_f32 v223, v159
  v_add_f32 v28, v28, v222
  v_mfma_f32_32x32x16_bf16 v[32:47], a[232:235], v[192:195], v[32:47]
  v_exp_f32 v208, v128
  v_add_f32 v28, v28, v223
  v_cvt_pk_bf16_f32 v207, v222, v223
  v_mfma_f32_32x32x16_bf16 v[48:63], a[236:239], v[192:195], v[48:63]
  v_exp_f32 v209, v129
  v_cmp_nge_f32 vcc, 0x47800000, v28
  v_mfma_f32_32x32x16_bf16 v[224:239], a[240:243], v[196:199], v[224:239]
  s_cbranch_vccnz L1_cbp2
L1_rbp2:
  v_exp_f32 v210, v130
  v_add_f32 v27, v208, v209
  v_cvt_pk_bf16_f32 v192, v208, v209
  v_mfma_f32_32x32x16_bf16 v[240:255], a[244:247], v[196:199], v[240:255]
  v_exp_f32 v211, v131
  v_add_f32 v26, v26, v28
  v_add_f32 v27, v27, v210
  v_mfma_f32_32x32x16_bf16 v[32:47], a[248:251], v[196:199], v[32:47]
  v_exp_f32 v212, v132
  v_add_f32 v27, v27, v211
  v_cvt_pk_bf16_f32 v193, v210, v211
  v_add_u32 v4, CP_j31-CP_base, v0
  v_mfma_f32_32x32x16_bf16 v[48:63], a[252:255], v[196:199], v[48:63]
  buffer_load_dword v4, v4, s[64:67], 0 offen
  v_exp_f32 v213, v133
  v_add_f32 v27, v27, v212
  v_mfma_f32_32x32x16_bf16 v[144:159], a[192:195], v[96:99], v[176:191]
  v_exp_f32 v214, v134
  v_add_f32 v27, v27, v213
  v_cvt_pk_bf16_f32 v194, v212, v213
  v_mfma_f32_32x32x16_bf16 v[144:159], a[196:199], v[100:103], v[144:159]
  ds_read_b128 a[192:195], v8 offset:24576
  v_exp_f32 v215, v135
  v_add_f32 v27, v27, v214
  v_mfma_f32_32x32x16_bf16 v[144:159], a[200:203], v[104:107], v[144:159]
  ds_read_b128 a[196:199], v9 offset:24576
  v_exp_f32 v208, v136
  v_add_f32 v27, v27, v215
  v_cvt_pk_bf16_f32 v195, v214, v215
  v_mfma_f32_32x32x16_bf16 v[144:159], a[204:207], v[108:111], v[144:159]
  ds_read_b128 a[200:203], v10 offset:24576
  v_exp_f32 v209, v137
  v_add_f32 v27, v27, v208
  v_mfma_f32_32x32x16_bf16 v[144:159], a[208:211], v[112:115], v[144:159]
  ds_read_b128 a[204:207], v11 offset:24576
  v_exp_f32 v210, v138
  v_add_f32 v27, v27, v209
  v_cvt_pk_bf16_f32 v196, v208, v209
  v_mfma_f32_32x32x16_bf16 v[144:159], a[212:215], v[116:119], v[144:159]
  ds_read_b128 a[208:211], v12 offset:24576
  v_exp_f32 v211, v139
  v_add_f32 v27, v27, v210
  v_mfma_f32_32x32x16_bf16 v[144:159], a[216:219], v[120:123], v[144:159]
  ds_read_b128 a[212:215], v13 offset:24576
  v_exp_f32 v212, v140
  v_add_f32 v27, v27, v211
  v_cvt_pk_bf16_f32 v197, v210, v211
  v_mfma_f32_32x32x16_bf16 v[144:159], a[220:223], v[124:127], v[144:159]
  ds_read_b128 a[216:219], v14 offset:24576
  v_exp_f32 v213, v141
  v_add_f32 v27, v27, v212
  s_add_u32 m0, s29, 0xe000
  v_mfma_f32_32x32x16_bf16 a[128:143], a[224:227], v[200:203], a[128:143]
  ds_read_b128 a[220:223], v15 offset:24576
  buffer_load_dwordx4 v20, s[12:15], s27 offen offset:0 nt lds
  v_exp_f32 v214, v142
  v_add_f32 v27, v27, v213
  v_cvt_pk_bf16_f32 v198, v212, v213
  v_mfma_f32_32x32x16_bf16 a[144:159], a[228:231], v[200:203], a[144:159]
  ds_read_b64_tr_b16 a[224:225], v16 offset:16384
  ds_read_b64_tr_b16 a[226:227], v16 offset:18432
  v_exp_f32 v215, v143
  v_add_f32 v27, v27, v214
  v_mfma_f32_32x32x16_bf16 a[160:175], a[232:235], v[200:203], a[160:175]
  ds_read_b64_tr_b16 a[228:229], v17 offset:16384
  buffer_load_dwordx4 v21, s[12:15], s27 offen offset:1024 nt lds
  v_exp_f32 v216, v144
  v_add_f32 v27, v27, v215
  v_cvt_pk_bf16_f32 v199, v214, v215
  v_mfma_f32_32x32x16_bf16 a[176:191], a[236:239], v[200:203], a[176:191]
  ds_read_b64_tr_b16 a[230:231], v17 offset:18432
  ds_read_b64_tr_b16 a[232:233], v18 offset:16384
  v_exp_f32 v217, v145
  v_cmp_nge_f32 vcc, 0x47800000, v27
  s_add_u32 m0, s29, 0x1c000
  v_mfma_f32_32x32x16_bf16 a[128:143], a[240:243], v[204:207], a[128:143]
  ds_read_b64_tr_b16 a[234:235], v18 offset:18432
  buffer_load_dwordx4 v22, s[16:19], s27 offen offset:0 nt lds
  s_cbranch_vccnz L1_cap2
L1_rap2:
  v_exp_f32 v218, v146
  v_add_f32 v28, v216, v217
  v_cvt_pk_bf16_f32 v200, v216, v217
  v_mfma_f32_32x32x16_bf16 a[144:159], a[244:247], v[204:207], a[144:159]
  ds_read_b64_tr_b16 a[236:237], v19 offset:16384
  v_exp_f32 v219, v147
  v_add_f32 v28, v28, v218
  v_add_f32 v25, v25, v27
  v_mfma_f32_32x32x16_bf16 a[160:175], a[248:251], v[204:207], a[160:175]
  ds_read_b64_tr_b16 a[238:239], v19 offset:18432
  buffer_load_dwordx4 v22, s[16:19], s27 offen offset:1024 nt lds
  v_exp_f32 v220, v148
  v_add_f32 v28, v28, v219
  v_cvt_pk_bf16_f32 v201, v218, v219
  v_mfma_f32_32x32x16_bf16 a[176:191], a[252:255], v[204:207], a[176:191]
  ds_read_b64_tr_b16 a[240:241], v16 offset:20480
  ds_read_b64_tr_b16 a[242:243], v16 offset:22528
  v_exp_f32 v221, v149
  v_add_f32 v28, v28, v220
  s_waitcnt lgkmcnt(10)
  v_mfma_f32_32x32x16_bf16 v[128:143], a[192:195], v[64:67], v[160:175]
  v_exp_f32 v222, v150
  v_add_f32 v28, v28, v221
  v_cvt_pk_bf16_f32 v202, v220, v221
  v_mfma_f32_32x32x16_bf16 v[128:143], a[196:199], v[68:71], v[128:143]
  ds_read_b64_tr_b16 a[244:245], v17 offset:20480
  ds_read_b64_tr_b16 a[246:247], v17 offset:22528
  v_exp_f32 v223, v151
  v_add_f32 v28, v28, v222
  v_mfma_f32_32x32x16_bf16 v[128:143], a[200:203], v[72:75], v[128:143]
  ds_read_b64_tr_b16 a[248:249], v18 offset:20480
  s_add_u32 s27, s27, 0x2000
  v_exp_f32 v216, v152
  v_add_f32 v28, v28, v223
  v_cvt_pk_bf16_f32 v203, v222, v223
  v_mfma_f32_32x32x16_bf16 v[128:143], a[204:207], v[76:79], v[128:143]
  ds_read_b64_tr_b16 a[250:251], v18 offset:22528
  ds_read_b64_tr_b16 a[252:253], v19 offset:20480
  v_exp_f32 v217, v153
  v_add_f32 v28, v28, v216
  v_mfma_f32_32x32x16_bf16 v[128:143], a[208:211], v[80:83], v[128:143]
  ds_read_b64_tr_b16 a[254:255], v19 offset:22528
  v_exp_f32 v218, v154
  v_add_f32 v28, v28, v217
  v_cvt_pk_bf16_f32 v204, v216, v217
  v_mfma_f32_32x32x16_bf16 v[128:143], a[212:215], v[84:87], v[128:143]
  v_exp_f32 v219, v155
  v_add_f32 v28, v28, v218
  v_mfma_f32_32x32x16_bf16 v[128:143], a[216:219], v[88:91], v[128:143]
  v_exp_f32 v220, v156
  v_add_f32 v28, v28, v219
  v_cvt_pk_bf16_f32 v205, v218, v219
  v_mfma_f32_32x32x16_bf16 v[128:143], a[220:223], v[92:95], v[128:143]
  v_exp_f32 v221, v157
  v_add_f32 v28, v28, v220
  s_waitcnt lgkmcnt(0)
  v_mfma_f32_32x32x16_bf16 v[224:239], a[224:227], v[192:195], v[224:239]
  v_exp_f32 v222, v158
  v_add_f32 v28, v28, v221
  v_cvt_pk_bf16_f32 v206, v220, v221
  v_mfma_f32_32x32x16_bf16 v[240:255], a[228:231], v[192:195], v[240:255]
  v_exp_f32 v223, v159
  v_add_f32 v28, v28, v222
  v_mfma_f32_32x32x16_bf16 v[32:47], a[232:235], v[192:195], v[32:47]
  v_exp_f32 v208, v128
  v_add_f32 v28, v28, v223
  v_cvt_pk_bf16_f32 v207, v222, v223
  v_mfma_f32_32x32x16_bf16 v[48:63], a[236:239], v[192:195], v[48:63]
  v_exp_f32 v209, v129
  v_cmp_nge_f32 vcc, 0x47800000, v28
  v_mfma_f32_32x32x16_bf16 v[224:239], a[240:243], v[196:199], v[224:239]
  s_cbranch_vccnz L1_cbp3
L1_rbp3:
  v_exp_f32 v210, v130
  v_add_f32 v27, v208, v209
  v_cvt_pk_bf16_f32 v192, v208, v209
  v_mfma_f32_32x32x16_bf16 v[240:255], a[244:247], v[196:199], v[240:255]
  v_exp_f32 v211, v131
  v_add_f32 v26, v26, v28
  v_add_f32 v27, v27, v210
  v_mfma_f32_32x32x16_bf16 v[32:47], a[248:251], v[196:199], v[32:47]
  v_exp_f32 v212, v132
  v_add_f32 v27, v27, v211
  v_cvt_pk_bf16_f32 v193, v210, v211
  v_mfma_f32_32x32x16_bf16 v[48:63], a[252:255], v[196:199], v[48:63]
  v_exp_f32 v213, v133
  v_add_f32 v27, v27, v212
  v_mfma_f32_32x32x16_bf16 v[144:159], a[192:195], v[96:99], v[176:191]
  s_waitcnt vmcnt(10)
  s_barrier
  v_exp_f32 v214, v134
  v_add_f32 v27, v27, v213
  v_cvt_pk_bf16_f32 v194, v212, v213
  v_mfma_f32_32x32x16_bf16 v[144:159], a[196:199], v[100:103], v[144:159]
  ds_read_b128 a[192:195], v8 offset:32768
  v_exp_f32 v215, v135
  v_add_f32 v27, v27, v214
  v_mfma_f32_32x32x16_bf16 v[144:159], a[200:203], v[104:107], v[144:159]
  ds_read_b128 a[196:199], v9 offset:32768
  v_exp_f32 v208, v136
  v_add_f32 v27, v27, v215
  v_cvt_pk_bf16_f32 v195, v214, v215
  v_mfma_f32_32x32x16_bf16 v[144:159], a[204:207], v[108:111], v[144:159]
  ds_read_b128 a[200:203], v10 offset:32768
  v_exp_f32 v209, v137
  v_add_f32 v27, v27, v208
  v_mfma_f32_32x32x16_bf16 v[144:159], a[208:211], v[112:115], v[144:159]
  ds_read_b128 a[204:207], v11 offset:32768
  v_exp_f32 v210, v138
  v_add_f32 v27, v27, v209
  v_cvt_pk_bf16_f32 v196, v208, v209
  v_mfma_f32_32x32x16_bf16 v[144:159], a[212:215], v[116:119], v[144:159]
  ds_read_b128 a[208:211], v12 offset:32768
  v_exp_f32 v211, v139
  v_add_f32 v27, v27, v210
  v_mfma_f32_32x32x16_bf16 v[144:159], a[216:219], v[120:123], v[144:159]
  ds_read_b128 a[212:215], v13 offset:32768
  v_exp_f32 v212, v140
  v_add_f32 v27, v27, v211
  v_cvt_pk_bf16_f32 v197, v210, v211
  v_mfma_f32_32x32x16_bf16 v[144:159], a[220:223], v[124:127], v[144:159]
  ds_read_b128 a[216:219], v14 offset:32768
  v_exp_f32 v213, v141
  v_add_f32 v27, v27, v212
  s_add_u32 m0, s29, 0x0
  v_mfma_f32_32x32x16_bf16 a[128:143], a[224:227], v[200:203], a[128:143]
  ds_read_b128 a[220:223], v15 offset:32768
  buffer_load_dwordx4 v20, s[12:15], s27 offen offset:0 nt lds
  v_exp_f32 v214, v142
  v_add_f32 v27, v27, v213
  v_cvt_pk_bf16_f32 v198, v212, v213
  v_mfma_f32_32x32x16_bf16 a[144:159], a[228:231], v[200:203], a[144:159]
  ds_read_b64_tr_b16 a[224:225], v16 offset:24576
  ds_read_b64_tr_b16 a[226:227], v16 offset:26624
  v_exp_f32 v215, v143
  v_add_f32 v27, v27, v214
  v_mfma_f32_32x32x16_bf16 a[160:175], a[232:235], v[200:203], a[160:175]
  ds_read_b64_tr_b16 a[228:229], v17 offset:24576
  buffer_load_dwordx4 v21, s[12:15], s27 offen offset:1024 nt lds
  v_exp_f32 v216, v144
  v_add_f32 v27, v27, v215
  v_cvt_pk_bf16_f32 v199, v214, v215
  v_mfma_f32_32x32x16_bf16 a[176:191], a[236:239], v[200:203], a[176:191]
  ds_read_b64_tr_b16 a[230:231], v17 offset:26624
  ds_read_b64_tr_b16 a[232:233], v18 offset:24576
  v_exp_f32 v217, v145
  v_cmp_nge_f32 vcc, 0x47800000, v27
  s_add_u32 m0, s29, 0x1e000
  v_mfma_f32_32x32x16_bf16 a[128:143], a[240:243], v[204:207], a[128:143]
  ds_read_b64_tr_b16 a[234:235], v18 offset:26624
  buffer_load_dwordx4 v22, s[16:19], s27 offen offset:0 nt lds
  s_cbranch_vccnz L1_cap3
L1_rap3:
  v_exp_f32 v218, v146
  v_add_f32 v28, v216, v217
  v_cvt_pk_bf16_f32 v200, v216, v217
  v_mfma_f32_32x32x16_bf16 a[144:159], a[244:247], v[204:207], a[144:159]
  ds_read_b64_tr_b16 a[236:237], v19 offset:24576
  v_exp_f32 v219, v147
  v_add_f32 v28, v28, v218
  v_add_f32 v25, v25, v27
  v_mfma_f32_32x32x16_bf16 a[160:175], a[248:251], v[204:207], a[160:175]
  ds_read_b64_tr_b16 a[238:239], v19 offset:26624
  buffer_load_dwordx4 v22, s[16:19], s27 offen offset:1024 nt lds
  v_exp_f32 v220, v148
  v_add_f32 v28, v28, v219
  v_cvt_pk_bf16_f32 v201, v218, v219
  v_mfma_f32_32x32x16_bf16 a[176:191], a[252:255], v[204:207], a[176:191]
  ds_read_b64_tr_b16 a[240:241], v16 offset:28672
  ds_read_b64_tr_b16 a[242:243], v16 offset:30720
  v_exp_f32 v221, v149
  v_add_f32 v28, v28, v220
  s_waitcnt lgkmcnt(10)
  v_mfma_f32_32x32x16_bf16 v[128:143], a[192:195], v[64:67], v[160:175]
  v_exp_f32 v222, v150
  v_add_f32 v28, v28, v221
  v_cvt_pk_bf16_f32 v202, v220, v221
  v_mfma_f32_32x32x16_bf16 v[128:143], a[196:199], v[68:71], v[128:143]
  ds_read_b64_tr_b16 a[244:245], v17 offset:28672
  ds_read_b64_tr_b16 a[246:247], v17 offset:30720
  v_exp_f32 v223, v151
  v_add_f32 v28, v28, v222
  v_mfma_f32_32x32x16_bf16 v[128:143], a[200:203], v[72:75], v[128:143]
  ds_read_b64_tr_b16 a[248:249], v18 offset:28672
  s_add_u32 s27, s27, 0x2000
  v_exp_f32 v216, v152
  v_add_f32 v28, v28, v223
  v_cvt_pk_bf16_f32 v203, v222, v223
  v_mfma_f32_32x32x16_bf16 v[128:143], a[204:207], v[76:79], v[128:143]
  ds_read_b64_tr_b16 a[250:251], v18 offset:30720
  ds_read_b64_tr_b16 a[252:253], v19 offset:28672
  v_exp_f32 v217, v153
  v_add_f32 v28, v28, v216
  v_mfma_f32_32x32x16_bf16 v[128:143], a[208:211], v[80:83], v[128:143]
  ds_read_b64_tr_b16 a[254:255], v19 offset:30720
  v_exp_f32 v218, v154
  v_add_f32 v28, v28, v217
  v_cvt_pk_bf16_f32 v204, v216, v217
  v_mfma_f32_32x32x16_bf16 v[128:143], a[212:215], v[84:87], v[128:143]
  v_exp_f32 v219, v155
  v_add_f32 v28, v28, v218
  v_mfma_f32_32x32x16_bf16 v[128:143], a[216:219], v[88:91], v[128:143]
  v_exp_f32 v220, v156
  v_add_f32 v28, v28, v219
  v_cvt_pk_bf16_f32 v205, v218, v219
  v_mfma_f32_32x32x16_bf16 v[128:143], a[220:223], v[92:95], v[128:143]
  v_exp_f32 v221, v157
  v_add_f32 v28, v28, v220
  s_waitcnt lgkmcnt(0)
  v_mfma_f32_32x32x16_bf16 v[224:239], a[224:227], v[192:195], v[224:239]
  v_exp_f32 v222, v158
  v_add_f32 v28, v28, v221
  v_cvt_pk_bf16_f32 v206, v220, v221
  v_mfma_f32_32x32x16_bf16 v[240:255], a[228:231], v[192:195], v[240:255]
  v_exp_f32 v223, v159
  v_add_f32 v28, v28, v222
  v_mfma_f32_32x32x16_bf16 v[32:47], a[232:235], v[192:195], v[32:47]
  v_exp_f32 v208, v128
  v_add_f32 v28, v28, v223
  v_cvt_pk_bf16_f32 v207, v222, v223
  v_mfma_f32_32x32x16_bf16 v[48:63], a[236:239], v[192:195], v[48:63]
  v_exp_f32 v209, v129
  v_cmp_nge_f32 vcc, 0x47800000, v28
  v_mfma_f32_32x32x16_bf16 v[224:239], a[240:243], v[196:199], v[224:239]
  s_cbranch_vccnz L1_cbp4
L1_rbp4:
  v_exp_f32 v210, v130
  v_add_f32 v27, v208, v209
  v_cvt_pk_bf16_f32 v192, v208, v209
  v_mfma_f32_32x32x16_bf16 v[240:255], a[244:247], v[196:199], v[240:255]
  v_exp_f32 v211, v131
  v_add_f32 v26, v26, v28
  v_add_f32 v27, v27, v210
  v_mfma_f32_32x32x16_bf16 v[32:47], a[248:251], v[196:199], v[32:47]
  v_exp_f32 v212, v132
  v_add_f32 v27, v27, v211
  v_cvt_pk_bf16_f32 v193, v210, v211
  v_mfma_f32_32x32x16_bf16 v[48:63], a[252:255], v[196:199], v[48:63]
  v_exp_f32 v213, v133
  v_add_f32 v27, v27, v212
  v_mfma_f32_32x32x16_bf16 v[144:159], a[192:195], v[96:99], v[176:191]
  v_exp_f32 v214, v134
  v_add_f32 v27, v27, v213
  v_cvt_pk_bf16_f32 v194, v212, v213
  v_mfma_f32_32x32x16_bf16 v[144:159], a[196:199], v[100:103], v[144:159]
  ds_read_b128 a[192:195], v8 offset:40960
  v_exp_f32 v215, v135
  v_add_f32 v27, v27, v214
  v_mfma_f32_32x32x16_bf16 v[144:159], a[200:203], v[104:107], v[144:159]
  ds_read_b128 a[196:199], v9 offset:40960
  v_exp_f32 v208, v136
  v_add_f32 v27, v27, v215
  v_cvt_pk_bf16_f32 v195, v214, v215
  v_mfma_f32_32x32x16_bf16 v[144:159], a[204:207], v[108:111], v[144:159]
  ds_read_b128 a[200:203], v10 offset:40960
  v_exp_f32 v209, v137
  v_add_f32 v27, v27, v208
  v_mfma_f32_32x32x16_bf16 v[144:159], a[208:211], v[112:115], v[144:159]
  ds_read_b128 a[204:207], v11 offset:40960
  v_exp_f32 v210, v138
  v_add_f32 v27, v27, v209
  v_cvt_pk_bf16_f32 v196, v208, v209
  v_mfma_f32_32x32x16_bf16 v[144:159], a[212:215], v[116:119], v[144:159]
  ds_read_b128 a[208:211], v12 offset:40960
  v_exp_f32 v211, v139
  v_add_f32 v27, v27, v210
  v_mfma_f32_32x32x16_bf16 v[144:159], a[216:219], v[120:123], v[144:159]
  ds_read_b128 a[212:215], v13 offset:40960
  v_exp_f32 v212, v140
  v_add_f32 v27, v27, v211
  v_cvt_pk_bf16_f32 v197, v210, v211
  v_mfma_f32_32x32x16_bf16 v[144:159], a[220:223], v[124:127], v[144:159]
  ds_read_b128 a[216:219], v14 offset:40960
  v_exp_f32 v213, v141
  v_add_f32 v27, v27, v212
  s_add_u32 m0, s29, 0x2000
  v_mfma_f32_32x32x16_bf16 a[128:143], a[224:227], v[200:203], a[128:143]
  ds_read_b128 a[220:223], v15 offset:40960
  buffer_load_dwordx4 v20, s[12:15], s27 offen offset:0 nt lds
  v_exp_f32 v214, v142
  v_add_f32 v27, v27, v213
  v_cvt_pk_bf16_f32 v198, v212, v213
  v_mfma_f32_32x32x16_bf16 a[144:159], a[228:231], v[200:203], a[144:159]
  ds_read_b64_tr_b16 a[224:225], v16 offset:32768
  ds_read_b64_tr_b16 a[226:227], v16 offset:34816
  v_exp_f32 v215, v143
  v_add_f32 v27, v27, v214
  v_mfma_f32_32x32x16_bf16 a[160:175], a[232:235], v[200:203], a[160:175]
  ds_read_b64_tr_b16 a[228:229], v17 offset:32768
  buffer_load_dwordx4 v21, s[12:15], s27 offen offset:1024 nt lds
  v_exp_f32 v216, v144
  v_add_f32 v27, v27, v215
  v_cvt_pk_bf16_f32 v199, v214, v215
  v_mfma_f32_32x32x16_bf16 a[176:191], a[236:239], v[200:203], a[176:191]
  ds_read_b64_tr_b16 a[230:231], v17 offset:34816
  ds_read_b64_tr_b16 a[232:233], v18 offset:32768
  v_exp_f32 v217, v145
  v_cmp_nge_f32 vcc, 0x47800000, v27
  s_add_u32 m0, s29, 0x10000
  v_mfma_f32_32x32x16_bf16 a[128:143], a[240:243], v[204:207], a[128:143]
  ds_read_b64_tr_b16 a[234:235], v18 offset:34816
  buffer_load_dwordx4 v22, s[16:19], s27 offen offset:0 nt lds
  s_cbranch_vccnz L1_cap4
L1_rap4:
  v_exp_f32 v218, v146
  v_add_f32 v28, v216, v217
  v_cvt_pk_bf16_f32 v200, v216, v217
  v_mfma_f32_32x32x16_bf16 a[144:159], a[244:247], v[204:207], a[144:159]
  ds_read_b64_tr_b16 a[236:237], v19 offset:32768
  v_exp_f32 v219, v147
  v_add_f32 v28, v28, v218
  v_add_f32 v25, v25, v27
  v_mfma_f32_32x32x16_bf16 a[160:175], a[248:251], v[204:207], a[160:175]
  ds_read_b64_tr_b16 a[238:239], v19 offset:34816
  buffer_load_dwordx4 v22, s[16:19], s27 offen offset:1024 nt lds
  v_exp_f32 v220, v148
  v_add_f32 v28, v28, v219
  v_cvt_pk_bf16_f32 v201, v218, v219
  v_mfma_f32_32x32x16_bf16 a[176:191], a[252:255], v[204:207], a[176:191]
  ds_read_b64_tr_b16 a[240:241], v16 offset:36864
  ds_read_b64_tr_b16 a[242:243], v16 offset:38912
  v_exp_f32 v221, v149
  v_add_f32 v28, v28, v220
  s_waitcnt lgkmcnt(10)
  v_mfma_f32_32x32x16_bf16 v[128:143], a[192:195], v[64:67], v[160:175]
  v_exp_f32 v222, v150
  v_add_f32 v28, v28, v221
  v_cvt_pk_bf16_f32 v202, v220, v221
  v_mfma_f32_32x32x16_bf16 v[128:143], a[196:199], v[68:71], v[128:143]
  ds_read_b64_tr_b16 a[244:245], v17 offset:36864
  ds_read_b64_tr_b16 a[246:247], v17 offset:38912
  v_exp_f32 v223, v151
  v_add_f32 v28, v28, v222
  v_mfma_f32_32x32x16_bf16 v[128:143], a[200:203], v[72:75], v[128:143]
  ds_read_b64_tr_b16 a[248:249], v18 offset:36864
  s_add_u32 s27, s27, 0x2000
  v_exp_f32 v216, v152
  v_add_f32 v28, v28, v223
  v_cvt_pk_bf16_f32 v203, v222, v223
  v_mfma_f32_32x32x16_bf16 v[128:143], a[204:207], v[76:79], v[128:143]
  ds_read_b64_tr_b16 a[250:251], v18 offset:38912
  ds_read_b64_tr_b16 a[252:253], v19 offset:36864
  v_exp_f32 v217, v153
  v_add_f32 v28, v28, v216
  v_mfma_f32_32x32x16_bf16 v[128:143], a[208:211], v[80:83], v[128:143]
  ds_read_b64_tr_b16 a[254:255], v19 offset:38912
  v_exp_f32 v218, v154
  v_add_f32 v28, v28, v217
  v_cvt_pk_bf16_f32 v204, v216, v217
  v_mfma_f32_32x32x16_bf16 v[128:143], a[212:215], v[84:87], v[128:143]
  v_exp_f32 v219, v155
  v_add_f32 v28, v28, v218
  v_mfma_f32_32x32x16_bf16 v[128:143], a[216:219], v[88:91], v[128:143]
  v_exp_f32 v220, v156
  v_add_f32 v28, v28, v219
  v_cvt_pk_bf16_f32 v205, v218, v219
  v_mfma_f32_32x32x16_bf16 v[128:143], a[220:223], v[92:95], v[128:143]
  v_exp_f32 v221, v157
  v_add_f32 v28, v28, v220
  s_waitcnt lgkmcnt(0)
  v_mfma_f32_32x32x16_bf16 v[224:239], a[224:227], v[192:195], v[224:239]
  v_exp_f32 v222, v158
  v_add_f32 v28, v28, v221
  v_cvt_pk_bf16_f32 v206, v220, v221
  v_mfma_f32_32x32x16_bf16 v[240:255], a[228:231], v[192:195], v[240:255]
  v_exp_f32 v223, v159
  v_add_f32 v28, v28, v222
  v_mfma_f32_32x32x16_bf16 v[32:47], a[232:235], v[192:195], v[32:47]
  v_exp_f32 v208, v128
  v_add_f32 v28, v28, v223
  v_cvt_pk_bf16_f32 v207, v222, v223
  v_mfma_f32_32x32x16_bf16 v[48:63], a[236:239], v[192:195], v[48:63]
  v_exp_f32 v209, v129
  v_cmp_nge_f32 vcc, 0x47800000, v28
  v_mfma_f32_32x32x16_bf16 v[224:239], a[240:243], v[196:199], v[224:239]
  s_cbranch_vccnz L1_cbp5
L1_rbp5:
  v_exp_f32 v210, v130
  v_add_f32 v27, v208, v209
  v_cvt_pk_bf16_f32 v192, v208, v209
  v_mfma_f32_32x32x16_bf16 v[240:255], a[244:247], v[196:199], v[240:255]
  v_exp_f32 v211, v131
  v_add_f32 v26, v26, v28
  v_add_f32 v27, v27, v210
  v_mfma_f32_32x32x16_bf16 v[32:47], a[248:251], v[196:199], v[32:47]
  v_exp_f32 v212, v132
  v_add_f32 v27, v27, v211
  v_cvt_pk_bf16_f32 v193, v210, v211
  v_mfma_f32_32x32x16_bf16 v[48:63], a[252:255], v[196:199], v[48:63]
  v_exp_f32 v213, v133
  v_add_f32 v27, v27, v212
  v_mfma_f32_32x32x16_bf16 v[144:159], a[192:195], v[96:99], v[176:191]
  s_waitcnt vmcnt(8)
  s_barrier
  v_exp_f32 v214, v134
  v_add_f32 v27, v27, v213
  v_cvt_pk_bf16_f32 v194, v212, v213
  v_mfma_f32_32x32x16_bf16 v[144:159], a[196:199], v[100:103], v[144:159]
  ds_read_b128 a[192:195], v8 offset:49152
  v_exp_f32 v215, v135
  v_add_f32 v27, v27, v214
  v_mfma_f32_32x32x16_bf16 v[144:159], a[200:203], v[104:107], v[144:159]
  ds_read_b128 a[196:199], v9 offset:49152
  v_exp_f32 v208, v136
  v_add_f32 v27, v27, v215
  v_cvt_pk_bf16_f32 v195, v214, v215
  v_mfma_f32_32x32x16_bf16 v[144:159], a[204:207], v[108:111], v[144:159]
  ds_read_b128 a[200:203], v10 offset:49152
  v_exp_f32 v209, v137
  v_add_f32 v27, v27, v208
  v_mfma_f32_32x32x16_bf16 v[144:159], a[208:211], v[112:115], v[144:159]
  ds_read_b128 a[204:207], v11 offset:49152
  v_exp_f32 v210, v138
  v_add_f32 v27, v27, v209
  v_cvt_pk_bf16_f32 v196, v208, v209
  v_mfma_f32_32x32x16_bf16 v[144:159], a[212:215], v[116:119], v[144:159]
  ds_read_b128 a[208:211], v12 offset:49152
  v_exp_f32 v211, v139
  v_add_f32 v27, v27, v210
  v_mfma_f32_32x32x16_bf16 v[144:159], a[216:219], v[120:123], v[144:159]
  ds_read_b128 a[212:215], v13 offset:49152
  v_exp_f32 v212, v140
  v_add_f32 v27, v27, v211
  v_cvt_pk_bf16_f32 v197, v210, v211
  v_mfma_f32_32x32x16_bf16 v[144:159], a[220:223], v[124:127], v[144:159]
  ds_read_b128 a[216:219], v14 offset:49152
  v_exp_f32 v213, v141
  v_add_f32 v27, v27, v212
  s_add_u32 m0, s29, 0x4000
  v_mfma_f32_32x32x16_bf16 a[128:143], a[224:227], v[200:203], a[128:143]
  ds_read_b128 a[220:223], v15 offset:49152
  buffer_load_dwordx4 v20, s[12:15], s27 offen offset:0 nt lds
  v_exp_f32 v214, v142
  v_add_f32 v27, v27, v213
  v_cvt_pk_bf16_f32 v198, v212, v213
  v_mfma_f32_32x32x16_bf16 a[144:159], a[228:231], v[200:203], a[144:159]
  ds_read_b64_tr_b16 a[224:225], v16 offset:40960
  ds_read_b64_tr_b16 a[226:227], v16 offset:43008
  v_exp_f32 v215, v143
  v_add_f32 v27, v27, v214
  v_mfma_f32_32x32x16_bf16 a[160:175], a[232:235], v[200:203], a[160:175]
  ds_read_b64_tr_b16 a[228:229], v17 offset:40960
  buffer_load_dwordx4 v21, s[12:15], s27 offen offset:1024 nt lds
  v_exp_f32 v216, v144
  v_add_f32 v27, v27, v215
  v_cvt_pk_bf16_f32 v199, v214, v215
  v_mfma_f32_32x32x16_bf16 a[176:191], a[236:239], v[200:203], a[176:191]
  ds_read_b64_tr_b16 a[230:231], v17 offset:43008
  ds_read_b64_tr_b16 a[232:233], v18 offset:40960
  v_exp_f32 v217, v145
  v_cmp_nge_f32 vcc, 0x47800000, v27
  s_add_u32 m0, s29, 0x12000
  v_mfma_f32_32x32x16_bf16 a[128:143], a[240:243], v[204:207], a[128:143]
  ds_read_b64_tr_b16 a[234:235], v18 offset:43008
  buffer_load_dwordx4 v22, s[16:19], s27 offen offset:0 nt lds
  s_cbranch_vccnz L1_cap5
L1_rap5:
  v_exp_f32 v218, v146
  v_add_f32 v28, v216, v217
  v_cvt_pk_bf16_f32 v200, v216, v217
  v_mfma_f32_32x32x16_bf16 a[144:159], a[244:247], v[204:207], a[144:159]
  ds_read_b64_tr_b16 a[236:237], v19 offset:40960
  v_exp_f32 v219, v147
  v_add_f32 v28, v28, v218
  v_add_f32 v25, v25, v27
  v_mfma_f32_32x32x16_bf16 a[160:175], a[248:251], v[204:207], a[160:175]
  ds_read_b64_tr_b16 a[238:239], v19 offset:43008
  buffer_load_dwordx4 v22, s[16:19], s27 offen offset:1024 nt lds
  v_exp_f32 v220, v148
  v_add_f32 v28, v28, v219
  v_cvt_pk_bf16_f32 v201, v218, v219
  v_mfma_f32_32x32x16_bf16 a[176:191], a[252:255], v[204:207], a[176:191]
  ds_read_b64_tr_b16 a[240:241], v16 offset:45056
  ds_read_b64_tr_b16 a[242:243], v16 offset:47104
  v_exp_f32 v221, v149
  v_add_f32 v28, v28, v220
  s_waitcnt lgkmcnt(10)
  v_mfma_f32_32x32x16_bf16 v[128:143], a[192:195], v[64:67], v[160:175]
  v_exp_f32 v222, v150
  v_add_f32 v28, v28, v221
  v_cvt_pk_bf16_f32 v202, v220, v221
  v_mfma_f32_32x32x16_bf16 v[128:143], a[196:199], v[68:71], v[128:143]
  ds_read_b64_tr_b16 a[244:245], v17 offset:45056
  ds_read_b64_tr_b16 a[246:247], v17 offset:47104
  v_exp_f32 v223, v151
  v_add_f32 v28, v28, v222
  v_mfma_f32_32x32x16_bf16 v[128:143], a[200:203], v[72:75], v[128:143]
  ds_read_b64_tr_b16 a[248:249], v18 offset:45056
  s_add_u32 s27, s27, 0x2000
  v_exp_f32 v216, v152
  v_add_f32 v28, v28, v223
  v_cvt_pk_bf16_f32 v203, v222, v223
  v_mfma_f32_32x32x16_bf16 v[128:143], a[204:207], v[76:79], v[128:143]
  s_waitcnt vmcnt(26)
  buffer_store_dwordx4 a[64:67], v29, s[4:7], s8 offen sc1
  ds_read_b64_tr_b16 a[250:251], v18 offset:47104
  ds_read_b64_tr_b16 a[252:253], v19 offset:45056
  v_exp_f32 v217, v153
  v_add_f32 v28, v28, v216
  v_mfma_f32_32x32x16_bf16 v[128:143], a[208:211], v[80:83], v[128:143]
  ds_read_b64_tr_b16 a[254:255], v19 offset:47104
  s_add_u32 s8, s8, 0x2000
  v_exp_f32 v218, v154
  v_add_f32 v28, v28, v217
  v_cvt_pk_bf16_f32 v204, v216, v217
  v_mfma_f32_32x32x16_bf16 v[128:143], a[212:215], v[84:87], v[128:143]
  v_exp_f32 v219, v155
  v_add_f32 v28, v28, v218
  v_mfma_f32_32x32x16_bf16 v[128:143], a[216:219], v[88:91], v[128:143]
  v_exp_f32 v220, v156
  v_add_f32 v28, v28, v219
  v_cvt_pk_bf16_f32 v205, v218, v219
  v_mfma_f32_32x32x16_bf16 v[128:143], a[220:223], v[92:95], v[128:143]
  v_exp_f32 v221, v157
  v_add_f32 v28, v28, v220
  s_waitcnt lgkmcnt(0)
  v_mfma_f32_32x32x16_bf16 v[224:239], a[224:227], v[192:195], v[224:239]
  v_exp_f32 v222, v158
  v_add_f32 v28, v28, v221
  v_cvt_pk_bf16_f32 v206, v220, v221
  v_mfma_f32_32x32x16_bf16 v[240:255], a[228:231], v[192:195], v[240:255]
  v_exp_f32 v223, v159
  v_add_f32 v28, v28, v222
  v_mfma_f32_32x32x16_bf16 v[32:47], a[232:235], v[192:195], v[32:47]
  v_exp_f32 v208, v128
  v_add_f32 v28, v28, v223
  v_cvt_pk_bf16_f32 v207, v222, v223
  v_mfma_f32_32x32x16_bf16 v[48:63], a[236:239], v[192:195], v[48:63]
  v_exp_f32 v209, v129
  v_cmp_nge_f32 vcc, 0x47800000, v28
  v_mfma_f32_32x32x16_bf16 v[224:239], a[240:243], v[196:199], v[224:239]
  s_cbranch_vccnz L1_cbp6
L1_rbp6:
  v_exp_f32 v210, v130
  v_add_f32 v27, v208, v209
  v_cvt_pk_bf16_f32 v192, v208, v209
  v_mfma_f32_32x32x16_bf16 v[240:255], a[244:247], v[196:199], v[240:255]
  v_exp_f32 v211, v131
  v_add_f32 v26, v26, v28
  v_add_f32 v27, v27, v210
  v_mfma_f32_32x32x16_bf16 v[32:47], a[248:251], v[196:199], v[32:47]
  s_waitcnt vmcnt(22)
  buffer_store_dwordx4 a[68:71], v29, s[4:7], s8 offen sc1
  v_exp_f32 v212, v132
  v_add_f32 v27, v27, v211
  v_cvt_pk_bf16_f32 v193, v210, v211
  v_mfma_f32_32x32x16_bf16 v[48:63], a[252:255], v[196:199], v[48:63]
  s_add_u32 s8, s8, 0x2000
  v_exp_f32 v213, v133
  v_add_f32 v27, v27, v212
  v_mfma_f32_32x32x16_bf16 v[144:159], a[192:195], v[96:99], v[176:191]
  v_exp_f32 v214, v134
  v_add_f32 v27, v27, v213
  v_cvt_pk_bf16_f32 v194, v212, v213
  v_mfma_f32_32x32x16_bf16 v[144:159], a[196:199], v[100:103], v[144:159]
  ds_read_b128 a[192:195], v8 offset:57344
  v_exp_f32 v215, v135
  v_add_f32 v27, v27, v214
  v_mfma_f32_32x32x16_bf16 v[144:159], a[200:203], v[104:107], v[144:159]
  ds_read_b128 a[196:199], v9 offset:57344
  v_exp_f32 v208, v136
  v_add_f32 v27, v27, v215
  v_cvt_pk_bf16_f32 v195, v214, v215
  v_mfma_f32_32x32x16_bf16 v[144:159], a[204:207], v[108:111], v[144:159]
  ds_read_b128 a[200:203], v10 offset:57344
  v_exp_f32 v209, v137
  v_add_f32 v27, v27, v208
  v_mfma_f32_32x32x16_bf16 v[144:159], a[208:211], v[112:115], v[144:159]
  ds_read_b128 a[204:207], v11 offset:57344
  v_exp_f32 v210, v138
  v_add_f32 v27, v27, v209
  v_cvt_pk_bf16_f32 v196, v208, v209
  v_mfma_f32_32x32x16_bf16 v[144:159], a[212:215], v[116:119], v[144:159]
  ds_read_b128 a[208:211], v12 offset:57344
  v_exp_f32 v211, v139
  v_add_f32 v27, v27, v210
  v_mfma_f32_32x32x16_bf16 v[144:159], a[216:219], v[120:123], v[144:159]
  ds_read_b128 a[212:215], v13 offset:57344
  v_exp_f32 v212, v140
  v_add_f32 v27, v27, v211
  v_cvt_pk_bf16_f32 v197, v210, v211
  v_mfma_f32_32x32x16_bf16 v[144:159], a[220:223], v[124:127], v[144:159]
  ds_read_b128 a[216:219], v14 offset:57344
  v_exp_f32 v213, v141
  v_add_f32 v27, v27, v212
  s_add_u32 m0, s29, 0x6000
  v_mfma_f32_32x32x16_bf16 a[128:143], a[224:227], v[200:203], a[128:143]
  ds_read_b128 a[220:223], v15 offset:57344
  buffer_load_dwordx4 v20, s[12:15], s27 offen offset:0 nt lds
  v_exp_f32 v214, v142
  v_add_f32 v27, v27, v213
  v_cvt_pk_bf16_f32 v198, v212, v213
  v_mfma_f32_32x32x16_bf16 a[144:159], a[228:231], v[200:203], a[144:159]
  ds_read_b64_tr_b16 a[224:225], v16 offset:49152
  ds_read_b64_tr_b16 a[226:227], v16 offset:51200
  v_exp_f32 v215, v143
  v_add_f32 v27, v27, v214
  v_mfma_f32_32x32x16_bf16 a[160:175], a[232:235], v[200:203], a[160:175]
  ds_read_b64_tr_b16 a[228:229], v17 offset:49152
  buffer_load_dwordx4 v21, s[12:15], s27 offen offset:1024 nt lds
  v_exp_f32 v216, v144
  v_add_f32 v27, v27, v215
  v_cvt_pk_bf16_f32 v199, v214, v215
  v_mfma_f32_32x32x16_bf16 a[176:191], a[236:239], v[200:203], a[176:191]
  ds_read_b64_tr_b16 a[230:231], v17 offset:51200
  ds_read_b64_tr_b16 a[232:233], v18 offset:49152
  v_exp_f32 v217, v145
  v_cmp_nge_f32 vcc, 0x47800000, v27
  s_add_u32 m0, s29, 0x14000
  v_mfma_f32_32x32x16_bf16 a[128:143], a[240:243], v[204:207], a[128:143]
  ds_read_b64_tr_b16 a[234:235], v18 offset:51200
  buffer_load_dwordx4 v22, s[16:19], s27 offen offset:0 nt lds
  s_cbranch_vccnz L1_cap6
L1_rap6:
  v_exp_f32 v218, v146
  v_add_f32 v28, v216, v217
  v_cvt_pk_bf16_f32 v200, v216, v217
  v_mfma_f32_32x32x16_bf16 a[144:159], a[244:247], v[204:207], a[144:159]
  ds_read_b64_tr_b16 a[236:237], v19 offset:49152
  v_exp_f32 v219, v147
  v_add_f32 v28, v28, v218
  v_add_f32 v25, v25, v27
  v_mfma_f32_32x32x16_bf16 a[160:175], a[248:251], v[204:207], a[160:175]
  ds_read_b64_tr_b16 a[238:239], v19 offset:51200
  buffer_load_dwordx4 v22, s[16:19], s27 offen offset:1024 nt lds
  v_exp_f32 v220, v148
  v_add_f32 v28, v28, v219
  v_cvt_pk_bf16_f32 v201, v218, v219
  v_mfma_f32_32x32x16_bf16 a[176:191], a[252:255], v[204:207], a[176:191]
  ds_read_b64_tr_b16 a[240:241], v16 offset:53248
  ds_read_b64_tr_b16 a[242:243], v16 offset:55296
  v_exp_f32 v221, v149
  v_add_f32 v28, v28, v220
  s_waitcnt lgkmcnt(10)
  v_mfma_f32_32x32x16_bf16 v[128:143], a[192:195], v[64:67], v[160:175]
  v_exp_f32 v222, v150
  v_add_f32 v28, v28, v221
  v_cvt_pk_bf16_f32 v202, v220, v221
  v_mfma_f32_32x32x16_bf16 v[128:143], a[196:199], v[68:71], v[128:143]
  ds_read_b64_tr_b16 a[244:245], v17 offset:53248
  ds_read_b64_tr_b16 a[246:247], v17 offset:55296
  v_exp_f32 v223, v151
  v_add_f32 v28, v28, v222
  v_mfma_f32_32x32x16_bf16 v[128:143], a[200:203], v[72:75], v[128:143]
  ds_read_b64_tr_b16 a[248:249], v18 offset:53248
  s_add_u32 s27, s27, 0x2000
  v_exp_f32 v216, v152
  v_add_f32 v28, v28, v223
  v_cvt_pk_bf16_f32 v203, v222, v223
  v_mfma_f32_32x32x16_bf16 v[128:143], a[204:207], v[76:79], v[128:143]
  ds_read_b64_tr_b16 a[250:251], v18 offset:55296
  ds_read_b64_tr_b16 a[252:253], v19 offset:53248
  v_exp_f32 v217, v153
  v_add_f32 v28, v28, v216
  v_mfma_f32_32x32x16_bf16 v[128:143], a[208:211], v[80:83], v[128:143]
  ds_read_b64_tr_b16 a[254:255], v19 offset:55296
  v_exp_f32 v218, v154
  v_add_f32 v28, v28, v217
  v_cvt_pk_bf16_f32 v204, v216, v217
  v_mfma_f32_32x32x16_bf16 v[128:143], a[212:215], v[84:87], v[128:143]
  v_exp_f32 v219, v155
  v_add_f32 v28, v28, v218
  v_mfma_f32_32x32x16_bf16 v[128:143], a[216:219], v[88:91], v[128:143]
  v_exp_f32 v220, v156
  v_add_f32 v28, v28, v219
  v_cvt_pk_bf16_f32 v205, v218, v219
  v_mfma_f32_32x32x16_bf16 v[128:143], a[220:223], v[92:95], v[128:143]
  v_exp_f32 v221, v157
  v_add_f32 v28, v28, v220
  s_waitcnt lgkmcnt(0)
  v_mfma_f32_32x32x16_bf16 v[224:239], a[224:227], v[192:195], v[224:239]
  v_exp_f32 v222, v158
  v_add_f32 v28, v28, v221
  v_cvt_pk_bf16_f32 v206, v220, v221
  v_mfma_f32_32x32x16_bf16 v[240:255], a[228:231], v[192:195], v[240:255]
  v_exp_f32 v223, v159
  v_add_f32 v28, v28, v222
  v_mfma_f32_32x32x16_bf16 v[32:47], a[232:235], v[192:195], v[32:47]
  v_exp_f32 v208, v128
  v_add_f32 v28, v28, v223
  v_cvt_pk_bf16_f32 v207, v222, v223
  v_mfma_f32_32x32x16_bf16 v[48:63], a[236:239], v[192:195], v[48:63]
  v_exp_f32 v209, v129
  v_cmp_nge_f32 vcc, 0x47800000, v28
  v_mfma_f32_32x32x16_bf16 v[224:239], a[240:243], v[196:199], v[224:239]
  s_cbranch_vccnz L1_cbp7
L1_rbp7:
  v_exp_f32 v210, v130
  v_add_f32 v27, v208, v209
  v_cvt_pk_bf16_f32 v192, v208, v209
  v_mfma_f32_32x32x16_bf16 v[240:255], a[244:247], v[196:199], v[240:255]
  v_exp_f32 v211, v131
  v_add_f32 v26, v26, v28
  v_add_f32 v27, v27, v210
  v_mfma_f32_32x32x16_bf16 v[32:47], a[248:251], v[196:199], v[32:47]
  v_exp_f32 v212, v132
  v_add_f32 v27, v27, v211
  v_cvt_pk_bf16_f32 v193, v210, v211
  v_mfma_f32_32x32x16_bf16 v[48:63], a[252:255], v[196:199], v[48:63]
  v_exp_f32 v213, v133
  v_add_f32 v27, v27, v212
  v_mfma_f32_32x32x16_bf16 v[144:159], a[192:195], v[96:99], v[176:191]
  s_waitcnt vmcnt(10)
  s_barrier
  v_exp_f32 v214, v134
  v_add_f32 v27, v27, v213
  v_cvt_pk_bf16_f32 v194, v212, v213
  v_mfma_f32_32x32x16_bf16 v[144:159], a[196:199], v[100:103], v[144:159]
  ds_read_b128 a[192:195], v8 offset:0
  v_exp_f32 v215, v135
  v_add_f32 v27, v27, v214
  v_mfma_f32_32x32x16_bf16 v[144:159], a[200:203], v[104:107], v[144:159]
  ds_read_b128 a[196:199], v9 offset:0
  v_exp_f32 v208, v136
  v_add_f32 v27, v27, v215
  v_cvt_pk_bf16_f32 v195, v214, v215
  v_mfma_f32_32x32x16_bf16 v[144:159], a[204:207], v[108:111], v[144:159]
  ds_read_b128 a[200:203], v10 offset:0
  v_exp_f32 v209, v137
  v_add_f32 v27, v27, v208
  v_mfma_f32_32x32x16_bf16 v[144:159], a[208:211], v[112:115], v[144:159]
  ds_read_b128 a[204:207], v11 offset:0
  v_exp_f32 v210, v138
  v_add_f32 v27, v27, v209
  v_cvt_pk_bf16_f32 v196, v208, v209
  v_mfma_f32_32x32x16_bf16 v[144:159], a[212:215], v[116:119], v[144:159]
  ds_read_b128 a[208:211], v12 offset:0
  v_exp_f32 v211, v139
  v_add_f32 v27, v27, v210
  v_mfma_f32_32x32x16_bf16 v[144:159], a[216:219], v[120:123], v[144:159]
  ds_read_b128 a[212:215], v13 offset:0
  v_exp_f32 v212, v140
  v_add_f32 v27, v27, v211
  v_cvt_pk_bf16_f32 v197, v210, v211
  v_mfma_f32_32x32x16_bf16 v[144:159], a[220:223], v[124:127], v[144:159]
  ds_read_b128 a[216:219], v14 offset:0
  v_exp_f32 v213, v141
  v_add_f32 v27, v27, v212
  s_add_u32 m0, s29, 0x8000
  v_mfma_f32_32x32x16_bf16 a[128:143], a[224:227], v[200:203], a[128:143]
  ds_read_b128 a[220:223], v15 offset:0
  buffer_load_dwordx4 v20, s[12:15], s27 offen offset:0 nt lds
  v_exp_f32 v214, v142
  v_add_f32 v27, v27, v213
  v_cvt_pk_bf16_f32 v198, v212, v213
  v_mfma_f32_32x32x16_bf16 a[144:159], a[228:231], v[200:203], a[144:159]
  ds_read_b64_tr_b16 a[224:225], v16 offset:57344
  ds_read_b64_tr_b16 a[226:227], v16 offset:59392
  v_exp_f32 v215, v143
  v_add_f32 v27, v27, v214
  v_mfma_f32_32x32x16_bf16 a[160:175], a[232:235], v[200:203], a[160:175]
  ds_read_b64_tr_b16 a[228:229], v17 offset:57344
  buffer_load_dwordx4 v21, s[12:15], s27 offen offset:1024 nt lds
  v_exp_f32 v216, v144
  v_add_f32 v27, v27, v215
  v_cvt_pk_bf16_f32 v199, v214, v215
  v_mfma_f32_32x32x16_bf16 a[176:191], a[236:239], v[200:203], a[176:191]
  ds_read_b64_tr_b16 a[230:231], v17 offset:59392
  ds_read_b64_tr_b16 a[232:233], v18 offset:57344
  v_exp_f32 v217, v145
  v_cmp_nge_f32 vcc, 0x47800000, v27
  s_add_u32 m0, s29, 0x16000
  v_mfma_f32_32x32x16_bf16 a[128:143], a[240:243], v[204:207], a[128:143]
  ds_read_b64_tr_b16 a[234:235], v18 offset:59392
  buffer_load_dwordx4 v22, s[16:19], s27 offen offset:0 nt lds
  s_cbranch_vccnz L1_cap7
L1_rap7:
  v_exp_f32 v218, v146
  v_add_f32 v28, v216, v217
  v_cvt_pk_bf16_f32 v200, v216, v217
  v_mfma_f32_32x32x16_bf16 a[144:159], a[244:247], v[204:207], a[144:159]
  ds_read_b64_tr_b16 a[236:237], v19 offset:57344
  s_add_u32 s30, s30, 1
  v_exp_f32 v219, v147
  v_add_f32 v28, v28, v218
  v_add_f32 v25, v25, v27
  v_mfma_f32_32x32x16_bf16 a[160:175], a[248:251], v[204:207], a[160:175]
  ds_read_b64_tr_b16 a[238:239], v19 offset:59392
  buffer_load_dwordx4 v22, s[16:19], s27 offen offset:1024 nt lds
  s_cmp_lt_u32 s30, 2
  v_exp_f32 v220, v148
  v_add_f32 v28, v28, v219
  v_cvt_pk_bf16_f32 v201, v218, v219
  v_mfma_f32_32x32x16_bf16 a[176:191], a[252:255], v[204:207], a[176:191]
  ds_read_b64_tr_b16 a[240:241], v16 offset:61440
  ds_read_b64_tr_b16 a[242:243], v16 offset:63488
  v_exp_f32 v221, v149
  v_add_f32 v28, v28, v220
  s_cbranch_scc1 L1_lp1
CP_j31:
  s_waitcnt lgkmcnt(10)
  v_mfma_f32_32x32x16_bf16 v[128:143], a[192:195], a[0:3], v[160:175]
  v_exp_f32 v222, v150
  v_add_f32 v28, v28, v221
  v_cvt_pk_bf16_f32 v202, v220, v221
  v_mov_b32 v4, v25
  v_mfma_f32_32x32x16_bf16 v[128:143], a[196:199], a[4:7], v[128:143]
  ds_read_b64_tr_b16 a[244:245], v17 offset:61440
  ds_read_b64_tr_b16 a[246:247], v17 offset:63488
  v_exp_f32 v223, v151
  v_add_f32 v28, v28, v222
  v_permlane32_swap_b32 v25, v4
  v_mfma_f32_32x32x16_bf16 v[128:143], a[200:203], a[16:19], v[128:143]
  ds_read_b64_tr_b16 a[248:249], v18 offset:61440
  s_add_u32 s27, s27, 0x2000
  v_exp_f32 v216, v152
  v_add_f32 v28, v28, v223
  v_cvt_pk_bf16_f32 v203, v222, v223
  v_mfma_f32_32x32x16_bf16 v[128:143], a[204:207], a[20:23], v[128:143]
  ds_read_b64_tr_b16 a[250:251], v18 offset:63488
  ds_read_b64_tr_b16 a[252:253], v19 offset:61440
  v_exp_f32 v217, v153
  v_add_f32 v28, v28, v216
  v_add_f32 v25, v25, v4
  v_mfma_f32_32x32x16_bf16 v[128:143], a[208:211], a[32:35], v[128:143]
  ds_read_b64_tr_b16 a[254:255], v19 offset:63488
  v_exp_f32 v218, v154
  v_add_f32 v28, v28, v217
  v_cvt_pk_bf16_f32 v204, v216, v217
  v_mfma_f32_32x32x16_bf16 v[128:143], a[212:215], a[36:39], v[128:143]
  v_exp_f32 v219, v155
  v_add_f32 v28, v28, v218
  v_rcp_f32 v25, v25
  v_mfma_f32_32x32x16_bf16 v[128:143], a[216:219], a[48:51], v[128:143]
  v_exp_f32 v220, v156
  v_add_f32 v28, v28, v219
  v_cvt_pk_bf16_f32 v205, v218, v219
  v_mfma_f32_32x32x16_bf16 v[128:143], a[220:223], a[52:55], v[128:143]
  v_exp_f32 v221, v157
  v_add_f32 v28, v28, v220
  s_waitcnt lgkmcnt(0)
  v_mfma_f32_32x32x16_bf16 v[224:239], a[224:227], v[192:195], v[224:239]
  v_exp_f32 v222, v158
  v_add_f32 v28, v28, v221
  v_cvt_pk_bf16_f32 v206, v220, v221
  v_mfma_f32_32x32x16_bf16 v[240:255], a[228:231], v[192:195], v[240:255]
  v_exp_f32 v223, v159
  v_add_f32 v28, v28, v222
  v_mfma_f32_32x32x16_bf16 v[32:47], a[232:235], v[192:195], v[32:47]
  v_exp_f32 v208, v128
  v_add_f32 v28, v28, v223
  v_cvt_pk_bf16_f32 v207, v222, v223
  v_mfma_f32_32x32x16_bf16 v[48:63], a[236:239], v[192:195], v[48:63]
  v_exp_f32 v209, v129
  v_cmp_nge_f32 vcc, 0x47800000, v28
  v_mfma_f32_32x32x16_bf16 v[224:239], a[240:243], v[196:199], v[224:239]
  s_cbranch_vccnz L1_cbJ31
L1_rbJ31:
  v_exp_f32 v210, v130
  v_add_f32 v27, v208, v209
  v_cvt_pk_bf16_f32 v192, v208, v209
  v_mfma_f32_32x32x16_bf16 v[240:255], a[244:247], v[196:199], v[240:255]
  v_exp_f32 v211, v131
  v_add_f32 v26, v26, v28
  v_add_f32 v27, v27, v210
  v_mfma_f32_32x32x16_bf16 v[32:47], a[248:251], v[196:199], v[32:47]
  v_exp_f32 v212, v132
  v_add_f32 v27, v27, v211
  v_cvt_pk_bf16_f32 v193, v210, v211
  v_mfma_f32_32x32x16_bf16 v[48:63], a[252:255], v[196:199], v[48:63]
  v_exp_f32 v213, v133
  v_add_f32 v27, v27, v212
  v_mov_b32 v4, v26
  v_mfma_f32_32x32x16_bf16 v[144:159], a[192:195], a[8:11], v[176:191]
  v_exp_f32 v214, v134
  v_add_f32 v27, v27, v213
  v_cvt_pk_bf16_f32 v194, v212, v213
  v_permlane32_swap_b32 v26, v4
  v_mfma_f32_32x32x16_bf16 v[144:159], a[196:199], a[12:15], v[144:159]
  ds_read_b128 a[192:195], v8 offset:8192
  v_exp_f32 v215, v135
  v_add_f32 v27, v27, v214
  v_add_f32 v26, v26, v4
  v_mfma_f32_32x32x16_bf16 v[144:159], a[200:203], a[24:27], v[144:159]
  ds_read_b128 a[196:199], v9 offset:8192
  v_exp_f32 v208, v136
  v_add_f32 v27, v27, v215
  v_cvt_pk_bf16_f32 v195, v214, v215
  v_mfma_f32_32x32x16_bf16 v[144:159], a[204:207], a[28:31], v[144:159]
  ds_read_b128 a[200:203], v10 offset:8192
  v_exp_f32 v209, v137
  v_add_f32 v27, v27, v208
  v_rcp_f32 v26, v26
  v_mfma_f32_32x32x16_bf16 v[144:159], a[208:211], a[40:43], v[144:159]
  ds_read_b128 a[204:207], v11 offset:8192
  v_exp_f32 v210, v138
  v_add_f32 v27, v27, v209
  v_cvt_pk_bf16_f32 v196, v208, v209
  v_mul_f32 v224, v224, v25
  v_mfma_f32_32x32x16_bf16 v[144:159], a[212:215], a[44:47], v[144:159]
  ds_read_b128 a[208:211], v12 offset:8192
  v_exp_f32 v211, v139
  v_add_f32 v27, v27, v210
  v_mul_f32 v225, v225, v25
  v_mul_f32 v226, v226, v25
  v_mfma_f32_32x32x16_bf16 v[144:159], a[216:219], a[56:59], v[144:159]
  ds_read_b128 a[212:215], v13 offset:8192
  v_exp_f32 v212, v140
  v_add_f32 v27, v27, v211
  v_cvt_pk_bf16_f32 v197, v210, v211
  v_mul_f32 v227, v227, v25
  v_mfma_f32_32x32x16_bf16 v[144:159], a[220:223], a[60:63], v[144:159]
  ds_read_b128 a[216:219], v14 offset:8192
  v_exp_f32 v213, v141
  v_add_f32 v27, v27, v212
  v_mul_f32 v228, v228, v25
  s_add_u32 m0, s29, 0xa000
  v_mfma_f32_32x32x16_bf16 a[128:143], a[224:227], v[200:203], a[128:143]
  ds_read_b128 a[220:223], v15 offset:8192
  buffer_load_dwordx4 v20, s[12:15], s27 offen offset:0 nt lds
  v_exp_f32 v214, v142
  v_add_f32 v27, v27, v213
  v_cvt_pk_bf16_f32 v198, v212, v213
  v_mfma_f32_32x32x16_bf16 a[144:159], a[228:231], v[200:203], a[144:159]
  ds_read_b64_tr_b16 a[224:225], v16 offset:0
  ds_read_b64_tr_b16 a[226:227], v16 offset:2048
  v_exp_f32 v215, v143
  v_add_f32 v27, v27, v214
  v_mul_f32 v229, v229, v25
  v_mfma_f32_32x32x16_bf16 a[160:175], a[232:235], v[200:203], a[160:175]
  ds_read_b64_tr_b16 a[228:229], v17 offset:0
  buffer_load_dwordx4 v21, s[12:15], s27 offen offset:1024 nt lds
  v_exp_f32 v216, v144
  v_add_f32 v27, v27, v215
  v_cvt_pk_bf16_f32 v199, v214, v215
  v_mfma_f32_32x32x16_bf16 a[176:191], a[236:239], v[200:203], a[176:191]
  ds_read_b64_tr_b16 a[230:231], v17 offset:2048
  ds_read_b64_tr_b16 a[232:233], v18 offset:0
  v_exp_f32 v217, v145
  v_subrev_u32 v7, 0x37800000, v27
  v_cmp_lt_u32 vcc, 0x10000000, v7
  s_add_u32 m0, s29, 0x18000
  v_mfma_f32_32x32x16_bf16 a[128:143], a[240:243], v[204:207], a[128:143]
  ds_read_b64_tr_b16 a[234:235], v18 offset:2048
  buffer_load_dwordx4 v22, s[16:19], s27 offen offset:0 nt lds
  s_cbranch_vccnz L1_caJ31
L1_raJ31:
  v_exp_f32 v218, v146
  v_add_f32 v28, v216, v217
  v_cvt_pk_bf16_f32 v200, v216, v217
  v_mfma_f32_32x32x16_bf16 a[144:159], a[244:247], v[204:207], a[144:159]
  ds_read_b64_tr_b16 a[236:237], v19 offset:0
  v_exp_f32 v219, v147
  v_add_f32 v28, v28, v218
  v_mov_b32 v29, v27
  v_mul_f32 v230, v230, v25
  v_mfma_f32_32x32x16_bf16 a[160:175], a[248:251], v[204:207], a[160:175]
  ds_read_b64_tr_b16 a[238:239], v19 offset:2048
  buffer_load_dwordx4 v22, s[16:19], s27 offen offset:1024 nt lds
  v_exp_f32 v220, v148
  v_add_f32 v28, v28, v219
  v_cvt_pk_bf16_f32 v201, v218, v219
  v_mfma_f32_32x32x16_bf16 a[176:191], a[252:255], v[204:207], a[176:191]
  ds_read_b64_tr_b16 a[240:241], v16 offset:4096
  ds_read_b64_tr_b16 a[242:243], v16 offset:6144
  v_exp_f32 v221, v149
  v_add_f32 v28, v28, v220
  v_mul_f32 v231, v231, v25
  s_waitcnt lgkmcnt(10)
  v_mfma_f32_32x32x16_bf16 v[128:143], a[192:195], a[0:3], v[160:175]
  v_exp_f32 v222, v150
  v_add_f32 v28, v28, v221
  v_cvt_pk_bf16_f32 v202, v220, v221
  v_cvt_pk_bf16_f32 v224, v224, v225
  v_cvt_pk_bf16_f32 v225, v226, v227
  v_mfma_f32_32x32x16_bf16 v[128:143], a[196:199], a[4:7], v[128:143]
  ds_read_b64_tr_b16 a[244:245], v17 offset:4096
  ds_read_b64_tr_b16 a[246:247], v17 offset:6144
  v_exp_f32 v223, v151
  v_add_f32 v28, v28, v222
  v_cvt_pk_bf16_f32 v226, v228, v229
  v_mfma_f32_32x32x16_bf16 v[128:143], a[200:203], a[16:19], v[128:143]
  ds_read_b64_tr_b16 a[248:249], v18 offset:4096
  s_add_u32 s27, s27, 0x2000
  v_exp_f32 v216, v152
  v_add_f32 v28, v28, v223
  v_cvt_pk_bf16_f32 v203, v222, v223
  v_mfma_f32_32x32x16_bf16 v[128:143], a[204:207], a[20:23], v[128:143]
  ds_read_b64_tr_b16 a[250:251], v18 offset:6144
  ds_read_b64_tr_b16 a[252:253], v19 offset:4096
  v_exp_f32 v217, v153
  v_add_f32 v28, v28, v216
  v_cvt_pk_bf16_f32 v227, v230, v231
  v_mfma_f32_32x32x16_bf16 v[128:143], a[208:211], a[32:35], v[128:143]
  ds_read_b64_tr_b16 a[254:255], v19 offset:6144
  v_exp_f32 v218, v154
  v_add_f32 v28, v28, v217
  v_cvt_pk_bf16_f32 v204, v216, v217
  v_mfma_f32_32x32x16_bf16 v[128:143], a[212:215], a[36:39], v[128:143]
  buffer_store_dwordx4 v[224:227], v23, s[20:23], s48 offen offset:0 sc1
  v_exp_f32 v219, v155
  v_add_f32 v28, v28, v218
  v_mul_f32 v232, v232, v25
  v_mfma_f32_32x32x16_bf16 v[128:143], a[216:219], a[48:51], v[128:143]
  v_exp_f32 v220, v156
  v_add_f32 v28, v28, v219
  v_cvt_pk_bf16_f32 v205, v218, v219
  v_mul_f32 v233, v233, v25
  v_mul_f32 v234, v234, v25
  v_mfma_f32_32x32x16_bf16 v[128:143], a[220:223], a[52:55], v[128:143]
  v_exp_f32 v221, v157
  v_add_f32 v28, v28, v220
  v_mul_f32 v235, v235, v25
  v_mul_f32 v236, v236, v25
  v_mul_f32 v237, v237, v25
  s_waitcnt lgkmcnt(0)
  v_mfma_f32_32x32x16_bf16 v[64:79], a[224:227], v[192:195], 0
  v_exp_f32 v222, v158
  v_add_f32 v28, v28, v221
  v_cvt_pk_bf16_f32 v206, v220, v221
  v_mul_f32 v238, v238, v25
  v_mul_f32 v239, v239, v25
  v_mfma_f32_32x32x16_bf16 v[80:95], a[228:231], v[192:195], 0
  v_exp_f32 v223, v159
  v_add_f32 v28, v28, v222
  v_cvt_pk_bf16_f32 v232, v232, v233
  v_cvt_pk_bf16_f32 v233, v234, v235
  v_cvt_pk_bf16_f32 v234, v236, v237
  v_mfma_f32_32x32x16_bf16 v[96:111], a[232:235], v[192:195], 0
  v_exp_f32 v208, v128
  v_add_f32 v28, v28, v223
  v_cvt_pk_bf16_f32 v207, v222, v223
  v_cvt_pk_bf16_f32 v235, v238, v239
  v_mfma_f32_32x32x16_bf16 v[112:127], a[236:239], v[192:195], 0
  v_exp_f32 v209, v129
  v_subrev_u32 v7, 0x37800000, v28
  v_cmp_lt_u32 vcc, 0x10000000, v7
  s_and_b64 vcc, vcc, s[50:51]
  v_mfma_f32_32x32x16_bf16 v[64:79], a[240:243], v[196:199], v[64:79]
  s_cbranch_vccnz L1_cbJ32
L1_rbJ32:
  v_exp_f32 v210, v130
  v_add_f32 v27, v208, v209
  v_cvt_pk_bf16_f32 v192, v208, v209
  v_mfma_f32_32x32x16_bf16 v[80:95], a[244:247], v[196:199], v[80:95]
  buffer_store_dwordx4 v[232:235], v23, s[20:23], s48 offen offset:512 sc1
  v_exp_f32 v211, v131
  v_mov_b32 v30, v28
  v_add_f32 v27, v27, v210
  v_mfma_f32_32x32x16_bf16 v[96:111], a[248:251], v[196:199], v[96:111]
  v_exp_f32 v212, v132
  v_add_f32 v27, v27, v211
  v_cvt_pk_bf16_f32 v193, v210, v211
  v_mul_f32 v240, v240, v25
  v_mul_f32 v241, v241, v25
  v_mfma_f32_32x32x16_bf16 v[112:127], a[252:255], v[196:199], v[112:127]
  v_exp_f32 v213, v133
  v_add_f32 v27, v27, v212
  v_mul_f32 v242, v242, v25
  v_mul_f32 v243, v243, v25
  v_mul_f32 v244, v244, v25
  v_mfma_f32_32x32x16_bf16 v[144:159], a[192:195], a[8:11], v[176:191]
  s_waitcnt vmcnt(10)
  s_barrier
  v_exp_f32 v214, v134
  v_add_f32 v27, v27, v213
  v_cvt_pk_bf16_f32 v194, v212, v213
  v_mul_f32 v245, v245, v25
  v_mfma_f32_32x32x16_bf16 v[144:159], a[196:199], a[12:15], v[144:159]
  ds_read_b128 a[192:195], v8 offset:16384
  v_exp_f32 v215, v135
  v_add_f32 v27, v27, v214
  v_mul_f32 v246, v246, v25
  v_mul_f32 v247, v247, v25
  v_mfma_f32_32x32x16_bf16 v[144:159], a[200:203], a[24:27], v[144:159]
  ds_read_b128 a[196:199], v9 offset:16384
  v_exp_f32 v208, v136
  v_add_f32 v27, v27, v215
  v_cvt_pk_bf16_f32 v195, v214, v215
  v_cvt_pk_bf16_f32 v240, v240, v241
  v_mfma_f32_32x32x16_bf16 v[144:159], a[204:207], a[28:31], v[144:159]
  ds_read_b128 a[200:203], v10 offset:16384
  v_exp_f32 v209, v137
  v_add_f32 v27, v27, v208
  v_cvt_pk_bf16_f32 v241, v242, v243
  v_cvt_pk_bf16_f32 v242, v244, v245
  v_mfma_f32_32x32x16_bf16 v[144:159], a[208:211], a[40:43], v[144:159]
  ds_read_b128 a[204:207], v11 offset:16384
  v_exp_f32 v210, v138
  v_add_f32 v27, v27, v209
  v_cvt_pk_bf16_f32 v196, v208, v209
  v_cvt_pk_bf16_f32 v243, v246, v247
  v_mfma_f32_32x32x16_bf16 v[144:159], a[212:215], a[44:47], v[144:159]
  ds_read_b128 a[208:211], v12 offset:16384
  buffer_store_dwordx4 v[240:243], v23, s[20:23], s48 offen offset:1024 sc1
  v_exp_f32 v211, v139
  v_add_f32 v27, v27, v210
  v_mfma_f32_32x32x16_bf16 v[144:159], a[216:219], a[56:59], v[144:159]
  ds_read_b128 a[212:215], v13 offset:16384
  v_exp_f32 v212, v140
  v_add_f32 v27, v27, v211
  v_cvt_pk_bf16_f32 v197, v210, v211
  v_mul_f32 v248, v248, v25
  v_mfma_f32_32x32x16_bf16 v[144:159], a[220:223], a[60:63], v[144:159]
  ds_read_b128 a[216:219], v14 offset:16384
  v_exp_f32 v213, v141
  v_add_f32 v27, v27, v212
  v_mul_f32 v249, v249, v25
  s_add_u32 m0, s29, 0xc000
  v_mfma_f32_32x32x16_bf16 a[64:79], a[224:227], v[200:203], 0
  ds_read_b128 a[220:223], v15 offset:16384
  buffer_load_dwordx4 v20, s[12:15], s27 offen offset:0 nt lds
  v_exp_f32 v214, v142
  v_add_f32 v27, v27, v213
  v_cvt_pk_bf16_f32 v198, v212, v213
  v_mfma_f32_32x32x16_bf16 a[80:95], a[228:231], v[200:203], 0
  ds_read_b64_tr_b16 a[224:225], v16 offset:8192
  ds_read_b64_tr_b16 a[226:227], v16 offset:10240
  v_exp_f32 v215, v143
  v_add_f32 v27, v27, v214
  v_mul_f32 v250, v250, v25
  v_mfma_f32_32x32x16_bf16 a[96:111], a[232:235], v[200:203], 0
  ds_read_b64_tr_b16 a[228:229], v17 offset:8192
  buffer_load_dwordx4 v21, s[12:15], s27 offen offset:1024 nt lds
  v_exp_f32 v216, v144
  v_add_f32 v27, v27, v215
  v_cvt_pk_bf16_f32 v199, v214, v215
  v_mfma_f32_32x32x16_bf16 a[112:127], a[236:239], v[200:203], 0
  ds_read_b64_tr_b16 a[230:231], v17 offset:10240
  ds_read_b64_tr_b16 a[232:233], v18 offset:8192
  v_exp_f32 v217, v145
  v_cmp_nge_f32 vcc, 0x47800000, v27
  s_add_u32 m0, s29, 0x1a000
  v_mfma_f32_32x32x16_bf16 a[64:79], a[240:243], v[204:207], a[64:79]
  ds_read_b64_tr_b16 a[234:235], v18 offset:10240
  buffer_load_dwordx4 v22, s[16:19], s27 offen offset:0 nt lds
  s_cbranch_vccnz L1_caJ32
L1_raJ32:
  v_exp_f32 v218, v146
  v_add_f32 v28, v216, v217
  v_cvt_pk_bf16_f32 v200, v216, v217
  v_mfma_f32_32x32x16_bf16 a[80:95], a[244:247], v[204:207], a[80:95]
  ds_read_b64_tr_b16 a[236:237], v19 offset:8192
  v_exp_f32 v219, v147
  v_add_f32 v28, v28, v218
  v_add_f32 v29, v29, v27
  v_mul_f32 v251, v251, v25
  v_mfma_f32_32x32x16_bf16 a[96:111], a[248:251], v[204:207], a[96:111]
  ds_read_b64_tr_b16 a[238:239], v19 offset:10240
  buffer_load_dwordx4 v22, s[16:19], s27 offen offset:1024 nt lds
  v_exp_f32 v220, v148
  v_add_f32 v28, v28, v219
  v_cvt_pk_bf16_f32 v201, v218, v219
  v_mfma_f32_32x32x16_bf16 a[112:127], a[252:255], v[204:207], a[112:127]
  ds_read_b64_tr_b16 a[240:241], v16 offset:12288
  ds_read_b64_tr_b16 a[242:243], v16 offset:14336
  v_exp_f32 v221, v149
  v_add_f32 v28, v28, v220
  v_mul_f32 v252, v252, v25
  s_waitcnt lgkmcnt(10)
  v_mfma_f32_32x32x16_bf16 v[128:143], a[192:195], a[0:3], v[160:175]
  v_exp_f32 v222, v150
  v_add_f32 v28, v28, v221
  v_cvt_pk_bf16_f32 v202, v220, v221
  v_mul_f32 v253, v253, v25
  v_mul_f32 v254, v254, v25
  v_mfma_f32_32x32x16_bf16 v[128:143], a[196:199], a[4:7], v[128:143]
  ds_read_b64_tr_b16 a[244:245], v17 offset:12288
  ds_read_b64_tr_b16 a[246:247], v17 offset:14336
  v_exp_f32 v223, v151
  v_add_f32 v28, v28, v222
  v_mul_f32 v255, v255, v25
  v_mfma_f32_32x32x16_bf16 v[128:143], a[200:203], a[16:19], v[128:143]
  ds_read_b64_tr_b16 a[248:249], v18 offset:12288
  s_add_u32 s27, s27, 0x2000
  v_exp_f32 v216, v152
  v_add_f32 v28, v28, v223
  v_cvt_pk_bf16_f32 v203, v222, v223
  v_mfma_f32_32x32x16_bf16 v[128:143], a[204:207], a[20:23], v[128:143]
  ds_read_b64_tr_b16 a[250:251], v18 offset:14336
  ds_read_b64_tr_b16 a[252:253], v19 offset:12288
  v_exp_f32 v217, v153
  v_add_f32 v28, v28, v216
  v_cvt_pk_bf16_f32 v248, v248, v249
  v_mfma_f32_32x32x16_bf16 v[128:143], a[208:211], a[32:35], v[128:143]
  ds_read_b64_tr_b16 a[254:255], v19 offset:14336
  v_exp_f32 v218, v154
  v_add_f32 v28, v28, v217
  v_cvt_pk_bf16_f32 v204, v216, v217
  v_cvt_pk_bf16_f32 v249, v250, v251
  v_mfma_f32_32x32x16_bf16 v[128:143], a[212:215], a[36:39], v[128:143]
  v_exp_f32 v219, v155
  v_add_f32 v28, v28, v218
  v_cvt_pk_bf16_f32 v250, v252, v253
  v_cvt_pk_bf16_f32 v251, v254, v255
  v_mfma_f32_32x32x16_bf16 v[128:143], a[216:219], a[48:51], v[128:143]
  buffer_store_dwordx4 v[248:251], v23, s[20:23], s48 offen offset:1536 sc1
  v_exp_f32 v220, v156
  v_add_f32 v28, v28, v219
  v_cvt_pk_bf16_f32 v205, v218, v219
  v_mfma_f32_32x32x16_bf16 v[128:143], a[220:223], a[52:55], v[128:143]
  v_exp_f32 v221, v157
  v_add_f32 v28, v28, v220
  v_mul_f32 v32, v32, v25
  v_mul_f32 v33, v33, v25
  v_mul_f32 v34, v34, v25
  s_waitcnt lgkmcnt(0)
  v_mfma_f32_32x32x16_bf16 v[64:79], a[224:227], v[192:195], v[64:79]
  v_exp_f32 v222, v158
  v_add_f32 v28, v28, v221
  v_cvt_pk_bf16_f32 v206, v220, v221
  v_mul_f32 v35, v35, v25
  v_mul_f32 v36, v36, v25
  v_mfma_f32_32x32x16_bf16 v[80:95], a[228:231], v[192:195], v[80:95]
  v_exp_f32 v223, v159
  v_add_f32 v28, v28, v222
  v_mul_f32 v37, v37, v25
  v_mul_f32 v38, v38, v25
  v_mul_f32 v39, v39, v25
  v_mfma_f32_32x32x16_bf16 v[96:111], a[232:235], v[192:195], v[96:111]
  v_exp_f32 v208, v128
  v_add_f32 v28, v28, v223
  v_cvt_pk_bf16_f32 v207, v222, v223
  v_cvt_pk_bf16_f32 v32, v32, v33
  v_cvt_pk_bf16_f32 v33, v34, v35
  v_mfma_f32_32x32x16_bf16 v[112:127], a[236:239], v[192:195], v[112:127]
  v_exp_f32 v209, v129
  v_cmp_nge_f32 vcc, 0x47800000, v28
  v_cvt_pk_bf16_f32 v34, v36, v37
  v_cvt_pk_bf16_f32 v35, v38, v39
  v_mfma_f32_32x32x16_bf16 v[64:79], a[240:243], v[196:199], v[64:79]
  s_cbranch_vccnz L1_cbJ33
L1_rbJ33:
  v_exp_f32 v210, v130
  v_add_f32 v27, v208, v209
  v_cvt_pk_bf16_f32 v192, v208, v209
  v_mfma_f32_32x32x16_bf16 v[80:95], a[244:247], v[196:199], v[80:95]
  buffer_store_dwordx4 v[32:35], v23, s[20:23], s48 offen offset:2048 sc1
  v_exp_f32 v211, v131
  v_add_f32 v30, v30, v28
  v_add_f32 v27, v27, v210
  v_mfma_f32_32x32x16_bf16 v[96:111], a[248:251], v[196:199], v[96:111]
  v_exp_f32 v212, v132
  v_add_f32 v27, v27, v211
  v_cvt_pk_bf16_f32 v193, v210, v211
  v_mul_f32 v40, v40, v25
  v_mul_f32 v41, v41, v25
  v_mfma_f32_32x32x16_bf16 v[112:127], a[252:255], v[196:199], v[112:127]
  v_exp_f32 v213, v133
  v_add_f32 v27, v27, v212
  v_mul_f32 v42, v42, v25
  v_mul_f32 v43, v43, v25
  v_mul_f32 v44, v44, v25
  v_mfma_f32_32x32x16_bf16 v[144:159], a[192:195], a[8:11], v[176:191]
  v_exp_f32 v214, v134
  v_add_f32 v27, v27, v213
  v_cvt_pk_bf16_f32 v194, v212, v213
  v_mul_f32 v45, v45, v25
  v_mul_f32 v46, v46, v25
  v_mfma_f32_32x32x16_bf16 v[144:159], a[196:199], a[12:15], v[144:159]
  ds_read_b128 a[192:195], v8 offset:24576
  v_exp_f32 v215, v135
  v_add_f32 v27, v27, v214
  v_mul_f32 v47, v47, v25
  v_cvt_pk_bf16_f32 v40, v40, v41
  v_mfma_f32_32x32x16_bf16 v[144:159], a[200:203], a[24:27], v[144:159]
  ds_read_b128 a[196:199], v9 offset:24576
  v_exp_f32 v208, v136
  v_add_f32 v27, v27, v215
  v_cvt_pk_bf16_f32 v195, v214, v215
  v_cvt_pk_bf16_f32 v41, v42, v43
  v_mfma_f32_32x32x16_bf16 v[144:159], a[204:207], a[28:31], v[144:159]
  ds_read_b128 a[200:203], v10 offset:24576
  v_exp_f32 v209, v137
  v_add_f32 v27, v27, v208
  v_cvt_pk_bf16_f32 v42, v44, v45
  v_cvt_pk_bf16_f32 v43, v46, v47
  v_mfma_f32_32x32x16_bf16 v[144:159], a[208:211], a[40:43], v[144:159]
  ds_read_b128 a[204:207], v11 offset:24576
  v_exp_f32 v210, v138
  v_add_f32 v27, v27, v209
  v_cvt_pk_bf16_f32 v196, v208, v209
  v_mfma_f32_32x32x16_bf16 v[144:159], a[212:215], a[44:47], v[144:159]
  ds_read_b128 a[208:211], v12 offset:24576
  buffer_store_dwordx4 v[40:43], v23, s[20:23], s48 offen offset:2560 sc1
  v_exp_f32 v211, v139
  v_add_f32 v27, v27, v210
  v_mfma_f32_32x32x16_bf16 v[144:159], a[216:219], a[56:59], v[144:159]
  ds_read_b128 a[212:215], v13 offset:24576
  v_exp_f32 v212, v140
  v_add_f32 v27, v27, v211
  v_cvt_pk_bf16_f32 v197, v210, v211
  v_mul_f32 v48, v48, v25
  v_mfma_f32_32x32x16_bf16 v[144:159], a[220:223], a[60:63], v[144:159]
  ds_read_b128 a[216:219], v14 offset:24576
  v_exp_f32 v213, v141
  v_add_f32 v27, v27, v212
  v_mul_f32 v49, v49, v25
  s_add_u32 m0, s29, 0xe000
  v_mfma_f32_32x32x16_bf16 a[64:79], a[224:227], v[200:203], a[64:79]
  ds_read_b128 a[220:223], v15 offset:24576
  buffer_load_dwordx4 v20, s[12:15], s27 offen offset:0 nt lds
  v_exp_f32 v214, v142
  v_add_f32 v27, v27, v213
  v_cvt_pk_bf16_f32 v198, v212, v213
  v_mfma_f32_32x32x16_bf16 a[80:95], a[228:231], v[200:203], a[80:95]
  ds_read_b64_tr_b16 a[224:225], v16 offset:16384
  ds_read_b64_tr_b16 a[226:227], v16 offset:18432
  v_exp_f32 v215, v143
  v_add_f32 v27, v27, v214
  v_mul_f32 v50, v50, v25
  v_mfma_f32_32x32x16_bf16 a[96:111], a[232:235], v[200:203], a[96:111]
  ds_read_b64_tr_b16 a[228:229], v17 offset:16384
  buffer_load_dwordx4 v21, s[12:15], s27 offen offset:1024 nt lds
  v_exp_f32 v216, v144
  v_add_f32 v27, v27, v215
  v_cvt_pk_bf16_f32 v199, v214, v215
  v_mfma_f32_32x32x16_bf16 a[112:127], a[236:239], v[200:203], a[112:127]
  ds_read_b64_tr_b16 a[230:231], v17 offset:18432
  ds_read_b64_tr_b16 a[232:233], v18 offset:16384
  v_exp_f32 v217, v145
  v_cmp_nge_f32 vcc, 0x47800000, v27
  s_add_u32 m0, s29, 0x1c000
  v_mfma_f32_32x32x16_bf16 a[64:79], a[240:243], v[204:207], a[64:79]
  ds_read_b64_tr_b16 a[234:235], v18 offset:18432
  buffer_load_dwordx4 v22, s[16:19], s27 offen offset:0 nt lds
  s_cbranch_vccnz L1_caJ33
L1_raJ33:
  v_exp_f32 v218, v146
  v_add_f32 v28, v216, v217
  v_cvt_pk_bf16_f32 v200, v216, v217
  v_mfma_f32_32x32x16_bf16 a[80:95], a[244:247], v[204:207], a[80:95]
  ds_read_b64_tr_b16 a[236:237], v19 offset:16384
  v_exp_f32 v219, v147
  v_add_f32 v28, v28, v218
  v_add_f32 v29, v29, v27
  v_mul_f32 v51, v51, v25
  v_mfma_f32_32x32x16_bf16 a[96:111], a[248:251], v[204:207], a[96:111]
  ds_read_b64_tr_b16 a[238:239], v19 offset:18432
  buffer_load_dwordx4 v22, s[16:19], s27 offen offset:1024 nt lds
  v_exp_f32 v220, v148
  v_add_f32 v28, v28, v219
  v_cvt_pk_bf16_f32 v201, v218, v219
  v_mfma_f32_32x32x16_bf16 a[112:127], a[252:255], v[204:207], a[112:127]
  ds_read_b64_tr_b16 a[240:241], v16 offset:20480
  ds_read_b64_tr_b16 a[242:243], v16 offset:22528
  v_exp_f32 v221, v149
  v_add_f32 v28, v28, v220
  v_mul_f32 v52, v52, v25
  s_waitcnt lgkmcnt(10)
  v_mfma_f32_32x32x16_bf16 v[128:143], a[192:195], a[0:3], v[160:175]
  v_exp_f32 v222, v150
  v_add_f32 v28, v28, v221
  v_cvt_pk_bf16_f32 v202, v220, v221
  v_mul_f32 v53, v53, v25
  v_mul_f32 v54, v54, v25
  v_mfma_f32_32x32x16_bf16 v[128:143], a[196:199], a[4:7], v[128:143]
  ds_read_b64_tr_b16 a[244:245], v17 offset:20480
  ds_read_b64_tr_b16 a[246:247], v17 offset:22528
  v_exp_f32 v223, v151
  v_add_f32 v28, v28, v222
  v_mul_f32 v55, v55, v25
  v_mfma_f32_32x32x16_bf16 v[128:143], a[200:203], a[16:19], v[128:143]
  ds_read_b64_tr_b16 a[248:249], v18 offset:20480
  s_add_u32 s27, s27, 0x2000
  v_exp_f32 v216, v152
  v_add_f32 v28, v28, v223
  v_cvt_pk_bf16_f32 v203, v222, v223
  v_mfma_f32_32x32x16_bf16 v[128:143], a[204:207], a[20:23], v[128:143]
  ds_read_b64_tr_b16 a[250:251], v18 offset:22528
  ds_read_b64_tr_b16 a[252:253], v19 offset:20480
  v_exp_f32 v217, v153
  v_add_f32 v28, v28, v216
  v_cvt_pk_bf16_f32 v48, v48, v49
  v_mfma_f32_32x32x16_bf16 v[128:143], a[208:211], a[32:35], v[128:143]
  ds_read_b64_tr_b16 a[254:255], v19 offset:22528
  v_exp_f32 v218, v154
  v_add_f32 v28, v28, v217
  v_cvt_pk_bf16_f32 v204, v216, v217
  v_cvt_pk_bf16_f32 v49, v50, v51
  v_mfma_f32_32x32x16_bf16 v[128:143], a[212:215], a[36:39], v[128:143]
  v_exp_f32 v219, v155
  v_add_f32 v28, v28, v218
  v_cvt_pk_bf16_f32 v50, v52, v53
  v_cvt_pk_bf16_f32 v51, v54, v55
  v_mfma_f32_32x32x16_bf16 v[128:143], a[216:219], a[48:51], v[128:143]
  buffer_store_dwordx4 v[48:51], v23, s[20:23], s48 offen offset:3072 sc1
  v_exp_f32 v220, v156
  v_add_f32 v28, v28, v219
  v_cvt_pk_bf16_f32 v205, v218, v219
  v_mfma_f32_32x32x16_bf16 v[128:143], a[220:223], a[52:55], v[128:143]
  v_exp_f32 v221, v157
  v_add_f32 v28, v28, v220
  v_mul_f32 v56, v56, v25
  v_mul_f32 v57, v57, v25
  v_mul_f32 v58, v58, v25
  s_waitcnt lgkmcnt(0)
  v_mfma_f32_32x32x16_bf16 v[64:79], a[224:227], v[192:195], v[64:79]
  v_exp_f32 v222, v158
  v_add_f32 v28, v28, v221
  v_cvt_pk_bf16_f32 v206, v220, v221
  v_mul_f32 v59, v59, v25
  v_mul_f32 v60, v60, v25
  v_mfma_f32_32x32x16_bf16 v[80:95], a[228:231], v[192:195], v[80:95]
  v_exp_f32 v223, v159
  v_add_f32 v28, v28, v222
  v_mul_f32 v61, v61, v25
  v_mul_f32 v62, v62, v25
  v_mul_f32 v63, v63, v25
  v_mfma_f32_32x32x16_bf16 v[96:111], a[232:235], v[192:195], v[96:111]
  v_exp_f32 v208, v128
  v_add_f32 v28, v28, v223
  v_cvt_pk_bf16_f32 v207, v222, v223
  v_cvt_pk_bf16_f32 v56, v56, v57
  v_cvt_pk_bf16_f32 v57, v58, v59
  v_mfma_f32_32x32x16_bf16 v[112:127], a[236:239], v[192:195], v[112:127]
  v_exp_f32 v209, v129
  v_cmp_nge_f32 vcc, 0x47800000, v28
  v_cvt_pk_bf16_f32 v58, v60, v61
  v_cvt_pk_bf16_f32 v59, v62, v63
  v_mfma_f32_32x32x16_bf16 v[64:79], a[240:243], v[196:199], v[64:79]
  s_cbranch_vccnz L1_cbJ34
L1_rbJ34:
  v_exp_f32 v210, v130
  v_add_f32 v27, v208, v209
  v_cvt_pk_bf16_f32 v192, v208, v209
  v_mfma_f32_32x32x16_bf16 v[80:95], a[244:247], v[196:199], v[80:95]
  buffer_store_dwordx4 v[56:59], v23, s[20:23], s48 offen offset:3584 sc1
  v_exp_f32 v211, v131
  v_add_f32 v30, v30, v28
  v_add_f32 v27, v27, v210
  v_mfma_f32_32x32x16_bf16 v[96:111], a[248:251], v[196:199], v[96:111]
  v_exp_f32 v212, v132
  v_add_f32 v27, v27, v211
  v_cvt_pk_bf16_f32 v193, v210, v211
  v_accvgpr_read_b32 v224, a128
  v_accvgpr_read_b32 v225, a129
  v_mfma_f32_32x32x16_bf16 v[112:127], a[252:255], v[196:199], v[112:127]
  v_exp_f32 v213, v133
  v_add_f32 v27, v27, v212
  v_accvgpr_read_b32 v226, a130
  v_accvgpr_read_b32 v227, a131
  v_accvgpr_read_b32 v228, a132
  v_mfma_f32_32x32x16_bf16 v[144:159], a[192:195], a[8:11], v[176:191]
  s_waitcnt vmcnt(16)
  s_barrier
  v_exp_f32 v214, v134
  v_add_f32 v27, v27, v213
  v_cvt_pk_bf16_f32 v194, v212, v213
  v_accvgpr_read_b32 v229, a133
  v_mfma_f32_32x32x16_bf16 v[144:159], a[196:199], a[12:15], v[144:159]
  ds_read_b128 a[192:195], v8 offset:32768
  v_exp_f32 v215, v135
  v_add_f32 v27, v27, v214
  v_accvgpr_read_b32 v230, a134
  v_accvgpr_read_b32 v231, a135
  v_mfma_f32_32x32x16_bf16 v[144:159], a[200:203], a[24:27], v[144:159]
  ds_read_b128 a[196:199], v9 offset:32768
  v_exp_f32 v208, v136
  v_add_f32 v27, v27, v215
  v_cvt_pk_bf16_f32 v195, v214, v215
  v_mul_f32 v224, v224, v26
  v_mfma_f32_32x32x16_bf16 v[144:159], a[204:207], a[28:31], v[144:159]
  ds_read_b128 a[200:203], v10 offset:32768
  v_exp_f32 v209, v137
  v_add_f32 v27, v27, v208
  v_mul_f32 v225, v225, v26
  v_mul_f32 v226, v226, v26
  v_mfma_f32_32x32x16_bf16 v[144:159], a[208:211], a[40:43], v[144:159]
  ds_read_b128 a[204:207], v11 offset:32768
  v_exp_f32 v210, v138
  v_add_f32 v27, v27, v209
  v_cvt_pk_bf16_f32 v196, v208, v209
  v_mul_f32 v227, v227, v26
  v_mfma_f32_32x32x16_bf16 v[144:159], a[212:215], a[44:47], v[144:159]
  ds_read_b128 a[208:211], v12 offset:32768
  v_exp_f32 v211, v139
  v_add_f32 v27, v27, v210
  v_mul_f32 v228, v228, v26
  v_mul_f32 v229, v229, v26
  v_mfma_f32_32x32x16_bf16 v[144:159], a[216:219], a[56:59], v[144:159]
  ds_read_b128 a[212:215], v13 offset:32768
  v_exp_f32 v212, v140
  v_add_f32 v27, v27, v211
  v_cvt_pk_bf16_f32 v197, v210, v211
  v_mul_f32 v230, v230, v26
  v_mfma_f32_32x32x16_bf16 v[144:159], a[220:223], a[60:63], v[144:159]
  ds_read_b128 a[216:219], v14 offset:32768
  v_exp_f32 v213, v141
  v_add_f32 v27, v27, v212
  v_mul_f32 v231, v231, v26
  s_add_u32 m0, s29, 0x0
  v_mfma_f32_32x32x16_bf16 a[64:79], a[224:227], v[200:203], a[64:79]
  ds_read_b128 a[220:223], v15 offset:32768
  buffer_load_dwordx4 v20, s[12:15], s27 offen offset:0 nt lds
  v_exp_f32 v214, v142
  v_add_f32 v27, v27, v213
  v_cvt_pk_bf16_f32 v198, v212, v213
  v_mfma_f32_32x32x16_bf16 a[80:95], a[228:231], v[200:203], a[80:95]
  ds_read_b64_tr_b16 a[224:225], v16 offset:24576
  ds_read_b64_tr_b16 a[226:227], v16 offset:26624
  v_exp_f32 v215, v143
  v_add_f32 v27, v27, v214
  v_cvt_pk_bf16_f32 v224, v224, v225
  v_mfma_f32_32x32x16_bf16 a[96:111], a[232:235], v[200:203], a[96:111]
  ds_read_b64_tr_b16 a[228:229], v17 offset:24576
  buffer_load_dwordx4 v21, s[12:15], s27 offen offset:1024 nt lds
  v_exp_f32 v216, v144
  v_add_f32 v27, v27, v215
  v_cvt_pk_bf16_f32 v199, v214, v215
  v_mfma_f32_32x32x16_bf16 a[112:127], a[236:239], v[200:203], a[112:127]
  ds_read_b64_tr_b16 a[230:231], v17 offset:26624
  ds_read_b64_tr_b16 a[232:233], v18 offset:24576
  v_exp_f32 v217, v145
  v_cmp_nge_f32 vcc, 0x47800000, v27
  s_add_u32 m0, s29, 0x1e000
  v_mfma_f32_32x32x16_bf16 a[64:79], a[240:243], v[204:207], a[64:79]
  ds_read_b64_tr_b16 a[234:235], v18 offset:26624
  buffer_load_dwordx4 v22, s[16:19], s27 offen offset:0 nt lds
  s_cbranch_vccnz L1_caJ34
L1_raJ34:
  v_exp_f32 v218, v146
  v_add_f32 v28, v216, v217
  v_cvt_pk_bf16_f32 v200, v216, v217
  v_mfma_f32_32x32x16_bf16 a[80:95], a[244:247], v[204:207], a[80:95]
  ds_read_b64_tr_b16 a[236:237], v19 offset:24576
  v_exp_f32 v219, v147
  v_add_f32 v28, v28, v218
  v_add_f32 v29, v29, v27
  v_cvt_pk_bf16_f32 v225, v226, v227
  v_mfma_f32_32x32x16_bf16 a[96:111], a[248:251], v[204:207], a[96:111]
  ds_read_b64_tr_b16 a[238:239], v19 offset:26624
  buffer_load_dwordx4 v22, s[16:19], s27 offen offset:1024 nt lds
  v_exp_f32 v220, v148
  v_add_f32 v28, v28, v219
  v_cvt_pk_bf16_f32 v201, v218, v219
  v_mfma_f32_32x32x16_bf16 a[112:127], a[252:255], v[204:207], a[112:127]
  ds_read_b64_tr_b16 a[240:241], v16 offset:28672
  ds_read_b64_tr_b16 a[242:243], v16 offset:30720
  v_exp_f32 v221, v149
  v_add_f32 v28, v28, v220
  v_cvt_pk_bf16_f32 v226, v228, v229
  s_waitcnt lgkmcnt(10)
  v_mfma_f32_32x32x16_bf16 v[128:143], a[192:195], a[0:3], v[160:175]
  v_exp_f32 v222, v150
  v_add_f32 v28, v28, v221
  v_cvt_pk_bf16_f32 v202, v220, v221
  v_cvt_pk_bf16_f32 v227, v230, v231
  v_mfma_f32_32x32x16_bf16 v[128:143], a[196:199], a[4:7], v[128:143]
  ds_read_b64_tr_b16 a[244:245], v17 offset:28672
  ds_read_b64_tr_b16 a[246:247], v17 offset:30720
  v_exp_f32 v223, v151
  v_add_f32 v28, v28, v222
  v_mfma_f32_32x32x16_bf16 v[128:143], a[200:203], a[16:19], v[128:143]
  ds_read_b64_tr_b16 a[248:249], v18 offset:28672
  s_add_u32 s27, s27, 0x2000
  v_exp_f32 v216, v152
  v_add_f32 v28, v28, v223
  v_cvt_pk_bf16_f32 v203, v222, v223
  v_mfma_f32_32x32x16_bf16 v[128:143], a[204:207], a[20:23], v[128:143]
  ds_read_b64_tr_b16 a[250:251], v18 offset:30720
  ds_read_b64_tr_b16 a[252:253], v19 offset:28672
  v_exp_f32 v217, v153
  v_add_f32 v28, v28, v216
  v_mfma_f32_32x32x16_bf16 v[128:143], a[208:211], a[32:35], v[128:143]
  ds_read_b64_tr_b16 a[254:255], v19 offset:30720
  v_exp_f32 v218, v154
  v_add_f32 v28, v28, v217
  v_cvt_pk_bf16_f32 v204, v216, v217
  v_mfma_f32_32x32x16_bf16 v[128:143], a[212:215], a[36:39], v[128:143]
  buffer_store_dwordx4 v[224:227], v24, s[20:23], s48 offen offset:0 sc1
  v_exp_f32 v219, v155
  v_add_f32 v28, v28, v218
  v_accvgpr_read_b32 v232, a136
  v_mfma_f32_32x32x16_bf16 v[128:143], a[216:219], a[48:51], v[128:143]
  v_exp_f32 v220, v156
  v_add_f32 v28, v28, v219
  v_cvt_pk_bf16_f32 v205, v218, v219
  v_accvgpr_read_b32 v233, a137
  v_accvgpr_read_b32 v234, a138
  v_mfma_f32_32x32x16_bf16 v[128:143], a[220:223], a[52:55], v[128:143]
  v_exp_f32 v221, v157
  v_add_f32 v28, v28, v220
  v_accvgpr_read_b32 v235, a139
  v_accvgpr_read_b32 v236, a140
  v_accvgpr_read_b32 v237, a141
  s_waitcnt lgkmcnt(0)
  v_mfma_f32_32x32x16_bf16 v[64:79], a[224:227], v[192:195], v[64:79]
  v_exp_f32 v222, v158
  v_add_f32 v28, v28, v221
  v_cvt_pk_bf16_f32 v206, v220, v221
  v_accvgpr_read_b32 v238, a142
  v_accvgpr_read_b32 v239, a143
  v_mfma_f32_32x32x16_bf16 v[80:95], a[228:231], v[192:195], v[80:95]
  v_exp_f32 v223, v159
  v_add_f32 v28, v28, v222
  v_mul_f32 v232, v232, v26
  v_mul_f32 v233, v233, v26
  v_mul_f32 v234, v234, v26
  v_mfma_f32_32x32x16_bf16 v[96:111], a[232:235], v[192:195], v[96:111]
  v_exp_f32 v208, v128
  v_add_f32 v28, v28, v223
  v_cvt_pk_bf16_f32 v207, v222, v223
  v_mul_f32 v235, v235, v26
  v_mul_f32 v236, v236, v26
  v_mfma_f32_32x32x16_bf16 v[112:127], a[236:239], v[192:195], v[112:127]
  v_exp_f32 v209, v129
  v_cmp_nge_f32 vcc, 0x47800000, v28
  v_mul_f32 v237, v237, v26
  v_mul_f32 v238, v238, v26
  v_mul_f32 v239, v239, v26
  v_mfma_f32_32x32x16_bf16 v[64:79], a[240:243], v[196:199], v[64:79]
  s_cbranch_vccnz L1_cbJ35
L1_rbJ35:
  v_exp_f32 v210, v130
  v_add_f32 v27, v208, v209
  v_cvt_pk_bf16_f32 v192, v208, v209
  v_cvt_pk_bf16_f32 v232, v232, v233
  v_mfma_f32_32x32x16_bf16 v[80:95], a[244:247], v[196:199], v[80:95]
  v_exp_f32 v211, v131
  v_add_f32 v30, v30, v28
  v_add_f32 v27, v27, v210
  v_cvt_pk_bf16_f32 v233, v234, v235
  v_cvt_pk_bf16_f32 v234, v236, v237
  v_mfma_f32_32x32x16_bf16 v[96:111], a[248:251], v[196:199], v[96:111]
  v_exp_f32 v212, v132
  v_add_f32 v27, v27, v211
  v_cvt_pk_bf16_f32 v193, v210, v211
  v_cvt_pk_bf16_f32 v235, v238, v239
  v_mfma_f32_32x32x16_bf16 v[112:127], a[252:255], v[196:199], v[112:127]
  buffer_store_dwordx4 v[232:235], v24, s[20:23], s48 offen offset:512 sc1
  v_exp_f32 v213, v133
  v_add_f32 v27, v27, v212
  v_accvgpr_read_b32 v240, a144
  v_mfma_f32_32x32x16_bf16 v[144:159], a[192:195], a[8:11], v[176:191]
  v_exp_f32 v214, v134
  v_add_f32 v27, v27, v213
  v_cvt_pk_bf16_f32 v194, v212, v213
  v_accvgpr_read_b32 v241, a145
  v_accvgpr_read_b32 v242, a146
  v_mfma_f32_32x32x16_bf16 v[144:159], a[196:199], a[12:15], v[144:159]
  ds_read_b128 a[192:195], v8 offset:40960
  v_exp_f32 v215, v135
  v_add_f32 v27, v27, v214
  v_accvgpr_read_b32 v243, a147
  v_accvgpr_read_b32 v244, a148
  v_mfma_f32_32x32x16_bf16 v[144:159], a[200:203], a[24:27], v[144:159]
  ds_read_b128 a[196:199], v9 offset:40960
  v_exp_f32 v208, v136
  v_add_f32 v27, v27, v215
  v_cvt_pk_bf16_f32 v195, v214, v215
  v_accvgpr_read_b32 v245, a149
  v_mfma_f32_32x32x16_bf16 v[144:159], a[204:207], a[28:31], v[144:159]
  ds_read_b128 a[200:203], v10 offset:40960
  v_exp_f32 v209, v137
  v_add_f32 v27, v27, v208
  v_accvgpr_read_b32 v246, a150
  v_accvgpr_read_b32 v247, a151
  v_mfma_f32_32x32x16_bf16 v[144:159], a[208:211], a[40:43], v[144:159]
  ds_read_b128 a[204:207], v11 offset:40960
  v_exp_f32 v210, v138
  v_add_f32 v27, v27, v209
  v_cvt_pk_bf16_f32 v196, v208, v209
  v_mul_f32 v240, v240, v26
  v_mfma_f32_32x32x16_bf16 v[144:159], a[212:215], a[44:47], v[144:159]
  ds_read_b128 a[208:211], v12 offset:40960
  v_exp_f32 v211, v139
  v_add_f32 v27, v27, v210
  v_mul_f32 v241, v241, v26
  v_mul_f32 v242, v242, v26
  v_mfma_f32_32x32x16_bf16 v[144:159], a[216:219], a[56:59], v[144:159]
  ds_read_b128 a[212:215], v13 offset:40960
  v_exp_f32 v212, v140
  v_add_f32 v27, v27, v211
  v_cvt_pk_bf16_f32 v197, v210, v211
  v_mul_f32 v243, v243, v26
  v_mfma_f32_32x32x16_bf16 v[144:159], a[220:223], a[60:63], v[144:159]
  ds_read_b128 a[216:219], v14 offset:40960
  v_exp_f32 v213, v141
  v_add_f32 v27, v27, v212
  v_mul_f32 v244, v244, v26
  s_add_u32 m0, s29, 0x2000
  v_mfma_f32_32x32x16_bf16 a[64:79], a[224:227], v[200:203], a[64:79]
  ds_read_b128 a[220:223], v15 offset:40960
  buffer_load_dwordx4 v20, s[12:15], s27 offen offset:0 nt lds
  v_exp_f32 v214, v142
  v_add_f32 v27, v27, v213
  v_cvt_pk_bf16_f32 v198, v212, v213
  v_mfma_f32_32x32x16_bf16 a[80:95], a[228:231], v[200:203], a[80:95]
  ds_read_b64_tr_b16 a[224:225], v16 offset:32768
  ds_read_b64_tr_b16 a[226:227], v16 offset:34816
  v_exp_f32 v215, v143
  v_add_f32 v27, v27, v214
  v_mul_f32 v245, v245, v26
  v_mfma_f32_32x32x16_bf16 a[96:111], a[232:235], v[200:203], a[96:111]
  ds_read_b64_tr_b16 a[228:229], v17 offset:32768
  buffer_load_dwordx4 v21, s[12:15], s27 offen offset:1024 nt lds
  v_exp_f32 v216, v144
  v_add_f32 v27, v27, v215
  v_cvt_pk_bf16_f32 v199, v214, v215
  v_mfma_f32_32x32x16_bf16 a[112:127], a[236:239], v[200:203], a[112:127]
  ds_read_b64_tr_b16 a[230:231], v17 offset:34816
  ds_read_b64_tr_b16 a[232:233], v18 offset:32768
  v_exp_f32 v217, v145
  v_cmp_nge_f32 vcc, 0x47800000, v27
  s_add_u32 m0, s29, 0x10000
  v_mfma_f32_32x32x16_bf16 a[64:79], a[240:243], v[204:207], a[64:79]
  ds_read_b64_tr_b16 a[234:235], v18 offset:34816
  buffer_load_dwordx4 v22, s[16:19], s27 offen offset:0 nt lds
  s_cbranch_vccnz L1_caJ35
L1_raJ35:
  v_exp_f32 v218, v146
  v_add_f32 v28, v216, v217
  v_cvt_pk_bf16_f32 v200, v216, v217
  v_mfma_f32_32x32x16_bf16 a[80:95], a[244:247], v[204:207], a[80:95]
  ds_read_b64_tr_b16 a[236:237], v19 offset:32768
  v_exp_f32 v219, v147
  v_add_f32 v28, v28, v218
  v_add_f32 v29, v29, v27
  v_mul_f32 v246, v246, v26
  v_mfma_f32_32x32x16_bf16 a[96:111], a[248:251], v[204:207], a[96:111]
  ds_read_b64_tr_b16 a[238:239], v19 offset:34816
  buffer_load_dwordx4 v22, s[16:19], s27 offen offset:1024 nt lds
  v_exp_f32 v220, v148
  v_add_f32 v28, v28, v219
  v_cvt_pk_bf16_f32 v201, v218, v219
  v_mfma_f32_32x32x16_bf16 a[112:127], a[252:255], v[204:207], a[112:127]
  ds_read_b64_tr_b16 a[240:241], v16 offset:36864
  ds_read_b64_tr_b16 a[242:243], v16 offset:38912
  v_exp_f32 v221, v149
  v_add_f32 v28, v28, v220
  v_mul_f32 v247, v247, v26
  s_waitcnt lgkmcnt(10)
  v_mfma_f32_32x32x16_bf16 v[128:143], a[192:195], a[0:3], v[160:175]
  v_exp_f32 v222, v150
  v_add_f32 v28, v28, v221
  v_cvt_pk_bf16_f32 v202, v220, v221
  v_cvt_pk_bf16_f32 v240, v240, v241
  v_cvt_pk_bf16_f32 v241, v242, v243
  v_mfma_f32_32x32x16_bf16 v[128:143], a[196:199], a[4:7], v[128:143]
  ds_read_b64_tr_b16 a[244:245], v17 offset:36864
  ds_read_b64_tr_b16 a[246:247], v17 offset:38912
  v_exp_f32 v223, v151
  v_add_f32 v28, v28, v222
  v_cvt_pk_bf16_f32 v242, v244, v245
  v_mfma_f32_32x32x16_bf16 v[128:143], a[200:203], a[16:19], v[128:143]
  ds_read_b64_tr_b16 a[248:249], v18 offset:36864
  s_add_u32 s27, s27, 0x2000
  v_exp_f32 v216, v152
  v_add_f32 v28, v28, v223
  v_cvt_pk_bf16_f32 v203, v222, v223
  v_mfma_f32_32x32x16_bf16 v[128:143], a[204:207], a[20:23], v[128:143]
  ds_read_b64_tr_b16 a[250:251], v18 offset:38912
  ds_read_b64_tr_b16 a[252:253], v19 offset:36864
  v_exp_f32 v217, v153
  v_add_f32 v28, v28, v216
  v_cvt_pk_bf16_f32 v243, v246, v247
  v_mfma_f32_32x32x16_bf16 v[128:143], a[208:211], a[32:35], v[128:143]
  ds_read_b64_tr_b16 a[254:255], v19 offset:38912
  v_exp_f32 v218, v154
  v_add_f32 v28, v28, v217
  v_cvt_pk_bf16_f32 v204, v216, v217
  v_mfma_f32_32x32x16_bf16 v[128:143], a[212:215], a[36:39], v[128:143]
  buffer_store_dwordx4 v[240:243], v24, s[20:23], s48 offen offset:1024 sc1
  v_exp_f32 v219, v155
  v_add_f32 v28, v28, v218
  v_accvgpr_read_b32 v248, a152
  v_mfma_f32_32x32x16_bf16 v[128:143], a[216:219], a[48:51], v[128:143]
  v_exp_f32 v220, v156
  v_add_f32 v28, v28, v219
  v_cvt_pk_bf16_f32 v205, v218, v219
  v_accvgpr_read_b32 v249, a153
  v_accvgpr_read_b32 v250, a154
  v_mfma_f32_32x32x16_bf16 v[128:143], a[220:223], a[52:55], v[128:143]
  v_exp_f32 v221, v157
  v_add_f32 v28, v28, v220
  v_accvgpr_read_b32 v251, a155
  v_accvgpr_read_b32 v252, a156
  v_accvgpr_read_b32 v253, a157
  s_waitcnt lgkmcnt(0)
  v_mfma_f32_32x32x16_bf16 v[64:79], a[224:227], v[192:195], v[64:79]
  v_exp_f32 v222, v158
  v_add_f32 v28, v28, v221
  v_cvt_pk_bf16_f32 v206, v220, v221
  v_accvgpr_read_b32 v254, a158
  v_accvgpr_read_b32 v255, a159
  v_mfma_f32_32x32x16_bf16 v[80:95], a[228:231], v[192:195], v[80:95]
  v_exp_f32 v223, v159
  v_add_f32 v28, v28, v222
  v_mul_f32 v248, v248, v26
  v_mul_f32 v249, v249, v26
  v_mul_f32 v250, v250, v26
  v_mfma_f32_32x32x16_bf16 v[96:111], a[232:235], v[192:195], v[96:111]
  v_exp_f32 v208, v128
  v_add_f32 v28, v28, v223
  v_cvt_pk_bf16_f32 v207, v222, v223
  v_mul_f32 v251, v251, v26
  v_mul_f32 v252, v252, v26
  v_mfma_f32_32x32x16_bf16 v[112:127], a[236:239], v[192:195], v[112:127]
  v_exp_f32 v209, v129
  v_cmp_nge_f32 vcc, 0x47800000, v28
  v_mul_f32 v253, v253, v26
  v_mul_f32 v254, v254, v26
  v_mul_f32 v255, v255, v26
  v_mfma_f32_32x32x16_bf16 v[64:79], a[240:243], v[196:199], v[64:79]
  s_cbranch_vccnz L1_cbJ36
L1_rbJ36:
  v_exp_f32 v210, v130
  v_add_f32 v27, v208, v209
  v_cvt_pk_bf16_f32 v192, v208, v209
  v_cvt_pk_bf16_f32 v248, v248, v249
  v_mfma_f32_32x32x16_bf16 v[80:95], a[244:247], v[196:199], v[80:95]
  v_exp_f32 v211, v131
  v_add_f32 v30, v30, v28
  v_add_f32 v27, v27, v210
  v_cvt_pk_bf16_f32 v249, v250, v251
  v_cvt_pk_bf16_f32 v250, v252, v253
  v_mfma_f32_32x32x16_bf16 v[96:111], a[248:251], v[196:199], v[96:111]
  v_exp_f32 v212, v132
  v_add_f32 v27, v27, v211
  v_cvt_pk_bf16_f32 v193, v210, v211
  v_cvt_pk_bf16_f32 v251, v254, v255
  v_mfma_f32_32x32x16_bf16 v[112:127], a[252:255], v[196:199], v[112:127]
  buffer_store_dwordx4 v[248:251], v24, s[20:23], s48 offen offset:1536 sc1
  v_exp_f32 v213, v133
  v_add_f32 v27, v27, v212
  v_accvgpr_read_b32 v224, a160
  v_mfma_f32_32x32x16_bf16 v[144:159], a[192:195], a[8:11], v[176:191]
  s_waitcnt vmcnt(14)
  s_barrier
  v_exp_f32 v214, v134
  v_add_f32 v27, v27, v213
  v_cvt_pk_bf16_f32 v194, v212, v213
  v_accvgpr_read_b32 v225, a161
  v_mfma_f32_32x32x16_bf16 v[144:159], a[196:199], a[12:15], v[144:159]
  ds_read_b128 a[192:195], v8 offset:49152
  v_exp_f32 v215, v135
  v_add_f32 v27, v27, v214
  v_accvgpr_read_b32 v226, a162
  v_accvgpr_read_b32 v227, a163
  v_mfma_f32_32x32x16_bf16 v[144:159], a[200:203], a[24:27], v[144:159]
  ds_read_b128 a[196:199], v9 offset:49152
  v_exp_f32 v208, v136
  v_add_f32 v27, v27, v215
  v_cvt_pk_bf16_f32 v195, v214, v215
  v_accvgpr_read_b32 v228, a164
  v_mfma_f32_32x32x16_bf16 v[144:159], a[204:207], a[28:31], v[144:159]
  ds_read_b128 a[200:203], v10 offset:49152
  v_exp_f32 v209, v137
  v_add_f32 v27, v27, v208
  v_accvgpr_read_b32 v229, a165
  v_accvgpr_read_b32 v230, a166
  v_mfma_f32_32x32x16_bf16 v[144:159], a[208:211], a[40:43], v[144:159]
  ds_read_b128 a[204:207], v11 offset:49152
  v_exp_f32 v210, v138
  v_add_f32 v27, v27, v209
  v_cvt_pk_bf16_f32 v196, v208, v209
  v_accvgpr_read_b32 v231, a167
  v_mfma_f32_32x32x16_bf16 v[144:159], a[212:215], a[44:47], v[144:159]
  ds_read_b128 a[208:211], v12 offset:49152
  v_exp_f32 v211, v139
  v_add_f32 v27, v27, v210
  v_mul_f32 v224, v224, v26
  v_mul_f32 v225, v225, v26
  v_mfma_f32_32x32x16_bf16 v[144:159], a[216:219], a[56:59], v[144:159]
  ds_read_b128 a[212:215], v13 offset:49152
  v_exp_f32 v212, v140
  v_add_f32 v27, v27, v211
  v_cvt_pk_bf16_f32 v197, v210, v211
  v_mul_f32 v226, v226, v26
  v_mfma_f32_32x32x16_bf16 v[144:159], a[220:223], a[60:63], v[144:159]
  ds_read_b128 a[216:219], v14 offset:49152
  v_exp_f32 v213, v141
  v_add_f32 v27, v27, v212
  v_mul_f32 v227, v227, v26
  s_add_u32 m0, s29, 0x4000
  v_mfma_f32_32x32x16_bf16 a[64:79], a[224:227], v[200:203], a[64:79]
  ds_read_b128 a[220:223], v15 offset:49152
  buffer_load_dwordx4 v20, s[12:15], s27 offen offset:0 nt lds
  v_exp_f32 v214, v142
  v_add_f32 v27, v27, v213
  v_cvt_pk_bf16_f32 v198, v212, v213
  v_mfma_f32_32x32x16_bf16 a[80:95], a[228:231], v[200:203], a[80:95]
  ds_read_b64_tr_b16 a[224:225], v16 offset:40960
  ds_read_b64_tr_b16 a[226:227], v16 offset:43008
  v_exp_f32 v215, v143
  v_add_f32 v27, v27, v214
  v_mul_f32 v228, v228, v26
  v_mfma_f32_32x32x16_bf16 a[96:111], a[232:235], v[200:203], a[96:111]
  ds_read_b64_tr_b16 a[228:229], v17 offset:40960
  buffer_load_dwordx4 v21, s[12:15], s27 offen offset:1024 nt lds
  v_exp_f32 v216, v144
  v_add_f32 v27, v27, v215
  v_cvt_pk_bf16_f32 v199, v214, v215
  v_mfma_f32_32x32x16_bf16 a[112:127], a[236:239], v[200:203], a[112:127]
  ds_read_b64_tr_b16 a[230:231], v17 offset:43008
  ds_read_b64_tr_b16 a[232:233], v18 offset:40960
  v_exp_f32 v217, v145
  v_cmp_nge_f32 vcc, 0x47800000, v27
  s_add_u32 m0, s29, 0x12000
  v_mfma_f32_32x32x16_bf16 a[64:79], a[240:243], v[204:207], a[64:79]
  ds_read_b64_tr_b16 a[234:235], v18 offset:43008
  buffer_load_dwordx4 v22, s[16:19], s27 offen offset:0 nt lds
  s_cbranch_vccnz L1_caJ36
L1_raJ36:
  v_exp_f32 v218, v146
  v_add_f32 v28, v216, v217
  v_cvt_pk_bf16_f32 v200, v216, v217
  v_mfma_f32_32x32x16_bf16 a[80:95], a[244:247], v[204:207], a[80:95]
  ds_read_b64_tr_b16 a[236:237], v19 offset:40960
  v_exp_f32 v219, v147
  v_add_f32 v28, v28, v218
  v_add_f32 v29, v29, v27
  v_mul_f32 v229, v229, v26
  v_mfma_f32_32x32x16_bf16 a[96:111], a[248:251], v[204:207], a[96:111]
  ds_read_b64_tr_b16 a[238:239], v19 offset:43008
  buffer_load_dwordx4 v22, s[16:19], s27 offen offset:1024 nt lds
  v_exp_f32 v220, v148
  v_add_f32 v28, v28, v219
  v_cvt_pk_bf16_f32 v201, v218, v219
  v_mfma_f32_32x32x16_bf16 a[112:127], a[252:255], v[204:207], a[112:127]
  ds_read_b64_tr_b16 a[240:241], v16 offset:45056
  ds_read_b64_tr_b16 a[242:243], v16 offset:47104
  v_exp_f32 v221, v149
  v_add_f32 v28, v28, v220
  v_mul_f32 v230, v230, v26
  s_waitcnt lgkmcnt(10)
  v_mfma_f32_32x32x16_bf16 v[128:143], a[192:195], a[0:3], v[160:175]
  v_exp_f32 v222, v150
  v_add_f32 v28, v28, v221
  v_cvt_pk_bf16_f32 v202, v220, v221
  v_mul_f32 v231, v231, v26
  v_cvt_pk_bf16_f32 v224, v224, v225
  v_mfma_f32_32x32x16_bf16 v[128:143], a[196:199], a[4:7], v[128:143]
  ds_read_b64_tr_b16 a[244:245], v17 offset:45056
  ds_read_b64_tr_b16 a[246:247], v17 offset:47104
  v_exp_f32 v223, v151
  v_add_f32 v28, v28, v222
  v_cvt_pk_bf16_f32 v225, v226, v227
  v_mfma_f32_32x32x16_bf16 v[128:143], a[200:203], a[16:19], v[128:143]
  ds_read_b64_tr_b16 a[248:249], v18 offset:45056
  s_add_u32 s27, s27, 0x2000
  v_exp_f32 v216, v152
  v_add_f32 v28, v28, v223
  v_cvt_pk_bf16_f32 v203, v222, v223
  v_mfma_f32_32x32x16_bf16 v[128:143], a[204:207], a[20:23], v[128:143]
  ds_read_b64_tr_b16 a[250:251], v18 offset:47104
  ds_read_b64_tr_b16 a[252:253], v19 offset:45056
  v_exp_f32 v217, v153
  v_add_f32 v28, v28, v216
  v_cvt_pk_bf16_f32 v226, v228, v229
  v_mfma_f32_32x32x16_bf16 v[128:143], a[208:211], a[32:35], v[128:143]
  ds_read_b64_tr_b16 a[254:255], v19 offset:47104
  v_exp_f32 v218, v154
  v_add_f32 v28, v28, v217
  v_cvt_pk_bf16_f32 v204, v216, v217
  v_cvt_pk_bf16_f32 v227, v230, v231
  v_mfma_f32_32x32x16_bf16 v[128:143], a[212:215], a[36:39], v[128:143]
  buffer_store_dwordx4 v[224:227], v24, s[20:23], s48 offen offset:2048 sc1
  v_exp_f32 v219, v155
  v_add_f32 v28, v28, v218
  v_accvgpr_read_b32 v232, a168
  v_mfma_f32_32x32x16_bf16 v[128:143], a[216:219], a[48:51], v[128:143]
  v_exp_f32 v220, v156
  v_add_f32 v28, v28, v219
  v_cvt_pk_bf16_f32 v205, v218, v219
  v_accvgpr_read_b32 v233, a169
  v_accvgpr_read_b32 v234, a170
  v_mfma_f32_32x32x16_bf16 v[128:143], a[220:223], a[52:55], v[128:143]
  v_exp_f32 v221, v157
  v_add_f32 v28, v28, v220
  v_accvgpr_read_b32 v235, a171
  v_accvgpr_read_b32 v236, a172
  v_accvgpr_read_b32 v237, a173
  s_waitcnt lgkmcnt(0)
  v_mfma_f32_32x32x16_bf16 v[64:79], a[224:227], v[192:195], v[64:79]
  v_exp_f32 v222, v158
  v_add_f32 v28, v28, v221
  v_cvt_pk_bf16_f32 v206, v220, v221
  v_accvgpr_read_b32 v238, a174
  v_accvgpr_read_b32 v239, a175
  v_mfma_f32_32x32x16_bf16 v[80:95], a[228:231], v[192:195], v[80:95]
  v_exp_f32 v223, v159
  v_add_f32 v28, v28, v222
  v_mul_f32 v232, v232, v26
  v_mul_f32 v233, v233, v26
  v_mul_f32 v234, v234, v26
  v_mfma_f32_32x32x16_bf16 v[96:111], a[232:235], v[192:195], v[96:111]
  v_exp_f32 v208, v128
  v_add_f32 v28, v28, v223
  v_cvt_pk_bf16_f32 v207, v222, v223
  v_mul_f32 v235, v235, v26
  v_mul_f32 v236, v236, v26
  v_mfma_f32_32x32x16_bf16 v[112:127], a[236:239], v[192:195], v[112:127]
  v_exp_f32 v209, v129
  v_cmp_nge_f32 vcc, 0x47800000, v28
  v_mul_f32 v237, v237, v26
  v_mul_f32 v238, v238, v26
  v_mul_f32 v239, v239, v26
  v_mfma_f32_32x32x16_bf16 v[64:79], a[240:243], v[196:199], v[64:79]
  s_cbranch_vccnz L1_cbJ37
L1_rbJ37:
  v_exp_f32 v210, v130
  v_add_f32 v27, v208, v209
  v_cvt_pk_bf16_f32 v192, v208, v209
  v_cvt_pk_bf16_f32 v232, v232, v233
  v_mfma_f32_32x32x16_bf16 v[80:95], a[244:247], v[196:199], v[80:95]
  v_exp_f32 v211, v131
  v_add_f32 v30, v30, v28
  v_add_f32 v27, v27, v210
  v_cvt_pk_bf16_f32 v233, v234, v235
  v_cvt_pk_bf16_f32 v234, v236, v237
  v_mfma_f32_32x32x16_bf16 v[96:111], a[248:251], v[196:199], v[96:111]
  v_exp_f32 v212, v132
  v_add_f32 v27, v27, v211
  v_cvt_pk_bf16_f32 v193, v210, v211
  v_cvt_pk_bf16_f32 v235, v238, v239
  v_mfma_f32_32x32x16_bf16 v[112:127], a[252:255], v[196:199], v[112:127]
  buffer_store_dwordx4 v[232:235], v24, s[20:23], s48 offen offset:2560 sc1
  v_exp_f32 v213, v133
  v_add_f32 v27, v27, v212
  v_accvgpr_read_b32 v240, a176
  v_mfma_f32_32x32x16_bf16 v[144:159], a[192:195], a[8:11], v[176:191]
  v_exp_f32 v214, v134
  v_add_f32 v27, v27, v213
  v_cvt_pk_bf16_f32 v194, v212, v213
  v_accvgpr_read_b32 v241, a177
  v_accvgpr_read_b32 v242, a178
  v_mfma_f32_32x32x16_bf16 v[144:159], a[196:199], a[12:15], v[144:159]
  ds_read_b128 a[192:195], v8 offset:57344
  v_exp_f32 v215, v135
  v_add_f32 v27, v27, v214
  v_accvgpr_read_b32 v243, a179
  v_accvgpr_read_b32 v244, a180
  v_mfma_f32_32x32x16_bf16 v[144:159], a[200:203], a[24:27], v[144:159]
  ds_read_b128 a[196:199], v9 offset:57344
  v_exp_f32 v208, v136
  v_add_f32 v27, v27, v215
  v_cvt_pk_bf16_f32 v195, v214, v215
  v_accvgpr_read_b32 v245, a181
  v_mfma_f32_32x32x16_bf16 v[144:159], a[204:207], a[28:31], v[144:159]
  ds_read_b128 a[200:203], v10 offset:57344
  v_exp_f32 v209, v137
  v_add_f32 v27, v27, v208
  v_accvgpr_read_b32 v246, a182
  v_accvgpr_read_b32 v247, a183
  v_mfma_f32_32x32x16_bf16 v[144:159], a[208:211], a[40:43], v[144:159]
  ds_read_b128 a[204:207], v11 offset:57344
  v_exp_f32 v210, v138
  v_add_f32 v27, v27, v209
  v_cvt_pk_bf16_f32 v196, v208, v209
  v_mul_f32 v240, v240, v26
  v_mfma_f32_32x32x16_bf16 v[144:159], a[212:215], a[44:47], v[144:159]
  ds_read_b128 a[208:211], v12 offset:57344
  v_exp_f32 v211, v139
  v_add_f32 v27, v27, v210
  v_mul_f32 v241, v241, v26
  v_mul_f32 v242, v242, v26
  v_mfma_f32_32x32x16_bf16 v[144:159], a[216:219], a[56:59], v[144:159]
  ds_read_b128 a[212:215], v13 offset:57344
  v_exp_f32 v212, v140
  v_add_f32 v27, v27, v211
  v_cvt_pk_bf16_f32 v197, v210, v211
  v_mul_f32 v243, v243, v26
  v_mfma_f32_32x32x16_bf16 v[144:159], a[220:223], a[60:63], v[144:159]
  ds_read_b128 a[216:219], v14 offset:57344
  v_exp_f32 v213, v141
  v_add_f32 v27, v27, v212
  v_mul_f32 v244, v244, v26
  s_add_u32 m0, s29, 0x6000
  v_mfma_f32_32x32x16_bf16 a[64:79], a[224:227], v[200:203], a[64:79]
  ds_read_b128 a[220:223], v15 offset:57344
  buffer_load_dwordx4 v20, s[12:15], s27 offen offset:0 nt lds
  v_exp_f32 v214, v142
  v_add_f32 v27, v27, v213
  v_cvt_pk_bf16_f32 v198, v212, v213
  v_mfma_f32_32x32x16_bf16 a[80:95], a[228:231], v[200:203], a[80:95]
  ds_read_b64_tr_b16 a[224:225], v16 offset:49152
  ds_read_b64_tr_b16 a[226:227], v16 offset:51200
  v_exp_f32 v215, v143
  v_add_f32 v27, v27, v214
  v_mul_f32 v245, v245, v26
  v_mfma_f32_32x32x16_bf16 a[96:111], a[232:235], v[200:203], a[96:111]
  ds_read_b64_tr_b16 a[228:229], v17 offset:49152
  buffer_load_dwordx4 v21, s[12:15], s27 offen offset:1024 nt lds
  v_exp_f32 v216, v144
  v_add_f32 v27, v27, v215
  v_cvt_pk_bf16_f32 v199, v214, v215
  v_mfma_f32_32x32x16_bf16 a[112:127], a[236:239], v[200:203], a[112:127]
  ds_read_b64_tr_b16 a[230:231], v17 offset:51200
  ds_read_b64_tr_b16 a[232:233], v18 offset:49152
  v_exp_f32 v217, v145
  v_cmp_nge_f32 vcc, 0x47800000, v27
  s_add_u32 m0, s29, 0x14000
  v_mfma_f32_32x32x16_bf16 a[64:79], a[240:243], v[204:207], a[64:79]
  ds_read_b64_tr_b16 a[234:235], v18 offset:51200
  buffer_load_dwordx4 v22, s[16:19], s27 offen offset:0 nt lds
  s_cbranch_vccnz L1_caJ37
L1_raJ37:
  v_exp_f32 v218, v146
  v_add_f32 v28, v216, v217
  v_cvt_pk_bf16_f32 v200, v216, v217
  v_mfma_f32_32x32x16_bf16 a[80:95], a[244:247], v[204:207], a[80:95]
  ds_read_b64_tr_b16 a[236:237], v19 offset:49152
  v_exp_f32 v219, v147
  v_add_f32 v28, v28, v218
  v_add_f32 v29, v29, v27
  v_mul_f32 v246, v246, v26
  v_mfma_f32_32x32x16_bf16 a[96:111], a[248:251], v[204:207], a[96:111]
  ds_read_b64_tr_b16 a[238:239], v19 offset:51200
  buffer_load_dwordx4 v22, s[16:19], s27 offen offset:1024 nt lds
  v_exp_f32 v220, v148
  v_add_f32 v28, v28, v219
  v_cvt_pk_bf16_f32 v201, v218, v219
  v_mfma_f32_32x32x16_bf16 a[112:127], a[252:255], v[204:207], a[112:127]
  ds_read_b64_tr_b16 a[240:241], v16 offset:53248
  ds_read_b64_tr_b16 a[242:243], v16 offset:55296
  v_exp_f32 v221, v149
  v_add_f32 v28, v28, v220
  v_mul_f32 v247, v247, v26
  s_waitcnt lgkmcnt(10)
  v_mfma_f32_32x32x16_bf16 v[128:143], a[192:195], a[0:3], v[160:175]
  v_exp_f32 v222, v150
  v_add_f32 v28, v28, v221
  v_cvt_pk_bf16_f32 v202, v220, v221
  v_cvt_pk_bf16_f32 v240, v240, v241
  v_cvt_pk_bf16_f32 v241, v242, v243
  v_mfma_f32_32x32x16_bf16 v[128:143], a[196:199], a[4:7], v[128:143]
  ds_read_b64_tr_b16 a[244:245], v17 offset:53248
  ds_read_b64_tr_b16 a[246:247], v17 offset:55296
  v_exp_f32 v223, v151
  v_add_f32 v28, v28, v222
  v_cvt_pk_bf16_f32 v242, v244, v245
  v_mfma_f32_32x32x16_bf16 v[128:143], a[200:203], a[16:19], v[128:143]
  ds_read_b64_tr_b16 a[248:249], v18 offset:53248
  s_add_u32 s27, s27, 0x2000
  v_exp_f32 v216, v152
  v_add_f32 v28, v28, v223
  v_cvt_pk_bf16_f32 v203, v222, v223
  v_mfma_f32_32x32x16_bf16 v[128:143], a[204:207], a[20:23], v[128:143]
  ds_read_b64_tr_b16 a[250:251], v18 offset:55296
  ds_read_b64_tr_b16 a[252:253], v19 offset:53248
  v_exp_f32 v217, v153
  v_add_f32 v28, v28, v216
  v_cvt_pk_bf16_f32 v243, v246, v247
  v_mfma_f32_32x32x16_bf16 v[128:143], a[208:211], a[32:35], v[128:143]
  ds_read_b64_tr_b16 a[254:255], v19 offset:55296
  v_exp_f32 v218, v154
  v_add_f32 v28, v28, v217
  v_cvt_pk_bf16_f32 v204, v216, v217
  v_mfma_f32_32x32x16_bf16 v[128:143], a[212:215], a[36:39], v[128:143]
  buffer_store_dwordx4 v[240:243], v24, s[20:23], s48 offen offset:3072 sc1
  v_exp_f32 v219, v155
  v_add_f32 v28, v28, v218
  v_accvgpr_read_b32 v248, a184
  v_mfma_f32_32x32x16_bf16 v[128:143], a[216:219], a[48:51], v[128:143]
  v_exp_f32 v220, v156
  v_add_f32 v28, v28, v219
  v_cvt_pk_bf16_f32 v205, v218, v219
  v_accvgpr_read_b32 v249, a185
  v_accvgpr_read_b32 v250, a186
  v_mfma_f32_32x32x16_bf16 v[128:143], a[220:223], a[52:55], v[128:143]
  v_exp_f32 v221, v157
  v_add_f32 v28, v28, v220
  v_accvgpr_read_b32 v251, a187
  v_accvgpr_read_b32 v252, a188
  v_accvgpr_read_b32 v253, a189
  s_waitcnt lgkmcnt(0)
  v_mfma_f32_32x32x16_bf16 v[64:79], a[224:227], v[192:195], v[64:79]
  v_exp_f32 v222, v158
  v_add_f32 v28, v28, v221
  v_cvt_pk_bf16_f32 v206, v220, v221
  v_accvgpr_read_b32 v254, a190
  v_accvgpr_read_b32 v255, a191
  v_mfma_f32_32x32x16_bf16 v[80:95], a[228:231], v[192:195], v[80:95]
  v_exp_f32 v223, v159
  v_add_f32 v28, v28, v222
  v_mul_f32 v248, v248, v26
  v_mul_f32 v249, v249, v26
  v_mul_f32 v250, v250, v26
  v_mfma_f32_32x32x16_bf16 v[96:111], a[232:235], v[192:195], v[96:111]
  v_exp_f32 v208, v128
  v_add_f32 v28, v28, v223
  v_cvt_pk_bf16_f32 v207, v222, v223
  v_mul_f32 v251, v251, v26
  v_mul_f32 v252, v252, v26
  v_mfma_f32_32x32x16_bf16 v[112:127], a[236:239], v[192:195], v[112:127]
  v_exp_f32 v209, v129
  v_cmp_nge_f32 vcc, 0x47800000, v28
  v_mul_f32 v253, v253, v26
  v_mul_f32 v254, v254, v26
  v_mul_f32 v255, v255, v26
  v_mfma_f32_32x32x16_bf16 v[64:79], a[240:243], v[196:199], v[64:79]
  s_cbranch_vccnz L1_cbJ38
L1_rbJ38:
  v_exp_f32 v210, v130
  v_add_f32 v27, v208, v209
  v_cvt_pk_bf16_f32 v192, v208, v209
  v_cvt_pk_bf16_f32 v248, v248, v249
  v_mfma_f32_32x32x16_bf16 v[80:95], a[244:247], v[196:199], v[80:95]
  v_exp_f32 v211, v131
  v_add_f32 v30, v30, v28
  v_add_f32 v27, v27, v210
  v_cvt_pk_bf16_f32 v249, v250, v251
  v_cvt_pk_bf16_f32 v250, v252, v253
  v_mfma_f32_32x32x16_bf16 v[96:111], a[248:251], v[196:199], v[96:111]
  v_exp_f32 v212, v132
  v_add_f32 v27, v27, v211
  v_cvt_pk_bf16_f32 v193, v210, v211
  v_cvt_pk_bf16_f32 v251, v254, v255
  v_mfma_f32_32x32x16_bf16 v[112:127], a[252:255], v[196:199], v[112:127]
  buffer_store_dwordx4 v[248:251], v24, s[20:23], s48 offen offset:3584 sc1
  v_exp_f32 v213, v133
  v_add_f32 v27, v27, v212
  v_mov_b32 v3, s96
  v_mfma_f32_32x32x16_bf16 v[144:159], a[192:195], a[8:11], v[176:191]
  s_waitcnt vmcnt(14)
  s_barrier
  v_exp_f32 v214, v134
  v_add_f32 v27, v27, v213
  v_cvt_pk_bf16_f32 v194, v212, v213
  v_mov_b32 v56, s97
  v_mfma_f32_32x32x16_bf16 v[144:159], a[196:199], a[12:15], v[144:159]
  ds_read_b128 a[192:195], v8 offset:0
  v_exp_f32 v215, v135
  v_add_f32 v27, v27, v214
  v_mov_b32 v7, 1
  v_cndmask_b32 v3, v56, v3, s[98:99]
  v_mfma_f32_32x32x16_bf16 v[144:159], a[200:203], a[24:27], v[144:159]
  ds_read_b128 a[196:199], v9 offset:0
  v_exp_f32 v208, v136
  v_add_f32 v27, v27, v215
  v_cvt_pk_bf16_f32 v195, v214, v215
  v_and_b32 v25, 7, v2
  v_mfma_f32_32x32x16_bf16 v[144:159], a[204:207], a[28:31], v[144:159]
  ds_read_b128 a[200:203], v10 offset:0
  v_exp_f32 v209, v137
  v_add_f32 v27, v27, v208
  v_lshlrev_b32 v25, 4, v25
  v_add_u32 v25, s9, v25
  v_mfma_f32_32x32x16_bf16 v[144:159], a[208:211], a[40:43], v[144:159]
  ds_read_b128 a[204:207], v11 offset:0
  v_exp_f32 v210, v138
  v_add_f32 v27, v27, v209
  v_cvt_pk_bf16_f32 v196, v208, v209
  v_mfma_f32_32x32x16_bf16 v[144:159], a[212:215], a[44:47], v[144:159]
  ds_read_b128 a[208:211], v12 offset:0
  v_exp_f32 v211, v139
  v_add_f32 v27, v27, v210
  v_mfma_f32_32x32x16_bf16 v[144:159], a[216:219], a[56:59], v[144:159]
  ds_read_b128 a[212:215], v13 offset:0
  v_exp_f32 v212, v140
  v_add_f32 v27, v27, v211
  v_cvt_pk_bf16_f32 v197, v210, v211
  v_mfma_f32_32x32x16_bf16 v[144:159], a[220:223], a[60:63], v[144:159]
  ds_read_b128 a[216:219], v14 offset:0
  v_exp_f32 v213, v141
  v_add_f32 v27, v27, v212
  s_add_u32 m0, s29, 0x8000
  v_mfma_f32_32x32x16_bf16 a[64:79], a[224:227], v[200:203], a[64:79]
  ds_read_b128 a[220:223], v15 offset:0
  buffer_load_dwordx4 v20, s[12:15], s27 offen offset:0 nt lds
  v_exp_f32 v214, v142
  v_add_f32 v27, v27, v213
  v_cvt_pk_bf16_f32 v198, v212, v213
  v_mfma_f32_32x32x16_bf16 a[80:95], a[228:231], v[200:203], a[80:95]
  ds_read_b64_tr_b16 a[224:225], v16 offset:57344
  ds_read_b64_tr_b16 a[226:227], v16 offset:59392
  v_exp_f32 v215, v143
  v_add_f32 v27, v27, v214
  v_mfma_f32_32x32x16_bf16 a[96:111], a[232:235], v[200:203], a[96:111]
  ds_read_b64_tr_b16 a[228:229], v17 offset:57344
  buffer_load_dwordx4 v21, s[12:15], s27 offen offset:1024 nt lds
  v_exp_f32 v216, v144
  v_add_f32 v27, v27, v215
  v_cvt_pk_bf16_f32 v199, v214, v215
  v_mfma_f32_32x32x16_bf16 a[112:127], a[236:239], v[200:203], a[112:127]
  ds_read_b64_tr_b16 a[230:231], v17 offset:59392
  ds_read_b64_tr_b16 a[232:233], v18 offset:57344
  v_exp_f32 v217, v145
  v_cmp_nge_f32 vcc, 0x47800000, v27
  s_add_u32 m0, s29, 0x16000
  v_mfma_f32_32x32x16_bf16 a[64:79], a[240:243], v[204:207], a[64:79]
  ds_read_b64_tr_b16 a[234:235], v18 offset:59392
  buffer_load_dwordx4 v22, s[16:19], s27 offen offset:0 nt lds
  s_cbranch_vccnz L1_caJ38
L1_raJ38:
  v_exp_f32 v218, v146
  v_add_f32 v28, v216, v217
  v_cvt_pk_bf16_f32 v200, v216, v217
  v_mfma_f32_32x32x16_bf16 a[80:95], a[244:247], v[204:207], a[80:95]
  ds_read_b64_tr_b16 a[236:237], v19 offset:57344
  v_exp_f32 v219, v147
  v_add_f32 v28, v28, v218
  v_add_f32 v29, v29, v27
  v_mfma_f32_32x32x16_bf16 a[96:111], a[248:251], v[204:207], a[96:111]
  ds_read_b64_tr_b16 a[238:239], v19 offset:59392
  buffer_load_dwordx4 v22, s[16:19], s27 offen offset:1024 nt lds
  v_exp_f32 v220, v148
  v_add_f32 v28, v28, v219
  v_cvt_pk_bf16_f32 v201, v218, v219
  v_mfma_f32_32x32x16_bf16 a[112:127], a[252:255], v[204:207], a[112:127]
  ds_read_b64_tr_b16 a[240:241], v16 offset:61440
  ds_read_b64_tr_b16 a[242:243], v16 offset:63488
  v_exp_f32 v221, v149
  v_add_f32 v28, v28, v220
  s_waitcnt lgkmcnt(10)
  v_mfma_f32_32x32x16_bf16 v[128:143], a[192:195], a[0:3], v[160:175]
  v_exp_f32 v222, v150
  v_add_f32 v28, v28, v221
  v_cvt_pk_bf16_f32 v202, v220, v221
  v_mfma_f32_32x32x16_bf16 v[128:143], a[196:199], a[4:7], v[128:143]
  ds_read_b64_tr_b16 a[244:245], v17 offset:61440
  ds_read_b64_tr_b16 a[246:247], v17 offset:63488
  v_exp_f32 v223, v151
  v_add_f32 v28, v28, v222
  v_mfma_f32_32x32x16_bf16 v[128:143], a[200:203], a[16:19], v[128:143]
  ds_read_b64_tr_b16 a[248:249], v18 offset:61440
  s_add_u32 s27, s27, 0x2000
  v_exp_f32 v216, v152
  v_add_f32 v28, v28, v223
  v_cvt_pk_bf16_f32 v203, v222, v223
  v_mfma_f32_32x32x16_bf16 v[128:143], a[204:207], a[20:23], v[128:143]
  ds_read_b64_tr_b16 a[250:251], v18 offset:63488
  ds_read_b64_tr_b16 a[252:253], v19 offset:61440
  v_exp_f32 v217, v153
  v_add_f32 v28, v28, v216
  v_mfma_f32_32x32x16_bf16 v[128:143], a[208:211], a[32:35], v[128:143]
  ds_read_b64_tr_b16 a[254:255], v19 offset:63488
  v_exp_f32 v218, v154
  v_add_f32 v28, v28, v217
  v_cvt_pk_bf16_f32 v204, v216, v217
  v_mfma_f32_32x32x16_bf16 v[128:143], a[212:215], a[36:39], v[128:143]
  v_exp_f32 v219, v155
  v_add_f32 v28, v28, v218
  v_mfma_f32_32x32x16_bf16 v[128:143], a[216:219], a[48:51], v[128:143]
  v_exp_f32 v220, v156
  v_add_f32 v28, v28, v219
  v_cvt_pk_bf16_f32 v205, v218, v219
  v_mfma_f32_32x32x16_bf16 v[128:143], a[220:223], a[52:55], v[128:143]
  v_exp_f32 v221, v157
  v_add_f32 v28, v28, v220
  s_waitcnt lgkmcnt(0)
  v_mfma_f32_32x32x16_bf16 v[64:79], a[224:227], v[192:195], v[64:79]
  v_exp_f32 v222, v158
  v_add_f32 v28, v28, v221
  v_cvt_pk_bf16_f32 v206, v220, v221
  v_mfma_f32_32x32x16_bf16 v[80:95], a[228:231], v[192:195], v[80:95]
  v_exp_f32 v223, v159
  v_add_f32 v28, v28, v222
  v_mfma_f32_32x32x16_bf16 v[96:111], a[232:235], v[192:195], v[96:111]
  v_exp_f32 v208, v128
  v_add_f32 v28, v28, v223
  v_cvt_pk_bf16_f32 v207, v222, v223
  v_mfma_f32_32x32x16_bf16 v[112:127], a[236:239], v[192:195], v[112:127]
  v_exp_f32 v209, v129
  v_cmp_nge_f32 vcc, 0x47800000, v28
  v_mfma_f32_32x32x16_bf16 v[64:79], a[240:243], v[196:199], v[64:79]
  s_cbranch_vccnz L1_cbJ39
L1_rbJ39:
  v_exp_f32 v210, v130
  v_add_f32 v27, v208, v209
  v_cvt_pk_bf16_f32 v192, v208, v209
  v_mfma_f32_32x32x16_bf16 v[80:95], a[244:247], v[196:199], v[80:95]
  v_exp_f32 v211, v131
  v_add_f32 v30, v30, v28
  v_add_f32 v27, v27, v210
  v_mfma_f32_32x32x16_bf16 v[96:111], a[248:251], v[196:199], v[96:111]
  s_mov_b32 s30, 0
  v_exp_f32 v212, v132
  v_add_f32 v27, v27, v211
  v_cvt_pk_bf16_f32 v193, v210, v211
  v_mfma_f32_32x32x16_bf16 v[112:127], a[252:255], v[196:199], v[112:127]
  v_exp_f32 v213, v133
  v_add_f32 v27, v27, v212
  v_mfma_f32_32x32x16_bf16 v[144:159], a[192:195], a[8:11], v[176:191]
  v_exp_f32 v214, v134
  v_add_f32 v27, v27, v213
  v_cvt_pk_bf16_f32 v194, v212, v213
  v_mfma_f32_32x32x16_bf16 v[144:159], a[196:199], a[12:15], v[144:159]
  ds_read_b128 a[192:195], v8 offset:8192
  v_exp_f32 v215, v135
  v_add_f32 v27, v27, v214
  v_mfma_f32_32x32x16_bf16 v[144:159], a[200:203], a[24:27], v[144:159]
  ds_read_b128 a[196:199], v9 offset:8192
  v_exp_f32 v208, v136
  v_add_f32 v27, v27, v215
  v_cvt_pk_bf16_f32 v195, v214, v215
  v_mfma_f32_32x32x16_bf16 v[144:159], a[204:207], a[28:31], v[144:159]
  ds_read_b128 a[200:203], v10 offset:8192
  v_exp_f32 v209, v137
  v_add_f32 v27, v27, v208
  v_mfma_f32_32x32x16_bf16 v[144:159], a[208:211], a[40:43], v[144:159]
  ds_read_b128 a[204:207], v11 offset:8192
  v_exp_f32 v210, v138
  v_add_f32 v27, v27, v209
  v_cvt_pk_bf16_f32 v196, v208, v209
  v_mfma_f32_32x32x16_bf16 v[144:159], a[212:215], a[44:47], v[144:159]
  ds_read_b128 a[208:211], v12 offset:8192
  v_exp_f32 v211, v139
  v_add_f32 v27, v27, v210
  v_mfma_f32_32x32x16_bf16 v[144:159], a[216:219], a[56:59], v[144:159]
  ds_read_b128 a[212:215], v13 offset:8192
  v_exp_f32 v212, v140
  v_add_f32 v27, v27, v211
  v_cvt_pk_bf16_f32 v197, v210, v211
  v_mfma_f32_32x32x16_bf16 v[144:159], a[220:223], a[60:63], v[144:159]
  ds_read_b128 a[216:219], v14 offset:8192
  v_exp_f32 v213, v141
  v_add_f32 v27, v27, v212
  s_add_u32 m0, s29, 0xa000
  v_mfma_f32_32x32x16_bf16 a[64:79], a[224:227], v[200:203], a[64:79]
  ds_read_b128 a[220:223], v15 offset:8192
  buffer_load_dwordx4 v20, s[12:15], s27 offen offset:0 nt lds
  v_exp_f32 v214, v142
  v_add_f32 v27, v27, v213
  v_cvt_pk_bf16_f32 v198, v212, v213
  v_mfma_f32_32x32x16_bf16 a[80:95], a[228:231], v[200:203], a[80:95]
  ds_read_b64_tr_b16 a[224:225], v16 offset:0
  ds_read_b64_tr_b16 a[226:227], v16 offset:2048
  v_exp_f32 v215, v143
  v_add_f32 v27, v27, v214
  v_mfma_f32_32x32x16_bf16 a[96:111], a[232:235], v[200:203], a[96:111]
  ds_read_b64_tr_b16 a[228:229], v17 offset:0
  buffer_load_dwordx4 v21, s[12:15], s27 offen offset:1024 nt lds
  v_exp_f32 v216, v144
  v_add_f32 v27, v27, v215
  v_cvt_pk_bf16_f32 v199, v214, v215
  v_mfma_f32_32x32x16_bf16 a[112:127], a[236:239], v[200:203], a[112:127]
  ds_read_b64_tr_b16 a[230:231], v17 offset:2048
  ds_read_b64_tr_b16 a[232:233], v18 offset:0
  v_exp_f32 v217, v145
  v_cmp_nge_f32 vcc, 0x47800000, v27
  s_add_u32 m0, s29, 0x18000
  v_mfma_f32_32x32x16_bf16 a[64:79], a[240:243], v[204:207], a[64:79]
  ds_read_b64_tr_b16 a[234:235], v18 offset:2048
  buffer_load_dwordx4 v22, s[16:19], s27 offen offset:0 nt lds
  s_cbranch_vccnz L1_caJ39
L1_raJ39:
  v_exp_f32 v218, v146
  v_add_f32 v28, v216, v217
  v_cvt_pk_bf16_f32 v200, v216, v217
  v_mfma_f32_32x32x16_bf16 a[80:95], a[244:247], v[204:207], a[80:95]
  ds_read_b64_tr_b16 a[236:237], v19 offset:0
  v_exp_f32 v219, v147
  v_add_f32 v28, v28, v218
  v_add_f32 v29, v29, v27
  v_mfma_f32_32x32x16_bf16 a[96:111], a[248:251], v[204:207], a[96:111]
  ds_read_b64_tr_b16 a[238:239], v19 offset:2048
  buffer_load_dwordx4 v22, s[16:19], s27 offen offset:1024 nt lds
  v_exp_f32 v220, v148
  v_add_f32 v28, v28, v219
  v_cvt_pk_bf16_f32 v201, v218, v219
  v_mfma_f32_32x32x16_bf16 a[112:127], a[252:255], v[204:207], a[112:127]
  ds_read_b64_tr_b16 a[240:241], v16 offset:4096
  ds_read_b64_tr_b16 a[242:243], v16 offset:6144
  v_exp_f32 v221, v149
  v_add_f32 v28, v28, v220
L1_lp2:
  s_waitcnt lgkmcnt(10)
  v_mfma_f32_32x32x16_bf16 v[128:143], a[192:195], a[0:3], v[160:175]
  v_exp_f32 v222, v150
  v_add_f32 v28, v28, v221
  v_cvt_pk_bf16_f32 v202, v220, v221
  v_mfma_f32_32x32x16_bf16 v[128:143], a[196:199], a[4:7], v[128:143]
  ds_read_b64_tr_b16 a[244:245], v17 offset:4096
  ds_read_b64_tr_b16 a[246:247], v17 offset:6144
  v_exp_f32 v223, v151
  v_add_f32 v28, v28, v222
  v_mfma_f32_32x32x16_bf16 v[128:143], a[200:203], a[16:19], v[128:143]
  ds_read_b64_tr_b16 a[248:249], v18 offset:4096
  s_add_u32 s27, s27, 0x2000
  v_exp_f32 v216, v152
  v_add_f32 v28, v28, v223
  v_cvt_pk_bf16_f32 v203, v222, v223
  v_mfma_f32_32x32x16_bf16 v[128:143], a[204:207], a[20:23], v[128:143]
  ds_read_b64_tr_b16 a[250:251], v18 offset:6144
  ds_read_b64_tr_b16 a[252:253], v19 offset:4096
  v_exp_f32 v217, v153
  v_add_f32 v28, v28, v216
  v_mfma_f32_32x32x16_bf16 v[128:143], a[208:211], a[32:35], v[128:143]
  ds_read_b64_tr_b16 a[254:255], v19 offset:6144
  v_exp_f32 v218, v154
  v_add_f32 v28, v28, v217
  v_cvt_pk_bf16_f32 v204, v216, v217
  v_mfma_f32_32x32x16_bf16 v[128:143], a[212:215], a[36:39], v[128:143]
  v_exp_f32 v219, v155
  v_add_f32 v28, v28, v218
  v_mfma_f32_32x32x16_bf16 v[128:143], a[216:219], a[48:51], v[128:143]
  v_exp_f32 v220, v156
  v_add_f32 v28, v28, v219
  v_cvt_pk_bf16_f32 v205, v218, v219
  v_mfma_f32_32x32x16_bf16 v[128:143], a[220:223], a[52:55], v[128:143]
  v_exp_f32 v221, v157
  v_add_f32 v28, v28, v220
  s_waitcnt lgkmcnt(0)
  v_mfma_f32_32x32x16_bf16 v[64:79], a[224:227], v[192:195], v[64:79]
  v_exp_f32 v222, v158
  v_add_f32 v28, v28, v221
  v_cvt_pk_bf16_f32 v206, v220, v221
  v_mfma_f32_32x32x16_bf16 v[80:95], a[228:231], v[192:195], v[80:95]
  v_exp_f32 v223, v159
  v_add_f32 v28, v28, v222
  v_mfma_f32_32x32x16_bf16 v[96:111], a[232:235], v[192:195], v[96:111]
  v_exp_f32 v208, v128
  v_add_f32 v28, v28, v223
  v_cvt_pk_bf16_f32 v207, v222, v223
  v_mfma_f32_32x32x16_bf16 v[112:127], a[236:239], v[192:195], v[112:127]
  v_exp_f32 v209, v129
  v_cmp_nge_f32 vcc, 0x47800000, v28
  v_mfma_f32_32x32x16_bf16 v[64:79], a[240:243], v[196:199], v[64:79]
  s_cbranch_vccnz L1_cbq0
L1_rbq0:
  v_exp_f32 v210, v130
  v_add_f32 v27, v208, v209
  v_cvt_pk_bf16_f32 v192, v208, v209
  v_mfma_f32_32x32x16_bf16 v[80:95], a[244:247], v[196:199], v[80:95]
  v_exp_f32 v211, v131
  v_add_f32 v30, v30, v28
  v_add_f32 v27, v27, v210
  v_mfma_f32_32x32x16_bf16 v[96:111], a[248:251], v[196:199], v[96:111]
  v_exp_f32 v212, v132
  v_add_f32 v27, v27, v211
  v_cvt_pk_bf16_f32 v193, v210, v211
  v_mfma_f32_32x32x16_bf16 v[112:127], a[252:255], v[196:199], v[112:127]
  v_exp_f32 v213, v133
  v_add_f32 v27, v27, v212
  v_mfma_f32_32x32x16_bf16 v[144:159], a[192:195], a[8:11], v[176:191]
  s_waitcnt vmcnt(8)
  s_barrier
  v_exp_f32 v214, v134
  v_add_f32 v27, v27, v213
  v_cvt_pk_bf16_f32 v194, v212, v213
  v_mfma_f32_32x32x16_bf16 v[144:159], a[196:199], a[12:15], v[144:159]
  ds_read_b128 a[192:195], v8 offset:16384
  v_exp_f32 v215, v135
  v_add_f32 v27, v27, v214
  v_mfma_f32_32x32x16_bf16 v[144:159], a[200:203], a[24:27], v[144:159]
  ds_read_b128 a[196:199], v9 offset:16384
  v_exp_f32 v208, v136
  v_add_f32 v27, v27, v215
  v_cvt_pk_bf16_f32 v195, v214, v215
  v_mfma_f32_32x32x16_bf16 v[144:159], a[204:207], a[28:31], v[144:159]
  ds_read_b128 a[200:203], v10 offset:16384
  v_exp_f32 v209, v137
  v_add_f32 v27, v27, v208
  v_mfma_f32_32x32x16_bf16 v[144:159], a[208:211], a[40:43], v[144:159]
  ds_read_b128 a[204:207], v11 offset:16384
  v_exp_f32 v210, v138
  v_add_f32 v27, v27, v209
  v_cvt_pk_bf16_f32 v196, v208, v209
  v_mfma_f32_32x32x16_bf16 v[144:159], a[212:215], a[44:47], v[144:159]
  ds_read_b128 a[208:211], v12 offset:16384
  v_exp_f32 v211, v139
  v_add_f32 v27, v27, v210
  v_mfma_f32_32x32x16_bf16 v[144:159], a[216:219], a[56:59], v[144:159]
  ds_read_b128 a[212:215], v13 offset:16384
  v_exp_f32 v212, v140
  v_add_f32 v27, v27, v211
  v_cvt_pk_bf16_f32 v197, v210, v211
  v_mfma_f32_32x32x16_bf16 v[144:159], a[220:223], a[60:63], v[144:159]
  ds_read_b128 a[216:219], v14 offset:16384
  v_exp_f32 v213, v141
  v_add_f32 v27, v27, v212
  s_add_u32 m0, s29, 0xc000
  v_mfma_f32_32x32x16_bf16 a[64:79], a[224:227], v[200:203], a[64:79]
  ds_read_b128 a[220:223], v15 offset:16384
  buffer_load_dwordx4 v20, s[12:15], s27 offen offset:0 nt lds
  v_exp_f32 v214, v142
  v_add_f32 v27, v27, v213
  v_cvt_pk_bf16_f32 v198, v212, v213
  v_mfma_f32_32x32x16_bf16 a[80:95], a[228:231], v[200:203], a[80:95]
  ds_read_b64_tr_b16 a[224:225], v16 offset:8192
  ds_read_b64_tr_b16 a[226:227], v16 offset:10240
  v_exp_f32 v215, v143
  v_add_f32 v27, v27, v214
  v_mfma_f32_32x32x16_bf16 a[96:111], a[232:235], v[200:203], a[96:111]
  ds_read_b64_tr_b16 a[228:229], v17 offset:8192
  buffer_load_dwordx4 v21, s[12:15], s27 offen offset:1024 nt lds
  v_exp_f32 v216, v144
  v_add_f32 v27, v27, v215
  v_cvt_pk_bf16_f32 v199, v214, v215
  v_mfma_f32_32x32x16_bf16 a[112:127], a[236:239], v[200:203], a[112:127]
  ds_read_b64_tr_b16 a[230:231], v17 offset:10240
  ds_read_b64_tr_b16 a[232:233], v18 offset:8192
  v_exp_f32 v217, v145
  v_cmp_nge_f32 vcc, 0x47800000, v27
  s_add_u32 m0, s29, 0x1a000
  v_mfma_f32_32x32x16_bf16 a[64:79], a[240:243], v[204:207], a[64:79]
  ds_read_b64_tr_b16 a[234:235], v18 offset:10240
  buffer_load_dwordx4 v22, s[16:19], s27 offen offset:0 nt lds
  s_cbranch_vccnz L1_caq0
L1_raq0:
  v_exp_f32 v218, v146
  v_add_f32 v28, v216, v217
  v_cvt_pk_bf16_f32 v200, v216, v217
  v_mfma_f32_32x32x16_bf16 a[80:95], a[244:247], v[204:207], a[80:95]
  ds_read_b64_tr_b16 a[236:237], v19 offset:8192
  v_exp_f32 v219, v147
  v_add_f32 v28, v28, v218
  v_add_f32 v29, v29, v27
  v_mfma_f32_32x32x16_bf16 a[96:111], a[248:251], v[204:207], a[96:111]
  ds_read_b64_tr_b16 a[238:239], v19 offset:10240
  buffer_load_dwordx4 v22, s[16:19], s27 offen offset:1024 nt lds
  v_exp_f32 v220, v148
  v_add_f32 v28, v28, v219
  v_cvt_pk_bf16_f32 v201, v218, v219
  v_mfma_f32_32x32x16_bf16 a[112:127], a[252:255], v[204:207], a[112:127]
  ds_read_b64_tr_b16 a[240:241], v16 offset:12288
  ds_read_b64_tr_b16 a[242:243], v16 offset:14336
  v_exp_f32 v221, v149
  v_add_f32 v28, v28, v220
  s_waitcnt lgkmcnt(10)
  v_mfma_f32_32x32x16_bf16 v[128:143], a[192:195], a[0:3], v[160:175]
  v_exp_f32 v222, v150
  v_add_f32 v28, v28, v221
  v_cvt_pk_bf16_f32 v202, v220, v221
  v_mfma_f32_32x32x16_bf16 v[128:143], a[196:199], a[4:7], v[128:143]
  ds_read_b64_tr_b16 a[244:245], v17 offset:12288
  ds_read_b64_tr_b16 a[246:247], v17 offset:14336
  v_exp_f32 v223, v151
  v_add_f32 v28, v28, v222
  v_mfma_f32_32x32x16_bf16 v[128:143], a[200:203], a[16:19], v[128:143]
  ds_read_b64_tr_b16 a[248:249], v18 offset:12288
  s_add_u32 s27, s27, 0x2000
  v_exp_f32 v216, v152
  v_add_f32 v28, v28, v223
  v_cvt_pk_bf16_f32 v203, v222, v223
  v_mfma_f32_32x32x16_bf16 v[128:143], a[204:207], a[20:23], v[128:143]
  ds_read_b64_tr_b16 a[250:251], v18 offset:14336
  ds_read_b64_tr_b16 a[252:253], v19 offset:12288
  v_exp_f32 v217, v153
  v_add_f32 v28, v28, v216
  v_mfma_f32_32x32x16_bf16 v[128:143], a[208:211], a[32:35], v[128:143]
  ds_read_b64_tr_b16 a[254:255], v19 offset:14336
  v_exp_f32 v218, v154
  v_add_f32 v28, v28, v217
  v_cvt_pk_bf16_f32 v204, v216, v217
  v_mfma_f32_32x32x16_bf16 v[128:143], a[212:215], a[36:39], v[128:143]
  v_exp_f32 v219, v155
  v_add_f32 v28, v28, v218
  v_mfma_f32_32x32x16_bf16 v[128:143], a[216:219], a[48:51], v[128:143]
  v_exp_f32 v220, v156
  v_add_f32 v28, v28, v219
  v_cvt_pk_bf16_f32 v205, v218, v219
  v_mfma_f32_32x32x16_bf16 v[128:143], a[220:223], a[52:55], v[128:143]
  v_exp_f32 v221, v157
  v_add_f32 v28, v28, v220
  s_waitcnt lgkmcnt(0)
  v_mfma_f32_32x32x16_bf16 v[64:79], a[224:227], v[192:195], v[64:79]
  v_exp_f32 v222, v158
  v_add_f32 v28, v28, v221
  v_cvt_pk_bf16_f32 v206, v220, v221
  v_mfma_f32_32x32x16_bf16 v[80:95], a[228:231], v[192:195], v[80:95]
  v_exp_f32 v223, v159
  v_add_f32 v28, v28, v222
  v_mfma_f32_32x32x16_bf16 v[96:111], a[232:235], v[192:195], v[96:111]
  v_exp_f32 v208, v128
  v_add_f32 v28, v28, v223
  v_cvt_pk_bf16_f32 v207, v222, v223
  v_mfma_f32_32x32x16_bf16 v[112:127], a[236:239], v[192:195], v[112:127]
  v_exp_f32 v209, v129
  v_cmp_nge_f32 vcc, 0x47800000, v28
  v_mfma_f32_32x32x16_bf16 v[64:79], a[240:243], v[196:199], v[64:79]
  s_cbranch_vccnz L1_cbq1
L1_rbq1:
  v_exp_f32 v210, v130
  v_add_f32 v27, v208, v209
  v_cvt_pk_bf16_f32 v192, v208, v209
  v_mfma_f32_32x32x16_bf16 v[80:95], a[244:247], v[196:199], v[80:95]
  v_exp_f32 v211, v131
  v_add_f32 v30, v30, v28
  v_add_f32 v27, v27, v210
  v_mfma_f32_32x32x16_bf16 v[96:111], a[248:251], v[196:199], v[96:111]
  v_exp_f32 v212, v132
  v_add_f32 v27, v27, v211
  v_cvt_pk_bf16_f32 v193, v210, v211
  v_mfma_f32_32x32x16_bf16 v[112:127], a[252:255], v[196:199], v[112:127]
  v_exp_f32 v213, v133
  v_add_f32 v27, v27, v212
  v_mfma_f32_32x32x16_bf16 v[144:159], a[192:195], a[8:11], v[176:191]
  v_exp_f32 v214, v134
  v_add_f32 v27, v27, v213
  v_cvt_pk_bf16_f32 v194, v212, v213
  v_mfma_f32_32x32x16_bf16 v[144:159], a[196:199], a[12:15], v[144:159]
  ds_read_b128 a[192:195], v8 offset:24576
  v_exp_f32 v215, v135
  v_add_f32 v27, v27, v214
  v_mfma_f32_32x32x16_bf16 v[144:159], a[200:203], a[24:27], v[144:159]
  ds_read_b128 a[196:199], v9 offset:24576
  v_exp_f32 v208, v136
  v_add_f32 v27, v27, v215
  v_cvt_pk_bf16_f32 v195, v214, v215
  v_mfma_f32_32x32x16_bf16 v[144:159], a[204:207], a[28:31], v[144:159]
  ds_read_b128 a[200:203], v10 offset:24576
  v_exp_f32 v209, v137
  v_add_f32 v27, v27, v208
  v_mfma_f32_32x32x16_bf16 v[144:159], a[208:211], a[40:43], v[144:159]
  ds_read_b128 a[204:207], v11 offset:24576
  v_exp_f32 v210, v138
  v_add_f32 v27, v27, v209
  v_cvt_pk_bf16_f32 v196, v208, v209
  v_mfma_f32_32x32x16_bf16 v[144:159], a[212:215], a[44:47], v[144:159]
  ds_read_b128 a[208:211], v12 offset:24576
  v_exp_f32 v211, v139
  v_add_f32 v27, v27, v210
  v_mfma_f32_32x32x16_bf16 v[144:159], a[216:219], a[56:59], v[144:159]
  ds_read_b128 a[212:215], v13 offset:24576
  v_exp_f32 v212, v140
  v_add_f32 v27, v27, v211
  v_cvt_pk_bf16_f32 v197, v210, v211
  v_mfma_f32_32x32x16_bf16 v[144:159], a[220:223], a[60:63], v[144:159]
  ds_read_b128 a[216:219], v14 offset:24576
  v_exp_f32 v213, v141
  v_add_f32 v27, v27, v212
  s_add_u32 m0, s29, 0xe000
  v_mfma_f32_32x32x16_bf16 a[64:79], a[224:227], v[200:203], a[64:79]
  ds_read_b128 a[220:223], v15 offset:24576
  buffer_load_dwordx4 v20, s[12:15], s27 offen offset:0 nt lds
  v_exp_f32 v214, v142
  v_add_f32 v27, v27, v213
  v_cvt_pk_bf16_f32 v198, v212, v213
  v_mfma_f32_32x32x16_bf16 a[80:95], a[228:231], v[200:203], a[80:95]
  ds_read_b64_tr_b16 a[224:225], v16 offset:16384
  ds_read_b64_tr_b16 a[226:227], v16 offset:18432
  v_exp_f32 v215, v143
  v_add_f32 v27, v27, v214
  v_mfma_f32_32x32x16_bf16 a[96:111], a[232:235], v[200:203], a[96:111]
  ds_read_b64_tr_b16 a[228:229], v17 offset:16384
  buffer_load_dwordx4 v21, s[12:15], s27 offen offset:1024 nt lds
  v_exp_f32 v216, v144
  v_add_f32 v27, v27, v215
  v_cvt_pk_bf16_f32 v199, v214, v215
  v_mfma_f32_32x32x16_bf16 a[112:127], a[236:239], v[200:203], a[112:127]
  ds_read_b64_tr_b16 a[230:231], v17 offset:18432
  ds_read_b64_tr_b16 a[232:233], v18 offset:16384
  v_exp_f32 v217, v145
  v_cmp_nge_f32 vcc, 0x47800000, v27
  s_add_u32 m0, s29, 0x1c000
  v_mfma_f32_32x32x16_bf16 a[64:79], a[240:243], v[204:207], a[64:79]
  ds_read_b64_tr_b16 a[234:235], v18 offset:18432
  buffer_load_dwordx4 v22, s[16:19], s27 offen offset:0 nt lds
  s_cbranch_vccnz L1_caq1
L1_raq1:
  v_exp_f32 v218, v146
  v_add_f32 v28, v216, v217
  v_cvt_pk_bf16_f32 v200, v216, v217
  v_mfma_f32_32x32x16_bf16 a[80:95], a[244:247], v[204:207], a[80:95]
  ds_read_b64_tr_b16 a[236:237], v19 offset:16384
  v_exp_f32 v219, v147
  v_add_f32 v28, v28, v218
  v_add_f32 v29, v29, v27
  v_mfma_f32_32x32x16_bf16 a[96:111], a[248:251], v[204:207], a[96:111]
  ds_read_b64_tr_b16 a[238:239], v19 offset:18432
  buffer_load_dwordx4 v22, s[16:19], s27 offen offset:1024 nt lds
  v_exp_f32 v220, v148
  v_add_f32 v28, v28, v219
  v_cvt_pk_bf16_f32 v201, v218, v219
  v_mfma_f32_32x32x16_bf16 a[112:127], a[252:255], v[204:207], a[112:127]
  ds_read_b64_tr_b16 a[240:241], v16 offset:20480
  ds_read_b64_tr_b16 a[242:243], v16 offset:22528
  v_exp_f32 v221, v149
  v_add_f32 v28, v28, v220
  s_waitcnt lgkmcnt(10)
  v_mfma_f32_32x32x16_bf16 v[128:143], a[192:195], a[0:3], v[160:175]
  v_exp_f32 v222, v150
  v_add_f32 v28, v28, v221
  v_cvt_pk_bf16_f32 v202, v220, v221
  v_mfma_f32_32x32x16_bf16 v[128:143], a[196:199], a[4:7], v[128:143]
  ds_read_b64_tr_b16 a[244:245], v17 offset:20480
  ds_read_b64_tr_b16 a[246:247], v17 offset:22528
  v_exp_f32 v223, v151
  v_add_f32 v28, v28, v222
  v_mfma_f32_32x32x16_bf16 v[128:143], a[200:203], a[16:19], v[128:143]
  ds_read_b64_tr_b16 a[248:249], v18 offset:20480
  s_add_u32 s27, s27, 0x2000
  v_exp_f32 v216, v152
  v_add_f32 v28, v28, v223
  v_cvt_pk_bf16_f32 v203, v222, v223
  v_mfma_f32_32x32x16_bf16 v[128:143], a[204:207], a[20:23], v[128:143]
  ds_read_b64_tr_b16 a[250:251], v18 offset:22528
  ds_read_b64_tr_b16 a[252:253], v19 offset:20480
  v_exp_f32 v217, v153
  v_add_f32 v28, v28, v216
  v_mfma_f32_32x32x16_bf16 v[128:143], a[208:211], a[32:35], v[128:143]
  ds_read_b64_tr_b16 a[254:255], v19 offset:22528
  v_exp_f32 v218, v154
  v_add_f32 v28, v28, v217
  v_cvt_pk_bf16_f32 v204, v216, v217
  v_mfma_f32_32x32x16_bf16 v[128:143], a[212:215], a[36:39], v[128:143]
  v_exp_f32 v219, v155
  v_add_f32 v28, v28, v218
  v_mfma_f32_32x32x16_bf16 v[128:143], a[216:219], a[48:51], v[128:143]
  v_exp_f32 v220, v156
  v_add_f32 v28, v28, v219
  v_cvt_pk_bf16_f32 v205, v218, v219
  v_mfma_f32_32x32x16_bf16 v[128:143], a[220:223], a[52:55], v[128:143]
  v_exp_f32 v221, v157
  v_add_f32 v28, v28, v220
  s_waitcnt lgkmcnt(0)
  v_mfma_f32_32x32x16_bf16 v[64:79], a[224:227], v[192:195], v[64:79]
  v_exp_f32 v222, v158
  v_add_f32 v28, v28, v221
  v_cvt_pk_bf16_f32 v206, v220, v221
  v_mfma_f32_32x32x16_bf16 v[80:95], a[228:231], v[192:195], v[80:95]
  v_exp_f32 v223, v159
  v_add_f32 v28, v28, v222
  v_mfma_f32_32x32x16_bf16 v[96:111], a[232:235], v[192:195], v[96:111]
  v_exp_f32 v208, v128
  v_add_f32 v28, v28, v223
  v_cvt_pk_bf16_f32 v207, v222, v223
  v_mfma_f32_32x32x16_bf16 v[112:127], a[236:239], v[192:195], v[112:127]
  v_exp_f32 v209, v129
  v_cmp_nge_f32 vcc, 0x47800000, v28
  v_mfma_f32_32x32x16_bf16 v[64:79], a[240:243], v[196:199], v[64:79]
  s_cbranch_vccnz L1_cbq2
L1_rbq2:
  v_exp_f32 v210, v130
  v_add_f32 v27, v208, v209
  v_cvt_pk_bf16_f32 v192, v208, v209
  v_mfma_f32_32x32x16_bf16 v[80:95], a[244:247], v[196:199], v[80:95]
  v_exp_f32 v211, v131
  v_add_f32 v30, v30, v28
  v_add_f32 v27, v27, v210
  v_mfma_f32_32x32x16_bf16 v[96:111], a[248:251], v[196:199], v[96:111]
  v_exp_f32 v212, v132
  v_add_f32 v27, v27, v211
  v_cvt_pk_bf16_f32 v193, v210, v211
  v_add_u32 v4, CP_j56-CP_base, v0
  v_mfma_f32_32x32x16_bf16 v[112:127], a[252:255], v[196:199], v[112:127]
  buffer_load_dword v4, v4, s[64:67], 0 offen
  v_exp_f32 v213, v133
  v_add_f32 v27, v27, v212
  v_mfma_f32_32x32x16_bf16 v[144:159], a[192:195], a[8:11], v[176:191]
  s_waitcnt vmcnt(9)
  s_barrier
  v_exp_f32 v214, v134
  v_add_f32 v27, v27, v213
  v_cvt_pk_bf16_f32 v194, v212, v213
  v_mfma_f32_32x32x16_bf16 v[144:159], a[196:199], a[12:15], v[144:159]
  ds_read_b128 a[192:195], v8 offset:32768
  v_exp_f32 v215, v135
  v_add_f32 v27, v27, v214
  v_mfma_f32_32x32x16_bf16 v[144:159], a[200:203], a[24:27], v[144:159]
  ds_read_b128 a[196:199], v9 offset:32768
  v_exp_f32 v208, v136
  v_add_f32 v27, v27, v215
  v_cvt_pk_bf16_f32 v195, v214, v215
  v_mfma_f32_32x32x16_bf16 v[144:159], a[204:207], a[28:31], v[144:159]
  ds_read_b128 a[200:203], v10 offset:32768
  v_exp_f32 v209, v137
  v_add_f32 v27, v27, v208
  v_mfma_f32_32x32x16_bf16 v[144:159], a[208:211], a[40:43], v[144:159]
  ds_read_b128 a[204:207], v11 offset:32768
  v_exp_f32 v210, v138
  v_add_f32 v27, v27, v209
  v_cvt_pk_bf16_f32 v196, v208, v209
  v_mfma_f32_32x32x16_bf16 v[144:159], a[212:215], a[44:47], v[144:159]
  ds_read_b128 a[208:211], v12 offset:32768
  v_exp_f32 v211, v139
  v_add_f32 v27, v27, v210
  v_mfma_f32_32x32x16_bf16 v[144:159], a[216:219], a[56:59], v[144:159]
  ds_read_b128 a[212:215], v13 offset:32768
  v_exp_f32 v212, v140
  v_add_f32 v27, v27, v211
  v_cvt_pk_bf16_f32 v197, v210, v211
  v_mfma_f32_32x32x16_bf16 v[144:159], a[220:223], a[60:63], v[144:159]
  ds_read_b128 a[216:219], v14 offset:32768
  v_exp_f32 v213, v141
  v_add_f32 v27, v27, v212
  s_add_u32 m0, s29, 0x0
  v_mfma_f32_32x32x16_bf16 a[64:79], a[224:227], v[200:203], a[64:79]
  ds_read_b128 a[220:223], v15 offset:32768
  buffer_load_dwordx4 v20, s[12:15], s27 offen offset:0 nt lds
  v_exp_f32 v214, v142
  v_add_f32 v27, v27, v213
  v_cvt_pk_bf16_f32 v198, v212, v213
  v_mfma_f32_32x32x16_bf16 a[80:95], a[228:231], v[200:203], a[80:95]
  ds_read_b64_tr_b16 a[224:225], v16 offset:24576
  ds_read_b64_tr_b16 a[226:227], v16 offset:26624
  v_exp_f32 v215, v143
  v_add_f32 v27, v27, v214
  v_mfma_f32_32x32x16_bf16 a[96:111], a[232:235], v[200:203], a[96:111]
  ds_read_b64_tr_b16 a[228:229], v17 offset:24576
  buffer_load_dwordx4 v21, s[12:15], s27 offen offset:1024 nt lds
  v_exp_f32 v216, v144
  v_add_f32 v27, v27, v215
  v_cvt_pk_bf16_f32 v199, v214, v215
  v_mfma_f32_32x32x16_bf16 a[112:127], a[236:239], v[200:203], a[112:127]
  ds_read_b64_tr_b16 a[230:231], v17 offset:26624
  ds_read_b64_tr_b16 a[232:233], v18 offset:24576
  v_exp_f32 v217, v145
  v_cmp_nge_f32 vcc, 0x47800000, v27
  s_add_u32 m0, s29, 0x1e000
  v_mfma_f32_32x32x16_bf16 a[64:79], a[240:243], v[204:207], a[64:79]
  ds_read_b64_tr_b16 a[234:235], v18 offset:26624
  buffer_load_dwordx4 v22, s[16:19], s27 offen offset:0 nt lds
  s_cbranch_vccnz L1_caq2
L1_raq2:
  v_exp_f32 v218, v146
  v_add_f32 v28, v216, v217
  v_cvt_pk_bf16_f32 v200, v216, v217
  v_mfma_f32_32x32x16_bf16 a[80:95], a[244:247], v[204:207], a[80:95]
  ds_read_b64_tr_b16 a[236:237], v19 offset:24576
  v_exp_f32 v219, v147
  v_add_f32 v28, v28, v218
  v_add_f32 v29, v29, v27
  v_mfma_f32_32x32x16_bf16 a[96:111], a[248:251], v[204:207], a[96:111]
  ds_read_b64_tr_b16 a[238:239], v19 offset:26624
  buffer_load_dwordx4 v22, s[16:19], s27 offen offset:1024 nt lds
  v_exp_f32 v220, v148
  v_add_f32 v28, v28, v219
  v_cvt_pk_bf16_f32 v201, v218, v219
  v_mfma_f32_32x32x16_bf16 a[112:127], a[252:255], v[204:207], a[112:127]
  ds_read_b64_tr_b16 a[240:241], v16 offset:28672
  ds_read_b64_tr_b16 a[242:243], v16 offset:30720
  v_exp_f32 v221, v149
  v_add_f32 v28, v28, v220
  s_waitcnt lgkmcnt(10)
  v_mfma_f32_32x32x16_bf16 v[128:143], a[192:195], a[0:3], v[160:175]
  v_exp_f32 v222, v150
  v_add_f32 v28, v28, v221
  v_cvt_pk_bf16_f32 v202, v220, v221
  v_mfma_f32_32x32x16_bf16 v[128:143], a[196:199], a[4:7], v[128:143]
  ds_read_b64_tr_b16 a[244:245], v17 offset:28672
  ds_read_b64_tr_b16 a[246:247], v17 offset:30720
  v_exp_f32 v223, v151
  v_add_f32 v28, v28, v222
  v_mfma_f32_32x32x16_bf16 v[128:143], a[200:203], a[16:19], v[128:143]
  ds_read_b64_tr_b16 a[248:249], v18 offset:28672
  s_add_u32 s27, s27, 0x2000
  v_exp_f32 v216, v152
  v_add_f32 v28, v28, v223
  v_cvt_pk_bf16_f32 v203, v222, v223
  v_mfma_f32_32x32x16_bf16 v[128:143], a[204:207], a[20:23], v[128:143]
  ds_read_b64_tr_b16 a[250:251], v18 offset:30720
  ds_read_b64_tr_b16 a[252:253], v19 offset:28672
  v_exp_f32 v217, v153
  v_add_f32 v28, v28, v216
  v_mfma_f32_32x32x16_bf16 v[128:143], a[208:211], a[32:35], v[128:143]
  ds_read_b64_tr_b16 a[254:255], v19 offset:30720
  v_exp_f32 v218, v154
  v_add_f32 v28, v28, v217
  v_cvt_pk_bf16_f32 v204, v216, v217
  v_mfma_f32_32x32x16_bf16 v[128:143], a[212:215], a[36:39], v[128:143]
  v_exp_f32 v219, v155
  v_add_f32 v28, v28, v218
  v_mfma_f32_32x32x16_bf16 v[128:143], a[216:219], a[48:51], v[128:143]
  v_exp_f32 v220, v156
  v_add_f32 v28, v28, v219
  v_cvt_pk_bf16_f32 v205, v218, v219
  v_mfma_f32_32x32x16_bf16 v[128:143], a[220:223], a[52:55], v[128:143]
  v_exp_f32 v221, v157
  v_add_f32 v28, v28, v220
  s_waitcnt lgkmcnt(0)
  v_mfma_f32_32x32x16_bf16 v[64:79], a[224:227], v[192:195], v[64:79]
  v_exp_f32 v222, v158
  v_add_f32 v28, v28, v221
  v_cvt_pk_bf16_f32 v206, v220, v221
  v_mfma_f32_32x32x16_bf16 v[80:95], a[228:231], v[192:195], v[80:95]
  v_exp_f32 v223, v159
  v_add_f32 v28, v28, v222
  v_mfma_f32_32x32x16_bf16 v[96:111], a[232:235], v[192:195], v[96:111]
  v_exp_f32 v208, v128
  v_add_f32 v28, v28, v223
  v_cvt_pk_bf16_f32 v207, v222, v223
  v_mfma_f32_32x32x16_bf16 v[112:127], a[236:239], v[192:195], v[112:127]
  v_exp_f32 v209, v129
  v_cmp_nge_f32 vcc, 0x47800000, v28
  v_mfma_f32_32x32x16_bf16 v[64:79], a[240:243], v[196:199], v[64:79]
  s_cbranch_vccnz L1_cbq3
L1_rbq3:
  v_exp_f32 v210, v130
  v_add_f32 v27, v208, v209
  v_cvt_pk_bf16_f32 v192, v208, v209
  v_mfma_f32_32x32x16_bf16 v[80:95], a[244:247], v[196:199], v[80:95]
  v_exp_f32 v211, v131
  v_add_f32 v30, v30, v28
  v_add_f32 v27, v27, v210
  v_mfma_f32_32x32x16_bf16 v[96:111], a[248:251], v[196:199], v[96:111]
  v_exp_f32 v212, v132
  v_add_f32 v27, v27, v211
  v_cvt_pk_bf16_f32 v193, v210, v211
  v_mfma_f32_32x32x16_bf16 v[112:127], a[252:255], v[196:199], v[112:127]
  v_exp_f32 v213, v133
  v_add_f32 v27, v27, v212
  v_mfma_f32_32x32x16_bf16 v[144:159], a[192:195], a[8:11], v[176:191]
  v_exp_f32 v214, v134
  v_add_f32 v27, v27, v213
  v_cvt_pk_bf16_f32 v194, v212, v213
  v_mfma_f32_32x32x16_bf16 v[144:159], a[196:199], a[12:15], v[144:159]
  ds_read_b128 a[192:195], v8 offset:40960
  v_exp_f32 v215, v135
  v_add_f32 v27, v27, v214
  v_mfma_f32_32x32x16_bf16 v[144:159], a[200:203], a[24:27], v[144:159]
  ds_read_b128 a[196:199], v9 offset:40960
  v_exp_f32 v208, v136
  v_add_f32 v27, v27, v215
  v_cvt_pk_bf16_f32 v195, v214, v215
  v_mfma_f32_32x32x16_bf16 v[144:159], a[204:207], a[28:31], v[144:159]
  ds_read_b128 a[200:203], v10 offset:40960
  v_exp_f32 v209, v137
  v_add_f32 v27, v27, v208
  v_mfma_f32_32x32x16_bf16 v[144:159], a[208:211], a[40:43], v[144:159]
  ds_read_b128 a[204:207], v11 offset:40960
  v_exp_f32 v210, v138
  v_add_f32 v27, v27, v209
  v_cvt_pk_bf16_f32 v196, v208, v209
  v_mfma_f32_32x32x16_bf16 v[144:159], a[212:215], a[44:47], v[144:159]
  ds_read_b128 a[208:211], v12 offset:40960
  v_exp_f32 v211, v139
  v_add_f32 v27, v27, v210
  v_mfma_f32_32x32x16_bf16 v[144:159], a[216:219], a[56:59], v[144:159]
  ds_read_b128 a[212:215], v13 offset:40960
  v_exp_f32 v212, v140
  v_add_f32 v27, v27, v211
  v_cvt_pk_bf16_f32 v197, v210, v211
  v_mfma_f32_32x32x16_bf16 v[144:159], a[220:223], a[60:63], v[144:159]
  ds_read_b128 a[216:219], v14 offset:40960
  v_exp_f32 v213, v141
  v_add_f32 v27, v27, v212
  s_add_u32 m0, s29, 0x2000
  v_mfma_f32_32x32x16_bf16 a[64:79], a[224:227], v[200:203], a[64:79]
  ds_read_b128 a[220:223], v15 offset:40960
  buffer_load_dwordx4 v20, s[12:15], s27 offen offset:0 nt lds
  v_exp_f32 v214, v142
  v_add_f32 v27, v27, v213
  v_cvt_pk_bf16_f32 v198, v212, v213
  v_mfma_f32_32x32x16_bf16 a[80:95], a[228:231], v[200:203], a[80:95]
  ds_read_b64_tr_b16 a[224:225], v16 offset:32768
  ds_read_b64_tr_b16 a[226:227], v16 offset:34816
  v_exp_f32 v215, v143
  v_add_f32 v27, v27, v214
  v_mfma_f32_32x32x16_bf16 a[96:111], a[232:235], v[200:203], a[96:111]
  ds_read_b64_tr_b16 a[228:229], v17 offset:32768
  buffer_load_dwordx4 v21, s[12:15], s27 offen offset:1024 nt lds
  v_exp_f32 v216, v144
  v_add_f32 v27, v27, v215
  v_cvt_pk_bf16_f32 v199, v214, v215
  v_mfma_f32_32x32x16_bf16 a[112:127], a[236:239], v[200:203], a[112:127]
  ds_read_b64_tr_b16 a[230:231], v17 offset:34816
  ds_read_b64_tr_b16 a[232:233], v18 offset:32768
  v_exp_f32 v217, v145
  v_cmp_nge_f32 vcc, 0x47800000, v27
  s_add_u32 m0, s29, 0x10000
  v_mfma_f32_32x32x16_bf16 a[64:79], a[240:243], v[204:207], a[64:79]
  ds_read_b64_tr_b16 a[234:235], v18 offset:34816
  buffer_load_dwordx4 v22, s[16:19], s27 offen offset:0 nt lds
  s_cbranch_vccnz L1_caq3
L1_raq3:
  v_exp_f32 v218, v146
  v_add_f32 v28, v216, v217
  v_cvt_pk_bf16_f32 v200, v216, v217
  v_mfma_f32_32x32x16_bf16 a[80:95], a[244:247], v[204:207], a[80:95]
  ds_read_b64_tr_b16 a[236:237], v19 offset:32768
  v_exp_f32 v219, v147
  v_add_f32 v28, v28, v218
  v_add_f32 v29, v29, v27
  v_mfma_f32_32x32x16_bf16 a[96:111], a[248:251], v[204:207], a[96:111]
  ds_read_b64_tr_b16 a[238:239], v19 offset:34816
  buffer_load_dwordx4 v22, s[16:19], s27 offen offset:1024 nt lds
  v_exp_f32 v220, v148
  v_add_f32 v28, v28, v219
  v_cvt_pk_bf16_f32 v201, v218, v219
  v_mfma_f32_32x32x16_bf16 a[112:127], a[252:255], v[204:207], a[112:127]
  ds_read_b64_tr_b16 a[240:241], v16 offset:36864
  ds_read_b64_tr_b16 a[242:243], v16 offset:38912
  v_exp_f32 v221, v149
  v_add_f32 v28, v28, v220
  s_waitcnt lgkmcnt(10)
  v_mfma_f32_32x32x16_bf16 v[128:143], a[192:195], a[0:3], v[160:175]
  v_exp_f32 v222, v150
  v_add_f32 v28, v28, v221
  v_cvt_pk_bf16_f32 v202, v220, v221
  v_mfma_f32_32x32x16_bf16 v[128:143], a[196:199], a[4:7], v[128:143]
  ds_read_b64_tr_b16 a[244:245], v17 offset:36864
  ds_read_b64_tr_b16 a[246:247], v17 offset:38912
  v_exp_f32 v223, v151
  v_add_f32 v28, v28, v222
  v_mfma_f32_32x32x16_bf16 v[128:143], a[200:203], a[16:19], v[128:143]
  ds_read_b64_tr_b16 a[248:249], v18 offset:36864
  s_add_u32 s27, s27, 0x2000
  v_exp_f32 v216, v152
  v_add_f32 v28, v28, v223
  v_cvt_pk_bf16_f32 v203, v222, v223
  v_mfma_f32_32x32x16_bf16 v[128:143], a[204:207], a[20:23], v[128:143]
  ds_read_b64_tr_b16 a[250:251], v18 offset:38912
  ds_read_b64_tr_b16 a[252:253], v19 offset:36864
  v_exp_f32 v217, v153
  v_add_f32 v28, v28, v216
  v_mfma_f32_32x32x16_bf16 v[128:143], a[208:211], a[32:35], v[128:143]
  ds_read_b64_tr_b16 a[254:255], v19 offset:38912
  v_exp_f32 v218, v154
  v_add_f32 v28, v28, v217
  v_cvt_pk_bf16_f32 v204, v216, v217
  v_mfma_f32_32x32x16_bf16 v[128:143], a[212:215], a[36:39], v[128:143]
  v_exp_f32 v219, v155
  v_add_f32 v28, v28, v218
  v_mfma_f32_32x32x16_bf16 v[128:143], a[216:219], a[48:51], v[128:143]
  v_exp_f32 v220, v156
  v_add_f32 v28, v28, v219
  v_cvt_pk_bf16_f32 v205, v218, v219
  v_mfma_f32_32x32x16_bf16 v[128:143], a[220:223], a[52:55], v[128:143]
  v_exp_f32 v221, v157
  v_add_f32 v28, v28, v220
  s_waitcnt lgkmcnt(0)
  v_mfma_f32_32x32x16_bf16 v[64:79], a[224:227], v[192:195], v[64:79]
  v_exp_f32 v222, v158
  v_add_f32 v28, v28, v221
  v_cvt_pk_bf16_f32 v206, v220, v221
  v_mfma_f32_32x32x16_bf16 v[80:95], a[228:231], v[192:195], v[80:95]
  v_exp_f32 v223, v159
  v_add_f32 v28, v28, v222
  v_mfma_f32_32x32x16_bf16 v[96:111], a[232:235], v[192:195], v[96:111]
  v_exp_f32 v208, v128
  v_add_f32 v28, v28, v223
  v_cvt_pk_bf16_f32 v207, v222, v223
  v_mfma_f32_32x32x16_bf16 v[112:127], a[236:239], v[192:195], v[112:127]
  v_exp_f32 v209, v129
  v_cmp_nge_f32 vcc, 0x47800000, v28
  v_mfma_f32_32x32x16_bf16 v[64:79], a[240:243], v[196:199], v[64:79]
  s_cbranch_vccnz L1_cbq4
L1_rbq4:
  v_exp_f32 v210, v130
  v_add_f32 v27, v208, v209
  v_cvt_pk_bf16_f32 v192, v208, v209
  v_mfma_f32_32x32x16_bf16 v[80:95], a[244:247], v[196:199], v[80:95]
  v_exp_f32 v211, v131
  v_add_f32 v30, v30, v28
  v_add_f32 v27, v27, v210
  v_mfma_f32_32x32x16_bf16 v[96:111], a[248:251], v[196:199], v[96:111]
  v_exp_f32 v212, v132
  v_add_f32 v27, v27, v211
  v_cvt_pk_bf16_f32 v193, v210, v211
  v_mfma_f32_32x32x16_bf16 v[112:127], a[252:255], v[196:199], v[112:127]
  v_exp_f32 v213, v133
  v_add_f32 v27, v27, v212
  v_mfma_f32_32x32x16_bf16 v[144:159], a[192:195], a[8:11], v[176:191]
  s_waitcnt vmcnt(9)
  s_barrier
  v_exp_f32 v214, v134
  v_add_f32 v27, v27, v213
  v_cvt_pk_bf16_f32 v194, v212, v213
  v_mfma_f32_32x32x16_bf16 v[144:159], a[196:199], a[12:15], v[144:159]
  ds_read_b128 a[192:195], v8 offset:49152
  v_exp_f32 v215, v135
  v_add_f32 v27, v27, v214
  v_mfma_f32_32x32x16_bf16 v[144:159], a[200:203], a[24:27], v[144:159]
  ds_read_b128 a[196:199], v9 offset:49152
  s_cmp_eq_u32 s30, s39
  v_exp_f32 v208, v136
  v_add_f32 v27, v27, v215
  v_cvt_pk_bf16_f32 v195, v214, v215
  v_mfma_f32_32x32x16_bf16 v[144:159], a[204:207], a[28:31], v[144:159]
  ds_read_b128 a[200:203], v10 offset:49152
  s_cbranch_scc1 L1_sig
L1_sig_ret:
  v_exp_f32 v209, v137
  v_add_f32 v27, v27, v208
  v_mfma_f32_32x32x16_bf16 v[144:159], a[208:211], a[40:43], v[144:159]
  ds_read_b128 a[204:207], v11 offset:49152
  v_exp_f32 v210, v138
  v_add_f32 v27, v27, v209
  v_cvt_pk_bf16_f32 v196, v208, v209
  v_mfma_f32_32x32x16_bf16 v[144:159], a[212:215], a[44:47], v[144:159]
  ds_read_b128 a[208:211], v12 offset:49152
  v_exp_f32 v211, v139
  v_add_f32 v27, v27, v210
  v_mfma_f32_32x32x16_bf16 v[144:159], a[216:219], a[56:59], v[144:159]
  ds_read_b128 a[212:215], v13 offset:49152
  v_exp_f32 v212, v140
  v_add_f32 v27, v27, v211
  v_cvt_pk_bf16_f32 v197, v210, v211
  v_mfma_f32_32x32x16_bf16 v[144:159], a[220:223], a[60:63], v[144:159]
  ds_read_b128 a[216:219], v14 offset:49152
  v_exp_f32 v213, v141
  v_add_f32 v27, v27, v212
  s_add_u32 m0, s29, 0x4000
  v_mfma_f32_32x32x16_bf16 a[64:79], a[224:227], v[200:203], a[64:79]
  ds_read_b128 a[220:223], v15 offset:49152
  buffer_load_dwordx4 v20, s[12:15], s27 offen offset:0 nt lds
  v_exp_f32 v214, v142
  v_add_f32 v27, v27, v213
  v_cvt_pk_bf16_f32 v198, v212, v213
  v_mfma_f32_32x32x16_bf16 a[80:95], a[228:231], v[200:203], a[80:95]
  ds_read_b64_tr_b16 a[224:225], v16 offset:40960
  ds_read_b64_tr_b16 a[226:227], v16 offset:43008
  v_exp_f32 v215, v143
  v_add_f32 v27, v27, v214
  v_mfma_f32_32x32x16_bf16 a[96:111], a[232:235], v[200:203], a[96:111]
  ds_read_b64_tr_b16 a[228:229], v17 offset:40960
  buffer_load_dwordx4 v21, s[12:15], s27 offen offset:1024 nt lds
  v_exp_f32 v216, v144
  v_add_f32 v27, v27, v215
  v_cvt_pk_bf16_f32 v199, v214, v215
  v_mfma_f32_32x32x16_bf16 a[112:127], a[236:239], v[200:203], a[112:127]
  ds_read_b64_tr_b16 a[230:231], v17 offset:43008
  ds_read_b64_tr_b16 a[232:233], v18 offset:40960
  v_exp_f32 v217, v145
  v_cmp_nge_f32 vcc, 0x47800000, v27
  s_add_u32 m0, s29, 0x12000
  v_mfma_f32_32x32x16_bf16 a[64:79], a[240:243], v[204:207], a[64:79]
  ds_read_b64_tr_b16 a[234:235], v18 offset:43008
  buffer_load_dwordx4 v22, s[16:19], s27 offen offset:0 nt lds
  s_cbranch_vccnz L1_caq4
L1_raq4:
  v_exp_f32 v218, v146
  v_add_f32 v28, v216, v217
  v_cvt_pk_bf16_f32 v200, v216, v217
  v_mfma_f32_32x32x16_bf16 a[80:95], a[244:247], v[204:207], a[80:95]
  ds_read_b64_tr_b16 a[236:237], v19 offset:40960
  v_exp_f32 v219, v147
  v_add_f32 v28, v28, v218
  v_add_f32 v29, v29, v27
  v_mfma_f32_32x32x16_bf16 a[96:111], a[248:251], v[204:207], a[96:111]
  ds_read_b64_tr_b16 a[238:239], v19 offset:43008
  buffer_load_dwordx4 v22, s[16:19], s27 offen offset:1024 nt lds
  v_exp_f32 v220, v148
  v_add_f32 v28, v28, v219
  v_cvt_pk_bf16_f32 v201, v218, v219
  v_mfma_f32_32x32x16_bf16 a[112:127], a[252:255], v[204:207], a[112:127]
  ds_read_b64_tr_b16 a[240:241], v16 offset:45056
  ds_read_b64_tr_b16 a[242:243], v16 offset:47104
  v_exp_f32 v221, v149
  v_add_f32 v28, v28, v220
  s_waitcnt lgkmcnt(10)
  v_mfma_f32_32x32x16_bf16 v[128:143], a[192:195], a[0:3], v[160:175]
  v_exp_f32 v222, v150
  v_add_f32 v28, v28, v221
  v_cvt_pk_bf16_f32 v202, v220, v221
  v_mfma_f32_32x32x16_bf16 v[128:143], a[196:199], a[4:7], v[128:143]
  ds_read_b64_tr_b16 a[244:245], v17 offset:45056
  ds_read_b64_tr_b16 a[246:247], v17 offset:47104
  v_exp_f32 v223, v151
  v_add_f32 v28, v28, v222
  v_mfma_f32_32x32x16_bf16 v[128:143], a[200:203], a[16:19], v[128:143]
  ds_read_b64_tr_b16 a[248:249], v18 offset:45056
  s_add_u32 s27, s27, 0x2000
  v_exp_f32 v216, v152
  v_add_f32 v28, v28, v223
  v_cvt_pk_bf16_f32 v203, v222, v223
  v_mfma_f32_32x32x16_bf16 v[128:143], a[204:207], a[20:23], v[128:143]
  ds_read_b64_tr_b16 a[250:251], v18 offset:47104
  ds_read_b64_tr_b16 a[252:253], v19 offset:45056
  v_exp_f32 v217, v153
  v_add_f32 v28, v28, v216
  v_mfma_f32_32x32x16_bf16 v[128:143], a[208:211], a[32:35], v[128:143]
  ds_read_b64_tr_b16 a[254:255], v19 offset:47104
  v_exp_f32 v218, v154
  v_add_f32 v28, v28, v217
  v_cvt_pk_bf16_f32 v204, v216, v217
  v_mfma_f32_32x32x16_bf16 v[128:143], a[212:215], a[36:39], v[128:143]
  v_exp_f32 v219, v155
  v_add_f32 v28, v28, v218
  v_mfma_f32_32x32x16_bf16 v[128:143], a[216:219], a[48:51], v[128:143]
  v_exp_f32 v220, v156
  v_add_f32 v28, v28, v219
  v_cvt_pk_bf16_f32 v205, v218, v219
  v_mfma_f32_32x32x16_bf16 v[128:143], a[220:223], a[52:55], v[128:143]
  v_exp_f32 v221, v157
  v_add_f32 v28, v28, v220
  s_waitcnt lgkmcnt(0)
  v_mfma_f32_32x32x16_bf16 v[64:79], a[224:227], v[192:195], v[64:79]
  v_exp_f32 v222, v158
  v_add_f32 v28, v28, v221
  v_cvt_pk_bf16_f32 v206, v220, v221
  v_mfma_f32_32x32x16_bf16 v[80:95], a[228:231], v[192:195], v[80:95]
  v_exp_f32 v223, v159
  v_add_f32 v28, v28, v222
  v_mfma_f32_32x32x16_bf16 v[96:111], a[232:235], v[192:195], v[96:111]
  v_exp_f32 v208, v128
  v_add_f32 v28, v28, v223
  v_cvt_pk_bf16_f32 v207, v222, v223
  v_mfma_f32_32x32x16_bf16 v[112:127], a[236:239], v[192:195], v[112:127]
  v_exp_f32 v209, v129
  v_cmp_nge_f32 vcc, 0x47800000, v28
  v_mfma_f32_32x32x16_bf16 v[64:79], a[240:243], v[196:199], v[64:79]
  s_cbranch_vccnz L1_cbq5
L1_rbq5:
  v_exp_f32 v210, v130
  v_add_f32 v27, v208, v209
  v_cvt_pk_bf16_f32 v192, v208, v209
  v_mfma_f32_32x32x16_bf16 v[80:95], a[244:247], v[196:199], v[80:95]
  v_exp_f32 v211, v131
  v_add_f32 v30, v30, v28
  v_add_f32 v27, v27, v210
  v_mfma_f32_32x32x16_bf16 v[96:111], a[248:251], v[196:199], v[96:111]
  v_exp_f32 v212, v132
  v_add_f32 v27, v27, v211
  v_cvt_pk_bf16_f32 v193, v210, v211
  v_mfma_f32_32x32x16_bf16 v[112:127], a[252:255], v[196:199], v[112:127]
  v_exp_f32 v213, v133
  v_add_f32 v27, v27, v212
  v_mfma_f32_32x32x16_bf16 v[144:159], a[192:195], a[8:11], v[176:191]
  v_exp_f32 v214, v134
  v_add_f32 v27, v27, v213
  v_cvt_pk_bf16_f32 v194, v212, v213
  v_mfma_f32_32x32x16_bf16 v[144:159], a[196:199], a[12:15], v[144:159]
  ds_read_b128 a[192:195], v8 offset:57344
  v_exp_f32 v215, v135
  v_add_f32 v27, v27, v214
  v_mfma_f32_32x32x16_bf16 v[144:159], a[200:203], a[24:27], v[144:159]
  ds_read_b128 a[196:199], v9 offset:57344
  v_exp_f32 v208, v136
  v_add_f32 v27, v27, v215
  v_cvt_pk_bf16_f32 v195, v214, v215
  v_mfma_f32_32x32x16_bf16 v[144:159], a[204:207], a[28:31], v[144:159]
  ds_read_b128 a[200:203], v10 offset:57344
  v_exp_f32 v209, v137
  v_add_f32 v27, v27, v208
  v_mfma_f32_32x32x16_bf16 v[144:159], a[208:211], a[40:43], v[144:159]
  ds_read_b128 a[204:207], v11 offset:57344
  v_exp_f32 v210, v138
  v_add_f32 v27, v27, v209
  v_cvt_pk_bf16_f32 v196, v208, v209
  v_mfma_f32_32x32x16_bf16 v[144:159], a[212:215], a[44:47], v[144:159]
  ds_read_b128 a[208:211], v12 offset:57344
  v_exp_f32 v211, v139
  v_add_f32 v27, v27, v210
  v_mfma_f32_32x32x16_bf16 v[144:159], a[216:219], a[56:59], v[144:159]
  ds_read_b128 a[212:215], v13 offset:57344
  v_exp_f32 v212, v140
  v_add_f32 v27, v27, v211
  v_cvt_pk_bf16_f32 v197, v210, v211
  v_mfma_f32_32x32x16_bf16 v[144:159], a[220:223], a[60:63], v[144:159]
  ds_read_b128 a[216:219], v14 offset:57344
  v_exp_f32 v213, v141
  v_add_f32 v27, v27, v212
  s_add_u32 m0, s29, 0x6000
  v_mfma_f32_32x32x16_bf16 a[64:79], a[224:227], v[200:203], a[64:79]
  ds_read_b128 a[220:223], v15 offset:57344
  buffer_load_dwordx4 v20, s[12:15], s27 offen offset:0 nt lds
  v_exp_f32 v214, v142
  v_add_f32 v27, v27, v213
  v_cvt_pk_bf16_f32 v198, v212, v213
  v_mfma_f32_32x32x16_bf16 a[80:95], a[228:231], v[200:203], a[80:95]
  ds_read_b64_tr_b16 a[224:225], v16 offset:49152
  ds_read_b64_tr_b16 a[226:227], v16 offset:51200
  v_exp_f32 v215, v143
  v_add_f32 v27, v27, v214
  v_mfma_f32_32x32x16_bf16 a[96:111], a[232:235], v[200:203], a[96:111]
  ds_read_b64_tr_b16 a[228:229], v17 offset:49152
  buffer_load_dwordx4 v21, s[12:15], s27 offen offset:1024 nt lds
  v_exp_f32 v216, v144
  v_add_f32 v27, v27, v215
  v_cvt_pk_bf16_f32 v199, v214, v215
  v_mfma_f32_32x32x16_bf16 a[112:127], a[236:239], v[200:203], a[112:127]
  ds_read_b64_tr_b16 a[230:231], v17 offset:51200
  ds_read_b64_tr_b16 a[232:233], v18 offset:49152
  v_exp_f32 v217, v145
  v_cmp_nge_f32 vcc, 0x47800000, v27
  s_add_u32 m0, s29, 0x14000
  v_mfma_f32_32x32x16_bf16 a[64:79], a[240:243], v[204:207], a[64:79]
  ds_read_b64_tr_b16 a[234:235], v18 offset:51200
  buffer_load_dwordx4 v22, s[16:19], s27 offen offset:0 nt lds
  s_cbranch_vccnz L1_caq5
L1_raq5:
  v_exp_f32 v218, v146
  v_add_f32 v28, v216, v217
  v_cvt_pk_bf16_f32 v200, v216, v217
  v_mfma_f32_32x32x16_bf16 a[80:95], a[244:247], v[204:207], a[80:95]
  ds_read_b64_tr_b16 a[236:237], v19 offset:49152
  v_exp_f32 v219, v147
  v_add_f32 v28, v28, v218
  v_add_f32 v29, v29, v27
  v_mfma_f32_32x32x16_bf16 a[96:111], a[248:251], v[204:207], a[96:111]
  ds_read_b64_tr_b16 a[238:239], v19 offset:51200
  buffer_load_dwordx4 v22, s[16:19], s27 offen offset:1024 nt lds
  v_exp_f32 v220, v148
  v_add_f32 v28, v28, v219
  v_cvt_pk_bf16_f32 v201, v218, v219
  v_mfma_f32_32x32x16_bf16 a[112:127], a[252:255], v[204:207], a[112:127]
  ds_read_b64_tr_b16 a[240:241], v16 offset:53248
  ds_read_b64_tr_b16 a[242:243], v16 offset:55296
  v_exp_f32 v221, v149
  v_add_f32 v28, v28, v220
  s_waitcnt lgkmcnt(10)
  v_mfma_f32_32x32x16_bf16 v[128:143], a[192:195], a[0:3], v[160:175]
  v_exp_f32 v222, v150
  v_add_f32 v28, v28, v221
  v_cvt_pk_bf16_f32 v202, v220, v221
  v_mfma_f32_32x32x16_bf16 v[128:143], a[196:199], a[4:7], v[128:143]
  ds_read_b64_tr_b16 a[244:245], v17 offset:53248
  ds_read_b64_tr_b16 a[246:247], v17 offset:55296
  v_exp_f32 v223, v151
  v_add_f32 v28, v28, v222
  v_mfma_f32_32x32x16_bf16 v[128:143], a[200:203], a[16:19], v[128:143]
  ds_read_b64_tr_b16 a[248:249], v18 offset:53248
  s_add_u32 s27, s27, 0x2000
  v_exp_f32 v216, v152
  v_add_f32 v28, v28, v223
  v_cvt_pk_bf16_f32 v203, v222, v223
  v_mfma_f32_32x32x16_bf16 v[128:143], a[204:207], a[20:23], v[128:143]
  ds_read_b64_tr_b16 a[250:251], v18 offset:55296
  ds_read_b64_tr_b16 a[252:253], v19 offset:53248
  v_exp_f32 v217, v153
  v_add_f32 v28, v28, v216
  v_mfma_f32_32x32x16_bf16 v[128:143], a[208:211], a[32:35], v[128:143]
  ds_read_b64_tr_b16 a[254:255], v19 offset:55296
  v_exp_f32 v218, v154
  v_add_f32 v28, v28, v217
  v_cvt_pk_bf16_f32 v204, v216, v217
  v_mfma_f32_32x32x16_bf16 v[128:143], a[212:215], a[36:39], v[128:143]
  v_exp_f32 v219, v155
  v_add_f32 v28, v28, v218
  v_mfma_f32_32x32x16_bf16 v[128:143], a[216:219], a[48:51], v[128:143]
  v_exp_f32 v220, v156
  v_add_f32 v28, v28, v219
  v_cvt_pk_bf16_f32 v205, v218, v219
  v_mfma_f32_32x32x16_bf16 v[128:143], a[220:223], a[52:55], v[128:143]
  v_exp_f32 v221, v157
  v_add_f32 v28, v28, v220
  s_waitcnt lgkmcnt(0)
  v_mfma_f32_32x32x16_bf16 v[64:79], a[224:227], v[192:195], v[64:79]
  v_exp_f32 v222, v158
  v_add_f32 v28, v28, v221
  v_cvt_pk_bf16_f32 v206, v220, v221
  v_mfma_f32_32x32x16_bf16 v[80:95], a[228:231], v[192:195], v[80:95]
  v_exp_f32 v223, v159
  v_add_f32 v28, v28, v222
  v_mfma_f32_32x32x16_bf16 v[96:111], a[232:235], v[192:195], v[96:111]
  v_exp_f32 v208, v128
  v_add_f32 v28, v28, v223
  v_cvt_pk_bf16_f32 v207, v222, v223
  v_mfma_f32_32x32x16_bf16 v[112:127], a[236:239], v[192:195], v[112:127]
  v_exp_f32 v209, v129
  v_cmp_nge_f32 vcc, 0x47800000, v28
  v_mfma_f32_32x32x16_bf16 v[64:79], a[240:243], v[196:199], v[64:79]
  s_cbranch_vccnz L1_cbq6
L1_rbq6:
  v_exp_f32 v210, v130
  v_add_f32 v27, v208, v209
  v_cvt_pk_bf16_f32 v192, v208, v209
  v_mfma_f32_32x32x16_bf16 v[80:95], a[244:247], v[196:199], v[80:95]
  v_exp_f32 v211, v131
  v_add_f32 v30, v30, v28
  v_add_f32 v27, v27, v210
  v_mfma_f32_32x32x16_bf16 v[96:111], a[248:251], v[196:199], v[96:111]
  v_exp_f32 v212, v132
  v_add_f32 v27, v27, v211
  v_cvt_pk_bf16_f32 v193, v210, v211
  v_mfma_f32_32x32x16_bf16 v[112:127], a[252:255], v[196:199], v[112:127]
  v_exp_f32 v213, v133
  v_add_f32 v27, v27, v212
  v_mfma_f32_32x32x16_bf16 v[144:159], a[192:195], a[8:11], v[176:191]
  s_waitcnt vmcnt(8)
  s_barrier
  v_exp_f32 v214, v134
  v_add_f32 v27, v27, v213
  v_cvt_pk_bf16_f32 v194, v212, v213
  v_mfma_f32_32x32x16_bf16 v[144:159], a[196:199], a[12:15], v[144:159]
  ds_read_b128 a[192:195], v8 offset:0
  v_exp_f32 v215, v135
  v_add_f32 v27, v27, v214
  v_mfma_f32_32x32x16_bf16 v[144:159], a[200:203], a[24:27], v[144:159]
  ds_read_b128 a[196:199], v9 offset:0
  v_exp_f32 v208, v136
  v_add_f32 v27, v27, v215
  v_cvt_pk_bf16_f32 v195, v214, v215
  v_mfma_f32_32x32x16_bf16 v[144:159], a[204:207], a[28:31], v[144:159]
  ds_read_b128 a[200:203], v10 offset:0
  v_exp_f32 v209, v137
  v_add_f32 v27, v27, v208
  v_mfma_f32_32x32x16_bf16 v[144:159], a[208:211], a[40:43], v[144:159]
  ds_read_b128 a[204:207], v11 offset:0
  v_exp_f32 v210, v138
  v_add_f32 v27, v27, v209
  v_cvt_pk_bf16_f32 v196, v208, v209
  v_mfma_f32_32x32x16_bf16 v[144:159], a[212:215], a[44:47], v[144:159]
  ds_read_b128 a[208:211], v12 offset:0
  v_exp_f32 v211, v139
  v_add_f32 v27, v27, v210
  v_mfma_f32_32x32x16_bf16 v[144:159], a[216:219], a[56:59], v[144:159]
  ds_read_b128 a[212:215], v13 offset:0
  v_exp_f32 v212, v140
  v_add_f32 v27, v27, v211
  v_cvt_pk_bf16_f32 v197, v210, v211
  v_mfma_f32_32x32x16_bf16 v[144:159], a[220:223], a[60:63], v[144:159]
  ds_read_b128 a[216:219], v14 offset:0
  v_exp_f32 v213, v141
  v_add_f32 v27, v27, v212
  s_add_u32 m0, s29, 0x8000
  v_mfma_f32_32x32x16_bf16 a[64:79], a[224:227], v[200:203], a[64:79]
  ds_read_b128 a[220:223], v15 offset:0
  buffer_load_dwordx4 v20, s[12:15], s27 offen offset:0 nt lds
  v_exp_f32 v214, v142
  v_add_f32 v27, v27, v213
  v_cvt_pk_bf16_f32 v198, v212, v213
  v_mfma_f32_32x32x16_bf16 a[80:95], a[228:231], v[200:203], a[80:95]
  ds_read_b64_tr_b16 a[224:225], v16 offset:57344
  ds_read_b64_tr_b16 a[226:227], v16 offset:59392
  v_exp_f32 v215, v143
  v_add_f32 v27, v27, v214
  v_mfma_f32_32x32x16_bf16 a[96:111], a[232:235], v[200:203], a[96:111]
  ds_read_b64_tr_b16 a[228:229], v17 offset:57344
  buffer_load_dwordx4 v21, s[12:15], s27 offen offset:1024 nt lds
  v_exp_f32 v216, v144
  v_add_f32 v27, v27, v215
  v_cvt_pk_bf16_f32 v199, v214, v215
  v_mfma_f32_32x32x16_bf16 a[112:127], a[236:239], v[200:203], a[112:127]
  ds_read_b64_tr_b16 a[230:231], v17 offset:59392
  ds_read_b64_tr_b16 a[232:233], v18 offset:57344
  v_exp_f32 v217, v145
  v_cmp_nge_f32 vcc, 0x47800000, v27
  s_add_u32 m0, s29, 0x16000
  v_mfma_f32_32x32x16_bf16 a[64:79], a[240:243], v[204:207], a[64:79]
  ds_read_b64_tr_b16 a[234:235], v18 offset:59392
  buffer_load_dwordx4 v22, s[16:19], s27 offen offset:0 nt lds
  s_cbranch_vccnz L1_caq6
L1_raq6:
  v_exp_f32 v218, v146
  v_add_f32 v28, v216, v217
  v_cvt_pk_bf16_f32 v200, v216, v217
  v_mfma_f32_32x32x16_bf16 a[80:95], a[244:247], v[204:207], a[80:95]
  ds_read_b64_tr_b16 a[236:237], v19 offset:57344
  v_exp_f32 v219, v147
  v_add_f32 v28, v28, v218
  v_add_f32 v29, v29, v27
  v_mfma_f32_32x32x16_bf16 a[96:111], a[248:251], v[204:207], a[96:111]
  ds_read_b64_tr_b16 a[238:239], v19 offset:59392
  buffer_load_dwordx4 v22, s[16:19], s27 offen offset:1024 nt lds
  v_exp_f32 v220, v148
  v_add_f32 v28, v28, v219
  v_cvt_pk_bf16_f32 v201, v218, v219
  v_mfma_f32_32x32x16_bf16 a[112:127], a[252:255], v[204:207], a[112:127]
  ds_read_b64_tr_b16 a[240:241], v16 offset:61440
  ds_read_b64_tr_b16 a[242:243], v16 offset:63488
  v_exp_f32 v221, v149
  v_add_f32 v28, v28, v220
  s_waitcnt lgkmcnt(10)
  v_mfma_f32_32x32x16_bf16 v[128:143], a[192:195], a[0:3], v[160:175]
  v_exp_f32 v222, v150
  v_add_f32 v28, v28, v221
  v_cvt_pk_bf16_f32 v202, v220, v221
  v_mfma_f32_32x32x16_bf16 v[128:143], a[196:199], a[4:7], v[128:143]
  ds_read_b64_tr_b16 a[244:245], v17 offset:61440
  ds_read_b64_tr_b16 a[246:247], v17 offset:63488
  v_exp_f32 v223, v151
  v_add_f32 v28, v28, v222
  v_mfma_f32_32x32x16_bf16 v[128:143], a[200:203], a[16:19], v[128:143]
  ds_read_b64_tr_b16 a[248:249], v18 offset:61440
  s_add_u32 s27, s27, 0x2000
  v_exp_f32 v216, v152
  v_add_f32 v28, v28, v223
  v_cvt_pk_bf16_f32 v203, v222, v223
  v_mfma_f32_32x32x16_bf16 v[128:143], a[204:207], a[20:23], v[128:143]
  ds_read_b64_tr_b16 a[250:251], v18 offset:63488
  ds_read_b64_tr_b16 a[252:253], v19 offset:61440
  v_exp_f32 v217, v153
  v_add_f32 v28, v28, v216
  v_mfma_f32_32x32x16_bf16 v[128:143], a[208:211], a[32:35], v[128:143]
  ds_read_b64_tr_b16 a[254:255], v19 offset:63488
  v_exp_f32 v218, v154
  v_add_f32 v28, v28, v217
  v_cvt_pk_bf16_f32 v204, v216, v217
  v_mfma_f32_32x32x16_bf16 v[128:143], a[212:215], a[36:39], v[128:143]
  v_exp_f32 v219, v155
  v_add_f32 v28, v28, v218
  v_mfma_f32_32x32x16_bf16 v[128:143], a[216:219], a[48:51], v[128:143]
  v_exp_f32 v220, v156
  v_add_f32 v28, v28, v219
  v_cvt_pk_bf16_f32 v205, v218, v219
  v_mfma_f32_32x32x16_bf16 v[128:143], a[220:223], a[52:55], v[128:143]
  v_exp_f32 v221, v157
  v_add_f32 v28, v28, v220
  s_waitcnt lgkmcnt(0)
  v_mfma_f32_32x32x16_bf16 v[64:79], a[224:227], v[192:195], v[64:79]
  v_exp_f32 v222, v158
  v_add_f32 v28, v28, v221
  v_cvt_pk_bf16_f32 v206, v220, v221
  v_mfma_f32_32x32x16_bf16 v[80:95], a[228:231], v[192:195], v[80:95]
  v_exp_f32 v223, v159
  v_add_f32 v28, v28, v222
  v_mfma_f32_32x32x16_bf16 v[96:111], a[232:235], v[192:195], v[96:111]
  v_exp_f32 v208, v128
  v_add_f32 v28, v28, v223
  v_cvt_pk_bf16_f32 v207, v222, v223
  v_mfma_f32_32x32x16_bf16 v[112:127], a[236:239], v[192:195], v[112:127]
  v_exp_f32 v209, v129
  v_cmp_nge_f32 vcc, 0x47800000, v28
  v_mfma_f32_32x32x16_bf16 v[64:79], a[240:243], v[196:199], v[64:79]
  s_cbranch_vccnz L1_cbq7
L1_rbq7:
  v_exp_f32 v210, v130
  v_add_f32 v27, v208, v209
  v_cvt_pk_bf16_f32 v192, v208, v209
  v_mfma_f32_32x32x16_bf16 v[80:95], a[244:247], v[196:199], v[80:95]
  v_exp_f32 v211, v131
  v_add_f32 v30, v30, v28
  v_add_f32 v27, v27, v210
  v_mfma_f32_32x32x16_bf16 v[96:111], a[248:251], v[196:199], v[96:111]
  v_exp_f32 v212, v132
  v_add_f32 v27, v27, v211
  v_cvt_pk_bf16_f32 v193, v210, v211
  v_mfma_f32_32x32x16_bf16 v[112:127], a[252:255], v[196:199], v[112:127]
  v_exp_f32 v213, v133
  v_add_f32 v27, v27, v212
  v_mfma_f32_32x32x16_bf16 v[144:159], a[192:195], a[8:11], v[176:191]
  v_exp_f32 v214, v134
  v_add_f32 v27, v27, v213
  v_cvt_pk_bf16_f32 v194, v212, v213
  v_mfma_f32_32x32x16_bf16 v[144:159], a[196:199], a[12:15], v[144:159]
  ds_read_b128 a[192:195], v8 offset:8192
  v_exp_f32 v215, v135
  v_add_f32 v27, v27, v214
  v_mfma_f32_32x32x16_bf16 v[144:159], a[200:203], a[24:27], v[144:159]
  ds_read_b128 a[196:199], v9 offset:8192
  v_exp_f32 v208, v136
  v_add_f32 v27, v27, v215
  v_cvt_pk_bf16_f32 v195, v214, v215
  v_mfma_f32_32x32x16_bf16 v[144:159], a[204:207], a[28:31], v[144:159]
  ds_read_b128 a[200:203], v10 offset:8192
  v_exp_f32 v209, v137
  v_add_f32 v27, v27, v208
  v_mfma_f32_32x32x16_bf16 v[144:159], a[208:211], a[40:43], v[144:159]
  ds_read_b128 a[204:207], v11 offset:8192
  v_exp_f32 v210, v138
  v_add_f32 v27, v27, v209
  v_cvt_pk_bf16_f32 v196, v208, v209
  v_mfma_f32_32x32x16_bf16 v[144:159], a[212:215], a[44:47], v[144:159]
  ds_read_b128 a[208:211], v12 offset:8192
  v_exp_f32 v211, v139
  v_add_f32 v27, v27, v210
  v_mfma_f32_32x32x16_bf16 v[144:159], a[216:219], a[56:59], v[144:159]
  ds_read_b128 a[212:215], v13 offset:8192
  v_exp_f32 v212, v140
  v_add_f32 v27, v27, v211
  v_cvt_pk_bf16_f32 v197, v210, v211
  v_mfma_f32_32x32x16_bf16 v[144:159], a[220:223], a[60:63], v[144:159]
  ds_read_b128 a[216:219], v14 offset:8192
  v_exp_f32 v213, v141
  v_add_f32 v27, v27, v212
  s_add_u32 m0, s29, 0xa000
  v_mfma_f32_32x32x16_bf16 a[64:79], a[224:227], v[200:203], a[64:79]
  ds_read_b128 a[220:223], v15 offset:8192
  buffer_load_dwordx4 v20, s[12:15], s27 offen offset:0 nt lds
  v_exp_f32 v214, v142
  v_add_f32 v27, v27, v213
  v_cvt_pk_bf16_f32 v198, v212, v213
  v_mfma_f32_32x32x16_bf16 a[80:95], a[228:231], v[200:203], a[80:95]
  ds_read_b64_tr_b16 a[224:225], v16 offset:0
  ds_read_b64_tr_b16 a[226:227], v16 offset:2048
  v_exp_f32 v215, v143
  v_add_f32 v27, v27, v214
  v_mfma_f32_32x32x16_bf16 a[96:111], a[232:235], v[200:203], a[96:111]
  ds_read_b64_tr_b16 a[228:229], v17 offset:0
  buffer_load_dwordx4 v21, s[12:15], s27 offen offset:1024 nt lds
  v_exp_f32 v216, v144
  v_add_f32 v27, v27, v215
  v_cvt_pk_bf16_f32 v199, v214, v215
  v_mfma_f32_32x32x16_bf16 a[112:127], a[236:239], v[200:203], a[112:127]
  ds_read_b64_tr_b16 a[230:231], v17 offset:2048
  ds_read_b64_tr_b16 a[232:233], v18 offset:0
  v_exp_f32 v217, v145
  v_cmp_nge_f32 vcc, 0x47800000, v27
  s_add_u32 m0, s29, 0x18000
  v_mfma_f32_32x32x16_bf16 a[64:79], a[240:243], v[204:207], a[64:79]
  ds_read_b64_tr_b16 a[234:235], v18 offset:2048
  buffer_load_dwordx4 v22, s[16:19], s27 offen offset:0 nt lds
  s_cbranch_vccnz L1_caq7
L1_raq7:
  v_exp_f32 v218, v146
  v_add_f32 v28, v216, v217
  v_cvt_pk_bf16_f32 v200, v216, v217
  v_mfma_f32_32x32x16_bf16 a[80:95], a[244:247], v[204:207], a[80:95]
  ds_read_b64_tr_b16 a[236:237], v19 offset:0
  s_add_u32 s30, s30, 1
  v_exp_f32 v219, v147
  v_add_f32 v28, v28, v218
  v_add_f32 v29, v29, v27
  v_mfma_f32_32x32x16_bf16 a[96:111], a[248:251], v[204:207], a[96:111]
  ds_read_b64_tr_b16 a[238:239], v19 offset:2048
  buffer_load_dwordx4 v22, s[16:19], s27 offen offset:1024 nt lds
  s_cmp_lt_u32 s30, 2
  v_exp_f32 v220, v148
  v_add_f32 v28, v28, v219
  v_cvt_pk_bf16_f32 v201, v218, v219
  v_mfma_f32_32x32x16_bf16 a[112:127], a[252:255], v[204:207], a[112:127]
  ds_read_b64_tr_b16 a[240:241], v16 offset:4096
  ds_read_b64_tr_b16 a[242:243], v16 offset:6144
  v_exp_f32 v221, v149
  v_add_f32 v28, v28, v220
  s_cbranch_scc1 L1_lp2
CP_j56:
  s_waitcnt lgkmcnt(10)
  v_mfma_f32_32x32x16_bf16 v[128:143], a[192:195], a[0:3], v[160:175]
  v_exp_f32 v222, v150
  v_add_f32 v28, v28, v221
  v_cvt_pk_bf16_f32 v202, v220, v221
  v_lshl_add_u32 v56, v1, 4, v5
  v_lshlrev_b32 v57, 1, v5
  v_mfma_f32_32x32x16_bf16 v[128:143], a[196:199], a[4:7], v[128:143]
  ds_read_b64_tr_b16 a[244:245], v17 offset:4096
  ds_read_b64_tr_b16 a[246:247], v17 offset:6144
  buffer_load_dword v4, v25, s[72:75], 0 offen offset:0 sc1
  v_exp_f32 v223, v151
  v_add_f32 v28, v28, v222
  v_mfma_f32_32x32x16_bf16 v[128:143], a[200:203], a[16:19], v[128:143]
  ds_read_b64_tr_b16 a[248:249], v18 offset:4096
  s_add_u32 s27, s27, 0x2000
  v_exp_f32 v216, v152
  v_add_f32 v28, v28, v223
  v_cvt_pk_bf16_f32 v203, v222, v223
  v_mfma_f32_32x32x16_bf16 v[128:143], a[204:207], a[20:23], v[128:143]
  ds_read_b64_tr_b16 a[250:251], v18 offset:6144
  ds_read_b64_tr_b16 a[252:253], v19 offset:4096
  v_exp_f32 v217, v153
  v_add_f32 v28, v28, v216
  v_lshlrev_b32 v56, 11, v56
  v_mfma_f32_32x32x16_bf16 v[128:143], a[208:211], a[32:35], v[128:143]
  ds_read_b64_tr_b16 a[254:255], v19 offset:6144
  v_exp_f32 v218, v154
  v_add_f32 v28, v28, v217
  v_cvt_pk_bf16_f32 v204, v216, v217
  v_add_u32 v58, 0, v57
  v_mfma_f32_32x32x16_bf16 v[128:143], a[212:215], a[36:39], v[128:143]
  v_exp_f32 v219, v155
  v_add_f32 v28, v28, v218
  v_xor_b32 v58, v58, v6
  v_lshl_add_u32 v58, v58, 4, v56
  v_add_u32 v48, 0x0, v58
  v_mfma_f32_32x32x16_bf16 v[128:143], a[216:219], a[48:51], v[128:143]
  v_exp_f32 v220, v156
  v_add_f32 v28, v28, v219
  v_cvt_pk_bf16_f32 v205, v218, v219
  v_add_u32 v58, 0, v57
  v_xor_b32 v58, v58, v6
  v_mfma_f32_32x32x16_bf16 v[128:143], a[220:223], a[52:55], v[128:143]
  v_exp_f32 v221, v157
  v_add_f32 v28, v28, v220
  v_lshl_add_u32 v58, v58, 4, v56
  v_add_u32 v49, 0x1c00, v58
  v_add_u32 v58, 8, v57
  s_waitcnt lgkmcnt(0)
  v_mfma_f32_32x32x16_bf16 v[64:79], a[224:227], v[192:195], v[64:79]
  v_exp_f32 v222, v158
  v_add_f32 v28, v28, v221
  v_cvt_pk_bf16_f32 v206, v220, v221
  v_xor_b32 v58, v58, v6
  v_lshl_add_u32 v58, v58, 4, v56
  v_mfma_f32_32x32x16_bf16 v[80:95], a[228:231], v[192:195], v[80:95]
  v_exp_f32 v223, v159
  v_add_f32 v28, v28, v222
  v_add_u32 v50, 0x3800, v58
  v_add_u32 v58, 8, v57
  v_xor_b32 v58, v58, v6
  v_mfma_f32_32x32x16_bf16 v[96:111], a[232:235], v[192:195], v[96:111]
  v_exp_f32 v208, v128
  v_add_f32 v28, v28, v223
  v_cvt_pk_bf16_f32 v207, v222, v223
  v_lshl_add_u32 v58, v58, 4, v56
  v_add_u32 v51, 0x5400, v58
  v_mfma_f32_32x32x16_bf16 v[112:127], a[236:239], v[192:195], v[112:127]
  v_exp_f32 v209, v129
  v_cmp_nge_f32 vcc, 0x47800000, v28
  v_lshlrev_b32 v52, 4, v2
  v_lshrrev_b32 v57, 2, v6
  v_add_u32 v53, 0x20000, v52
  v_mfma_f32_32x32x16_bf16 v[64:79], a[240:243], v[196:199], v[64:79]
  s_cbranch_vccnz L1_cbJ56
L1_rbJ56:
  v_exp_f32 v210, v130
  v_add_f32 v27, v208, v209
  v_cvt_pk_bf16_f32 v192, v208, v209
  v_and_b32 v58, 3, v2
  v_mfma_f32_32x32x16_bf16 v[80:95], a[244:247], v[196:199], v[80:95]
  v_exp_f32 v211, v131
  v_add_f32 v30, v30, v28
  v_add_f32 v27, v27, v210
  v_lshl_add_u32 v56, v5, 3, v57
  v_and_b32 v59, 1, v5
  v_mfma_f32_32x32x16_bf16 v[96:111], a[248:251], v[196:199], v[96:111]
  s_mov_b32 s88, 0
  v_exp_f32 v212, v132
  v_add_f32 v27, v27, v211
  v_cvt_pk_bf16_f32 v193, v210, v211
  v_lshlrev_b32 v56, 8, v56
  v_mfma_f32_32x32x16_bf16 v[112:127], a[252:255], v[196:199], v[112:127]
  v_exp_f32 v213, v133
  v_add_f32 v27, v27, v212
  v_lshl_add_u32 v59, v59, 2, v57
  v_lshl_add_u32 v56, v58, 3, v56
  v_xor_b32 v58, 0, v59
  v_mfma_f32_32x32x16_bf16 v[144:159], a[192:195], a[8:11], v[176:191]
  s_waitcnt vmcnt(9)
  s_barrier
  v_exp_f32 v214, v134
  v_add_f32 v27, v27, v213
  v_cvt_pk_bf16_f32 v194, v212, v213
  v_lshl_add_u32 v32, v58, 5, v56
  v_mfma_f32_32x32x16_bf16 v[144:159], a[196:199], a[12:15], v[144:159]
  ds_read_b128 a[192:195], v8 offset:16384
  v_exp_f32 v215, v135
  v_add_f32 v27, v27, v214
  v_add_u32 v40, 0x10000, v32
  v_xor_b32 v58, 1, v59
  v_mfma_f32_32x32x16_bf16 v[144:159], a[200:203], a[24:27], v[144:159]
  ds_read_b128 a[196:199], v9 offset:16384
  v_exp_f32 v208, v136
  v_add_f32 v27, v27, v215
  v_cvt_pk_bf16_f32 v195, v214, v215
  v_lshl_add_u32 v33, v58, 5, v56
  v_mfma_f32_32x32x16_bf16 v[144:159], a[204:207], a[28:31], v[144:159]
  ds_read_b128 a[200:203], v10 offset:16384
  v_exp_f32 v209, v137
  v_add_f32 v27, v27, v208
  v_add_u32 v41, 0x10000, v33
  v_xor_b32 v58, 2, v59
  v_mfma_f32_32x32x16_bf16 v[144:159], a[208:211], a[40:43], v[144:159]
  ds_read_b128 a[204:207], v11 offset:16384
  v_exp_f32 v210, v138
  v_add_f32 v27, v27, v209
  v_cvt_pk_bf16_f32 v196, v208, v209
  v_lshl_add_u32 v34, v58, 5, v56
  v_mfma_f32_32x32x16_bf16 v[144:159], a[212:215], a[44:47], v[144:159]
  ds_read_b128 a[208:211], v12 offset:16384
  v_exp_f32 v211, v139
  v_add_f32 v27, v27, v210
  v_add_u32 v42, 0x10000, v34
  v_xor_b32 v58, 3, v59
  v_mfma_f32_32x32x16_bf16 v[144:159], a[216:219], a[56:59], v[144:159]
  ds_read_b128 a[212:215], v13 offset:16384
  v_exp_f32 v212, v140
  v_add_f32 v27, v27, v211
  v_cvt_pk_bf16_f32 v197, v210, v211
  v_lshl_add_u32 v35, v58, 5, v56
  v_mfma_f32_32x32x16_bf16 v[144:159], a[220:223], a[60:63], v[144:159]
  ds_read_b128 a[216:219], v14 offset:16384
  v_exp_f32 v213, v141
  v_add_f32 v27, v27, v212
  v_add_u32 v43, 0x10000, v35
  s_add_u32 m0, s29, 0xc000
  v_mfma_f32_32x32x16_bf16 a[64:79], a[224:227], v[200:203], a[64:79]
  ds_read_b128 a[220:223], v15 offset:16384
  buffer_load_dwordx4 v20, s[12:15], s27 offen offset:0 nt lds
  v_exp_f32 v214, v142
  v_add_f32 v27, v27, v213
  v_cvt_pk_bf16_f32 v198, v212, v213
  v_mfma_f32_32x32x16_bf16 a[80:95], a[228:231], v[200:203], a[80:95]
  ds_read_b64_tr_b16 a[224:225], v16 offset:8192
  ds_read_b64_tr_b16 a[226:227], v16 offset:10240
  v_exp_f32 v215, v143
  v_add_f32 v27, v27, v214
  v_xor_b32 v58, 4, v59
  v_mfma_f32_32x32x16_bf16 a[96:111], a[232:235], v[200:203], a[96:111]
  ds_read_b64_tr_b16 a[228:229], v17 offset:8192
  buffer_load_dwordx4 v21, s[12:15], s27 offen offset:1024 nt lds
  v_exp_f32 v216, v144
  v_add_f32 v27, v27, v215
  v_cvt_pk_bf16_f32 v199, v214, v215
  v_mfma_f32_32x32x16_bf16 a[112:127], a[236:239], v[200:203], a[112:127]
  ds_read_b64_tr_b16 a[230:231], v17 offset:10240
  ds_read_b64_tr_b16 a[232:233], v18 offset:8192
  v_exp_f32 v217, v145
  v_cmp_nge_f32 vcc, 0x47800000, v27
  s_add_u32 m0, s29, 0x1a000
  v_mfma_f32_32x32x16_bf16 a[64:79], a[240:243], v[204:207], a[64:79]
  ds_read_b64_tr_b16 a[234:235], v18 offset:10240
  buffer_load_dwordx4 v22, s[16:19], s27 offen offset:0 nt lds
  s_cbranch_vccnz L1_caJ56
L1_raJ56:
  v_exp_f32 v218, v146
  v_add_f32 v28, v216, v217
  v_cvt_pk_bf16_f32 v200, v216, v217
  v_mfma_f32_32x32x16_bf16 a[80:95], a[244:247], v[204:207], a[80:95]
  ds_read_b64_tr_b16 a[236:237], v19 offset:8192
  v_exp_f32 v219, v147
  v_add_f32 v28, v28, v218
  v_add_f32 v29, v29, v27
  v_lshl_add_u32 v36, v58, 5, v56
  v_mfma_f32_32x32x16_bf16 a[96:111], a[248:251], v[204:207], a[96:111]
  ds_read_b64_tr_b16 a[238:239], v19 offset:10240
  buffer_load_dwordx4 v22, s[16:19], s27 offen offset:1024 nt lds
  v_exp_f32 v220, v148
  v_add_f32 v28, v28, v219
  v_cvt_pk_bf16_f32 v201, v218, v219
  v_mfma_f32_32x32x16_bf16 a[112:127], a[252:255], v[204:207], a[112:127]
  ds_read_b64_tr_b16 a[240:241], v16 offset:12288
  ds_read_b64_tr_b16 a[242:243], v16 offset:14336
  v_exp_f32 v221, v149
  v_add_f32 v28, v28, v220
  v_add_u32 v44, 0x10000, v36
  s_waitcnt lgkmcnt(10)
  v_mfma_f32_32x32x16_bf16 v[128:143], a[192:195], a[0:3], v[160:175]
  v_exp_f32 v222, v150
  v_add_f32 v28, v28, v221
  v_cvt_pk_bf16_f32 v202, v220, v221
  v_xor_b32 v58, 5, v59
  v_lshl_add_u32 v37, v58, 5, v56
  v_mfma_f32_32x32x16_bf16 v[128:143], a[196:199], a[4:7], v[128:143]
  ds_read_b64_tr_b16 a[244:245], v17 offset:12288
  ds_read_b64_tr_b16 a[246:247], v17 offset:14336
  v_exp_f32 v223, v151
  v_add_f32 v28, v28, v222
  v_add_u32 v45, 0x10000, v37
  v_mfma_f32_32x32x16_bf16 v[128:143], a[200:203], a[16:19], v[128:143]
  ds_read_b64_tr_b16 a[248:249], v18 offset:12288
  s_add_u32 s27, s27, 0x2000
  v_exp_f32 v216, v152
  v_add_f32 v28, v28, v223
  v_cvt_pk_bf16_f32 v203, v222, v223
  v_mfma_f32_32x32x16_bf16 v[128:143], a[204:207], a[20:23], v[128:143]
  ds_read_b64_tr_b16 a[250:251], v18 offset:14336
  ds_read_b64_tr_b16 a[252:253], v19 offset:12288
  v_exp_f32 v217, v153
  v_add_f32 v28, v28, v216
  v_xor_b32 v58, 6, v59
  v_mfma_f32_32x32x16_bf16 v[128:143], a[208:211], a[32:35], v[128:143]
  ds_read_b64_tr_b16 a[254:255], v19 offset:14336
  v_exp_f32 v218, v154
  v_add_f32 v28, v28, v217
  v_cvt_pk_bf16_f32 v204, v216, v217
  v_lshl_add_u32 v38, v58, 5, v56
  v_mfma_f32_32x32x16_bf16 v[128:143], a[212:215], a[36:39], v[128:143]
  v_exp_f32 v219, v155
  v_add_f32 v28, v28, v218
  v_add_u32 v46, 0x10000, v38
  v_xor_b32 v58, 7, v59
  v_lshl_add_u32 v39, v58, 5, v56
  v_mfma_f32_32x32x16_bf16 v[128:143], a[216:219], a[48:51], v[128:143]
  v_exp_f32 v220, v156
  v_add_f32 v28, v28, v219
  v_cvt_pk_bf16_f32 v205, v218, v219
  v_add_u32 v47, 0x10000, v39
  v_lshlrev_b32 v56, 12, v6
  v_mfma_f32_32x32x16_bf16 v[128:143], a[220:223], a[52:55], v[128:143]
  v_exp_f32 v221, v157
  v_add_f32 v28, v28, v220
  v_and_b32 v57, 1, v5
  v_lshrrev_b32 v58, 1, v5
  v_lshl_add_u32 v56, v57, 5, v56
  s_waitcnt lgkmcnt(0)
  v_mfma_f32_32x32x16_bf16 v[64:79], a[224:227], v[192:195], v[64:79]
  v_exp_f32 v222, v158
  v_add_f32 v28, v28, v221
  v_cvt_pk_bf16_f32 v206, v220, v221
  v_lshl_add_u32 v54, v58, 4, v56
  v_add_u32 v55, 0x10000, v54
  v_mfma_f32_32x32x16_bf16 v[80:95], a[228:231], v[192:195], v[80:95]
  v_exp_f32 v223, v159
  v_add_f32 v28, v28, v222
  v_mov_b32 v60, 0
  v_mov_b32 v61, 0
  v_mov_b32 v62, 0
  v_mfma_f32_32x32x16_bf16 v[96:111], a[232:235], v[192:195], v[96:111]
  v_exp_f32 v208, v128
  v_add_f32 v28, v28, v223
  v_cvt_pk_bf16_f32 v207, v222, v223
  v_mov_b32 v63, 0
  v_mfma_f32_32x32x16_bf16 v[112:127], a[236:239], v[192:195], v[112:127]
  v_exp_f32 v209, v129
  v_cmp_nge_f32 vcc, 0x47800000, v28
  v_mfma_f32_32x32x16_bf16 v[64:79], a[240:243], v[196:199], v[64:79]
  s_cbranch_vccnz L1_cbJ57
L1_rbJ57:
  v_exp_f32 v210, v130
  v_add_f32 v27, v208, v209
  v_cvt_pk_bf16_f32 v192, v208, v209
  v_mfma_f32_32x32x16_bf16 v[80:95], a[244:247], v[196:199], v[80:95]
  v_exp_f32 v211, v131
  v_add_f32 v30, v30, v28
  v_add_f32 v27, v27, v210
  v_mfma_f32_32x32x16_bf16 v[96:111], a[248:251], v[196:199], v[96:111]
  s_mov_b32 s35, 0x60000
  v_exp_f32 v212, v132
  v_add_f32 v27, v27, v211
  v_cvt_pk_bf16_f32 v193, v210, v211
  v_mfma_f32_32x32x16_bf16 v[112:127], a[252:255], v[196:199], v[112:127]
  v_exp_f32 v213, v133
  v_add_f32 v27, v27, v212
  v_mfma_f32_32x32x16_bf16 v[144:159], a[192:195], a[8:11], v[176:191]
  v_exp_f32 v214, v134
  v_add_f32 v27, v27, v213
  v_cvt_pk_bf16_f32 v194, v212, v213
  v_mfma_f32_32x32x16_bf16 v[144:159], a[196:199], a[12:15], v[144:159]
  ds_read_b128 a[192:195], v8 offset:24576
  v_exp_f32 v215, v135
  v_add_f32 v27, v27, v214
  v_mfma_f32_32x32x16_bf16 v[144:159], a[200:203], a[24:27], v[144:159]
  ds_read_b128 a[196:199], v9 offset:24576
  v_exp_f32 v208, v136
  v_add_f32 v27, v27, v215
  v_cvt_pk_bf16_f32 v195, v214, v215
  v_mfma_f32_32x32x16_bf16 v[144:159], a[204:207], a[28:31], v[144:159]
  ds_read_b128 a[200:203], v10 offset:24576
  v_exp_f32 v209, v137
  v_add_f32 v27, v27, v208
  v_mfma_f32_32x32x16_bf16 v[144:159], a[208:211], a[40:43], v[144:159]
  ds_read_b128 a[204:207], v11 offset:24576
  v_exp_f32 v210, v138
  v_add_f32 v27, v27, v209
  v_cvt_pk_bf16_f32 v196, v208, v209
  v_mfma_f32_32x32x16_bf16 v[144:159], a[212:215], a[44:47], v[144:159]
  ds_read_b128 a[208:211], v12 offset:24576
  v_exp_f32 v211, v139
  v_add_f32 v27, v27, v210
  v_mfma_f32_32x32x16_bf16 v[144:159], a[216:219], a[56:59], v[144:159]
  ds_read_b128 a[212:215], v13 offset:24576
  v_exp_f32 v212, v140
  v_add_f32 v27, v27, v211
  v_cvt_pk_bf16_f32 v197, v210, v211
  v_mfma_f32_32x32x16_bf16 v[144:159], a[220:223], a[60:63], v[144:159]
  ds_read_b128 a[216:219], v14 offset:24576
  v_exp_f32 v213, v141
  v_add_f32 v27, v27, v212
  s_add_u32 m0, s29, 0xe000
  v_mfma_f32_32x32x16_bf16 a[64:79], a[224:227], v[200:203], a[64:79]
  ds_read_b128 a[220:223], v15 offset:24576
  buffer_load_dwordx4 v20, s[12:15], s27 offen offset:0 nt lds
  v_exp_f32 v214, v142
  v_add_f32 v27, v27, v213
  v_cvt_pk_bf16_f32 v198, v212, v213
  v_mfma_f32_32x32x16_bf16 a[80:95], a[228:231], v[200:203], a[80:95]
  ds_read_b64_tr_b16 a[224:225], v16 offset:16384
  ds_read_b64_tr_b16 a[226:227], v16 offset:18432
  v_exp_f32 v215, v143
  v_add_f32 v27, v27, v214
  v_mfma_f32_32x32x16_bf16 a[96:111], a[232:235], v[200:203], a[96:111]
  ds_read_b64_tr_b16 a[228:229], v17 offset:16384
  buffer_load_dwordx4 v21, s[12:15], s27 offen offset:1024 nt lds
  v_exp_f32 v216, v144
  v_add_f32 v27, v27, v215
  v_cvt_pk_bf16_f32 v199, v214, v215
  v_mfma_f32_32x32x16_bf16 a[112:127], a[236:239], v[200:203], a[112:127]
  ds_read_b64_tr_b16 a[230:231], v17 offset:18432
  ds_read_b64_tr_b16 a[232:233], v18 offset:16384
  v_exp_f32 v217, v145
  v_cmp_nge_f32 vcc, 0x47800000, v27
  s_add_u32 m0, s29, 0x1c000
  v_mfma_f32_32x32x16_bf16 a[64:79], a[240:243], v[204:207], a[64:79]
  ds_read_b64_tr_b16 a[234:235], v18 offset:18432
  buffer_load_dwordx4 v22, s[16:19], s27 offen offset:0 nt lds
  s_cbranch_vccnz L1_caJ57
L1_raJ57:
  v_exp_f32 v218, v146
  v_add_f32 v28, v216, v217
  v_cvt_pk_bf16_f32 v200, v216, v217
  v_mfma_f32_32x32x16_bf16 a[80:95], a[244:247], v[204:207], a[80:95]
  ds_read_b64_tr_b16 a[236:237], v19 offset:16384
  v_exp_f32 v219, v147
  v_add_f32 v28, v28, v218
  v_add_f32 v29, v29, v27
  v_mfma_f32_32x32x16_bf16 a[96:111], a[248:251], v[204:207], a[96:111]
  ds_read_b64_tr_b16 a[238:239], v19 offset:18432
  buffer_load_dwordx4 v22, s[16:19], s27 offen offset:1024 nt lds
  v_exp_f32 v220, v148
  v_add_f32 v28, v28, v219
  v_cvt_pk_bf16_f32 v201, v218, v219
  v_mfma_f32_32x32x16_bf16 a[112:127], a[252:255], v[204:207], a[112:127]
  ds_read_b64_tr_b16 a[240:241], v16 offset:20480
  ds_read_b64_tr_b16 a[242:243], v16 offset:22528
  v_exp_f32 v221, v149
  v_add_f32 v28, v28, v220
  s_waitcnt lgkmcnt(10)
  v_mfma_f32_32x32x16_bf16 v[128:143], a[192:195], a[0:3], v[160:175]
  v_exp_f32 v222, v150
  v_add_f32 v28, v28, v221
  v_cvt_pk_bf16_f32 v202, v220, v221
  v_mfma_f32_32x32x16_bf16 v[128:143], a[196:199], a[4:7], v[128:143]
  ds_read_b64_tr_b16 a[244:245], v17 offset:20480
  ds_read_b64_tr_b16 a[246:247], v17 offset:22528
  v_exp_f32 v223, v151
  v_add_f32 v28, v28, v222
  v_mfma_f32_32x32x16_bf16 v[128:143], a[200:203], a[16:19], v[128:143]
  ds_read_b64_tr_b16 a[248:249], v18 offset:20480
  s_add_u32 s27, s27, 0x2000
  v_exp_f32 v216, v152
  v_add_f32 v28, v28, v223
  v_cvt_pk_bf16_f32 v203, v222, v223
  v_mfma_f32_32x32x16_bf16 v[128:143], a[204:207], a[20:23], v[128:143]
  ds_read_b64_tr_b16 a[250:251], v18 offset:22528
  ds_read_b64_tr_b16 a[252:253], v19 offset:20480
  v_exp_f32 v217, v153
  v_add_f32 v28, v28, v216
  v_mfma_f32_32x32x16_bf16 v[128:143], a[208:211], a[32:35], v[128:143]
  ds_read_b64_tr_b16 a[254:255], v19 offset:22528
  v_exp_f32 v218, v154
  v_add_f32 v28, v28, v217
  v_cvt_pk_bf16_f32 v204, v216, v217
  v_mfma_f32_32x32x16_bf16 v[128:143], a[212:215], a[36:39], v[128:143]
  v_exp_f32 v219, v155
  v_add_f32 v28, v28, v218
  v_mfma_f32_32x32x16_bf16 v[128:143], a[216:219], a[48:51], v[128:143]
  v_exp_f32 v220, v156
  v_add_f32 v28, v28, v219
  v_cvt_pk_bf16_f32 v205, v218, v219
  v_mfma_f32_32x32x16_bf16 v[128:143], a[220:223], a[52:55], v[128:143]
  v_exp_f32 v221, v157
  v_add_f32 v28, v28, v220
  s_waitcnt lgkmcnt(0)
  v_mfma_f32_32x32x16_bf16 v[64:79], a[224:227], v[192:195], v[64:79]
  v_exp_f32 v222, v158
  v_add_f32 v28, v28, v221
  v_cvt_pk_bf16_f32 v206, v220, v221
  s_add_u32 m0, s29, 0x1e000
  v_mfma_f32_32x32x16_bf16 v[80:95], a[228:231], v[192:195], v[80:95]
  buffer_load_dwordx4 v22, s[16:19], s27 offen offset:0 nt lds
  v_exp_f32 v223, v159
  v_add_f32 v28, v28, v222
  v_mfma_f32_32x32x16_bf16 v[96:111], a[232:235], v[192:195], v[96:111]
  v_exp_f32 v208, v128
  v_add_f32 v28, v28, v223
  v_cvt_pk_bf16_f32 v207, v222, v223
  v_mfma_f32_32x32x16_bf16 v[112:127], a[236:239], v[192:195], v[112:127]
  buffer_load_dwordx4 v22, s[16:19], s27 offen offset:1024 nt lds
  v_exp_f32 v209, v129
  v_cmp_nge_f32 vcc, 0x47800000, v28
  v_mfma_f32_32x32x16_bf16 v[64:79], a[240:243], v[196:199], v[64:79]
  s_cbranch_vccnz L1_cbJ58
L1_rbJ58:
  v_exp_f32 v210, v130
  v_add_f32 v27, v208, v209
  v_cvt_pk_bf16_f32 v192, v208, v209
  v_mfma_f32_32x32x16_bf16 v[80:95], a[244:247], v[196:199], v[80:95]
  v_exp_f32 v211, v131
  v_add_f32 v30, v30, v28
  v_add_f32 v27, v27, v210
  v_mfma_f32_32x32x16_bf16 v[96:111], a[248:251], v[196:199], v[96:111]
  v_exp_f32 v212, v132
  v_add_f32 v27, v27, v211
  v_cvt_pk_bf16_f32 v193, v210, v211
  v_mfma_f32_32x32x16_bf16 v[112:127], a[252:255], v[196:199], v[112:127]
  v_exp_f32 v213, v133
  v_add_f32 v27, v27, v212
  v_mfma_f32_32x32x16_bf16 v[144:159], a[192:195], a[8:11], v[176:191]
  s_waitcnt vmcnt(11)
  s_barrier
  v_exp_f32 v214, v134
  v_add_f32 v27, v27, v213
  v_cvt_pk_bf16_f32 v194, v212, v213
  v_mfma_f32_32x32x16_bf16 v[144:159], a[196:199], a[12:15], v[144:159]
  s_waitcnt vmcnt(10)
  v_cmp_gt_u32 vcc, 16, v4
  ds_read_b128 a[192:195], v8 offset:32768
  v_exp_f32 v215, v135
  v_add_f32 v27, v27, v214
  v_mfma_f32_32x32x16_bf16 v[144:159], a[200:203], a[24:27], v[144:159]
  ds_read_b128 a[196:199], v9 offset:32768
  s_cbranch_vccnz L_spin0
L_spin0_ret:
  v_exp_f32 v208, v136
  v_add_f32 v27, v27, v215
  v_cvt_pk_bf16_f32 v195, v214, v215
  v_mfma_f32_32x32x16_bf16 v[144:159], a[204:207], a[28:31], v[144:159]
  ds_read_b128 a[200:203], v10 offset:32768
  v_exp_f32 v209, v137
  v_add_f32 v27, v27, v208
  s_mov_b32 s89, 0x0
  s_add_u32 m0, s90, 0x0
  v_mfma_f32_32x32x16_bf16 v[144:159], a[208:211], a[40:43], v[144:159]
  ds_read_b128 a[204:207], v11 offset:32768
  buffer_load_dwordx4 v48, s[80:83], s89 offen offset:0 lds
  v_exp_f32 v210, v138
  v_add_f32 v27, v27, v209
  v_cvt_pk_bf16_f32 v196, v208, v209
  v_mfma_f32_32x32x16_bf16 v[144:159], a[212:215], a[44:47], v[144:159]
  ds_read_b128 a[208:211], v12 offset:32768
  v_exp_f32 v211, v139
  v_add_f32 v27, v27, v210
  v_mfma_f32_32x32x16_bf16 v[144:159], a[216:219], a[56:59], v[144:159]
  ds_read_b128 a[212:215], v13 offset:32768
  buffer_load_dwordx4 v49, s[80:83], s89 offen offset:1024 lds
  v_exp_f32 v212, v140
  v_add_f32 v27, v27, v211
  v_cvt_pk_bf16_f32 v197, v210, v211
  v_mfma_f32_32x32x16_bf16 v[144:159], a[220:223], a[60:63], v[144:159]
  ds_read_b128 a[216:219], v14 offset:32768
  v_exp_f32 v213, v141
  v_add_f32 v27, v27, v212
  v_mfma_f32_32x32x16_bf16 a[64:79], a[224:227], v[200:203], a[64:79]
  ds_read_b128 a[220:223], v15 offset:32768
  buffer_load_dwordx4 v50, s[80:83], s89 offen offset:2048 lds
  v_exp_f32 v214, v142
  v_add_f32 v27, v27, v213
  v_cvt_pk_bf16_f32 v198, v212, v213
  v_mfma_f32_32x32x16_bf16 a[80:95], a[228:231], v[200:203], a[80:95]
  ds_read_b64_tr_b16 a[224:225], v16 offset:24576
  ds_read_b64_tr_b16 a[226:227], v16 offset:26624
  v_exp_f32 v215, v143
  v_add_f32 v27, v27, v214
  v_mfma_f32_32x32x16_bf16 a[96:111], a[232:235], v[200:203], a[96:111]
  ds_read_b64_tr_b16 a[228:229], v17 offset:24576
  buffer_load_dwordx4 v51, s[80:83], s89 offen offset:3072 lds
  v_exp_f32 v216, v144
  v_add_f32 v27, v27, v215
  v_cvt_pk_bf16_f32 v199, v214, v215
  v_mfma_f32_32x32x16_bf16 a[112:127], a[236:239], v[200:203], a[112:127]
  ds_read_b64_tr_b16 a[230:231], v17 offset:26624
  ds_read_b64_tr_b16 a[232:233], v18 offset:24576
  v_exp_f32 v217, v145
  v_cmp_nge_f32 vcc, 0x47800000, v27
  v_mfma_f32_32x32x16_bf16 a[64:79], a[240:243], v[204:207], a[64:79]
  ds_read_b64_tr_b16 a[234:235], v18 offset:26624
  s_cbranch_vccnz L1_caJ58
L1_raJ58:
  v_exp_f32 v218, v146
  v_add_f32 v28, v216, v217
  v_cvt_pk_bf16_f32 v200, v216, v217
  v_mfma_f32_32x32x16_bf16 a[80:95], a[244:247], v[204:207], a[80:95]
  ds_read_b64_tr_b16 a[236:237], v19 offset:24576
  v_exp_f32 v219, v147
  v_add_f32 v28, v28, v218
  v_add_f32 v29, v29, v27
  v_mfma_f32_32x32x16_bf16 a[96:111], a[248:251], v[204:207], a[96:111]
  ds_read_b64_tr_b16 a[238:239], v19 offset:26624
  v_exp_f32 v220, v148
  v_add_f32 v28, v28, v219
  v_cvt_pk_bf16_f32 v201, v218, v219
  v_mfma_f32_32x32x16_bf16 a[112:127], a[252:255], v[204:207], a[112:127]
  ds_read_b64_tr_b16 a[240:241], v16 offset:28672
  ds_read_b64_tr_b16 a[242:243], v16 offset:30720
  v_exp_f32 v221, v149
  v_add_f32 v28, v28, v220
  s_waitcnt lgkmcnt(10)
  v_mfma_f32_32x32x16_bf16 v[128:143], a[192:195], a[0:3], v[160:175]
  v_exp_f32 v222, v150
  v_add_f32 v28, v28, v221
  v_cvt_pk_bf16_f32 v202, v220, v221
  v_mfma_f32_32x32x16_bf16 v[128:143], a[196:199], a[4:7], v[128:143]
  ds_read_b64_tr_b16 a[244:245], v17 offset:28672
  ds_read_b64_tr_b16 a[246:247], v17 offset:30720
  buffer_load_dwordx4 v[224:227], v52, s[76:79], s88 offen offset:0
  v_exp_f32 v223, v151
  v_add_f32 v28, v28, v222
  v_mfma_f32_32x32x16_bf16 v[128:143], a[200:203], a[16:19], v[128:143]
  ds_read_b64_tr_b16 a[248:249], v18 offset:28672
  v_exp_f32 v216, v152
  v_add_f32 v28, v28, v223
  v_cvt_pk_bf16_f32 v203, v222, v223
  v_mfma_f32_32x32x16_bf16 v[128:143], a[204:207], a[20:23], v[128:143]
  ds_read_b64_tr_b16 a[250:251], v18 offset:30720
  ds_read_b64_tr_b16 a[252:253], v19 offset:28672
  buffer_load_dwordx4 v[228:231], v53, s[76:79], s88 offen offset:0
  v_exp_f32 v217, v153
  v_add_f32 v28, v28, v216
  v_mfma_f32_32x32x16_bf16 v[128:143], a[208:211], a[32:35], v[128:143]
  ds_read_b64_tr_b16 a[254:255], v19 offset:30720
  v_exp_f32 v218, v154
  v_add_f32 v28, v28, v217
  v_cvt_pk_bf16_f32 v204, v216, v217
  v_mfma_f32_32x32x16_bf16 v[128:143], a[212:215], a[36:39], v[128:143]
  buffer_load_dwordx4 v[232:235], v52, s[76:79], s88 offen offset:1024
  v_exp_f32 v219, v155
  v_add_f32 v28, v28, v218
  v_mfma_f32_32x32x16_bf16 v[128:143], a[216:219], a[48:51], v[128:143]
  v_exp_f32 v220, v156
  v_add_f32 v28, v28, v219
  v_cvt_pk_bf16_f32 v205, v218, v219
  v_mfma_f32_32x32x16_bf16 v[128:143], a[220:223], a[52:55], v[128:143]
  buffer_load_dwordx4 v[236:239], v53, s[76:79], s88 offen offset:1024
  v_exp_f32 v221, v157
  v_add_f32 v28, v28, v220
  s_waitcnt lgkmcnt(0)
  v_mfma_f32_32x32x16_bf16 v[64:79], a[224:227], v[192:195], v[64:79]
  v_exp_f32 v222, v158
  v_add_f32 v28, v28, v221
  v_cvt_pk_bf16_f32 v206, v220, v221
  v_mfma_f32_32x32x16_bf16 v[80:95], a[228:231], v[192:195], v[80:95]
  buffer_load_dwordx4 v[240:243], v52, s[76:79], s88 offen offset:2048
  v_exp_f32 v223, v159
  v_add_f32 v28, v28, v222
  v_mfma_f32_32x32x16_bf16 v[96:111], a[232:235], v[192:195], v[96:111]
  v_exp_f32 v208, v128
  v_add_f32 v28, v28, v223
  v_cvt_pk_bf16_f32 v207, v222, v223
  v_mfma_f32_32x32x16_bf16 v[112:127], a[236:239], v[192:195], v[112:127]
  buffer_load_dwordx4 v[244:247], v53, s[76:79], s88 offen offset:2048
  v_exp_f32 v209, v129
  v_cmp_nge_f32 vcc, 0x47800000, v28
  v_mfma_f32_32x32x16_bf16 v[64:79], a[240:243], v[196:199], v[64:79]
  s_cbranch_vccnz L1_cbJ59
L1_rbJ59:
  v_exp_f32 v210, v130
  v_add_f32 v27, v208, v209
  v_cvt_pk_bf16_f32 v192, v208, v209
  v_mfma_f32_32x32x16_bf16 v[80:95], a[244:247], v[196:199], v[80:95]
  buffer_load_dwordx4 v[248:251], v52, s[76:79], s88 offen offset:3072
  v_exp_f32 v211, v131
  v_add_f32 v30, v30, v28
  v_add_f32 v27, v27, v210
  v_mfma_f32_32x32x16_bf16 v[96:111], a[248:251], v[196:199], v[96:111]
  v_exp_f32 v212, v132
  v_add_f32 v27, v27, v211
  v_cvt_pk_bf16_f32 v193, v210, v211
  v_mfma_f32_32x32x16_bf16 v[112:127], a[252:255], v[196:199], v[112:127]
  buffer_load_dwordx4 v[252:255], v53, s[76:79], s88 offen offset:3072
  v_exp_f32 v213, v133
  v_add_f32 v27, v27, v212
  v_mfma_f32_32x32x16_bf16 v[144:159], a[192:195], a[8:11], v[176:191]
  s_add_u32 s88, s88, 0x1000
  v_exp_f32 v214, v134
  v_add_f32 v27, v27, v213
  v_cvt_pk_bf16_f32 v194, v212, v213
  v_mfma_f32_32x32x16_bf16 v[144:159], a[196:199], a[12:15], v[144:159]
  ds_read_b128 a[192:195], v8 offset:40960
  v_exp_f32 v215, v135
  v_add_f32 v27, v27, v214
  s_mov_b32 s89, 0x20000
  s_add_u32 m0, s90, 0x4000
  v_mfma_f32_32x32x16_bf16 v[144:159], a[200:203], a[24:27], v[144:159]
  ds_read_b128 a[196:199], v9 offset:40960
  buffer_load_dwordx4 v48, s[80:83], s89 offen offset:0 lds
  v_exp_f32 v208, v136
  v_add_f32 v27, v27, v215
  v_cvt_pk_bf16_f32 v195, v214, v215
  v_mfma_f32_32x32x16_bf16 v[144:159], a[204:207], a[28:31], v[144:159]
  ds_read_b128 a[200:203], v10 offset:40960
  v_exp_f32 v209, v137
  v_add_f32 v27, v27, v208
  v_mfma_f32_32x32x16_bf16 v[144:159], a[208:211], a[40:43], v[144:159]
  ds_read_b128 a[204:207], v11 offset:40960
  buffer_load_dwordx4 v49, s[80:83], s89 offen offset:1024 lds
  v_exp_f32 v210, v138
  v_add_f32 v27, v27, v209
  v_cvt_pk_bf16_f32 v196, v208, v209
  v_mfma_f32_32x32x16_bf16 v[144:159], a[212:215], a[44:47], v[144:159]
  ds_read_b128 a[208:211], v12 offset:40960
  v_exp_f32 v211, v139
  v_add_f32 v27, v27, v210
  v_mfma_f32_32x32x16_bf16 v[144:159], a[216:219], a[56:59], v[144:159]
  ds_read_b128 a[212:215], v13 offset:40960
  buffer_load_dwordx4 v50, s[80:83], s89 offen offset:2048 lds
  v_exp_f32 v212, v140
  v_add_f32 v27, v27, v211
  v_cvt_pk_bf16_f32 v197, v210, v211
  v_mfma_f32_32x32x16_bf16 v[144:159], a[220:223], a[60:63], v[144:159]
  ds_read_b128 a[216:219], v14 offset:40960
  v_exp_f32 v213, v141
  v_add_f32 v27, v27, v212
  v_mfma_f32_32x32x16_bf16 a[64:79], a[224:227], v[200:203], a[64:79]
  ds_read_b128 a[220:223], v15 offset:40960
  buffer_load_dwordx4 v51, s[80:83], s89 offen offset:3072 lds
  v_exp_f32 v214, v142
  v_add_f32 v27, v27, v213
  v_cvt_pk_bf16_f32 v198, v212, v213
  v_mfma_f32_32x32x16_bf16 a[80:95], a[228:231], v[200:203], a[80:95]
  ds_read_b64_tr_b16 a[224:225], v16 offset:32768
  ds_read_b64_tr_b16 a[226:227], v16 offset:34816
  v_exp_f32 v215, v143
  v_add_f32 v27, v27, v214
  v_mfma_f32_32x32x16_bf16 a[96:111], a[232:235], v[200:203], a[96:111]
  ds_read_b64_tr_b16 a[228:229], v17 offset:32768
  v_exp_f32 v216, v144
  v_add_f32 v27, v27, v215
  v_cvt_pk_bf16_f32 v199, v214, v215
  v_mfma_f32_32x32x16_bf16 a[112:127], a[236:239], v[200:203], a[112:127]
  ds_read_b64_tr_b16 a[230:231], v17 offset:34816
  ds_read_b64_tr_b16 a[232:233], v18 offset:32768
  v_exp_f32 v217, v145
  v_cmp_nge_f32 vcc, 0x47800000, v27
  v_mfma_f32_32x32x16_bf16 a[64:79], a[240:243], v[204:207], a[64:79]
  ds_read_b64_tr_b16 a[234:235], v18 offset:34816
  s_cbranch_vccnz L1_caJ59
L1_raJ59:
  v_exp_f32 v218, v146
  v_add_f32 v28, v216, v217
  v_cvt_pk_bf16_f32 v200, v216, v217
  v_mfma_f32_32x32x16_bf16 a[80:95], a[244:247], v[204:207], a[80:95]
  ds_read_b64_tr_b16 a[236:237], v19 offset:32768
  v_exp_f32 v219, v147
  v_add_f32 v28, v28, v218
  v_add_f32 v29, v29, v27
  v_mfma_f32_32x32x16_bf16 a[96:111], a[248:251], v[204:207], a[96:111]
  ds_read_b64_tr_b16 a[238:239], v19 offset:34816
  v_exp_f32 v220, v148
  v_add_f32 v28, v28, v219
  v_cvt_pk_bf16_f32 v201, v218, v219
  v_mfma_f32_32x32x16_bf16 a[112:127], a[252:255], v[204:207], a[112:127]
  ds_read_b64_tr_b16 a[240:241], v16 offset:36864
  ds_read_b64_tr_b16 a[242:243], v16 offset:38912
  v_exp_f32 v221, v149
  v_add_f32 v28, v28, v220
  s_waitcnt lgkmcnt(10)
  v_mfma_f32_32x32x16_bf16 v[128:143], a[192:195], a[0:3], v[160:175]
  v_exp_f32 v222, v150
  v_add_f32 v28, v28, v221
  v_cvt_pk_bf16_f32 v202, v220, v221
  v_mfma_f32_32x32x16_bf16 v[128:143], a[196:199], a[4:7], v[128:143]
  ds_read_b64_tr_b16 a[244:245], v17 offset:36864
  ds_read_b64_tr_b16 a[246:247], v17 offset:38912
  v_exp_f32 v223, v151
  v_add_f32 v28, v28, v222
  v_mfma_f32_32x32x16_bf16 v[128:143], a[200:203], a[16:19], v[128:143]
  ds_read_b64_tr_b16 a[248:249], v18 offset:36864
  v_exp_f32 v216, v152
  v_add_f32 v28, v28, v223
  v_cvt_pk_bf16_f32 v203, v222, v223
  v_mfma_f32_32x32x16_bf16 v[128:143], a[204:207], a[20:23], v[128:143]
  ds_read_b64_tr_b16 a[250:251], v18 offset:38912
  ds_read_b64_tr_b16 a[252:253], v19 offset:36864
  v_exp_f32 v217, v153
  v_add_f32 v28, v28, v216
  v_mfma_f32_32x32x16_bf16 v[128:143], a[208:211], a[32:35], v[128:143]
  ds_read_b64_tr_b16 a[254:255], v19 offset:38912
  v_exp_f32 v218, v154
  v_add_f32 v28, v28, v217
  v_cvt_pk_bf16_f32 v204, v216, v217
  v_mfma_f32_32x32x16_bf16 v[128:143], a[212:215], a[36:39], v[128:143]
  v_exp_f32 v219, v155
  v_add_f32 v28, v28, v218
  v_mfma_f32_32x32x16_bf16 v[128:143], a[216:219], a[48:51], v[128:143]
  v_exp_f32 v220, v156
  v_add_f32 v28, v28, v219
  v_cvt_pk_bf16_f32 v205, v218, v219
  v_mfma_f32_32x32x16_bf16 v[128:143], a[220:223], a[52:55], v[128:143]
  v_exp_f32 v221, v157
  v_add_f32 v28, v28, v220
  s_waitcnt lgkmcnt(0)
  v_mfma_f32_32x32x16_bf16 v[64:79], a[224:227], v[192:195], v[64:79]
  v_exp_f32 v222, v158
  v_add_f32 v28, v28, v221
  v_cvt_pk_bf16_f32 v206, v220, v221
  v_mfma_f32_32x32x16_bf16 v[80:95], a[228:231], v[192:195], v[80:95]
  v_exp_f32 v223, v159
  v_add_f32 v28, v28, v222
  v_mfma_f32_32x32x16_bf16 v[96:111], a[232:235], v[192:195], v[96:111]
  v_exp_f32 v208, v128
  v_add_f32 v28, v28, v223
  v_cvt_pk_bf16_f32 v207, v222, v223
  v_mfma_f32_32x32x16_bf16 v[112:127], a[236:239], v[192:195], v[112:127]
  v_exp_f32 v209, v129
  v_cmp_nge_f32 vcc, 0x47800000, v28
  v_mfma_f32_32x32x16_bf16 v[64:79], a[240:243], v[196:199], v[64:79]
  s_cbranch_vccnz L1_cbJ60
L1_rbJ60:
  v_exp_f32 v210, v130
  v_add_f32 v27, v208, v209
  v_cvt_pk_bf16_f32 v192, v208, v209
  v_mfma_f32_32x32x16_bf16 v[80:95], a[244:247], v[196:199], v[80:95]
  v_exp_f32 v211, v131
  v_add_f32 v30, v30, v28
  v_add_f32 v27, v27, v210
  v_mfma_f32_32x32x16_bf16 v[96:111], a[248:251], v[196:199], v[96:111]
  v_exp_f32 v212, v132
  v_add_f32 v27, v27, v211
  v_cvt_pk_bf16_f32 v193, v210, v211
  v_mfma_f32_32x32x16_bf16 v[112:127], a[252:255], v[196:199], v[112:127]
  v_exp_f32 v213, v133
  v_add_f32 v27, v27, v212
  v_mfma_f32_32x32x16_bf16 v[144:159], a[192:195], a[8:11], v[176:191]
  s_waitcnt vmcnt(18)
  s_barrier
  v_exp_f32 v214, v134
  v_add_f32 v27, v27, v213
  v_cvt_pk_bf16_f32 v194, v212, v213
  v_mfma_f32_32x32x16_bf16 v[144:159], a[196:199], a[12:15], v[144:159]
  ds_read_b128 a[192:195], v8 offset:49152
  v_exp_f32 v215, v135
  v_add_f32 v27, v27, v214
  s_mov_b32 s89, 0x80000
  s_add_u32 m0, s90, 0x8000
  v_mfma_f32_32x32x16_bf16 v[144:159], a[200:203], a[24:27], v[144:159]
  ds_read_b128 a[196:199], v9 offset:49152
  buffer_load_dwordx4 v48, s[80:83], s89 offen offset:0 lds
  v_exp_f32 v208, v136
  v_add_f32 v27, v27, v215
  v_cvt_pk_bf16_f32 v195, v214, v215
  v_mfma_f32_32x32x16_bf16 v[144:159], a[204:207], a[28:31], v[144:159]
  ds_read_b128 a[200:203], v10 offset:49152
  v_exp_f32 v209, v137
  v_add_f32 v27, v27, v208
  v_mfma_f32_32x32x16_bf16 v[144:159], a[208:211], a[40:43], v[144:159]
  ds_read_b128 a[204:207], v11 offset:49152
  buffer_load_dwordx4 v49, s[80:83], s89 offen offset:1024 lds
  v_exp_f32 v210, v138
  v_add_f32 v27, v27, v209
  v_cvt_pk_bf16_f32 v196, v208, v209
  v_mfma_f32_32x32x16_bf16 v[144:159], a[212:215], a[44:47], v[144:159]
  ds_read_b128 a[208:211], v12 offset:49152
  v_exp_f32 v211, v139
  v_add_f32 v27, v27, v210
  v_mfma_f32_32x32x16_bf16 v[144:159], a[216:219], a[56:59], v[144:159]
  ds_read_b128 a[212:215], v13 offset:49152
  buffer_load_dwordx4 v50, s[80:83], s89 offen offset:2048 lds
  v_exp_f32 v212, v140
  v_add_f32 v27, v27, v211
  v_cvt_pk_bf16_f32 v197, v210, v211
  v_mfma_f32_32x32x16_bf16 v[144:159], a[220:223], a[60:63], v[144:159]
  ds_read_b128 a[216:219], v14 offset:49152
  v_exp_f32 v213, v141
  v_add_f32 v27, v27, v212
  v_mfma_f32_32x32x16_bf16 a[64:79], a[224:227], v[200:203], a[64:79]
  ds_read_b128 a[220:223], v15 offset:49152
  buffer_load_dwordx4 v51, s[80:83], s89 offen offset:3072 lds
  v_exp_f32 v214, v142
  v_add_f32 v27, v27, v213
  v_cvt_pk_bf16_f32 v198, v212, v213
  v_mfma_f32_32x32x16_bf16 a[80:95], a[228:231], v[200:203], a[80:95]
  ds_read_b64_tr_b16 a[224:225], v16 offset:40960
  ds_read_b64_tr_b16 a[226:227], v16 offset:43008
  v_exp_f32 v215, v143
  v_add_f32 v27, v27, v214
  v_mfma_f32_32x32x16_bf16 a[96:111], a[232:235], v[200:203], a[96:111]
  ds_read_b64_tr_b16 a[228:229], v17 offset:40960
  v_exp_f32 v216, v144
  v_add_f32 v27, v27, v215
  v_cvt_pk_bf16_f32 v199, v214, v215
  v_mfma_f32_32x32x16_bf16 a[112:127], a[236:239], v[200:203], a[112:127]
  ds_read_b64_tr_b16 a[230:231], v17 offset:43008
  ds_read_b64_tr_b16 a[232:233], v18 offset:40960
  v_exp_f32 v217, v145
  v_cmp_nge_f32 vcc, 0x47800000, v27
  v_mfma_f32_32x32x16_bf16 a[64:79], a[240:243], v[204:207], a[64:79]
  ds_read_b64_tr_b16 a[234:235], v18 offset:43008
  s_cbranch_vccnz L1_caJ60
L1_raJ60:
  v_exp_f32 v218, v146
  v_add_f32 v28, v216, v217
  v_cvt_pk_bf16_f32 v200, v216, v217
  v_mfma_f32_32x32x16_bf16 a[80:95], a[244:247], v[204:207], a[80:95]
  ds_read_b64_tr_b16 a[236:237], v19 offset:40960
  v_exp_f32 v219, v147
  v_add_f32 v28, v28, v218
  v_add_f32 v29, v29, v27
  v_mfma_f32_32x32x16_bf16 a[96:111], a[248:251], v[204:207], a[96:111]
  ds_read_b64_tr_b16 a[238:239], v19 offset:43008
  v_exp_f32 v220, v148
  v_add_f32 v28, v28, v219
  v_cvt_pk_bf16_f32 v201, v218, v219
  v_mfma_f32_32x32x16_bf16 a[112:127], a[252:255], v[204:207], a[112:127]
  ds_read_b64_tr_b16 a[240:241], v16 offset:45056
  ds_read_b64_tr_b16 a[242:243], v16 offset:47104
  v_exp_f32 v221, v149
  v_add_f32 v28, v28, v220
  s_waitcnt lgkmcnt(10)
  v_mfma_f32_32x32x16_bf16 v[128:143], a[192:195], a[0:3], v[160:175]
  v_exp_f32 v222, v150
  v_add_f32 v28, v28, v221
  v_cvt_pk_bf16_f32 v202, v220, v221
  v_mfma_f32_32x32x16_bf16 v[128:143], a[196:199], a[4:7], v[128:143]
  ds_read_b64_tr_b16 a[244:245], v17 offset:45056
  ds_read_b64_tr_b16 a[246:247], v17 offset:47104
  v_exp_f32 v223, v151
  v_add_f32 v28, v28, v222
  v_mfma_f32_32x32x16_bf16 v[128:143], a[200:203], a[16:19], v[128:143]
  ds_read_b64_tr_b16 a[248:249], v18 offset:45056
  v_exp_f32 v216, v152
  v_add_f32 v28, v28, v223
  v_cvt_pk_bf16_f32 v203, v222, v223
  v_mfma_f32_32x32x16_bf16 v[128:143], a[204:207], a[20:23], v[128:143]
  ds_read_b64_tr_b16 a[250:251], v18 offset:47104
  ds_read_b64_tr_b16 a[252:253], v19 offset:45056
  v_exp_f32 v217, v153
  v_add_f32 v28, v28, v216
  v_mfma_f32_32x32x16_bf16 v[128:143], a[208:211], a[32:35], v[128:143]
  ds_read_b64_tr_b16 a[254:255], v19 offset:47104
  v_exp_f32 v218, v154
  v_add_f32 v28, v28, v217
  v_cvt_pk_bf16_f32 v204, v216, v217
  v_mfma_f32_32x32x16_bf16 v[128:143], a[212:215], a[36:39], v[128:143]
  v_exp_f32 v219, v155
  v_add_f32 v28, v28, v218
  v_mfma_f32_32x32x16_bf16 v[128:143], a[216:219], a[48:51], v[128:143]
  v_exp_f32 v220, v156
  v_add_f32 v28, v28, v219
  v_cvt_pk_bf16_f32 v205, v218, v219
  v_mfma_f32_32x32x16_bf16 v[128:143], a[220:223], a[52:55], v[128:143]
  v_exp_f32 v221, v157
  v_add_f32 v28, v28, v220
  s_waitcnt lgkmcnt(0)
  v_mfma_f32_32x32x16_bf16 v[64:79], a[224:227], v[192:195], v[64:79]
  v_exp_f32 v222, v158
  v_add_f32 v28, v28, v221
  v_cvt_pk_bf16_f32 v206, v220, v221
  v_mfma_f32_32x32x16_bf16 v[80:95], a[228:231], v[192:195], v[80:95]
  v_exp_f32 v223, v159
  v_add_f32 v28, v28, v222
  v_mfma_f32_32x32x16_bf16 v[96:111], a[232:235], v[192:195], v[96:111]
  v_exp_f32 v208, v128
  v_add_f32 v28, v28, v223
  v_cvt_pk_bf16_f32 v207, v222, v223
  v_mfma_f32_32x32x16_bf16 v[112:127], a[236:239], v[192:195], v[112:127]
  v_exp_f32 v209, v129
  v_cmp_nge_f32 vcc, 0x47800000, v28
  v_mfma_f32_32x32x16_bf16 v[64:79], a[240:243], v[196:199], v[64:79]
  s_cbranch_vccnz L1_cbJ61
L1_rbJ61:
  v_exp_f32 v210, v130
  v_add_f32 v27, v208, v209
  v_cvt_pk_bf16_f32 v192, v208, v209
  v_mfma_f32_32x32x16_bf16 v[80:95], a[244:247], v[196:199], v[80:95]
  v_exp_f32 v211, v131
  v_add_f32 v30, v30, v28
  v_add_f32 v27, v27, v210
  v_mfma_f32_32x32x16_bf16 v[96:111], a[248:251], v[196:199], v[96:111]
  v_exp_f32 v212, v132
  v_add_f32 v27, v27, v211
  v_cvt_pk_bf16_f32 v193, v210, v211
  v_mfma_f32_32x32x16_bf16 v[112:127], a[252:255], v[196:199], v[112:127]
  v_exp_f32 v213, v133
  v_add_f32 v27, v27, v212
  v_mfma_f32_32x32x16_bf16 v[144:159], a[192:195], a[8:11], v[176:191]
  v_exp_f32 v214, v134
  v_add_f32 v27, v27, v213
  v_cvt_pk_bf16_f32 v194, v212, v213
  v_mfma_f32_32x32x16_bf16 v[144:159], a[196:199], a[12:15], v[144:159]
  ds_read_b128 a[192:195], v8 offset:57344
  v_exp_f32 v215, v135
  v_add_f32 v27, v27, v214
  v_mfma_f32_32x32x16_bf16 v[144:159], a[200:203], a[24:27], v[144:159]
  ds_read_b128 a[196:199], v9 offset:57344
  v_exp_f32 v208, v136
  v_add_f32 v27, v27, v215
  v_cvt_pk_bf16_f32 v195, v214, v215
  v_mfma_f32_32x32x16_bf16 v[144:159], a[204:207], a[28:31], v[144:159]
  ds_read_b128 a[200:203], v10 offset:57344
  v_exp_f32 v209, v137
  v_add_f32 v27, v27, v208
  v_mfma_f32_32x32x16_bf16 v[144:159], a[208:211], a[40:43], v[144:159]
  ds_read_b128 a[204:207], v11 offset:57344
  v_exp_f32 v210, v138
  v_add_f32 v27, v27, v209
  v_cvt_pk_bf16_f32 v196, v208, v209
  v_mfma_f32_32x32x16_bf16 v[144:159], a[212:215], a[44:47], v[144:159]
  ds_read_b128 a[208:211], v12 offset:57344
  v_exp_f32 v211, v139
  v_add_f32 v27, v27, v210
  v_mfma_f32_32x32x16_bf16 v[144:159], a[216:219], a[56:59], v[144:159]
  ds_read_b128 a[212:215], v13 offset:57344
  v_exp_f32 v212, v140
  v_add_f32 v27, v27, v211
  v_cvt_pk_bf16_f32 v197, v210, v211
  v_mfma_f32_32x32x16_bf16 v[144:159], a[220:223], a[60:63], v[144:159]
  ds_read_b128 a[216:219], v14 offset:57344
  v_exp_f32 v213, v141
  v_add_f32 v27, v27, v212
  v_mfma_f32_32x32x16_bf16 a[64:79], a[224:227], v[200:203], a[64:79]
  ds_read_b128 a[220:223], v15 offset:57344
  v_exp_f32 v214, v142
  v_add_f32 v27, v27, v213
  v_cvt_pk_bf16_f32 v198, v212, v213
  v_mfma_f32_32x32x16_bf16 a[80:95], a[228:231], v[200:203], a[80:95]
  ds_read_b64_tr_b16 a[224:225], v16 offset:49152
  ds_read_b64_tr_b16 a[226:227], v16 offset:51200
  v_exp_f32 v215, v143
  v_add_f32 v27, v27, v214
  v_mfma_f32_32x32x16_bf16 a[96:111], a[232:235], v[200:203], a[96:111]
  ds_read_b64_tr_b16 a[228:229], v17 offset:49152
  v_exp_f32 v216, v144
  v_add_f32 v27, v27, v215
  v_cvt_pk_bf16_f32 v199, v214, v215
  v_mfma_f32_32x32x16_bf16 a[112:127], a[236:239], v[200:203], a[112:127]
  ds_read_b64_tr_b16 a[230:231], v17 offset:51200
  ds_read_b64_tr_b16 a[232:233], v18 offset:49152
  v_exp_f32 v217, v145
  v_cmp_nge_f32 vcc, 0x47800000, v27
  v_mfma_f32_32x32x16_bf16 a[64:79], a[240:243], v[204:207], a[64:79]
  ds_read_b64_tr_b16 a[234:235], v18 offset:51200
  s_cbranch_vccnz L1_caJ61
L1_raJ61:
  v_exp_f32 v218, v146
  v_add_f32 v28, v216, v217
  v_cvt_pk_bf16_f32 v200, v216, v217
  v_mfma_f32_32x32x16_bf16 a[80:95], a[244:247], v[204:207], a[80:95]
  ds_read_b64_tr_b16 a[236:237], v19 offset:49152
  v_exp_f32 v219, v147
  v_add_f32 v28, v28, v218
  v_add_f32 v29, v29, v27
  v_mfma_f32_32x32x16_bf16 a[96:111], a[248:251], v[204:207], a[96:111]
  ds_read_b64_tr_b16 a[238:239], v19 offset:51200
  v_exp_f32 v220, v148
  v_add_f32 v28, v28, v219
  v_cvt_pk_bf16_f32 v201, v218, v219
  v_mfma_f32_32x32x16_bf16 a[112:127], a[252:255], v[204:207], a[112:127]
  ds_read_b64_tr_b16 a[240:241], v16 offset:53248
  ds_read_b64_tr_b16 a[242:243], v16 offset:55296
  v_exp_f32 v221, v149
  v_add_f32 v28, v28, v220
  s_waitcnt lgkmcnt(10)
  v_mfma_f32_32x32x16_bf16 v[128:143], a[192:195], a[0:3], v[160:175]
  v_exp_f32 v222, v150
  v_add_f32 v28, v28, v221
  v_cvt_pk_bf16_f32 v202, v220, v221
  v_mfma_f32_32x32x16_bf16 v[128:143], a[196:199], a[4:7], v[128:143]
  ds_read_b64_tr_b16 a[244:245], v17 offset:53248
  ds_read_b64_tr_b16 a[246:247], v17 offset:55296
  v_exp_f32 v223, v151
  v_add_f32 v28, v28, v222
  v_mfma_f32_32x32x16_bf16 v[128:143], a[200:203], a[16:19], v[128:143]
  ds_read_b64_tr_b16 a[248:249], v18 offset:53248
  v_exp_f32 v216, v152
  v_add_f32 v28, v28, v223
  v_cvt_pk_bf16_f32 v203, v222, v223
  v_mfma_f32_32x32x16_bf16 v[128:143], a[204:207], a[20:23], v[128:143]
  ds_read_b64_tr_b16 a[250:251], v18 offset:55296
  ds_read_b64_tr_b16 a[252:253], v19 offset:53248
  v_exp_f32 v217, v153
  v_add_f32 v28, v28, v216
  v_mfma_f32_32x32x16_bf16 v[128:143], a[208:211], a[32:35], v[128:143]
  ds_read_b64_tr_b16 a[254:255], v19 offset:55296
  v_exp_f32 v218, v154
  v_add_f32 v28, v28, v217
  v_cvt_pk_bf16_f32 v204, v216, v217
  v_mfma_f32_32x32x16_bf16 v[128:143], a[212:215], a[36:39], v[128:143]
  v_exp_f32 v219, v155
  v_add_f32 v28, v28, v218
  v_mfma_f32_32x32x16_bf16 v[128:143], a[216:219], a[48:51], v[128:143]
  v_exp_f32 v220, v156
  v_add_f32 v28, v28, v219
  v_cvt_pk_bf16_f32 v205, v218, v219
  v_mfma_f32_32x32x16_bf16 v[128:143], a[220:223], a[52:55], v[128:143]
  v_exp_f32 v221, v157
  v_add_f32 v28, v28, v220
  s_waitcnt lgkmcnt(0)
  v_mfma_f32_32x32x16_bf16 v[64:79], a[224:227], v[192:195], v[64:79]
  v_exp_f32 v222, v158
  v_add_f32 v28, v28, v221
  v_cvt_pk_bf16_f32 v206, v220, v221
  v_mfma_f32_32x32x16_bf16 v[80:95], a[228:231], v[192:195], v[80:95]
  v_exp_f32 v223, v159
  v_add_f32 v28, v28, v222
  v_mfma_f32_32x32x16_bf16 v[96:111], a[232:235], v[192:195], v[96:111]
  v_exp_f32 v208, v128
  v_add_f32 v28, v28, v223
  v_cvt_pk_bf16_f32 v207, v222, v223
  v_mfma_f32_32x32x16_bf16 v[112:127], a[236:239], v[192:195], v[112:127]
  v_exp_f32 v209, v129
  v_cmp_nge_f32 vcc, 0x47800000, v28
  v_mfma_f32_32x32x16_bf16 v[64:79], a[240:243], v[196:199], v[64:79]
  s_cbranch_vccnz L1_cbJ62
L1_rbJ62:
  v_exp_f32 v210, v130
  v_add_f32 v27, v208, v209
  v_cvt_pk_bf16_f32 v192, v208, v209
  v_mfma_f32_32x32x16_bf16 v[80:95], a[244:247], v[196:199], v[80:95]
  v_exp_f32 v211, v131
  v_add_f32 v30, v30, v28
  v_add_f32 v27, v27, v210
  v_mfma_f32_32x32x16_bf16 v[96:111], a[248:251], v[196:199], v[96:111]
  v_exp_f32 v212, v132
  v_add_f32 v27, v27, v211
  v_cvt_pk_bf16_f32 v193, v210, v211
  v_mfma_f32_32x32x16_bf16 v[112:127], a[252:255], v[196:199], v[112:127]
  v_exp_f32 v213, v133
  v_add_f32 v27, v27, v212
  v_mfma_f32_32x32x16_bf16 v[144:159], a[192:195], a[8:11], v[176:191]
  s_waitcnt vmcnt(16)
  s_barrier
  v_exp_f32 v214, v134
  v_add_f32 v27, v27, v213
  v_cvt_pk_bf16_f32 v194, v212, v213
  v_mfma_f32_32x32x16_bf16 v[144:159], a[196:199], a[12:15], v[144:159]
  v_exp_f32 v215, v135
  v_add_f32 v27, v27, v214
  s_mov_b32 s89, 0xa0000
  s_add_u32 m0, s90, 0xc000
  v_mfma_f32_32x32x16_bf16 v[144:159], a[200:203], a[24:27], v[144:159]
  buffer_load_dwordx4 v48, s[80:83], s89 offen offset:0 lds
  v_exp_f32 v208, v136
  v_add_f32 v27, v27, v215
  v_cvt_pk_bf16_f32 v195, v214, v215
  v_mfma_f32_32x32x16_bf16 v[144:159], a[204:207], a[28:31], v[144:159]
  v_exp_f32 v209, v137
  v_add_f32 v27, v27, v208
  v_mfma_f32_32x32x16_bf16 v[144:159], a[208:211], a[40:43], v[144:159]
  buffer_load_dwordx4 v49, s[80:83], s89 offen offset:1024 lds
  v_exp_f32 v210, v138
  v_add_f32 v27, v27, v209
  v_cvt_pk_bf16_f32 v196, v208, v209
  v_mfma_f32_32x32x16_bf16 v[144:159], a[212:215], a[44:47], v[144:159]
  v_exp_f32 v211, v139
  v_add_f32 v27, v27, v210
  v_mfma_f32_32x32x16_bf16 v[144:159], a[216:219], a[56:59], v[144:159]
  v_exp_f32 v212, v140
  v_add_f32 v27, v27, v211
  v_cvt_pk_bf16_f32 v197, v210, v211
  v_mfma_f32_32x32x16_bf16 v[144:159], a[220:223], a[60:63], v[144:159]
  v_exp_f32 v213, v141
  v_add_f32 v27, v27, v212
  v_mfma_f32_32x32x16_bf16 a[64:79], a[224:227], v[200:203], a[64:79]
  v_exp_f32 v214, v142
  v_add_f32 v27, v27, v213
  v_cvt_pk_bf16_f32 v198, v212, v213
  v_mfma_f32_32x32x16_bf16 a[80:95], a[228:231], v[200:203], a[80:95]
  ds_read_b64_tr_b16 a[224:225], v16 offset:57344
  ds_read_b64_tr_b16 a[226:227], v16 offset:59392
  v_exp_f32 v215, v143
  v_add_f32 v27, v27, v214
  v_mfma_f32_32x32x16_bf16 a[96:111], a[232:235], v[200:203], a[96:111]
  ds_read_b64_tr_b16 a[228:229], v17 offset:57344
  v_exp_f32 v216, v144
  v_add_f32 v27, v27, v215
  v_cvt_pk_bf16_f32 v199, v214, v215
  v_mfma_f32_32x32x16_bf16 a[112:127], a[236:239], v[200:203], a[112:127]
  ds_read_b64_tr_b16 a[230:231], v17 offset:59392
  ds_read_b64_tr_b16 a[232:233], v18 offset:57344
  v_exp_f32 v217, v145
  v_cmp_nge_f32 vcc, 0x47800000, v27
  v_mfma_f32_32x32x16_bf16 a[64:79], a[240:243], v[204:207], a[64:79]
  ds_read_b64_tr_b16 a[234:235], v18 offset:59392
  s_cbranch_vccnz L1_caJ62
L1_raJ62:
  v_exp_f32 v218, v146
  v_add_f32 v28, v216, v217
  v_cvt_pk_bf16_f32 v200, v216, v217
  v_mfma_f32_32x32x16_bf16 a[80:95], a[244:247], v[204:207], a[80:95]
  ds_read_b64_tr_b16 a[236:237], v19 offset:57344
  v_exp_f32 v219, v147
  v_add_f32 v28, v28, v218
  v_add_f32 v29, v29, v27
  v_mfma_f32_32x32x16_bf16 a[96:111], a[248:251], v[204:207], a[96:111]
  ds_read_b64_tr_b16 a[238:239], v19 offset:59392
  ds_read_b64_tr_b16 a[244:245], v17 offset:61440
  ds_read_b64_tr_b16 a[246:247], v17 offset:63488
  v_exp_f32 v220, v148
  v_add_f32 v28, v28, v219
  v_cvt_pk_bf16_f32 v201, v218, v219
  v_mfma_f32_32x32x16_bf16 a[112:127], a[252:255], v[204:207], a[112:127]
  ds_read_b64_tr_b16 a[240:241], v16 offset:61440
  ds_read_b64_tr_b16 a[242:243], v16 offset:63488
  ds_read_b64_tr_b16 a[248:249], v18 offset:61440
  ds_read_b64_tr_b16 a[250:251], v18 offset:63488
  v_exp_f32 v221, v149
  v_add_f32 v28, v28, v220
  s_waitcnt lgkmcnt(2)
  v_mfma_f32_32x32x16_bf16 v[64:79], a[224:227], v[192:195], v[64:79]
  ds_read_b64_tr_b16 a[252:253], v19 offset:61440
  ds_read_b64_tr_b16 a[254:255], v19 offset:63488
  v_exp_f32 v222, v150
  v_add_f32 v28, v28, v221
  v_cvt_pk_bf16_f32 v202, v220, v221
  v_mfma_f32_32x32x16_bf16 v[80:95], a[228:231], v[192:195], v[80:95]
  buffer_load_dwordx4 v[160:163], v52, s[76:79], s88 offen offset:0
  v_exp_f32 v223, v151
  v_add_f32 v28, v28, v222
  v_mov_b32 v4, v29
  v_mfma_f32_32x32x16_bf16 v[96:111], a[232:235], v[192:195], v[96:111]
  ds_read_b64_tr_b16 a[192:193], v32 offset:0
  ds_read_b64_tr_b16 a[194:195], v32 offset:1024
  v_exp_f32 v216, v152
  v_exp_f32 v217, v153
  v_add_f32 v28, v28, v223
  v_cvt_pk_bf16_f32 v203, v222, v223
  v_add_f32 v28, v28, v216
  v_mfma_f32_32x32x16_bf16 v[112:127], a[236:239], v[192:195], v[112:127]
  buffer_load_dwordx4 v[164:167], v53, s[76:79], s88 offen offset:0
  ds_read_b64_tr_b16 a[196:197], v33 offset:0
  ds_read_b64_tr_b16 a[198:199], v33 offset:1024
  v_exp_f32 v218, v154
  v_add_f32 v28, v28, v217
  v_cvt_pk_bf16_f32 v204, v216, v217
  v_mfma_f32_32x32x16_bf16 v[64:79], a[240:243], v[196:199], v[64:79]
  ds_read_b64_tr_b16 a[200:201], v34 offset:0
  ds_read_b64_tr_b16 a[202:203], v34 offset:1024
  v_exp_f32 v219, v155
  v_exp_f32 v220, v156
  v_add_f32 v28, v28, v218
  v_add_f32 v28, v28, v219
  v_cvt_pk_bf16_f32 v205, v218, v219
  s_waitcnt lgkmcnt(6)
  v_mfma_f32_32x32x16_bf16 v[80:95], a[244:247], v[196:199], v[80:95]
  ds_read_b64_tr_b16 a[204:205], v35 offset:0
  ds_read_b64_tr_b16 a[206:207], v35 offset:1024
  v_exp_f32 v221, v157
  v_add_f32 v28, v28, v220
  v_permlane32_swap_b32 v29, v4
  v_mfma_f32_32x32x16_bf16 v[96:111], a[248:251], v[196:199], v[96:111]
  ds_read_b64_tr_b16 a[208:209], v36 offset:0
  ds_read_b64_tr_b16 a[210:211], v36 offset:1024
  v_exp_f32 v222, v158
  v_exp_f32 v223, v159
  v_add_f32 v28, v28, v221
  v_cvt_pk_bf16_f32 v206, v220, v221
  v_add_f32 v28, v28, v222
  v_mfma_f32_32x32x16_bf16 v[112:127], a[252:255], v[196:199], v[112:127]
  ds_read_b64_tr_b16 a[212:213], v37 offset:0
  ds_read_b64_tr_b16 a[214:215], v37 offset:1024
  v_add_f32 v28, v28, v223
  v_cvt_pk_bf16_f32 v207, v222, v223
  v_cmp_nge_f32 vcc, 0x47800000, v28
  s_cbranch_vccnz L1_cbz
L1_rbz:
  v_mfma_f32_32x32x16_bf16 a[64:79], a[224:227], v[200:203], a[64:79]
  ds_read_b64_tr_b16 a[216:217], v38 offset:0
  ds_read_b64_tr_b16 a[218:219], v38 offset:1024
  v_add_f32 v30, v30, v28
  v_add_f32 v29, v29, v4
  v_rcp_f32 v29, v29
  v_mfma_f32_32x32x16_bf16 a[80:95], a[228:231], v[200:203], a[80:95]
  ds_read_b64_tr_b16 a[220:221], v39 offset:0
  ds_read_b64_tr_b16 a[222:223], v39 offset:1024
  v_mul_f32 v64, v64, v29
  v_mul_f32 v65, v65, v29
  v_mul_f32 v66, v66, v29
  v_mul_f32 v67, v67, v29
  v_mfma_f32_32x32x16_bf16 a[96:111], a[232:235], v[200:203], a[96:111]
  v_mul_f32 v68, v68, v29
  v_mul_f32 v69, v69, v29
  v_mul_f32 v70, v70, v29
  v_mul_f32 v71, v71, v29
  v_cvt_pk_bf16_f32 v64, v64, v65
  v_cvt_pk_bf16_f32 v65, v66, v67
  v_mfma_f32_32x32x16_bf16 a[112:127], a[236:239], v[200:203], a[112:127]
  v_cvt_pk_bf16_f32 v66, v68, v69
  v_cvt_pk_bf16_f32 v67, v70, v71
  v_mfma_f32_32x32x16_bf16 a[64:79], a[240:243], v[204:207], a[64:79]
  buffer_store_dwordx4 v[64:67], v23, s[20:23], s46 offen offset:0 sc1
  v_mul_f32 v72, v72, v29
  v_mul_f32 v73, v73, v29
  v_mul_f32 v74, v74, v29
  v_mul_f32 v75, v75, v29
  v_mfma_f32_32x32x16_bf16 a[80:95], a[244:247], v[204:207], a[80:95]
  v_mul_f32 v76, v76, v29
  v_mul_f32 v77, v77, v29
  v_mul_f32 v78, v78, v29
  v_mul_f32 v79, v79, v29
  v_cvt_pk_bf16_f32 v72, v72, v73
  v_cvt_pk_bf16_f32 v73, v74, v75
  v_mfma_f32_32x32x16_bf16 a[96:111], a[248:251], v[204:207], a[96:111]
  v_cvt_pk_bf16_f32 v74, v76, v77
  v_cvt_pk_bf16_f32 v75, v78, v79
  v_mfma_f32_32x32x16_bf16 a[112:127], a[252:255], v[204:207], a[112:127]
  buffer_store_dwordx4 v[72:75], v23, s[20:23], s46 offen offset:512 sc1
  v_mul_f32 v80, v80, v29
  v_mul_f32 v81, v81, v29
  v_mul_f32 v82, v82, v29
  v_mul_f32 v83, v83, v29
  v_mul_f32 v84, v84, v29
  v_mul_f32 v85, v85, v29
  v_mul_f32 v86, v86, v29
  v_mul_f32 v87, v87, v29
  v_cvt_pk_bf16_f32 v80, v80, v81
  v_cvt_pk_bf16_f32 v81, v82, v83
  v_cvt_pk_bf16_f32 v82, v84, v85
  v_cvt_pk_bf16_f32 v83, v86, v87
  buffer_store_dwordx4 v[80:83], v23, s[20:23], s46 offen offset:1024 sc1
  v_mul_f32 v88, v88, v29
  v_mul_f32 v89, v89, v29
  v_mul_f32 v90, v90, v29
  v_mul_f32 v91, v91, v29
  v_mul_f32 v92, v92, v29
  v_mul_f32 v93, v93, v29
  v_mul_f32 v94, v94, v29
  v_mul_f32 v95, v95, v29
  v_cvt_pk_bf16_f32 v88, v88, v89
  v_cvt_pk_bf16_f32 v89, v90, v91
  v_cvt_pk_bf16_f32 v90, v92, v93
  v_cvt_pk_bf16_f32 v91, v94, v95
  buffer_store_dwordx4 v[88:91], v23, s[20:23], s46 offen offset:1536 sc1
  v_mul_f32 v96, v96, v29
  v_mul_f32 v97, v97, v29
  v_mul_f32 v98, v98, v29
  v_mul_f32 v99, v99, v29
  v_mul_f32 v100, v100, v29
  v_mul_f32 v101, v101, v29
  v_mul_f32 v102, v102, v29
  v_mul_f32 v103, v103, v29
  v_cvt_pk_bf16_f32 v96, v96, v97
  v_cvt_pk_bf16_f32 v97, v98, v99
  v_cvt_pk_bf16_f32 v98, v100, v101
  v_cvt_pk_bf16_f32 v99, v102, v103
  buffer_store_dwordx4 v[96:99], v23, s[20:23], s46 offen offset:2048 sc1
  v_mul_f32 v104, v104, v29
  v_mul_f32 v105, v105, v29
  v_mul_f32 v106, v106, v29
  v_mul_f32 v107, v107, v29
  v_mul_f32 v108, v108, v29
  v_mul_f32 v109, v109, v29
  v_mul_f32 v110, v110, v29
  v_mul_f32 v111, v111, v29
  v_cvt_pk_bf16_f32 v104, v104, v105
  v_cvt_pk_bf16_f32 v105, v106, v107
  v_cvt_pk_bf16_f32 v106, v108, v109
  v_cvt_pk_bf16_f32 v107, v110, v111
  buffer_store_dwordx4 v[104:107], v23, s[20:23], s46 offen offset:2560 sc1
  v_mul_f32 v112, v112, v29
  v_mul_f32 v113, v113, v29
  v_mul_f32 v114, v114, v29
  v_mul_f32 v115, v115, v29
  v_mul_f32 v116, v116, v29
  v_mul_f32 v117, v117, v29
  v_mul_f32 v118, v118, v29
  v_mul_f32 v119, v119, v29
  v_cvt_pk_bf16_f32 v112, v112, v113
  v_cvt_pk_bf16_f32 v113, v114, v115
  v_cvt_pk_bf16_f32 v114, v116, v117
  v_cvt_pk_bf16_f32 v115, v118, v119
  buffer_store_dwordx4 v[112:115], v23, s[20:23], s46 offen offset:3072 sc1
  v_mul_f32 v120, v120, v29
  v_mul_f32 v121, v121, v29
  v_mul_f32 v122, v122, v29
  v_mul_f32 v123, v123, v29
  v_mul_f32 v124, v124, v29
  v_mul_f32 v125, v125, v29
  v_mul_f32 v126, v126, v29
  v_mul_f32 v127, v127, v29
  v_cvt_pk_bf16_f32 v120, v120, v121
  v_cvt_pk_bf16_f32 v121, v122, v123
  v_cvt_pk_bf16_f32 v122, v124, v125
  v_cvt_pk_bf16_f32 v123, v126, v127
  buffer_store_dwordx4 v[120:123], v23, s[20:23], s46 offen offset:3584 sc1
  v_mov_b32 v4, v30
  s_nop 1
  v_permlane32_swap_b32 v30, v4
  v_add_f32 v30, v30, v4
  v_rcp_f32 v30, v30
  v_mfma_f32_32x32x16_bf16 a[128:143], v[60:63], v[60:63], 0
  v_mfma_f32_32x32x16_bf16 a[144:159], v[60:63], v[60:63], 0
  v_mfma_f32_32x32x16_bf16 a[160:175], v[60:63], v[60:63], 0
  v_mfma_f32_32x32x16_bf16 a[176:191], v[60:63], v[60:63], 0
  v_accvgpr_read_b32 v128, a64
  v_accvgpr_read_b32 v129, a65
  v_accvgpr_read_b32 v130, a66
  v_accvgpr_read_b32 v131, a67
  v_accvgpr_read_b32 v132, a68
  v_accvgpr_read_b32 v133, a69
  v_accvgpr_read_b32 v134, a70
  v_accvgpr_read_b32 v135, a71
  v_pk_mul_f32 v[128:129], v[128:129], v[30:31] op_sel_hi:[1,0]
  v_pk_mul_f32 v[130:131], v[130:131], v[30:31] op_sel_hi:[1,0]
  v_pk_mul_f32 v[132:133], v[132:133], v[30:31] op_sel_hi:[1,0]
  v_pk_mul_f32 v[134:135], v[134:135], v[30:31] op_sel_hi:[1,0]
  v_cvt_pk_bf16_f32 v128, v128, v129
  v_cvt_pk_bf16_f32 v129, v130, v131
  v_cvt_pk_bf16_f32 v130, v132, v133
  v_cvt_pk_bf16_f32 v131, v134, v135
  buffer_store_dwordx4 v[128:131], v24, s[20:23], s46 offen offset:0 sc1
  v_accvgpr_read_b32 v136, a72
  v_accvgpr_read_b32 v137, a73
  v_accvgpr_read_b32 v138, a74
  v_accvgpr_read_b32 v139, a75
  v_accvgpr_read_b32 v140, a76
  v_accvgpr_read_b32 v141, a77
  v_accvgpr_read_b32 v142, a78
  v_accvgpr_read_b32 v143, a79
  v_pk_mul_f32 v[136:137], v[136:137], v[30:31] op_sel_hi:[1,0]
  v_pk_mul_f32 v[138:139], v[138:139], v[30:31] op_sel_hi:[1,0]
  v_pk_mul_f32 v[140:141], v[140:141], v[30:31] op_sel_hi:[1,0]
  v_pk_mul_f32 v[142:143], v[142:143], v[30:31] op_sel_hi:[1,0]
  v_cvt_pk_bf16_f32 v136, v136, v137
  v_cvt_pk_bf16_f32 v137, v138, v139
  v_cvt_pk_bf16_f32 v138, v140, v141
  v_cvt_pk_bf16_f32 v139, v142, v143
  buffer_store_dwordx4 v[136:139], v24, s[20:23], s46 offen offset:512 sc1
  v_accvgpr_read_b32 v144, a80
  v_accvgpr_read_b32 v145, a81
  v_accvgpr_read_b32 v146, a82
  v_accvgpr_read_b32 v147, a83
  v_accvgpr_read_b32 v148, a84
  v_accvgpr_read_b32 v149, a85
  v_accvgpr_read_b32 v150, a86
  v_accvgpr_read_b32 v151, a87
  v_pk_mul_f32 v[144:145], v[144:145], v[30:31] op_sel_hi:[1,0]
  v_pk_mul_f32 v[146:147], v[146:147], v[30:31] op_sel_hi:[1,0]
  v_pk_mul_f32 v[148:149], v[148:149], v[30:31] op_sel_hi:[1,0]
  v_pk_mul_f32 v[150:151], v[150:151], v[30:31] op_sel_hi:[1,0]
  v_cvt_pk_bf16_f32 v144, v144, v145
  v_cvt_pk_bf16_f32 v145, v146, v147
  v_cvt_pk_bf16_f32 v146, v148, v149
  v_cvt_pk_bf16_f32 v147, v150, v151
  buffer_store_dwordx4 v[144:147], v24, s[20:23], s46 offen offset:1024 sc1
  v_accvgpr_read_b32 v152, a88
  v_accvgpr_read_b32 v153, a89
  v_accvgpr_read_b32 v154, a90
  v_accvgpr_read_b32 v155, a91
  v_accvgpr_read_b32 v156, a92
  v_accvgpr_read_b32 v157, a93
  v_accvgpr_read_b32 v158, a94
  v_accvgpr_read_b32 v159, a95
  v_pk_mul_f32 v[152:153], v[152:153], v[30:31] op_sel_hi:[1,0]
  v_pk_mul_f32 v[154:155], v[154:155], v[30:31] op_sel_hi:[1,0]
  v_pk_mul_f32 v[156:157], v[156:157], v[30:31] op_sel_hi:[1,0]
  v_pk_mul_f32 v[158:159], v[158:159], v[30:31] op_sel_hi:[1,0]
  v_cvt_pk_bf16_f32 v152, v152, v153
  v_cvt_pk_bf16_f32 v153, v154, v155
  v_cvt_pk_bf16_f32 v154, v156, v157
  v_cvt_pk_bf16_f32 v155, v158, v159
  buffer_store_dwordx4 v[152:155], v24, s[20:23], s46 offen offset:1536 sc1
  v_accvgpr_read_b32 v128, a96
  v_accvgpr_read_b32 v129, a97
  v_accvgpr_read_b32 v130, a98
  v_accvgpr_read_b32 v131, a99
  v_accvgpr_read_b32 v132, a100
  v_accvgpr_read_b32 v133, a101
  v_accvgpr_read_b32 v134, a102
  v_accvgpr_read_b32 v135, a103
  v_pk_mul_f32 v[128:129], v[128:129], v[30:31] op_sel_hi:[1,0]
  v_pk_mul_f32 v[130:131], v[130:131], v[30:31] op_sel_hi:[1,0]
  v_pk_mul_f32 v[132:133], v[132:133], v[30:31] op_sel_hi:[1,0]
  v_pk_mul_f32 v[134:135], v[134:135], v[30:31] op_sel_hi:[1,0]
  v_cvt_pk_bf16_f32 v128, v128, v129
  v_cvt_pk_bf16_f32 v129, v130, v131
  v_cvt_pk_bf16_f32 v130, v132, v133
  v_cvt_pk_bf16_f32 v131, v134, v135
  buffer_store_dwordx4 v[128:131], v24, s[20:23], s46 offen offset:2048 sc1
  v_accvgpr_read_b32 v136, a104
  v_accvgpr_read_b32 v137, a105
  v_accvgpr_read_b32 v138, a106
  v_accvgpr_read_b32 v139, a107
  v_accvgpr_read_b32 v140, a108
  v_accvgpr_read_b32 v141, a109
  v_accvgpr_read_b32 v142, a110
  v_accvgpr_read_b32 v143, a111
  v_pk_mul_f32 v[136:137], v[136:137], v[30:31] op_sel_hi:[1,0]
  v_pk_mul_f32 v[138:139], v[138:139], v[30:31] op_sel_hi:[1,0]
  v_pk_mul_f32 v[140:141], v[140:141], v[30:31] op_sel_hi:[1,0]
  v_pk_mul_f32 v[142:143], v[142:143], v[30:31] op_sel_hi:[1,0]
  v_cvt_pk_bf16_f32 v136, v136, v137
  v_cvt_pk_bf16_f32 v137, v138, v139
  v_cvt_pk_bf16_f32 v138, v140, v141
  v_cvt_pk_bf16_f32 v139, v142, v143
  buffer_store_dwordx4 v[136:139], v24, s[20:23], s46 offen offset:2560 sc1
  v_accvgpr_read_b32 v144, a112
  v_accvgpr_read_b32 v145, a113
  v_accvgpr_read_b32 v146, a114
  v_accvgpr_read_b32 v147, a115
  v_accvgpr_read_b32 v148, a116
  v_accvgpr_read_b32 v149, a117
  v_accvgpr_read_b32 v150, a118
  v_accvgpr_read_b32 v151, a119
  v_pk_mul_f32 v[144:145], v[144:145], v[30:31] op_sel_hi:[1,0]
  v_pk_mul_f32 v[146:147], v[146:147], v[30:31] op_sel_hi:[1,0]
  v_pk_mul_f32 v[148:149], v[148:149], v[30:31] op_sel_hi:[1,0]
  v_pk_mul_f32 v[150:151], v[150:151], v[30:31] op_sel_hi:[1,0]
  v_cvt_pk_bf16_f32 v144, v144, v145
  v_cvt_pk_bf16_f32 v145, v146, v147
  v_cvt_pk_bf16_f32 v146, v148, v149
  v_cvt_pk_bf16_f32 v147, v150, v151
  buffer_store_dwordx4 v[144:147], v24, s[20:23], s46 offen offset:3072 sc1
  v_accvgpr_read_b32 v152, a120
  v_accvgpr_read_b32 v153, a121
  v_accvgpr_read_b32 v154, a122
  v_accvgpr_read_b32 v155, a123
  v_accvgpr_read_b32 v156, a124
  v_accvgpr_read_b32 v157, a125
  v_accvgpr_read_b32 v158, a126
  v_accvgpr_read_b32 v159, a127
  v_pk_mul_f32 v[152:153], v[152:153], v[30:31] op_sel_hi:[1,0]
  v_pk_mul_f32 v[154:155], v[154:155], v[30:31] op_sel_hi:[1,0]
  v_pk_mul_f32 v[156:157], v[156:157], v[30:31] op_sel_hi:[1,0]
  v_pk_mul_f32 v[158:159], v[158:159], v[30:31] op_sel_hi:[1,0]
  v_cvt_pk_bf16_f32 v152, v152, v153
  v_cvt_pk_bf16_f32 v153, v154, v155
  v_cvt_pk_bf16_f32 v154, v156, v157
  v_cvt_pk_bf16_f32 v155, v158, v159
  buffer_store_dwordx4 v[152:155], v24, s[20:23], s46 offen offset:3584 sc1
  s_cmp_eq_u32 s38, 1
  s_cbranch_scc0 L1_notile
  s_waitcnt vmcnt(34) lgkmcnt(0)
  s_mov_b32 s91, 0
L2_loop:
  s_waitcnt lgkmcnt(8)
  v_mfma_f32_16x16x32_bf16 a[128:131], a[192:195], v[224:227], a[128:131]
  ds_read_b64_tr_b16 a[224:225], v32 offset:8192
  v_mfma_f32_16x16x32_bf16 a[160:163], a[192:195], v[228:231], a[160:163]
  ds_read_b64_tr_b16 a[226:227], v32 offset:9216
  v_mfma_f32_16x16x32_bf16 a[132:135], a[196:199], v[224:227], a[132:135]
  ds_read_b64_tr_b16 a[228:229], v33 offset:8192
  v_mfma_f32_16x16x32_bf16 a[164:167], a[196:199], v[228:231], a[164:167]
  ds_read_b64_tr_b16 a[230:231], v33 offset:9216
  buffer_load_dwordx4 v[168:171], v52, s[76:79], s88 offen offset:1024
  v_mfma_f32_16x16x32_bf16 a[136:139], a[200:203], v[224:227], a[136:139]
  ds_read_b64_tr_b16 a[232:233], v34 offset:8192
  v_mfma_f32_16x16x32_bf16 a[168:171], a[200:203], v[228:231], a[168:171]
  ds_read_b64_tr_b16 a[234:235], v34 offset:9216
  v_mfma_f32_16x16x32_bf16 a[140:143], a[204:207], v[224:227], a[140:143]
  ds_read_b64_tr_b16 a[236:237], v35 offset:8192
  buffer_load_dwordx4 v50, s[80:83], s89 offen offset:2048 lds
  v_mfma_f32_16x16x32_bf16 a[172:175], a[204:207], v[228:231], a[172:175]
  ds_read_b64_tr_b16 a[238:239], v35 offset:9216
  s_waitcnt lgkmcnt(8)
  v_mfma_f32_16x16x32_bf16 a[144:147], a[208:211], v[224:227], a[144:147]
  ds_read_b64_tr_b16 a[240:241], v36 offset:8192
  v_mfma_f32_16x16x32_bf16 a[176:179], a[208:211], v[228:231], a[176:179]
  ds_read_b64_tr_b16 a[242:243], v36 offset:9216
  v_mfma_f32_16x16x32_bf16 a[148:151], a[212:215], v[224:227], a[148:151]
  ds_read_b64_tr_b16 a[244:245], v37 offset:8192
  v_mfma_f32_16x16x32_bf16 a[180:183], a[212:215], v[228:231], a[180:183]
  ds_read_b64_tr_b16 a[246:247], v37 offset:9216
  buffer_load_dwordx4 v[172:175], v53, s[76:79], s88 offen offset:1024
  v_mfma_f32_16x16x32_bf16 a[152:155], a[216:219], v[224:227], a[152:155]
  ds_read_b64_tr_b16 a[248:249], v38 offset:8192
  v_mfma_f32_16x16x32_bf16 a[184:187], a[216:219], v[228:231], a[184:187]
  ds_read_b64_tr_b16 a[250:251], v38 offset:9216
  v_mfma_f32_16x16x32_bf16 a[156:159], a[220:223], v[224:227], a[156:159]
  ds_read_b64_tr_b16 a[252:253], v39 offset:8192
  buffer_load_dwordx4 v51, s[80:83], s89 offen offset:3072 lds
  v_mfma_f32_16x16x32_bf16 a[188:191], a[220:223], v[228:231], a[188:191]
  ds_read_b64_tr_b16 a[254:255], v39 offset:9216
  s_add_u32 s89, s89, 0x60000
  s_waitcnt vmcnt(13)
  s_barrier
  s_waitcnt lgkmcnt(8)
  v_mfma_f32_16x16x32_bf16 a[128:131], a[224:227], v[232:235], a[128:131]
  ds_read_b64_tr_b16 a[192:193], v32 offset:16384
  v_mfma_f32_16x16x32_bf16 a[160:163], a[224:227], v[236:239], a[160:163]
  ds_read_b64_tr_b16 a[194:195], v32 offset:17408
  v_mfma_f32_16x16x32_bf16 a[132:135], a[228:231], v[232:235], a[132:135]
  ds_read_b64_tr_b16 a[196:197], v33 offset:16384
  v_mfma_f32_16x16x32_bf16 a[164:167], a[228:231], v[236:239], a[164:167]
  ds_read_b64_tr_b16 a[198:199], v33 offset:17408
  buffer_load_dwordx4 v[176:179], v52, s[76:79], s88 offen offset:2048
  v_mfma_f32_16x16x32_bf16 a[136:139], a[232:235], v[232:235], a[136:139]
  ds_read_b64_tr_b16 a[200:201], v34 offset:16384
  v_mfma_f32_16x16x32_bf16 a[168:171], a[232:235], v[236:239], a[168:171]
  ds_read_b64_tr_b16 a[202:203], v34 offset:17408
  s_add_u32 m0, s90, 0x10000
  v_mfma_f32_16x16x32_bf16 a[140:143], a[236:239], v[232:235], a[140:143]
  ds_read_b64_tr_b16 a[204:205], v35 offset:16384
  buffer_load_dwordx4 v48, s[80:83], s89 offen offset:0 lds
  v_mfma_f32_16x16x32_bf16 a[172:175], a[236:239], v[236:239], a[172:175]
  ds_read_b64_tr_b16 a[206:207], v35 offset:17408
  s_waitcnt lgkmcnt(8)
  v_mfma_f32_16x16x32_bf16 a[144:147], a[240:243], v[232:235], a[144:147]
  ds_read_b64_tr_b16 a[208:209], v36 offset:16384
  v_mfma_f32_16x16x32_bf16 a[176:179], a[240:243], v[236:239], a[176:179]
  ds_read_b64_tr_b16 a[210:211], v36 offset:17408
  v_mfma_f32_16x16x32_bf16 a[148:151], a[244:247], v[232:235], a[148:151]
  ds_read_b64_tr_b16 a[212:213], v37 offset:16384
  v_mfma_f32_16x16x32_bf16 a[180:183], a[244:247], v[236:239], a[180:183]
  ds_read_b64_tr_b16 a[214:215], v37 offset:17408
  buffer_load_dwordx4 v[180:183], v53, s[76:79], s88 offen offset:2048
  v_mfma_f32_16x16x32_bf16 a[152:155], a[248:251], v[232:235], a[152:155]
  ds_read_b64_tr_b16 a[216:217], v38 offset:16384
  v_mfma_f32_16x16x32_bf16 a[184:187], a[248:251], v[236:239], a[184:187]
  ds_read_b64_tr_b16 a[218:219], v38 offset:17408
  v_mfma_f32_16x16x32_bf16 a[156:159], a[252:255], v[232:235], a[156:159]
  ds_read_b64_tr_b16 a[220:221], v39 offset:16384
  buffer_load_dwordx4 v49, s[80:83], s89 offen offset:1024 lds
  v_mfma_f32_16x16x32_bf16 a[188:191], a[252:255], v[236:239], a[188:191]
  ds_read_b64_tr_b16 a[222:223], v39 offset:17408
  s_waitcnt lgkmcnt(8)
  v_mfma_f32_16x16x32_bf16 a[128:131], a[192:195], v[240:243], a[128:131]
  ds_read_b64_tr_b16 a[224:225], v32 offset:24576
  v_mfma_f32_16x16x32_bf16 a[160:163], a[192:195], v[244:247], a[160:163]
  ds_read_b64_tr_b16 a[226:227], v32 offset:25600
  v_mfma_f32_16x16x32_bf16 a[132:135], a[196:199], v[240:243], a[132:135]
  ds_read_b64_tr_b16 a[228:229], v33 offset:24576
  v_mfma_f32_16x16x32_bf16 a[164:167], a[196:199], v[244:247], a[164:167]
  ds_read_b64_tr_b16 a[230:231], v33 offset:25600
  buffer_load_dwordx4 v[184:187], v52, s[76:79], s88 offen offset:3072
  v_mfma_f32_16x16x32_bf16 a[136:139], a[200:203], v[240:243], a[136:139]
  ds_read_b64_tr_b16 a[232:233], v34 offset:24576
  v_mfma_f32_16x16x32_bf16 a[168:171], a[200:203], v[244:247], a[168:171]
  ds_read_b64_tr_b16 a[234:235], v34 offset:25600
  v_mfma_f32_16x16x32_bf16 a[140:143], a[204:207], v[240:243], a[140:143]
  ds_read_b64_tr_b16 a[236:237], v35 offset:24576
  buffer_load_dwordx4 v50, s[80:83], s89 offen offset:2048 lds
  v_mfma_f32_16x16x32_bf16 a[172:175], a[204:207], v[244:247], a[172:175]
  ds_read_b64_tr_b16 a[238:239], v35 offset:25600
  s_waitcnt lgkmcnt(8)
  v_mfma_f32_16x16x32_bf16 a[144:147], a[208:211], v[240:243], a[144:147]
  ds_read_b64_tr_b16 a[240:241], v36 offset:24576
  s_cmp_eq_u32 s91, 3
  v_mfma_f32_16x16x32_bf16 a[176:179], a[208:211], v[244:247], a[176:179]
  ds_read_b64_tr_b16 a[242:243], v36 offset:25600
  s_cbranch_scc1 L2_poll
L2_poll_ret:
  v_mfma_f32_16x16x32_bf16 a[148:151], a[212:215], v[240:243], a[148:151]
  ds_read_b64_tr_b16 a[244:245], v37 offset:24576
  v_mfma_f32_16x16x32_bf16 a[180:183], a[212:215], v[244:247], a[180:183]
  ds_read_b64_tr_b16 a[246:247], v37 offset:25600
  buffer_load_dwordx4 v[188:191], v53, s[76:79], s88 offen offset:3072
  v_mfma_f32_16x16x32_bf16 a[152:155], a[216:219], v[240:243], a[152:155]
  ds_read_b64_tr_b16 a[248:249], v38 offset:24576
  s_add_u32 s88, s88, 0x1000
  v_mfma_f32_16x16x32_bf16 a[184:187], a[216:219], v[244:247], a[184:187]
  ds_read_b64_tr_b16 a[250:251], v38 offset:25600
  v_mfma_f32_16x16x32_bf16 a[156:159], a[220:223], v[240:243], a[156:159]
  ds_read_b64_tr_b16 a[252:253], v39 offset:24576
  buffer_load_dwordx4 v51, s[80:83], s89 offen offset:3072 lds
  v_mfma_f32_16x16x32_bf16 a[188:191], a[220:223], v[244:247], a[188:191]
  ds_read_b64_tr_b16 a[254:255], v39 offset:25600
  s_add_u32 s89, s89, 0x20000
  s_waitcnt vmcnt(13)
  s_barrier
  s_waitcnt lgkmcnt(8)
  v_mfma_f32_16x16x32_bf16 a[128:131], a[224:227], v[248:251], a[128:131]
  ds_read_b64_tr_b16 a[192:193], v32 offset:32768
  v_mfma_f32_16x16x32_bf16 a[160:163], a[224:227], v[252:255], a[160:163]
  ds_read_b64_tr_b16 a[194:195], v32 offset:33792
  v_mfma_f32_16x16x32_bf16 a[132:135], a[228:231], v[248:251], a[132:135]
  ds_read_b64_tr_b16 a[196:197], v33 offset:32768
  v_mfma_f32_16x16x32_bf16 a[164:167], a[228:231], v[252:255], a[164:167]
  ds_read_b64_tr_b16 a[198:199], v33 offset:33792
  buffer_load_dwordx4 v[224:227], v52, s[76:79], s88 offen offset:0
  v_mfma_f32_16x16x32_bf16 a[136:139], a[232:235], v[248:251], a[136:139]
  ds_read_b64_tr_b16 a[200:201], v34 offset:32768
  v_mfma_f32_16x16x32_bf16 a[168:171], a[232:235], v[252:255], a[168:171]
  ds_read_b64_tr_b16 a[202:203], v34 offset:33792
  s_add_u32 m0, s90, 0x14000
  v_mfma_f32_16x16x32_bf16 a[140:143], a[236:239], v[248:251], a[140:143]
  ds_read_b64_tr_b16 a[204:205], v35 offset:32768
  buffer_load_dwordx4 v48, s[80:83], s89 offen offset:0 lds
  v_mfma_f32_16x16x32_bf16 a[172:175], a[236:239], v[252:255], a[172:175]
  ds_read_b64_tr_b16 a[206:207], v35 offset:33792
  s_waitcnt lgkmcnt(8)
  v_mfma_f32_16x16x32_bf16 a[144:147], a[240:243], v[248:251], a[144:147]
  ds_read_b64_tr_b16 a[208:209], v36 offset:32768
  v_mfma_f32_16x16x32_bf16 a[176:179], a[240:243], v[252:255], a[176:179]
  ds_read_b64_tr_b16 a[210:211], v36 offset:33792
  v_mfma_f32_16x16x32_bf16 a[148:151], a[244:247], v[248:251], a[148:151]
  ds_read_b64_tr_b16 a[212:213], v37 offset:32768
  v_mfma_f32_16x16x32_bf16 a[180:183], a[244:247], v[252:255], a[180:183]
  ds_read_b64_tr_b16 a[214:215], v37 offset:33792
  buffer_load_dwordx4 v[228:231], v53, s[76:79], s88 offen offset:0
  v_mfma_f32_16x16x32_bf16 a[152:155], a[248:251], v[248:251], a[152:155]
  ds_read_b64_tr_b16 a[216:217], v38 offset:32768
  v_mfma_f32_16x16x32_bf16 a[184:187], a[248:251], v[252:255], a[184:187]
  ds_read_b64_tr_b16 a[218:219], v38 offset:33792
  v_mfma_f32_16x16x32_bf16 a[156:159], a[252:255], v[248:251], a[156:159]
  ds_read_b64_tr_b16 a[220:221], v39 offset:32768
  buffer_load_dwordx4 v49, s[80:83], s89 offen offset:1024 lds
  v_mfma_f32_16x16x32_bf16 a[188:191], a[252:255], v[252:255], a[188:191]
  ds_read_b64_tr_b16 a[222:223], v39 offset:33792
  s_waitcnt lgkmcnt(8)
  v_mfma_f32_16x16x32_bf16 a[128:131], a[192:195], v[160:163], a[128:131]
  ds_read_b64_tr_b16 a[224:225], v32 offset:40960
  v_mfma_f32_16x16x32_bf16 a[160:163], a[192:195], v[164:167], a[160:163]
  ds_read_b64_tr_b16 a[226:227], v32 offset:41984
  v_mfma_f32_16x16x32_bf16 a[132:135], a[196:199], v[160:163], a[132:135]
  ds_read_b64_tr_b16 a[228:229], v33 offset:40960
  v_mfma_f32_16x16x32_bf16 a[164:167], a[196:199], v[164:167], a[164:167]
  ds_read_b64_tr_b16 a[230:231], v33 offset:41984
  buffer_load_dwordx4 v[232:235], v52, s[76:79], s88 offen offset:1024
  v_mfma_f32_16x16x32_bf16 a[136:139], a[200:203], v[160:163], a[136:139]
  ds_read_b64_tr_b16 a[232:233], v34 offset:40960
  v_mfma_f32_16x16x32_bf16 a[168:171], a[200:203], v[164:167], a[168:171]
  ds_read_b64_tr_b16 a[234:235], v34 offset:41984
  v_mfma_f32_16x16x32_bf16 a[140:143], a[204:207], v[160:163], a[140:143]
  ds_read_b64_tr_b16 a[236:237], v35 offset:40960
  buffer_load_dwordx4 v50, s[80:83], s89 offen offset:2048 lds
  v_mfma_f32_16x16x32_bf16 a[172:175], a[204:207], v[164:167], a[172:175]
  ds_read_b64_tr_b16 a[238:239], v35 offset:41984
  s_waitcnt lgkmcnt(8)
  v_mfma_f32_16x16x32_bf16 a[144:147], a[208:211], v[160:163], a[144:147]
  ds_read_b64_tr_b16 a[240:241], v36 offset:40960
  v_mfma_f32_16x16x32_bf16 a[176:179], a[208:211], v[164:167], a[176:179]
  ds_read_b64_tr_b16 a[242:243], v36 offset:41984
  v_mfma_f32_16x16x32_bf16 a[148:151], a[212:215], v[160:163], a[148:151]
  ds_read_b64_tr_b16 a[244:245], v37 offset:40960
  v_mfma_f32_16x16x32_bf16 a[180:183], a[212:215], v[164:167], a[180:183]
  ds_read_b64_tr_b16 a[246:247], v37 offset:41984
  buffer_load_dwordx4 v[236:239], v53, s[76:79], s88 offen offset:1024
  v_mfma_f32_16x16x32_bf16 a[152:155], a[216:219], v[160:163], a[152:155]
  ds_read_b64_tr_b16 a[248:249], v38 offset:40960
  v_mfma_f32_16x16x32_bf16 a[184:187], a[216:219], v[164:167], a[184:187]
  ds_read_b64_tr_b16 a[250:251], v38 offset:41984
  v_mfma_f32_16x16x32_bf16 a[156:159], a[220:223], v[160:163], a[156:159]
  ds_read_b64_tr_b16 a[252:253], v39 offset:40960
  buffer_load_dwordx4 v51, s[80:83], s89 offen offset:3072 lds
  v_mfma_f32_16x16x32_bf16 a[188:191], a[220:223], v[164:167], a[188:191]
  ds_read_b64_tr_b16 a[254:255], v39 offset:41984
  s_add_u32 s89, s89, 0x60000
  s_waitcnt vmcnt(13)
  s_barrier
  s_waitcnt lgkmcnt(8)
  v_mfma_f32_16x16x32_bf16 a[128:131], a[224:227], v[168:171], a[128:131]
  ds_read_b64_tr_b16 a[192:193], v32 offset:49152
  v_mfma_f32_16x16x32_bf16 a[160:163], a[224:227], v[172:175], a[160:163]
  ds_read_b64_tr_b16 a[194:195], v32 offset:50176
  v_mfma_f32_16x16x32_bf16 a[132:135], a[228:231], v[168:171], a[132:135]
  ds_read_b64_tr_b16 a[196:197], v33 offset:49152
  v_mfma_f32_16x16x32_bf16 a[164:167], a[228:231], v[172:175], a[164:167]
  ds_read_b64_tr_b16 a[198:199], v33 offset:50176
  buffer_load_dwordx4 v[240:243], v52, s[76:79], s88 offen offset:2048
  v_mfma_f32_16x16x32_bf16 a[136:139], a[232:235], v[168:171], a[136:139]
  ds_read_b64_tr_b16 a[200:201], v34 offset:49152
  v_mfma_f32_16x16x32_bf16 a[168:171], a[232:235], v[172:175], a[168:171]
  ds_read_b64_tr_b16 a[202:203], v34 offset:50176
  s_add_u32 m0, s90, 0x18000
  v_mfma_f32_16x16x32_bf16 a[140:143], a[236:239], v[168:171], a[140:143]
  ds_read_b64_tr_b16 a[204:205], v35 offset:49152
  buffer_load_dwordx4 v48, s[80:83], s89 offen offset:0 lds
  v_mfma_f32_16x16x32_bf16 a[172:175], a[236:239], v[172:175], a[172:175]
  ds_read_b64_tr_b16 a[206:207], v35 offset:50176
  s_waitcnt lgkmcnt(8)
  v_mfma_f32_16x16x32_bf16 a[144:147], a[240:243], v[168:171], a[144:147]
  ds_read_b64_tr_b16 a[208:209], v36 offset:49152
  v_mfma_f32_16x16x32_bf16 a[176:179], a[240:243], v[172:175], a[176:179]
  ds_read_b64_tr_b16 a[210:211], v36 offset:50176
  v_mfma_f32_16x16x32_bf16 a[148:151], a[244:247], v[168:171], a[148:151]
  ds_read_b64_tr_b16 a[212:213], v37 offset:49152
  v_mfma_f32_16x16x32_bf16 a[180:183], a[244:247], v[172:175], a[180:183]
  ds_read_b64_tr_b16 a[214:215], v37 offset:50176
  buffer_load_dwordx4 v[244:247], v53, s[76:79], s88 offen offset:2048
  v_mfma_f32_16x16x32_bf16 a[152:155], a[248:251], v[168:171], a[152:155]
  ds_read_b64_tr_b16 a[216:217], v38 offset:49152
  v_mfma_f32_16x16x32_bf16 a[184:187], a[248:251], v[172:175], a[184:187]
  ds_read_b64_tr_b16 a[218:219], v38 offset:50176
  v_mfma_f32_16x16x32_bf16 a[156:159], a[252:255], v[168:171], a[156:159]
  ds_read_b64_tr_b16 a[220:221], v39 offset:49152
  buffer_load_dwordx4 v49, s[80:83], s89 offen offset:1024 lds
  v_mfma_f32_16x16x32_bf16 a[188:191], a[252:255], v[172:175], a[188:191]
  ds_read_b64_tr_b16 a[222:223], v39 offset:50176
  s_waitcnt lgkmcnt(8)
  v_mfma_f32_16x16x32_bf16 a[128:131], a[192:195], v[176:179], a[128:131]
  ds_read_b64_tr_b16 a[224:225], v32 offset:57344
  v_mfma_f32_16x16x32_bf16 a[160:163], a[192:195], v[180:183], a[160:163]
  ds_read_b64_tr_b16 a[226:227], v32 offset:58368
  v_mfma_f32_16x16x32_bf16 a[132:135], a[196:199], v[176:179], a[132:135]
  ds_read_b64_tr_b16 a[228:229], v33 offset:57344
  v_mfma_f32_16x16x32_bf16 a[164:167], a[196:199], v[180:183], a[164:167]
  ds_read_b64_tr_b16 a[230:231], v33 offset:58368
  buffer_load_dwordx4 v[248:251], v52, s[76:79], s88 offen offset:3072
  v_mfma_f32_16x16x32_bf16 a[136:139], a[200:203], v[176:179], a[136:139]
  ds_read_b64_tr_b16 a[232:233], v34 offset:57344
  v_mfma_f32_16x16x32_bf16 a[168:171], a[200:203], v[180:183], a[168:171]
  ds_read_b64_tr_b16 a[234:235], v34 offset:58368
  v_mfma_f32_16x16x32_bf16 a[140:143], a[204:207], v[176:179], a[140:143]
  ds_read_b64_tr_b16 a[236:237], v35 offset:57344
  buffer_load_dwordx4 v50, s[80:83], s89 offen offset:2048 lds
  v_mfma_f32_16x16x32_bf16 a[172:175], a[204:207], v[180:183], a[172:175]
  ds_read_b64_tr_b16 a[238:239], v35 offset:58368
  s_waitcnt lgkmcnt(8)
  v_mfma_f32_16x16x32_bf16 a[144:147], a[208:211], v[176:179], a[144:147]
  ds_read_b64_tr_b16 a[240:241], v36 offset:57344
  s_cmp_eq_u32 s91, 0
  v_mfma_f32_16x16x32_bf16 a[176:179], a[208:211], v[180:183], a[176:179]
  ds_read_b64_tr_b16 a[242:243], v36 offset:58368
  s_cbranch_scc1 L2_stw
L2_stw_ret:
  v_mfma_f32_16x16x32_bf16 a[148:151], a[212:215], v[176:179], a[148:151]
  ds_read_b64_tr_b16 a[244:245], v37 offset:57344
  v_mfma_f32_16x16x32_bf16 a[180:183], a[212:215], v[180:183], a[180:183]
  ds_read_b64_tr_b16 a[246:247], v37 offset:58368
  buffer_load_dwordx4 v[252:255], v53, s[76:79], s88 offen offset:3072
  v_mfma_f32_16x16x32_bf16 a[152:155], a[216:219], v[176:179], a[152:155]
  ds_read_b64_tr_b16 a[248:249], v38 offset:57344
  s_add_u32 s88, s88, 0x1000
  v_mfma_f32_16x16x32_bf16 a[184:187], a[216:219], v[180:183], a[184:187]
  ds_read_b64_tr_b16 a[250:251], v38 offset:58368
  v_mfma_f32_16x16x32_bf16 a[156:159], a[220:223], v[176:179], a[156:159]
  ds_read_b64_tr_b16 a[252:253], v39 offset:57344
  buffer_load_dwordx4 v51, s[80:83], s89 offen offset:3072 lds
  v_mfma_f32_16x16x32_bf16 a[188:191], a[220:223], v[180:183], a[188:191]
  ds_read_b64_tr_b16 a[254:255], v39 offset:58368
  s_add_u32 s89, s89, 0x20000
  s_waitcnt vmcnt(13)
  s_barrier
  s_waitcnt lgkmcnt(8)
  v_mfma_f32_16x16x32_bf16 a[128:131], a[224:227], v[184:187], a[128:131]
  ds_read_b64_tr_b16 a[192:193], v40 offset:0
  v_mfma_f32_16x16x32_bf16 a[160:163], a[224:227], v[188:191], a[160:163]
  ds_read_b64_tr_b16 a[194:195], v40 offset:1024
  v_mfma_f32_16x16x32_bf16 a[132:135], a[228:231], v[184:187], a[132:135]
  ds_read_b64_tr_b16 a[196:197], v41 offset:0
  v_mfma_f32_16x16x32_bf16 a[164:167], a[228:231], v[188:191], a[164:167]
  ds_read_b64_tr_b16 a[198:199], v41 offset:1024
  buffer_load_dwordx4 v[160:163], v52, s[76:79], s88 offen offset:0
  v_mfma_f32_16x16x32_bf16 a[136:139], a[232:235], v[184:187], a[136:139]
  ds_read_b64_tr_b16 a[200:201], v42 offset:0
  v_mfma_f32_16x16x32_bf16 a[168:171], a[232:235], v[188:191], a[168:171]
  ds_read_b64_tr_b16 a[202:203], v42 offset:1024
  s_add_u32 m0, s90, 0x1c000
  v_mfma_f32_16x16x32_bf16 a[140:143], a[236:239], v[184:187], a[140:143]
  ds_read_b64_tr_b16 a[204:205], v43 offset:0
  buffer_load_dwordx4 v48, s[80:83], s89 offen offset:0 lds
  v_mfma_f32_16x16x32_bf16 a[172:175], a[236:239], v[188:191], a[172:175]
  ds_read_b64_tr_b16 a[206:207], v43 offset:1024
  s_waitcnt lgkmcnt(8)
  v_mfma_f32_16x16x32_bf16 a[144:147], a[240:243], v[184:187], a[144:147]
  ds_read_b64_tr_b16 a[208:209], v44 offset:0
  s_cmp_eq_u32 s91, s40
  v_mfma_f32_16x16x32_bf16 a[176:179], a[240:243], v[188:191], a[176:179]
  ds_read_b64_tr_b16 a[210:211], v44 offset:1024
  s_cbranch_scc1 L2_sig
L2_sig_ret:
  v_mfma_f32_16x16x32_bf16 a[148:151], a[244:247], v[184:187], a[148:151]
  ds_read_b64_tr_b16 a[212:213], v45 offset:0
  v_mfma_f32_16x16x32_bf16 a[180:183], a[244:247], v[188:191], a[180:183]
  ds_read_b64_tr_b16 a[214:215], v45 offset:1024
  buffer_load_dwordx4 v[164:167], v53, s[76:79], s88 offen offset:0
  v_mfma_f32_16x16x32_bf16 a[152:155], a[248:251], v[184:187], a[152:155]
  ds_read_b64_tr_b16 a[216:217], v46 offset:0
  v_mfma_f32_16x16x32_bf16 a[184:187], a[248:251], v[188:191], a[184:187]
  ds_read_b64_tr_b16 a[218:219], v46 offset:1024
  v_mfma_f32_16x16x32_bf16 a[156:159], a[252:255], v[184:187], a[156:159]
  ds_read_b64_tr_b16 a[220:221], v47 offset:0
  buffer_load_dwordx4 v49, s[80:83], s89 offen offset:1024 lds
  v_mfma_f32_16x16x32_bf16 a[188:191], a[252:255], v[188:191], a[188:191]
  ds_read_b64_tr_b16 a[222:223], v47 offset:1024
  s_waitcnt lgkmcnt(8)
  v_mfma_f32_16x16x32_bf16 a[128:131], a[192:195], v[224:227], a[128:131]
  ds_read_b64_tr_b16 a[224:225], v40 offset:8192
  v_mfma_f32_16x16x32_bf16 a[160:163], a[192:195], v[228:231], a[160:163]
  ds_read_b64_tr_b16 a[226:227], v40 offset:9216
  v_mfma_f32_16x16x32_bf16 a[132:135], a[196:199], v[224:227], a[132:135]
  ds_read_b64_tr_b16 a[228:229], v41 offset:8192
  v_mfma_f32_16x16x32_bf16 a[164:167], a[196:199], v[228:231], a[164:167]
  ds_read_b64_tr_b16 a[230:231], v41 offset:9216
  buffer_load_dwordx4 v[168:171], v52, s[76:79], s88 offen offset:1024
  v_mfma_f32_16x16x32_bf16 a[136:139], a[200:203], v[224:227], a[136:139]
  ds_read_b64_tr_b16 a[232:233], v42 offset:8192
  v_mfma_f32_16x16x32_bf16 a[168:171], a[200:203], v[228:231], a[168:171]
  ds_read_b64_tr_b16 a[234:235], v42 offset:9216
  v_mfma_f32_16x16x32_bf16 a[140:143], a[204:207], v[224:227], a[140:143]
  ds_read_b64_tr_b16 a[236:237], v43 offset:8192
  buffer_load_dwordx4 v50, s[80:83], s89 offen offset:2048 lds
  v_mfma_f32_16x16x32_bf16 a[172:175], a[204:207], v[228:231], a[172:175]
  ds_read_b64_tr_b16 a[238:239], v43 offset:9216
  s_waitcnt lgkmcnt(8)
  v_mfma_f32_16x16x32_bf16 a[144:147], a[208:211], v[224:227], a[144:147]
  ds_read_b64_tr_b16 a[240:241], v44 offset:8192
  s_cmp_eq_u32 s91, 3
  v_mfma_f32_16x16x32_bf16 a[176:179], a[208:211], v[228:231], a[176:179]
  ds_read_b64_tr_b16 a[242:243], v44 offset:9216
  s_cselect_b32 s34, 0xff8a0000, s35
  v_mfma_f32_16x16x32_bf16 a[148:151], a[212:215], v[224:227], a[148:151]
  ds_read_b64_tr_b16 a[244:245], v45 offset:8192
  v_mfma_f32_16x16x32_bf16 a[180:183], a[212:215], v[228:231], a[180:183]
  ds_read_b64_tr_b16 a[246:247], v45 offset:9216
  buffer_load_dwordx4 v[172:175], v53, s[76:79], s88 offen offset:1024
  v_mfma_f32_16x16x32_bf16 a[152:155], a[216:219], v[224:227], a[152:155]
  ds_read_b64_tr_b16 a[248:249], v46 offset:8192
  v_mfma_f32_16x16x32_bf16 a[184:187], a[216:219], v[228:231], a[184:187]
  ds_read_b64_tr_b16 a[250:251], v46 offset:9216
  v_mfma_f32_16x16x32_bf16 a[156:159], a[220:223], v[224:227], a[156:159]
  ds_read_b64_tr_b16 a[252:253], v47 offset:8192
  buffer_load_dwordx4 v51, s[80:83], s89 offen offset:3072 lds
  v_mfma_f32_16x16x32_bf16 a[188:191], a[220:223], v[228:231], a[188:191]
  ds_read_b64_tr_b16 a[254:255], v47 offset:9216
  s_add_u32 s89, s89, s34
  s_waitcnt vmcnt(13)
  s_barrier
  s_waitcnt lgkmcnt(8)
  v_mfma_f32_16x16x32_bf16 a[128:131], a[224:227], v[232:235], a[128:131]
  ds_read_b64_tr_b16 a[192:193], v40 offset:16384
  s_cmp_eq_u32 s91, 7
  v_mfma_f32_16x16x32_bf16 a[160:163], a[224:227], v[236:239], a[160:163]
  ds_read_b64_tr_b16 a[194:195], v40 offset:17408
  s_cselect_b32 s82, s48, s37
  v_mfma_f32_16x16x32_bf16 a[132:135], a[228:231], v[232:235], a[132:135]
  ds_read_b64_tr_b16 a[196:197], v41 offset:16384
  v_mfma_f32_16x16x32_bf16 a[164:167], a[228:231], v[236:239], a[164:167]
  ds_read_b64_tr_b16 a[198:199], v41 offset:17408
  buffer_load_dwordx4 v[176:179], v52, s[76:79], s88 offen offset:2048
  v_mfma_f32_16x16x32_bf16 a[136:139], a[232:235], v[232:235], a[136:139]
  ds_read_b64_tr_b16 a[200:201], v42 offset:16384
  v_mfma_f32_16x16x32_bf16 a[168:171], a[232:235], v[236:239], a[168:171]
  ds_read_b64_tr_b16 a[202:203], v42 offset:17408
  s_add_u32 m0, s90, 0x0
  v_mfma_f32_16x16x32_bf16 a[140:143], a[236:239], v[232:235], a[140:143]
  ds_read_b64_tr_b16 a[204:205], v43 offset:16384
  buffer_load_dwordx4 v48, s[80:83], s89 offen offset:0 lds
  v_mfma_f32_16x16x32_bf16 a[172:175], a[236:239], v[236:239], a[172:175]
  ds_read_b64_tr_b16 a[206:207], v43 offset:17408
  s_waitcnt lgkmcnt(8)
  v_mfma_f32_16x16x32_bf16 a[144:147], a[240:243], v[232:235], a[144:147]
  ds_read_b64_tr_b16 a[208:209], v44 offset:16384
  v_mfma_f32_16x16x32_bf16 a[176:179], a[240:243], v[236:239], a[176:179]
  ds_read_b64_tr_b16 a[210:211], v44 offset:17408
  v_mfma_f32_16x16x32_bf16 a[148:151], a[244:247], v[232:235], a[148:151]
  ds_read_b64_tr_b16 a[212:213], v45 offset:16384
  v_mfma_f32_16x16x32_bf16 a[180:183], a[244:247], v[236:239], a[180:183]
  ds_read_b64_tr_b16 a[214:215], v45 offset:17408
  buffer_load_dwordx4 v[180:183], v53, s[76:79], s88 offen offset:2048
  v_mfma_f32_16x16x32_bf16 a[152:155], a[248:251], v[232:235], a[152:155]
  ds_read_b64_tr_b16 a[216:217], v46 offset:16384
  v_mfma_f32_16x16x32_bf16 a[184:187], a[248:251], v[236:239], a[184:187]
  ds_read_b64_tr_b16 a[218:219], v46 offset:17408
  v_mfma_f32_16x16x32_bf16 a[156:159], a[252:255], v[232:235], a[156:159]
  ds_read_b64_tr_b16 a[220:221], v47 offset:16384
  buffer_load_dwordx4 v49, s[80:83], s89 offen offset:1024 lds
  v_mfma_f32_16x16x32_bf16 a[188:191], a[252:255], v[236:239], a[188:191]
  ds_read_b64_tr_b16 a[222:223], v47 offset:17408
  s_waitcnt lgkmcnt(8)
  v_mfma_f32_16x16x32_bf16 a[128:131], a[192:195], v[240:243], a[128:131]
  ds_read_b64_tr_b16 a[224:225], v40 offset:24576
  v_mfma_f32_16x16x32_bf16 a[160:163], a[192:195], v[244:247], a[160:163]
  ds_read_b64_tr_b16 a[226:227], v40 offset:25600
  v_mfma_f32_16x16x32_bf16 a[132:135], a[196:199], v[240:243], a[132:135]
  ds_read_b64_tr_b16 a[228:229], v41 offset:24576
  v_mfma_f32_16x16x32_bf16 a[164:167], a[196:199], v[244:247], a[164:167]
  ds_read_b64_tr_b16 a[230:231], v41 offset:25600
  buffer_load_dwordx4 v[184:187], v52, s[76:79], s88 offen offset:3072
  v_mfma_f32_16x16x32_bf16 a[136:139], a[200:203], v[240:243], a[136:139]
  ds_read_b64_tr_b16 a[232:233], v42 offset:24576
  v_mfma_f32_16x16x32_bf16 a[168:171], a[200:203], v[244:247], a[168:171]
  ds_read_b64_tr_b16 a[234:235], v42 offset:25600
  v_mfma_f32_16x16x32_bf16 a[140:143], a[204:207], v[240:243], a[140:143]
  ds_read_b64_tr_b16 a[236:237], v43 offset:24576
  buffer_load_dwordx4 v50, s[80:83], s89 offen offset:2048 lds
  v_mfma_f32_16x16x32_bf16 a[172:175], a[204:207], v[244:247], a[172:175]
  ds_read_b64_tr_b16 a[238:239], v43 offset:25600
  s_waitcnt lgkmcnt(8)
  v_mfma_f32_16x16x32_bf16 a[144:147], a[208:211], v[240:243], a[144:147]
  ds_read_b64_tr_b16 a[240:241], v44 offset:24576
  s_cmp_eq_u32 s91, 3
  v_mfma_f32_16x16x32_bf16 a[176:179], a[208:211], v[244:247], a[176:179]
  ds_read_b64_tr_b16 a[242:243], v44 offset:25600
  s_cbranch_scc1 L2_chk
L2_chk_ret:
  v_mfma_f32_16x16x32_bf16 a[148:151], a[212:215], v[240:243], a[148:151]
  ds_read_b64_tr_b16 a[244:245], v45 offset:24576
  v_mfma_f32_16x16x32_bf16 a[180:183], a[212:215], v[244:247], a[180:183]
  ds_read_b64_tr_b16 a[246:247], v45 offset:25600
  buffer_load_dwordx4 v[188:191], v53, s[76:79], s88 offen offset:3072
  v_mfma_f32_16x16x32_bf16 a[152:155], a[216:219], v[240:243], a[152:155]
  ds_read_b64_tr_b16 a[248:249], v46 offset:24576
  s_add_u32 s88, s88, 0x1000
  v_mfma_f32_16x16x32_bf16 a[184:187], a[216:219], v[244:247], a[184:187]
  ds_read_b64_tr_b16 a[250:251], v46 offset:25600
  v_mfma_f32_16x16x32_bf16 a[156:159], a[220:223], v[240:243], a[156:159]
  ds_read_b64_tr_b16 a[252:253], v47 offset:24576
  buffer_load_dwordx4 v51, s[80:83], s89 offen offset:3072 lds
  v_mfma_f32_16x16x32_bf16 a[188:191], a[220:223], v[244:247], a[188:191]
  ds_read_b64_tr_b16 a[254:255], v47 offset:25600
  s_add_u32 s89, s89, 0x20000
  s_waitcnt vmcnt(13)
  s_barrier
  s_waitcnt lgkmcnt(8)
  v_mfma_f32_16x16x32_bf16 a[128:131], a[224:227], v[248:251], a[128:131]
  ds_read_b64_tr_b16 a[192:193], v40 offset:32768
  s_cmp_eq_u32 s91, 7
  v_mfma_f32_16x16x32_bf16 a[160:163], a[224:227], v[252:255], a[160:163]
  ds_read_b64_tr_b16 a[194:195], v40 offset:33792
  s_cselect_b32 s78, s48, s36
  v_mfma_f32_16x16x32_bf16 a[132:135], a[228:231], v[248:251], a[132:135]
  ds_read_b64_tr_b16 a[196:197], v41 offset:32768
  v_mfma_f32_16x16x32_bf16 a[164:167], a[228:231], v[252:255], a[164:167]
  ds_read_b64_tr_b16 a[198:199], v41 offset:33792
  buffer_load_dwordx4 v[224:227], v52, s[76:79], s88 offen offset:0
  v_mfma_f32_16x16x32_bf16 a[136:139], a[232:235], v[248:251], a[136:139]
  ds_read_b64_tr_b16 a[200:201], v42 offset:32768
  v_mfma_f32_16x16x32_bf16 a[168:171], a[232:235], v[252:255], a[168:171]
  ds_read_b64_tr_b16 a[202:203], v42 offset:33792
  s_add_u32 m0, s90, 0x4000
  v_mfma_f32_16x16x32_bf16 a[140:143], a[236:239], v[248:251], a[140:143]
  ds_read_b64_tr_b16 a[204:205], v43 offset:32768
  buffer_load_dwordx4 v48, s[80:83], s89 offen offset:0 lds
  v_mfma_f32_16x16x32_bf16 a[172:175], a[236:239], v[252:255], a[172:175]
  ds_read_b64_tr_b16 a[206:207], v43 offset:33792
  s_waitcnt lgkmcnt(8)
  v_mfma_f32_16x16x32_bf16 a[144:147], a[240:243], v[248:251], a[144:147]
  ds_read_b64_tr_b16 a[208:209], v44 offset:32768
  v_mfma_f32_16x16x32_bf16 a[176:179], a[240:243], v[252:255], a[176:179]
  ds_read_b64_tr_b16 a[210:211], v44 offset:33792
  v_mfma_f32_16x16x32_bf16 a[148:151], a[244:247], v[248:251], a[148:151]
  ds_read_b64_tr_b16 a[212:213], v45 offset:32768
  v_mfma_f32_16x16x32_bf16 a[180:183], a[244:247], v[252:255], a[180:183]
  ds_read_b64_tr_b16 a[214:215], v45 offset:33792
  buffer_load_dwordx4 v[228:231], v53, s[76:79], s88 offen offset:0
  v_mfma_f32_16x16x32_bf16 a[152:155], a[248:251], v[248:251], a[152:155]
  ds_read_b64_tr_b16 a[216:217], v46 offset:32768
  v_mfma_f32_16x16x32_bf16 a[184:187], a[248:251], v[252:255], a[184:187]
  ds_read_b64_tr_b16 a[218:219], v46 offset:33792
  v_mfma_f32_16x16x32_bf16 a[156:159], a[252:255], v[248:251], a[156:159]
  ds_read_b64_tr_b16 a[220:221], v47 offset:32768
  buffer_load_dwordx4 v49, s[80:83], s89 offen offset:1024 lds
  v_mfma_f32_16x16x32_bf16 a[188:191], a[252:255], v[252:255], a[188:191]
  ds_read_b64_tr_b16 a[222:223], v47 offset:33792
  s_waitcnt lgkmcnt(8)
  v_mfma_f32_16x16x32_bf16 a[128:131], a[192:195], v[160:163], a[128:131]
  ds_read_b64_tr_b16 a[224:225], v40 offset:40960
  v_mfma_f32_16x16x32_bf16 a[160:163], a[192:195], v[164:167], a[160:163]
  ds_read_b64_tr_b16 a[226:227], v40 offset:41984
  v_mfma_f32_16x16x32_bf16 a[132:135], a[196:199], v[160:163], a[132:135]
  ds_read_b64_tr_b16 a[228:229], v41 offset:40960
  v_mfma_f32_16x16x32_bf16 a[164:167], a[196:199], v[164:167], a[164:167]
  ds_read_b64_tr_b16 a[230:231], v41 offset:41984
  buffer_load_dwordx4 v[232:235], v52, s[76:79], s88 offen offset:1024
  v_mfma_f32_16x16x32_bf16 a[136:139], a[200:203], v[160:163], a[136:139]
  ds_read_b64_tr_b16 a[232:233], v42 offset:40960
  v_mfma_f32_16x16x32_bf16 a[168:171], a[200:203], v[164:167], a[168:171]
  ds_read_b64_tr_b16 a[234:235], v42 offset:41984
  v_mfma_f32_16x16x32_bf16 a[140:143], a[204:207], v[160:163], a[140:143]
  ds_read_b64_tr_b16 a[236:237], v43 offset:40960
  buffer_load_dwordx4 v50, s[80:83], s89 offen offset:2048 lds
  v_mfma_f32_16x16x32_bf16 a[172:175], a[204:207], v[164:167], a[172:175]
  ds_read_b64_tr_b16 a[238:239], v43 offset:41984
  s_waitcnt lgkmcnt(8)
  v_mfma_f32_16x16x32_bf16 a[144:147], a[208:211], v[160:163], a[144:147]
  ds_read_b64_tr_b16 a[240:241], v44 offset:40960
  v_mfma_f32_16x16x32_bf16 a[176:179], a[208:211], v[164:167], a[176:179]
  ds_read_b64_tr_b16 a[242:243], v44 offset:41984
  v_mfma_f32_16x16x32_bf16 a[148:151], a[212:215], v[160:163], a[148:151]
  ds_read_b64_tr_b16 a[244:245], v45 offset:40960
  v_mfma_f32_16x16x32_bf16 a[180:183], a[212:215], v[164:167], a[180:183]
  ds_read_b64_tr_b16 a[246:247], v45 offset:41984
  buffer_load_dwordx4 v[236:239], v53, s[76:79], s88 offen offset:1024
  v_mfma_f32_16x16x32_bf16 a[152:155], a[216:219], v[160:163], a[152:155]
  ds_read_b64_tr_b16 a[248:249], v46 offset:40960
  v_mfma_f32_16x16x32_bf16 a[184:187], a[216:219], v[164:167], a[184:187]
  ds_read_b64_tr_b16 a[250:251], v46 offset:41984
  v_mfma_f32_16x16x32_bf16 a[156:159], a[220:223], v[160:163], a[156:159]
  ds_read_b64_tr_b16 a[252:253], v47 offset:40960
  buffer_load_dwordx4 v51, s[80:83], s89 offen offset:3072 lds
  v_mfma_f32_16x16x32_bf16 a[188:191], a[220:223], v[164:167], a[188:191]
  ds_read_b64_tr_b16 a[254:255], v47 offset:41984
  s_add_u32 s89, s89, 0x60000
  s_waitcnt vmcnt(13)
  s_barrier
  s_waitcnt lgkmcnt(8)
  v_mfma_f32_16x16x32_bf16 a[128:131], a[224:227], v[168:171], a[128:131]
  ds_read_b64_tr_b16 a[192:193], v40 offset:49152
  v_mfma_f32_16x16x32_bf16 a[160:163], a[224:227], v[172:175], a[160:163]
  ds_read_b64_tr_b16 a[194:195], v40 offset:50176
  v_mfma_f32_16x16x32_bf16 a[132:135], a[228:231], v[168:171], a[132:135]
  ds_read_b64_tr_b16 a[196:197], v41 offset:49152
  v_mfma_f32_16x16x32_bf16 a[164:167], a[228:231], v[172:175], a[164:167]
  ds_read_b64_tr_b16 a[198:199], v41 offset:50176
  buffer_load_dwordx4 v[240:243], v52, s[76:79], s88 offen offset:2048
  v_mfma_f32_16x16x32_bf16 a[136:139], a[232:235], v[168:171], a[136:139]
  ds_read_b64_tr_b16 a[200:201], v42 offset:49152
  v_mfma_f32_16x16x32_bf16 a[168:171], a[232:235], v[172:175], a[168:171]
  ds_read_b64_tr_b16 a[202:203], v42 offset:50176
  s_add_u32 m0, s90, 0x8000
  v_mfma_f32_16x16x32_bf16 a[140:143], a[236:239], v[168:171], a[140:143]
  ds_read_b64_tr_b16 a[204:205], v43 offset:49152
  buffer_load_dwordx4 v48, s[80:83], s89 offen offset:0 lds
  v_mfma_f32_16x16x32_bf16 a[172:175], a[236:239], v[172:175], a[172:175]
  ds_read_b64_tr_b16 a[206:207], v43 offset:50176
  s_waitcnt lgkmcnt(8)
  v_mfma_f32_16x16x32_bf16 a[144:147], a[240:243], v[168:171], a[144:147]
  ds_read_b64_tr_b16 a[208:209], v44 offset:49152
  v_mfma_f32_16x16x32_bf16 a[176:179], a[240:243], v[172:175], a[176:179]
  ds_read_b64_tr_b16 a[210:211], v44 offset:50176
  v_mfma_f32_16x16x32_bf16 a[148:151], a[244:247], v[168:171], a[148:151]
  ds_read_b64_tr_b16 a[212:213], v45 offset:49152
  v_mfma_f32_16x16x32_bf16 a[180:183], a[244:247], v[172:175], a[180:183]
  ds_read_b64_tr_b16 a[214:215], v45 offset:50176
  buffer_load_dwordx4 v[244:247], v53, s[76:79], s88 offen offset:2048
  v_mfma_f32_16x16x32_bf16 a[152:155], a[248:251], v[168:171], a[152:155]
  ds_read_b64_tr_b16 a[216:217], v46 offset:49152
  v_mfma_f32_16x16x32_bf16 a[184:187], a[248:251], v[172:175], a[184:187]
  ds_read_b64_tr_b16 a[218:219], v46 offset:50176
  v_mfma_f32_16x16x32_bf16 a[156:159], a[252:255], v[168:171], a[156:159]
  ds_read_b64_tr_b16 a[220:221], v47 offset:49152
  buffer_load_dwordx4 v49, s[80:83], s89 offen offset:1024 lds
  v_mfma_f32_16x16x32_bf16 a[188:191], a[252:255], v[172:175], a[188:191]
  ds_read_b64_tr_b16 a[222:223], v47 offset:50176
  s_waitcnt lgkmcnt(8)
  v_mfma_f32_16x16x32_bf16 a[128:131], a[192:195], v[176:179], a[128:131]
  ds_read_b64_tr_b16 a[224:225], v40 offset:57344
  v_mfma_f32_16x16x32_bf16 a[160:163], a[192:195], v[180:183], a[160:163]
  ds_read_b64_tr_b16 a[226:227], v40 offset:58368
  v_mfma_f32_16x16x32_bf16 a[132:135], a[196:199], v[176:179], a[132:135]
  ds_read_b64_tr_b16 a[228:229], v41 offset:57344
  v_mfma_f32_16x16x32_bf16 a[164:167], a[196:199], v[180:183], a[164:167]
  ds_read_b64_tr_b16 a[230:231], v41 offset:58368
  buffer_load_dwordx4 v[248:251], v52, s[76:79], s88 offen offset:3072
  v_mfma_f32_16x16x32_bf16 a[136:139], a[200:203], v[176:179], a[136:139]
  ds_read_b64_tr_b16 a[232:233], v42 offset:57344
  v_mfma_f32_16x16x32_bf16 a[168:171], a[200:203], v[180:183], a[168:171]
  ds_read_b64_tr_b16 a[234:235], v42 offset:58368
  v_mfma_f32_16x16x32_bf16 a[140:143], a[204:207], v[176:179], a[140:143]
  ds_read_b64_tr_b16 a[236:237], v43 offset:57344
  buffer_load_dwordx4 v50, s[80:83], s89 offen offset:2048 lds
  v_mfma_f32_16x16x32_bf16 a[172:175], a[204:207], v[180:183], a[172:175]
  ds_read_b64_tr_b16 a[238:239], v43 offset:58368
  s_waitcnt lgkmcnt(8)
  v_mfma_f32_16x16x32_bf16 a[144:147], a[208:211], v[176:179], a[144:147]
  ds_read_b64_tr_b16 a[240:241], v44 offset:57344
  v_mfma_f32_16x16x32_bf16 a[176:179], a[208:211], v[180:183], a[176:179]
  ds_read_b64_tr_b16 a[242:243], v44 offset:58368
  v_mfma_f32_16x16x32_bf16 a[148:151], a[212:215], v[176:179], a[148:151]
  ds_read_b64_tr_b16 a[244:245], v45 offset:57344
  v_mfma_f32_16x16x32_bf16 a[180:183], a[212:215], v[180:183], a[180:183]
  ds_read_b64_tr_b16 a[246:247], v45 offset:58368
  buffer_load_dwordx4 v[252:255], v53, s[76:79], s88 offen offset:3072
  v_mfma_f32_16x16x32_bf16 a[152:155], a[216:219], v[176:179], a[152:155]
  ds_read_b64_tr_b16 a[248:249], v46 offset:57344
  s_add_u32 s88, s88, 0x1000
  v_mfma_f32_16x16x32_bf16 a[184:187], a[216:219], v[180:183], a[184:187]
  ds_read_b64_tr_b16 a[250:251], v46 offset:58368
  v_mfma_f32_16x16x32_bf16 a[156:159], a[220:223], v[176:179], a[156:159]
  ds_read_b64_tr_b16 a[252:253], v47 offset:57344
  buffer_load_dwordx4 v51, s[80:83], s89 offen offset:3072 lds
  v_mfma_f32_16x16x32_bf16 a[188:191], a[220:223], v[180:183], a[188:191]
  ds_read_b64_tr_b16 a[254:255], v47 offset:58368
  s_add_u32 s89, s89, 0x20000
  s_waitcnt vmcnt(13)
  s_barrier
  s_waitcnt lgkmcnt(8)
  v_mfma_f32_16x16x32_bf16 a[128:131], a[224:227], v[184:187], a[128:131]
  ds_read_b64_tr_b16 a[192:193], v32 offset:0
  v_mfma_f32_16x16x32_bf16 a[160:163], a[224:227], v[188:191], a[160:163]
  ds_read_b64_tr_b16 a[194:195], v32 offset:1024
  v_mfma_f32_16x16x32_bf16 a[132:135], a[228:231], v[184:187], a[132:135]
  ds_read_b64_tr_b16 a[196:197], v33 offset:0
  v_mfma_f32_16x16x32_bf16 a[164:167], a[228:231], v[188:191], a[164:167]
  ds_read_b64_tr_b16 a[198:199], v33 offset:1024
  buffer_load_dwordx4 v[160:163], v52, s[76:79], s88 offen offset:0
  v_mfma_f32_16x16x32_bf16 a[136:139], a[232:235], v[184:187], a[136:139]
  ds_read_b64_tr_b16 a[200:201], v34 offset:0
  v_mfma_f32_16x16x32_bf16 a[168:171], a[232:235], v[188:191], a[168:171]
  ds_read_b64_tr_b16 a[202:203], v34 offset:1024
  s_add_u32 m0, s90, 0xc000
  v_mfma_f32_16x16x32_bf16 a[140:143], a[236:239], v[184:187], a[140:143]
  ds_read_b64_tr_b16 a[204:205], v35 offset:0
  buffer_load_dwordx4 v48, s[80:83], s89 offen offset:0 lds
  v_mfma_f32_16x16x32_bf16 a[172:175], a[236:239], v[188:191], a[172:175]
  ds_read_b64_tr_b16 a[206:207], v35 offset:1024
  s_waitcnt lgkmcnt(8)
  v_mfma_f32_16x16x32_bf16 a[144:147], a[240:243], v[184:187], a[144:147]
  ds_read_b64_tr_b16 a[208:209], v36 offset:0
  v_mfma_f32_16x16x32_bf16 a[176:179], a[240:243], v[188:191], a[176:179]
  ds_read_b64_tr_b16 a[210:211], v36 offset:1024
  v_mfma_f32_16x16x32_bf16 a[148:151], a[244:247], v[184:187], a[148:151]
  ds_read_b64_tr_b16 a[212:213], v37 offset:0
  v_mfma_f32_16x16x32_bf16 a[180:183], a[244:247], v[188:191], a[180:183]
  ds_read_b64_tr_b16 a[214:215], v37 offset:1024
  buffer_load_dwordx4 v[164:167], v53, s[76:79], s88 offen offset:0
  v_mfma_f32_16x16x32_bf16 a[152:155], a[248:251], v[184:187], a[152:155]
  ds_read_b64_tr_b16 a[216:217], v38 offset:0
  v_mfma_f32_16x16x32_bf16 a[184:187], a[248:251], v[188:191], a[184:187]
  ds_read_b64_tr_b16 a[218:219], v38 offset:1024
  s_add_u32 s91, s91, 1
  v_mfma_f32_16x16x32_bf16 a[156:159], a[252:255], v[184:187], a[156:159]
  ds_read_b64_tr_b16 a[220:221], v39 offset:0
  buffer_load_dwordx4 v49, s[80:83], s89 offen offset:1024 lds
  v_mfma_f32_16x16x32_bf16 a[188:191], a[252:255], v[188:191], a[188:191]
  ds_read_b64_tr_b16 a[222:223], v39 offset:1024
  s_cmp_lt_u32 s91, 8
  s_cbranch_scc1 L2_loop
  v_accvgpr_read_b32 v64, a128
  v_accvgpr_read_b32 v65, a129
  v_accvgpr_read_b32 v66, a130
  v_accvgpr_read_b32 v67, a131
  v_accvgpr_read_b32 v68, a132
  v_accvgpr_read_b32 v69, a133
  v_accvgpr_read_b32 v70, a134
  v_accvgpr_read_b32 v71, a135
  v_cvt_pk_bf16_f32 v80, v64, v65
  v_cvt_pk_bf16_f32 v81, v66, v67
  v_cvt_pk_bf16_f32 v82, v68, v69
  v_cvt_pk_bf16_f32 v83, v70, v71
  s_nop 0
  v_permlane16_swap_b32 v80, v82
  v_permlane16_swap_b32 v81, v83
  buffer_store_dwordx4 v[80:83], v54, s[84:87], 0 offen offset:0 sc1 nt
  v_accvgpr_read_b32 v72, a136
  v_accvgpr_read_b32 v73, a137
  v_accvgpr_read_b32 v74, a138
  v_accvgpr_read_b32 v75, a139
  v_accvgpr_read_b32 v76, a140
  v_accvgpr_read_b32 v77, a141
  v_accvgpr_read_b32 v78, a142
  v_accvgpr_read_b32 v79, a143
  v_cvt_pk_bf16_f32 v84, v72, v73
  v_cvt_pk_bf16_f32 v85, v74, v75
  v_cvt_pk_bf16_f32 v86, v76, v77
  v_cvt_pk_bf16_f32 v87, v78, v79
  s_nop 0
  v_permlane16_swap_b32 v84, v86
  v_permlane16_swap_b32 v85, v87
  buffer_store_dwordx4 v[84:87], v54, s[84:87], 0 offen offset:64 sc1 nt
  v_accvgpr_read_b32 v64, a144
  v_accvgpr_read_b32 v65, a145
  v_accvgpr_read_b32 v66, a146
  v_accvgpr_read_b32 v67, a147
  v_accvgpr_read_b32 v68, a148
  v_accvgpr_read_b32 v69, a149
  v_accvgpr_read_b32 v70, a150
  v_accvgpr_read_b32 v71, a151
  v_cvt_pk_bf16_f32 v88, v64, v65
  v_cvt_pk_bf16_f32 v89, v66, v67
  v_cvt_pk_bf16_f32 v90, v68, v69
  v_cvt_pk_bf16_f32 v91, v70, v71
  s_nop 0
  v_permlane16_swap_b32 v88, v90
  v_permlane16_swap_b32 v89, v91
  buffer_store_dwordx4 v[88:91], v54, s[84:87], 0 offen offset:128 sc1 nt
  v_accvgpr_read_b32 v72, a152
  v_accvgpr_read_b32 v73, a153
  v_accvgpr_read_b32 v74, a154
  v_accvgpr_read_b32 v75, a155
  v_accvgpr_read_b32 v76, a156
  v_accvgpr_read_b32 v77, a157
  v_accvgpr_read_b32 v78, a158
  v_accvgpr_read_b32 v79, a159
  v_cvt_pk_bf16_f32 v92, v72, v73
  v_cvt_pk_bf16_f32 v93, v74, v75
  v_cvt_pk_bf16_f32 v94, v76, v77
  v_cvt_pk_bf16_f32 v95, v78, v79
  s_nop 0
  v_permlane16_swap_b32 v92, v94
  v_permlane16_swap_b32 v93, v95
  buffer_store_dwordx4 v[92:95], v54, s[84:87], 0 offen offset:192 sc1 nt
  v_accvgpr_read_b32 v64, a160
  v_accvgpr_read_b32 v65, a161
  v_accvgpr_read_b32 v66, a162
  v_accvgpr_read_b32 v67, a163
  v_accvgpr_read_b32 v68, a164
  v_accvgpr_read_b32 v69, a165
  v_accvgpr_read_b32 v70, a166
  v_accvgpr_read_b32 v71, a167
  v_cvt_pk_bf16_f32 v96, v64, v65
  v_cvt_pk_bf16_f32 v97, v66, v67
  v_cvt_pk_bf16_f32 v98, v68, v69
  v_cvt_pk_bf16_f32 v99, v70, v71
  s_nop 0
  v_permlane16_swap_b32 v96, v98
  v_permlane16_swap_b32 v97, v99
  buffer_store_dwordx4 v[96:99], v55, s[84:87], 0 offen offset:0 sc1 nt
  v_accvgpr_read_b32 v72, a168
  v_accvgpr_read_b32 v73, a169
  v_accvgpr_read_b32 v74, a170
  v_accvgpr_read_b32 v75, a171
  v_accvgpr_read_b32 v76, a172
  v_accvgpr_read_b32 v77, a173
  v_accvgpr_read_b32 v78, a174
  v_accvgpr_read_b32 v79, a175
  v_cvt_pk_bf16_f32 v100, v72, v73
  v_cvt_pk_bf16_f32 v101, v74, v75
  v_cvt_pk_bf16_f32 v102, v76, v77
  v_cvt_pk_bf16_f32 v103, v78, v79
  s_nop 0
  v_permlane16_swap_b32 v100, v102
  v_permlane16_swap_b32 v101, v103
  buffer_store_dwordx4 v[100:103], v55, s[84:87], 0 offen offset:64 sc1 nt
  v_accvgpr_read_b32 v64, a176
  v_accvgpr_read_b32 v65, a177
  v_accvgpr_read_b32 v66, a178
  v_accvgpr_read_b32 v67, a179
  v_accvgpr_read_b32 v68, a180
  v_accvgpr_read_b32 v69, a181
  v_accvgpr_read_b32 v70, a182
  v_accvgpr_read_b32 v71, a183
  v_cvt_pk_bf16_f32 v104, v64, v65
  v_cvt_pk_bf16_f32 v105, v66, v67
  v_cvt_pk_bf16_f32 v106, v68, v69
  v_cvt_pk_bf16_f32 v107, v70, v71
  s_nop 0
  v_permlane16_swap_b32 v104, v106
  v_permlane16_swap_b32 v105, v107
  buffer_store_dwordx4 v[104:107], v55, s[84:87], 0 offen offset:128 sc1 nt
  v_accvgpr_read_b32 v72, a184
  v_accvgpr_read_b32 v73, a185
  v_accvgpr_read_b32 v74, a186
  v_accvgpr_read_b32 v75, a187
  v_accvgpr_read_b32 v76, a188
  v_accvgpr_read_b32 v77, a189
  v_accvgpr_read_b32 v78, a190
  v_accvgpr_read_b32 v79, a191
  v_cvt_pk_bf16_f32 v108, v72, v73
  v_cvt_pk_bf16_f32 v109, v74, v75
  v_cvt_pk_bf16_f32 v110, v76, v77
  v_cvt_pk_bf16_f32 v111, v78, v79
  s_nop 0
  v_permlane16_swap_b32 v108, v110
  v_permlane16_swap_b32 v109, v111
  buffer_store_dwordx4 v[108:111], v55, s[84:87], 0 offen offset:192 sc1 nt
L1_end:
  s_endpgm
L1_sig:
  s_mov_b64 exec, 1
  buffer_atomic_add v7, off, s[72:75], s41 offset:0
  s_mov_b64 exec, -1
  s_branch L1_sig_ret
L2_poll:
  buffer_load_dword v4, v3, s[72:75], 0 offen offset:4 sc1
  s_branch L2_poll_ret
L2_stw:
  s_waitcnt vmcnt(26)
  s_branch L2_stw_ret
L2_sig:
  s_mov_b64 exec, 1
  buffer_atomic_add v7, off, s[72:75], s41 offset:4
  s_mov_b64 exec, -1
  s_branch L2_sig_ret
L2_chk:
  s_waitcnt vmcnt(32)
  v_cmp_gt_u32 vcc, 16, v4
  s_cbranch_vccnz L_spin1
L_spin1_ret:
  s_branch L2_chk_ret
L1_cam:
  s_call_b64 s[44:45], L1_slowa0f
  s_branch L1_ram
L1_cbJ0:
  s_call_b64 s[44:45], L1_slowb0f
  s_branch L1_rbJ0
L1_caJ0:
  s_call_b64 s[44:45], L1_slowa0
  s_branch L1_raJ0
L1_cbJ1:
  s_call_b64 s[44:45], L1_slowb0
  s_branch L1_rbJ1
L1_caJ1:
  s_call_b64 s[44:45], L1_slowa0
  s_branch L1_raJ1
L1_cbJ2:
  s_call_b64 s[44:45], L1_slowb0
  s_branch L1_rbJ2
L1_caJ2:
  s_call_b64 s[44:45], L1_slowa0
  s_branch L1_raJ2
L1_cbJ3:
  s_call_b64 s[44:45], L1_slowb0
  s_branch L1_rbJ3
L1_caJ3:
  s_call_b64 s[44:45], L1_slowa0
  s_branch L1_raJ3
L1_cbJ4:
  s_call_b64 s[44:45], L1_slowb0
  s_branch L1_rbJ4
L1_caJ4:
  s_call_b64 s[44:45], L1_slowa0
  s_branch L1_raJ4
L1_cbJ5:
  s_call_b64 s[44:45], L1_slowb0
  s_branch L1_rbJ5
L1_caJ5:
  s_call_b64 s[44:45], L1_slowa0
  s_branch L1_raJ5
L1_cbJ6:
  s_call_b64 s[44:45], L1_slowb0
  s_branch L1_rbJ6
L1_caJ6:
  s_call_b64 s[44:45], L1_slowa0
  s_branch L1_raJ6
L1_cbJ7:
  s_call_b64 s[44:45], L1_slowb0
  s_branch L1_rbJ7
L1_caJ7:
  s_call_b64 s[44:45], L1_slowa0
  s_branch L1_raJ7
L1_cbJ8:
  s_call_b64 s[44:45], L1_slowb0
  s_branch L1_rbJ8
L1_caJ8:
  s_call_b64 s[44:45], L1_slowa0
  s_branch L1_raJ8
L1_cbJ9:
  s_call_b64 s[44:45], L1_slowb0
  s_branch L1_rbJ9
L1_caJ9:
  s_call_b64 s[44:45], L1_slowa0
  s_branch L1_raJ9
L1_cbJ10:
  s_call_b64 s[44:45], L1_slowb0
  s_branch L1_rbJ10
L1_caJ10:
  s_call_b64 s[44:45], L1_slowa0
  s_branch L1_raJ10
L1_cbJ11:
  s_call_b64 s[44:45], L1_slowb0
  s_branch L1_rbJ11
L1_caJ11:
  s_call_b64 s[44:45], L1_slowa0
  s_branch L1_raJ11
L1_cbJ12:
  s_call_b64 s[44:45], L1_slowb0
  s_branch L1_rbJ12
L1_caJ12:
  s_call_b64 s[44:45], L1_slowa0
  s_branch L1_raJ12
L1_cbJ13:
  s_call_b64 s[44:45], L1_slowb0
  s_branch L1_rbJ13
L1_caJ13:
  s_call_b64 s[44:45], L1_slowa0
  s_branch L1_raJ13
L1_cbJ14:
  s_call_b64 s[44:45], L1_slowb0
  s_branch L1_rbJ14
L1_caJ14:
  s_call_b64 s[44:45], L1_slowa0
  s_branch L1_raJ14
L1_cbp0:
  s_call_b64 s[44:45], L1_slowb0
  s_branch L1_rbp0
L1_cap0:
  s_call_b64 s[44:45], L1_slowa0
  s_branch L1_rap0
L1_cbp1:
  s_call_b64 s[44:45], L1_slowb0
  s_branch L1_rbp1
L1_cap1:
  s_call_b64 s[44:45], L1_slowa0
  s_branch L1_rap1
L1_cbp2:
  s_call_b64 s[44:45], L1_slowb0
  s_branch L1_rbp2
L1_cap2:
  s_call_b64 s[44:45], L1_slowa0
  s_branch L1_rap2
L1_cbp3:
  s_call_b64 s[44:45], L1_slowb0
  s_branch L1_rbp3
L1_cap3:
  s_call_b64 s[44:45], L1_slowa0
  s_branch L1_rap3
L1_cbp4:
  s_call_b64 s[44:45], L1_slowb0
  s_branch L1_rbp4
L1_cap4:
  s_call_b64 s[44:45], L1_slowa0
  s_branch L1_rap4
L1_cbp5:
  s_call_b64 s[44:45], L1_slowb0
  s_branch L1_rbp5
L1_cap5:
  s_call_b64 s[44:45], L1_slowa0
  s_branch L1_rap5
L1_cbp6:
  s_call_b64 s[44:45], L1_slowb0
  s_branch L1_rbp6
L1_cap6:
  s_call_b64 s[44:45], L1_slowa0
  s_branch L1_rap6
L1_cbp7:
  s_call_b64 s[44:45], L1_slowb0
  s_branch L1_rbp7
L1_cap7:
  s_call_b64 s[44:45], L1_slowa0
  s_branch L1_rap7
L1_cbJ31:
  s_call_b64 s[44:45], L1_slowb0
  s_branch L1_rbJ31
L1_caJ31:
  s_call_b64 s[44:45], L1_slowa1f
  s_branch L1_raJ31
L1_cbJ32:
  s_call_b64 s[44:45], L1_slowb1f
  s_branch L1_rbJ32
L1_caJ32:
  s_call_b64 s[44:45], L1_slowa1
  s_branch L1_raJ32
L1_cbJ33:
  s_call_b64 s[44:45], L1_slowb1
  s_branch L1_rbJ33
L1_caJ33:
  s_call_b64 s[44:45], L1_slowa1
  s_branch L1_raJ33
L1_cbJ34:
  s_call_b64 s[44:45], L1_slowb1
  s_branch L1_rbJ34
L1_caJ34:
  s_call_b64 s[44:45], L1_slowa1
  s_branch L1_raJ34
L1_cbJ35:
  s_call_b64 s[44:45], L1_slowb1
  s_branch L1_rbJ35
L1_caJ35:
  s_call_b64 s[44:45], L1_slowa1
  s_branch L1_raJ35
L1_cbJ36:
  s_call_b64 s[44:45], L1_slowb1
  s_branch L1_rbJ36
L1_caJ36:
  s_call_b64 s[44:45], L1_slowa1
  s_branch L1_raJ36
L1_cbJ37:
  s_call_b64 s[44:45], L1_slowb1
  s_branch L1_rbJ37
L1_caJ37:
  s_call_b64 s[44:45], L1_slowa1
  s_branch L1_raJ37
L1_cbJ38:
  s_call_b64 s[44:45], L1_slowb1
  s_branch L1_rbJ38
L1_caJ38:
  s_call_b64 s[44:45], L1_slowa1
  s_branch L1_raJ38
L1_cbJ39:
  s_call_b64 s[44:45], L1_slowb1
  s_branch L1_rbJ39
L1_caJ39:
  s_call_b64 s[44:45], L1_slowa1
  s_branch L1_raJ39
L1_cbq0:
  s_call_b64 s[44:45], L1_slowb1
  s_branch L1_rbq0
L1_caq0:
  s_call_b64 s[44:45], L1_slowa1
  s_branch L1_raq0
L1_cbq1:
  s_call_b64 s[44:45], L1_slowb1
  s_branch L1_rbq1
L1_caq1:
  s_call_b64 s[44:45], L1_slowa1
  s_branch L1_raq1
L1_cbq2:
  s_call_b64 s[44:45], L1_slowb1
  s_branch L1_rbq2
L1_caq2:
  s_call_b64 s[44:45], L1_slowa1
  s_branch L1_raq2
L1_cbq3:
  s_call_b64 s[44:45], L1_slowb1
  s_branch L1_rbq3
L1_caq3:
  s_call_b64 s[44:45], L1_slowa1
  s_branch L1_raq3
L1_cbq4:
  s_call_b64 s[44:45], L1_slowb1
  s_branch L1_rbq4
L1_caq4:
  s_call_b64 s[44:45], L1_slowa1
  s_branch L1_raq4
L1_cbq5:
  s_call_b64 s[44:45], L1_slowb1
  s_branch L1_rbq5
L1_caq5:
  s_call_b64 s[44:45], L1_slowa1
  s_branch L1_raq5
L1_cbq6:
  s_call_b64 s[44:45], L1_slowb1
  s_branch L1_rbq6
L1_caq6:
  s_call_b64 s[44:45], L1_slowa1
  s_branch L1_raq6
L1_cbq7:
  s_call_b64 s[44:45], L1_slowb1
  s_branch L1_rbq7
L1_caq7:
  s_call_b64 s[44:45], L1_slowa1
  s_branch L1_raq7
L1_cbJ56:
  s_call_b64 s[44:45], L1_slowb1
  s_branch L1_rbJ56
L1_caJ56:
  s_call_b64 s[44:45], L1_slowa1
  s_branch L1_raJ56
L1_cbJ57:
  s_call_b64 s[44:45], L1_slowb1
  s_branch L1_rbJ57
L1_caJ57:
  s_call_b64 s[44:45], L1_slowa1
  s_branch L1_raJ57
L1_cbJ58:
  s_call_b64 s[44:45], L1_slowb1
  s_branch L1_rbJ58
L1_caJ58:
  s_call_b64 s[44:45], L1_slowa1
  s_branch L1_raJ58
L1_cbJ59:
  s_call_b64 s[44:45], L1_slowb1
  s_branch L1_rbJ59
L1_caJ59:
  s_call_b64 s[44:45], L1_slowa1
  s_branch L1_raJ59
L1_cbJ60:
  s_call_b64 s[44:45], L1_slowb1
  s_branch L1_rbJ60
L1_caJ60:
  s_call_b64 s[44:45], L1_slowa1
  s_branch L1_raJ60
L1_cbJ61:
  s_call_b64 s[44:45], L1_slowb1
  s_branch L1_rbJ61
L1_caJ61:
  s_call_b64 s[44:45], L1_slowa1
  s_branch L1_raJ61
L1_cbJ62:
  s_call_b64 s[44:45], L1_slowb1
  s_branch L1_rbJ62
L1_caJ62:
  s_call_b64 s[44:45], L1_slowa1
  s_branch L1_raJ62
L1_cbz:
  s_call_b64 s[44:45], L1_slowb1
  s_branch L1_rbz
L1_slowa0:
  s_nop 15
  v_max3_f32 v208, v128, v129, v130
  v_max3_f32 v208, v208, v131, v132
  v_max3_f32 v208, v208, v133, v134
  v_max3_f32 v208, v208, v135, v136
  v_max3_f32 v208, v208, v137, v138
  v_max3_f32 v208, v208, v139, v140
  v_max3_f32 v208, v208, v141, v142
  v_max_f32 v208, v208, v143
  v_mov_b32 v209, v208
  s_nop 1
  v_permlane32_swap_b32 v208, v209
  v_max_f32 v208, v208, v209
  v_max_f32 v208, 0, v208
  v_sub_f32 v209, 0, v208
  v_exp_f32 v209, v209
  v_sub_f32 v160, v160, v208
  v_mov_b32 v161, v160
  v_mov_b32 v162, v160
  v_mov_b32 v163, v160
  v_mov_b32 v164, v160
  v_mov_b32 v165, v160
  v_mov_b32 v166, v160
  v_mov_b32 v167, v160
  v_mov_b32 v168, v160
  v_mov_b32 v169, v160
  v_mov_b32 v170, v160
  v_mov_b32 v171, v160
  v_mov_b32 v172, v160
  v_mov_b32 v173, v160
  v_mov_b32 v174, v160
  v_mov_b32 v175, v160
  v_mul_f32 v25, v25, v209
  v_mul_f32 v224, v224, v209
  v_mul_f32 v225, v225, v209
  v_mul_f32 v226, v226, v209
  v_mul_f32 v227, v227, v209
  v_mul_f32 v228, v228, v209
  v_mul_f32 v229, v229, v209
  v_mul_f32 v230, v230, v209
  v_mul_f32 v231, v231, v209
  v_mul_f32 v232, v232, v209
  v_mul_f32 v233, v233, v209
  v_mul_f32 v234, v234, v209
  v_mul_f32 v235, v235, v209
  v_mul_f32 v236, v236, v209
  v_mul_f32 v237, v237, v209
  v_mul_f32 v238, v238, v209
  v_mul_f32 v239, v239, v209
  v_mul_f32 v240, v240, v209
  v_mul_f32 v241, v241, v209
  v_mul_f32 v242, v242, v209
  v_mul_f32 v243, v243, v209
  v_mul_f32 v244, v244, v209
  v_mul_f32 v245, v245, v209
  v_mul_f32 v246, v246, v209
  v_mul_f32 v247, v247, v209
  v_mul_f32 v248, v248, v209
  v_mul_f32 v249, v249, v209
  v_mul_f32 v250, v250, v209
  v_mul_f32 v251, v251, v209
  v_mul_f32 v252, v252, v209
  v_mul_f32 v253, v253, v209
  v_mul_f32 v254, v254, v209
  v_mul_f32 v255, v255, v209
  v_mul_f32 v32, v32, v209
  v_mul_f32 v33, v33, v209
  v_mul_f32 v34, v34, v209
  v_mul_f32 v35, v35, v209
  v_mul_f32 v36, v36, v209
  v_mul_f32 v37, v37, v209
  v_mul_f32 v38, v38, v209
  v_mul_f32 v39, v39, v209
  v_mul_f32 v40, v40, v209
  v_mul_f32 v41, v41, v209
  v_mul_f32 v42, v42, v209
  v_mul_f32 v43, v43, v209
  v_mul_f32 v44, v44, v209
  v_mul_f32 v45, v45, v209
  v_mul_f32 v46, v46, v209
  v_mul_f32 v47, v47, v209
  v_mul_f32 v48, v48, v209
  v_mul_f32 v49, v49, v209
  v_mul_f32 v50, v50, v209
  v_mul_f32 v51, v51, v209
  v_mul_f32 v52, v52, v209
  v_mul_f32 v53, v53, v209
  v_mul_f32 v54, v54, v209
  v_mul_f32 v55, v55, v209
  v_mul_f32 v56, v56, v209
  v_mul_f32 v57, v57, v209
  v_mul_f32 v58, v58, v209
  v_mul_f32 v59, v59, v209
  v_mul_f32 v60, v60, v209
  v_mul_f32 v61, v61, v209
  v_mul_f32 v62, v62, v209
  v_mul_f32 v63, v63, v209
  v_sub_f32 v128, v128, v208
  v_sub_f32 v129, v129, v208
  v_sub_f32 v130, v130, v208
  v_sub_f32 v131, v131, v208
  v_sub_f32 v132, v132, v208
  v_sub_f32 v133, v133, v208
  v_sub_f32 v134, v134, v208
  v_sub_f32 v135, v135, v208
  v_sub_f32 v136, v136, v208
  v_sub_f32 v137, v137, v208
  v_sub_f32 v138, v138, v208
  v_sub_f32 v139, v139, v208
  v_sub_f32 v140, v140, v208
  v_sub_f32 v141, v141, v208
  v_sub_f32 v142, v142, v208
  v_sub_f32 v143, v143, v208
  v_exp_f32 v128, v128
  v_exp_f32 v129, v129
  v_exp_f32 v130, v130
  v_exp_f32 v131, v131
  v_exp_f32 v132, v132
  v_exp_f32 v133, v133
  v_exp_f32 v134, v134
  v_exp_f32 v135, v135
  v_exp_f32 v136, v136
  v_exp_f32 v137, v137
  v_exp_f32 v138, v138
  v_exp_f32 v139, v139
  v_exp_f32 v140, v140
  v_exp_f32 v141, v141
  v_exp_f32 v142, v142
  v_exp_f32 v143, v143
  v_add_f32 v27, v128, v129
  v_add_f32 v27, v27, v130
  v_add_f32 v27, v27, v131
  v_add_f32 v27, v27, v132
  v_add_f32 v27, v27, v133
  v_add_f32 v27, v27, v134
  v_add_f32 v27, v27, v135
  v_add_f32 v27, v27, v136
  v_add_f32 v27, v27, v137
  v_add_f32 v27, v27, v138
  v_add_f32 v27, v27, v139
  v_add_f32 v27, v27, v140
  v_add_f32 v27, v27, v141
  v_add_f32 v27, v27, v142
  v_add_f32 v27, v27, v143
  v_cvt_pk_bf16_f32 v192, v128, v129
  v_cvt_pk_bf16_f32 v193, v130, v131
  v_cvt_pk_bf16_f32 v194, v132, v133
  v_cvt_pk_bf16_f32 v195, v134, v135
  v_cvt_pk_bf16_f32 v196, v136, v137
  v_cvt_pk_bf16_f32 v197, v138, v139
  v_cvt_pk_bf16_f32 v198, v140, v141
  v_cvt_pk_bf16_f32 v199, v142, v143
  s_nop 7
  s_setpc_b64 s[44:45]
L1_slowa0f:
  s_nop 15
  v_max3_f32 v208, v128, v129, v130
  v_max3_f32 v208, v208, v131, v132
  v_max3_f32 v208, v208, v133, v134
  v_max3_f32 v208, v208, v135, v136
  v_max3_f32 v208, v208, v137, v138
  v_max3_f32 v208, v208, v139, v140
  v_max3_f32 v208, v208, v141, v142
  v_max_f32 v208, v208, v143
  v_mov_b32 v209, v208
  s_nop 1
  v_permlane32_swap_b32 v208, v209
  v_max_f32 v208, v208, v209
  v_sub_f32 v160, v160, v208
  v_mov_b32 v161, v160
  v_mov_b32 v162, v160
  v_mov_b32 v163, v160
  v_mov_b32 v164, v160
  v_mov_b32 v165, v160
  v_mov_b32 v166, v160
  v_mov_b32 v167, v160
  v_mov_b32 v168, v160
  v_mov_b32 v169, v160
  v_mov_b32 v170, v160
  v_mov_b32 v171, v160
  v_mov_b32 v172, v160
  v_mov_b32 v173, v160
  v_mov_b32 v174, v160
  v_mov_b32 v175, v160
  v_sub_f32 v128, v128, v208
  v_sub_f32 v129, v129, v208
  v_sub_f32 v130, v130, v208
  v_sub_f32 v131, v131, v208
  v_sub_f32 v132, v132, v208
  v_sub_f32 v133, v133, v208
  v_sub_f32 v134, v134, v208
  v_sub_f32 v135, v135, v208
  v_sub_f32 v136, v136, v208
  v_sub_f32 v137, v137, v208
  v_sub_f32 v138, v138, v208
  v_sub_f32 v139, v139, v208
  v_sub_f32 v140, v140, v208
  v_sub_f32 v141, v141, v208
  v_sub_f32 v142, v142, v208
  v_sub_f32 v143, v143, v208
  v_exp_f32 v128, v128
  v_exp_f32 v129, v129
  v_exp_f32 v130, v130
  v_exp_f32 v131, v131
  v_exp_f32 v132, v132
  v_exp_f32 v133, v133
  v_exp_f32 v134, v134
  v_exp_f32 v135, v135
  v_exp_f32 v136, v136
  v_exp_f32 v137, v137
  v_exp_f32 v138, v138
  v_exp_f32 v139, v139
  v_exp_f32 v140, v140
  v_exp_f32 v141, v141
  v_exp_f32 v142, v142
  v_exp_f32 v143, v143
  v_add_f32 v27, v128, v129
  v_add_f32 v27, v27, v130
  v_add_f32 v27, v27, v131
  v_add_f32 v27, v27, v132
  v_add_f32 v27, v27, v133
  v_add_f32 v27, v27, v134
  v_add_f32 v27, v27, v135
  v_add_f32 v27, v27, v136
  v_add_f32 v27, v27, v137
  v_add_f32 v27, v27, v138
  v_add_f32 v27, v27, v139
  v_add_f32 v27, v27, v140
  v_add_f32 v27, v27, v141
  v_add_f32 v27, v27, v142
  v_add_f32 v27, v27, v143
  v_cvt_pk_bf16_f32 v192, v128, v129
  v_cvt_pk_bf16_f32 v193, v130, v131
  v_cvt_pk_bf16_f32 v194, v132, v133
  v_cvt_pk_bf16_f32 v195, v134, v135
  v_cvt_pk_bf16_f32 v196, v136, v137
  v_cvt_pk_bf16_f32 v197, v138, v139
  v_cvt_pk_bf16_f32 v198, v140, v141
  v_cvt_pk_bf16_f32 v199, v142, v143
  s_nop 7
  s_setpc_b64 s[44:45]
L1_slowb0:
  s_nop 15
  v_max3_f32 v216, v144, v145, v146
  v_max3_f32 v216, v216, v147, v148
  v_max3_f32 v216, v216, v149, v150
  v_max3_f32 v216, v216, v151, v152
  v_max3_f32 v216, v216, v153, v154
  v_max3_f32 v216, v216, v155, v156
  v_max3_f32 v216, v216, v157, v158
  v_max_f32 v216, v216, v159
  v_mov_b32 v217, v216
  s_nop 1
  v_permlane32_swap_b32 v216, v217
  v_max_f32 v216, v216, v217
  v_max_f32 v216, 0, v216
  v_sub_f32 v217, 0, v216
  v_exp_f32 v217, v217
  v_sub_f32 v176, v176, v216
  v_mov_b32 v177, v176
  v_mov_b32 v178, v176
  v_mov_b32 v179, v176
  v_mov_b32 v180, v176
  v_mov_b32 v181, v176
  v_mov_b32 v182, v176
  v_mov_b32 v183, v176
  v_mov_b32 v184, v176
  v_mov_b32 v185, v176
  v_mov_b32 v186, v176
  v_mov_b32 v187, v176
  v_mov_b32 v188, v176
  v_mov_b32 v189, v176
  v_mov_b32 v190, v176
  v_mov_b32 v191, v176
  v_mul_f32 v26, v26, v217
  v_accvgpr_read_b32 v218, a128
  v_accvgpr_read_b32 v219, a129
  v_accvgpr_read_b32 v220, a130
  v_accvgpr_read_b32 v221, a131
  v_mul_f32 v218, v218, v217
  v_mul_f32 v219, v219, v217
  v_mul_f32 v220, v220, v217
  v_mul_f32 v221, v221, v217
  v_accvgpr_write_b32 a128, v218
  v_accvgpr_write_b32 a129, v219
  v_accvgpr_write_b32 a130, v220
  v_accvgpr_write_b32 a131, v221
  v_accvgpr_read_b32 v218, a132
  v_accvgpr_read_b32 v219, a133
  v_accvgpr_read_b32 v220, a134
  v_accvgpr_read_b32 v221, a135
  v_mul_f32 v218, v218, v217
  v_mul_f32 v219, v219, v217
  v_mul_f32 v220, v220, v217
  v_mul_f32 v221, v221, v217
  v_accvgpr_write_b32 a132, v218
  v_accvgpr_write_b32 a133, v219
  v_accvgpr_write_b32 a134, v220
  v_accvgpr_write_b32 a135, v221
  v_accvgpr_read_b32 v218, a136
  v_accvgpr_read_b32 v219, a137
  v_accvgpr_read_b32 v220, a138
  v_accvgpr_read_b32 v221, a139
  v_mul_f32 v218, v218, v217
  v_mul_f32 v219, v219, v217
  v_mul_f32 v220, v220, v217
  v_mul_f32 v221, v221, v217
  v_accvgpr_write_b32 a136, v218
  v_accvgpr_write_b32 a137, v219
  v_accvgpr_write_b32 a138, v220
  v_accvgpr_write_b32 a139, v221
  v_accvgpr_read_b32 v218, a140
  v_accvgpr_read_b32 v219, a141
  v_accvgpr_read_b32 v220, a142
  v_accvgpr_read_b32 v221, a143
  v_mul_f32 v218, v218, v217
  v_mul_f32 v219, v219, v217
  v_mul_f32 v220, v220, v217
  v_mul_f32 v221, v221, v217
  v_accvgpr_write_b32 a140, v218
  v_accvgpr_write_b32 a141, v219
  v_accvgpr_write_b32 a142, v220
  v_accvgpr_write_b32 a143, v221
  v_accvgpr_read_b32 v218, a144
  v_accvgpr_read_b32 v219, a145
  v_accvgpr_read_b32 v220, a146
  v_accvgpr_read_b32 v221, a147
  v_mul_f32 v218, v218, v217
  v_mul_f32 v219, v219, v217
  v_mul_f32 v220, v220, v217
  v_mul_f32 v221, v221, v217
  v_accvgpr_write_b32 a144, v218
  v_accvgpr_write_b32 a145, v219
  v_accvgpr_write_b32 a146, v220
  v_accvgpr_write_b32 a147, v221
  v_accvgpr_read_b32 v218, a148
  v_accvgpr_read_b32 v219, a149
  v_accvgpr_read_b32 v220, a150
  v_accvgpr_read_b32 v221, a151
  v_mul_f32 v218, v218, v217
  v_mul_f32 v219, v219, v217
  v_mul_f32 v220, v220, v217
  v_mul_f32 v221, v221, v217
  v_accvgpr_write_b32 a148, v218
  v_accvgpr_write_b32 a149, v219
  v_accvgpr_write_b32 a150, v220
  v_accvgpr_write_b32 a151, v221
  v_accvgpr_read_b32 v218, a152
  v_accvgpr_read_b32 v219, a153
  v_accvgpr_read_b32 v220, a154
  v_accvgpr_read_b32 v221, a155
  v_mul_f32 v218, v218, v217
  v_mul_f32 v219, v219, v217
  v_mul_f32 v220, v220, v217
  v_mul_f32 v221, v221, v217
  v_accvgpr_write_b32 a152, v218
  v_accvgpr_write_b32 a153, v219
  v_accvgpr_write_b32 a154, v220
  v_accvgpr_write_b32 a155, v221
  v_accvgpr_read_b32 v218, a156
  v_accvgpr_read_b32 v219, a157
  v_accvgpr_read_b32 v220, a158
  v_accvgpr_read_b32 v221, a159
  v_mul_f32 v218, v218, v217
  v_mul_f32 v219, v219, v217
  v_mul_f32 v220, v220, v217
  v_mul_f32 v221, v221, v217
  v_accvgpr_write_b32 a156, v218
  v_accvgpr_write_b32 a157, v219
  v_accvgpr_write_b32 a158, v220
  v_accvgpr_write_b32 a159, v221
  v_accvgpr_read_b32 v218, a160
  v_accvgpr_read_b32 v219, a161
  v_accvgpr_read_b32 v220, a162
  v_accvgpr_read_b32 v221, a163
  v_mul_f32 v218, v218, v217
  v_mul_f32 v219, v219, v217
  v_mul_f32 v220, v220, v217
  v_mul_f32 v221, v221, v217
  v_accvgpr_write_b32 a160, v218
  v_accvgpr_write_b32 a161, v219
  v_accvgpr_write_b32 a162, v220
  v_accvgpr_write_b32 a163, v221
  v_accvgpr_read_b32 v218, a164
  v_accvgpr_read_b32 v219, a165
  v_accvgpr_read_b32 v220, a166
  v_accvgpr_read_b32 v221, a167
  v_mul_f32 v218, v218, v217
  v_mul_f32 v219, v219, v217
  v_mul_f32 v220, v220, v217
  v_mul_f32 v221, v221, v217
  v_accvgpr_write_b32 a164, v218
  v_accvgpr_write_b32 a165, v219
  v_accvgpr_write_b32 a166, v220
  v_accvgpr_write_b32 a167, v221
  v_accvgpr_read_b32 v218, a168
  v_accvgpr_read_b32 v219, a169
  v_accvgpr_read_b32 v220, a170
  v_accvgpr_read_b32 v221, a171
  v_mul_f32 v218, v218, v217
  v_mul_f32 v219, v219, v217
  v_mul_f32 v220, v220, v217
  v_mul_f32 v221, v221, v217
  v_accvgpr_write_b32 a168, v218
  v_accvgpr_write_b32 a169, v219
  v_accvgpr_write_b32 a170, v220
  v_accvgpr_write_b32 a171, v221
  v_accvgpr_read_b32 v218, a172
  v_accvgpr_read_b32 v219, a173
  v_accvgpr_read_b32 v220, a174
  v_accvgpr_read_b32 v221, a175
  v_mul_f32 v218, v218, v217
  v_mul_f32 v219, v219, v217
  v_mul_f32 v220, v220, v217
  v_mul_f32 v221, v221, v217
  v_accvgpr_write_b32 a172, v218
  v_accvgpr_write_b32 a173, v219
  v_accvgpr_write_b32 a174, v220
  v_accvgpr_write_b32 a175, v221
  v_accvgpr_read_b32 v218, a176
  v_accvgpr_read_b32 v219, a177
  v_accvgpr_read_b32 v220, a178
  v_accvgpr_read_b32 v221, a179
  v_mul_f32 v218, v218, v217
  v_mul_f32 v219, v219, v217
  v_mul_f32 v220, v220, v217
  v_mul_f32 v221, v221, v217
  v_accvgpr_write_b32 a176, v218
  v_accvgpr_write_b32 a177, v219
  v_accvgpr_write_b32 a178, v220
  v_accvgpr_write_b32 a179, v221
  v_accvgpr_read_b32 v218, a180
  v_accvgpr_read_b32 v219, a181
  v_accvgpr_read_b32 v220, a182
  v_accvgpr_read_b32 v221, a183
  v_mul_f32 v218, v218, v217
  v_mul_f32 v219, v219, v217
  v_mul_f32 v220, v220, v217
  v_mul_f32 v221, v221, v217
  v_accvgpr_write_b32 a180, v218
  v_accvgpr_write_b32 a181, v219
  v_accvgpr_write_b32 a182, v220
  v_accvgpr_write_b32 a183, v221
  v_accvgpr_read_b32 v218, a184
  v_accvgpr_read_b32 v219, a185
  v_accvgpr_read_b32 v220, a186
  v_accvgpr_read_b32 v221, a187
  v_mul_f32 v218, v218, v217
  v_mul_f32 v219, v219, v217
  v_mul_f32 v220, v220, v217
  v_mul_f32 v221, v221, v217
  v_accvgpr_write_b32 a184, v218
  v_accvgpr_write_b32 a185, v219
  v_accvgpr_write_b32 a186, v220
  v_accvgpr_write_b32 a187, v221
  v_accvgpr_read_b32 v218, a188
  v_accvgpr_read_b32 v219, a189
  v_accvgpr_read_b32 v220, a190
  v_accvgpr_read_b32 v221, a191
  v_mul_f32 v218, v218, v217
  v_mul_f32 v219, v219, v217
  v_mul_f32 v220, v220, v217
  v_mul_f32 v221, v221, v217
  v_accvgpr_write_b32 a188, v218
  v_accvgpr_write_b32 a189, v219
  v_accvgpr_write_b32 a190, v220
  v_accvgpr_write_b32 a191, v221
  v_sub_f32 v144, v144, v216
  v_sub_f32 v145, v145, v216
  v_sub_f32 v146, v146, v216
  v_sub_f32 v147, v147, v216
  v_sub_f32 v148, v148, v216
  v_sub_f32 v149, v149, v216
  v_sub_f32 v150, v150, v216
  v_sub_f32 v151, v151, v216
  v_sub_f32 v152, v152, v216
  v_sub_f32 v153, v153, v216
  v_sub_f32 v154, v154, v216
  v_sub_f32 v155, v155, v216
  v_sub_f32 v156, v156, v216
  v_sub_f32 v157, v157, v216
  v_sub_f32 v158, v158, v216
  v_sub_f32 v159, v159, v216
  v_exp_f32 v144, v144
  v_exp_f32 v145, v145
  v_exp_f32 v146, v146
  v_exp_f32 v147, v147
  v_exp_f32 v148, v148
  v_exp_f32 v149, v149
  v_exp_f32 v150, v150
  v_exp_f32 v151, v151
  v_exp_f32 v152, v152
  v_exp_f32 v153, v153
  v_exp_f32 v154, v154
  v_exp_f32 v155, v155
  v_exp_f32 v156, v156
  v_exp_f32 v157, v157
  v_exp_f32 v158, v158
  v_exp_f32 v159, v159
  v_add_f32 v28, v144, v145
  v_add_f32 v28, v28, v146
  v_add_f32 v28, v28, v147
  v_add_f32 v28, v28, v148
  v_add_f32 v28, v28, v149
  v_add_f32 v28, v28, v150
  v_add_f32 v28, v28, v151
  v_add_f32 v28, v28, v152
  v_add_f32 v28, v28, v153
  v_add_f32 v28, v28, v154
  v_add_f32 v28, v28, v155
  v_add_f32 v28, v28, v156
  v_add_f32 v28, v28, v157
  v_add_f32 v28, v28, v158
  v_add_f32 v28, v28, v159
  v_cvt_pk_bf16_f32 v200, v144, v145
  v_cvt_pk_bf16_f32 v201, v146, v147
  v_cvt_pk_bf16_f32 v202, v148, v149
  v_cvt_pk_bf16_f32 v203, v150, v151
  v_cvt_pk_bf16_f32 v204, v152, v153
  v_cvt_pk_bf16_f32 v205, v154, v155
  v_cvt_pk_bf16_f32 v206, v156, v157
  v_cvt_pk_bf16_f32 v207, v158, v159
  s_nop 7
  s_setpc_b64 s[44:45]
L1_slowb0f:
  s_nop 15
  v_max3_f32 v216, v144, v145, v146
  v_max3_f32 v216, v216, v147, v148
  v_max3_f32 v216, v216, v149, v150
  v_max3_f32 v216, v216, v151, v152
  v_max3_f32 v216, v216, v153, v154
  v_max3_f32 v216, v216, v155, v156
  v_max3_f32 v216, v216, v157, v158
  v_max_f32 v216, v216, v159
  v_mov_b32 v217, v216
  s_nop 1
  v_permlane32_swap_b32 v216, v217
  v_max_f32 v216, v216, v217
  v_sub_f32 v176, v176, v216
  v_mov_b32 v177, v176
  v_mov_b32 v178, v176
  v_mov_b32 v179, v176
  v_mov_b32 v180, v176
  v_mov_b32 v181, v176
  v_mov_b32 v182, v176
  v_mov_b32 v183, v176
  v_mov_b32 v184, v176
  v_mov_b32 v185, v176
  v_mov_b32 v186, v176
  v_mov_b32 v187, v176
  v_mov_b32 v188, v176
  v_mov_b32 v189, v176
  v_mov_b32 v190, v176
  v_mov_b32 v191, v176
  v_sub_f32 v144, v144, v216
  v_sub_f32 v145, v145, v216
  v_sub_f32 v146, v146, v216
  v_sub_f32 v147, v147, v216
  v_sub_f32 v148, v148, v216
  v_sub_f32 v149, v149, v216
  v_sub_f32 v150, v150, v216
  v_sub_f32 v151, v151, v216
  v_sub_f32 v152, v152, v216
  v_sub_f32 v153, v153, v216
  v_sub_f32 v154, v154, v216
  v_sub_f32 v155, v155, v216
  v_sub_f32 v156, v156, v216
  v_sub_f32 v157, v157, v216
  v_sub_f32 v158, v158, v216
  v_sub_f32 v159, v159, v216
  v_exp_f32 v144, v144
  v_exp_f32 v145, v145
  v_exp_f32 v146, v146
  v_exp_f32 v147, v147
  v_exp_f32 v148, v148
  v_exp_f32 v149, v149
  v_exp_f32 v150, v150
  v_exp_f32 v151, v151
  v_exp_f32 v152, v152
  v_exp_f32 v153, v153
  v_exp_f32 v154, v154
  v_exp_f32 v155, v155
  v_exp_f32 v156, v156
  v_exp_f32 v157, v157
  v_exp_f32 v158, v158
  v_exp_f32 v159, v159
  v_add_f32 v28, v144, v145
  v_add_f32 v28, v28, v146
  v_add_f32 v28, v28, v147
  v_add_f32 v28, v28, v148
  v_add_f32 v28, v28, v149
  v_add_f32 v28, v28, v150
  v_add_f32 v28, v28, v151
  v_add_f32 v28, v28, v152
  v_add_f32 v28, v28, v153
  v_add_f32 v28, v28, v154
  v_add_f32 v28, v28, v155
  v_add_f32 v28, v28, v156
  v_add_f32 v28, v28, v157
  v_add_f32 v28, v28, v158
  v_add_f32 v28, v28, v159
  v_cvt_pk_bf16_f32 v200, v144, v145
  v_cvt_pk_bf16_f32 v201, v146, v147
  v_cvt_pk_bf16_f32 v202, v148, v149
  v_cvt_pk_bf16_f32 v203, v150, v151
  v_cvt_pk_bf16_f32 v204, v152, v153
  v_cvt_pk_bf16_f32 v205, v154, v155
  v_cvt_pk_bf16_f32 v206, v156, v157
  v_cvt_pk_bf16_f32 v207, v158, v159
  s_nop 7
  s_setpc_b64 s[44:45]
L1_slowa1:
  s_nop 15
  v_max3_f32 v208, v128, v129, v130
  v_max3_f32 v208, v208, v131, v132
  v_max3_f32 v208, v208, v133, v134
  v_max3_f32 v208, v208, v135, v136
  v_max3_f32 v208, v208, v137, v138
  v_max3_f32 v208, v208, v139, v140
  v_max3_f32 v208, v208, v141, v142
  v_max_f32 v208, v208, v143
  v_mov_b32 v209, v208
  s_nop 1
  v_permlane32_swap_b32 v208, v209
  v_max_f32 v208, v208, v209
  v_max_f32 v208, 0, v208
  v_sub_f32 v209, 0, v208
  v_exp_f32 v209, v209
  v_sub_f32 v160, v160, v208
  v_mov_b32 v161, v160
  v_mov_b32 v162, v160
  v_mov_b32 v163, v160
  v_mov_b32 v164, v160
  v_mov_b32 v165, v160
  v_mov_b32 v166, v160
  v_mov_b32 v167, v160
  v_mov_b32 v168, v160
  v_mov_b32 v169, v160
  v_mov_b32 v170, v160
  v_mov_b32 v171, v160
  v_mov_b32 v172, v160
  v_mov_b32 v173, v160
  v_mov_b32 v174, v160
  v_mov_b32 v175, v160
  v_mul_f32 v29, v29, v209
  v_mul_f32 v64, v64, v209
  v_mul_f32 v65, v65, v209
  v_mul_f32 v66, v66, v209
  v_mul_f32 v67, v67, v209
  v_mul_f32 v68, v68, v209
  v_mul_f32 v69, v69, v209
  v_mul_f32 v70, v70, v209
  v_mul_f32 v71, v71, v209
  v_mul_f32 v72, v72, v209
  v_mul_f32 v73, v73, v209
  v_mul_f32 v74, v74, v209
  v_mul_f32 v75, v75, v209
  v_mul_f32 v76, v76, v209
  v_mul_f32 v77, v77, v209
  v_mul_f32 v78, v78, v209
  v_mul_f32 v79, v79, v209
  v_mul_f32 v80, v80, v209
  v_mul_f32 v81, v81, v209
  v_mul_f32 v82, v82, v209
  v_mul_f32 v83, v83, v209
  v_mul_f32 v84, v84, v209
  v_mul_f32 v85, v85, v209
  v_mul_f32 v86, v86, v209
  v_mul_f32 v87, v87, v209
  v_mul_f32 v88, v88, v209
  v_mul_f32 v89, v89, v209
  v_mul_f32 v90, v90, v209
  v_mul_f32 v91, v91, v209
  v_mul_f32 v92, v92, v209
  v_mul_f32 v93, v93, v209
  v_mul_f32 v94, v94, v209
  v_mul_f32 v95, v95, v209
  v_mul_f32 v96, v96, v209
  v_mul_f32 v97, v97, v209
  v_mul_f32 v98, v98, v209
  v_mul_f32 v99, v99, v209
  v_mul_f32 v100, v100, v209
  v_mul_f32 v101, v101, v209
  v_mul_f32 v102, v102, v209
  v_mul_f32 v103, v103, v209
  v_mul_f32 v104, v104, v209
  v_mul_f32 v105, v105, v209
  v_mul_f32 v106, v106, v209
  v_mul_f32 v107, v107, v209
  v_mul_f32 v108, v108, v209
  v_mul_f32 v109, v109, v209
  v_mul_f32 v110, v110, v209
  v_mul_f32 v111, v111, v209
  v_mul_f32 v112, v112, v209
  v_mul_f32 v113, v113, v209
  v_mul_f32 v114, v114, v209
  v_mul_f32 v115, v115, v209
  v_mul_f32 v116, v116, v209
  v_mul_f32 v117, v117, v209
  v_mul_f32 v118, v118, v209
  v_mul_f32 v119, v119, v209
  v_mul_f32 v120, v120, v209
  v_mul_f32 v121, v121, v209
  v_mul_f32 v122, v122, v209
  v_mul_f32 v123, v123, v209
  v_mul_f32 v124, v124, v209
  v_mul_f32 v125, v125, v209
  v_mul_f32 v126, v126, v209
  v_mul_f32 v127, v127, v209
  v_sub_f32 v128, v128, v208
  v_sub_f32 v129, v129, v208
  v_sub_f32 v130, v130, v208
  v_sub_f32 v131, v131, v208
  v_sub_f32 v132, v132, v208
  v_sub_f32 v133, v133, v208
  v_sub_f32 v134, v134, v208
  v_sub_f32 v135, v135, v208
  v_sub_f32 v136, v136, v208
  v_sub_f32 v137, v137, v208
  v_sub_f32 v138, v138, v208
  v_sub_f32 v139, v139, v208
  v_sub_f32 v140, v140, v208
  v_sub_f32 v141, v141, v208
  v_sub_f32 v142, v142, v208
  v_sub_f32 v143, v143, v208
  v_exp_f32 v128, v128
  v_exp_f32 v129, v129
  v_exp_f32 v130, v130
  v_exp_f32 v131, v131
  v_exp_f32 v132, v132
  v_exp_f32 v133, v133
  v_exp_f32 v134, v134
  v_exp_f32 v135, v135
  v_exp_f32 v136, v136
  v_exp_f32 v137, v137
  v_exp_f32 v138, v138
  v_exp_f32 v139, v139
  v_exp_f32 v140, v140
  v_exp_f32 v141, v141
  v_exp_f32 v142, v142
  v_exp_f32 v143, v143
  v_add_f32 v27, v128, v129
  v_add_f32 v27, v27, v130
  v_add_f32 v27, v27, v131
  v_add_f32 v27, v27, v132
  v_add_f32 v27, v27, v133
  v_add_f32 v27, v27, v134
  v_add_f32 v27, v27, v135
  v_add_f32 v27, v27, v136
  v_add_f32 v27, v27, v137
  v_add_f32 v27, v27, v138
  v_add_f32 v27, v27, v139
  v_add_f32 v27, v27, v140
  v_add_f32 v27, v27, v141
  v_add_f32 v27, v27, v142
  v_add_f32 v27, v27, v143
  v_cvt_pk_bf16_f32 v192, v128, v129
  v_cvt_pk_bf16_f32 v193, v130, v131
  v_cvt_pk_bf16_f32 v194, v132, v133
  v_cvt_pk_bf16_f32 v195, v134, v135
  v_cvt_pk_bf16_f32 v196, v136, v137
  v_cvt_pk_bf16_f32 v197, v138, v139
  v_cvt_pk_bf16_f32 v198, v140, v141
  v_cvt_pk_bf16_f32 v199, v142, v143
  s_nop 7
  s_setpc_b64 s[44:45]
L1_slowa1f:
  s_nop 15
  v_max3_f32 v208, v128, v129, v130
  v_max3_f32 v208, v208, v131, v132
  v_max3_f32 v208, v208, v133, v134
  v_max3_f32 v208, v208, v135, v136
  v_max3_f32 v208, v208, v137, v138
  v_max3_f32 v208, v208, v139, v140
  v_max3_f32 v208, v208, v141, v142
  v_max_f32 v208, v208, v143
  v_mov_b32 v209, v208
  s_nop 1
  v_permlane32_swap_b32 v208, v209
  v_max_f32 v208, v208, v209
  v_sub_f32 v160, v160, v208
  v_mov_b32 v161, v160
  v_mov_b32 v162, v160
  v_mov_b32 v163, v160
  v_mov_b32 v164, v160
  v_mov_b32 v165, v160
  v_mov_b32 v166, v160
  v_mov_b32 v167, v160
  v_mov_b32 v168, v160
  v_mov_b32 v169, v160
  v_mov_b32 v170, v160
  v_mov_b32 v171, v160
  v_mov_b32 v172, v160
  v_mov_b32 v173, v160
  v_mov_b32 v174, v160
  v_mov_b32 v175, v160
  v_sub_f32 v128, v128, v208
  v_sub_f32 v129, v129, v208
  v_sub_f32 v130, v130, v208
  v_sub_f32 v131, v131, v208
  v_sub_f32 v132, v132, v208
  v_sub_f32 v133, v133, v208
  v_sub_f32 v134, v134, v208
  v_sub_f32 v135, v135, v208
  v_sub_f32 v136, v136, v208
  v_sub_f32 v137, v137, v208
  v_sub_f32 v138, v138, v208
  v_sub_f32 v139, v139, v208
  v_sub_f32 v140, v140, v208
  v_sub_f32 v141, v141, v208
  v_sub_f32 v142, v142, v208
  v_sub_f32 v143, v143, v208
  v_exp_f32 v128, v128
  v_exp_f32 v129, v129
  v_exp_f32 v130, v130
  v_exp_f32 v131, v131
  v_exp_f32 v132, v132
  v_exp_f32 v133, v133
  v_exp_f32 v134, v134
  v_exp_f32 v135, v135
  v_exp_f32 v136, v136
  v_exp_f32 v137, v137
  v_exp_f32 v138, v138
  v_exp_f32 v139, v139
  v_exp_f32 v140, v140
  v_exp_f32 v141, v141
  v_exp_f32 v142, v142
  v_exp_f32 v143, v143
  v_add_f32 v27, v128, v129
  v_add_f32 v27, v27, v130
  v_add_f32 v27, v27, v131
  v_add_f32 v27, v27, v132
  v_add_f32 v27, v27, v133
  v_add_f32 v27, v27, v134
  v_add_f32 v27, v27, v135
  v_add_f32 v27, v27, v136
  v_add_f32 v27, v27, v137
  v_add_f32 v27, v27, v138
  v_add_f32 v27, v27, v139
  v_add_f32 v27, v27, v140
  v_add_f32 v27, v27, v141
  v_add_f32 v27, v27, v142
  v_add_f32 v27, v27, v143
  v_cvt_pk_bf16_f32 v192, v128, v129
  v_cvt_pk_bf16_f32 v193, v130, v131
  v_cvt_pk_bf16_f32 v194, v132, v133
  v_cvt_pk_bf16_f32 v195, v134, v135
  v_cvt_pk_bf16_f32 v196, v136, v137
  v_cvt_pk_bf16_f32 v197, v138, v139
  v_cvt_pk_bf16_f32 v198, v140, v141
  v_cvt_pk_bf16_f32 v199, v142, v143
  s_nop 7
  s_setpc_b64 s[44:45]
L1_slowb1:
  s_nop 15
  v_max3_f32 v216, v144, v145, v146
  v_max3_f32 v216, v216, v147, v148
  v_max3_f32 v216, v216, v149, v150
  v_max3_f32 v216, v216, v151, v152
  v_max3_f32 v216, v216, v153, v154
  v_max3_f32 v216, v216, v155, v156
  v_max3_f32 v216, v216, v157, v158
  v_max_f32 v216, v216, v159
  v_mov_b32 v217, v216
  s_nop 1
  v_permlane32_swap_b32 v216, v217
  v_max_f32 v216, v216, v217
  v_max_f32 v216, 0, v216
  v_sub_f32 v217, 0, v216
  v_exp_f32 v217, v217
  v_sub_f32 v176, v176, v216
  v_mov_b32 v177, v176
  v_mov_b32 v178, v176
  v_mov_b32 v179, v176
  v_mov_b32 v180, v176
  v_mov_b32 v181, v176
  v_mov_b32 v182, v176
  v_mov_b32 v183, v176
  v_mov_b32 v184, v176
  v_mov_b32 v185, v176
  v_mov_b32 v186, v176
  v_mov_b32 v187, v176
  v_mov_b32 v188, v176
  v_mov_b32 v189, v176
  v_mov_b32 v190, v176
  v_mov_b32 v191, v176
  v_mul_f32 v30, v30, v217
  v_accvgpr_read_b32 v218, a64
  v_accvgpr_read_b32 v219, a65
  v_accvgpr_read_b32 v220, a66
  v_accvgpr_read_b32 v221, a67
  v_mul_f32 v218, v218, v217
  v_mul_f32 v219, v219, v217
  v_mul_f32 v220, v220, v217
  v_mul_f32 v221, v221, v217
  v_accvgpr_write_b32 a64, v218
  v_accvgpr_write_b32 a65, v219
  v_accvgpr_write_b32 a66, v220
  v_accvgpr_write_b32 a67, v221
  v_accvgpr_read_b32 v218, a68
  v_accvgpr_read_b32 v219, a69
  v_accvgpr_read_b32 v220, a70
  v_accvgpr_read_b32 v221, a71
  v_mul_f32 v218, v218, v217
  v_mul_f32 v219, v219, v217
  v_mul_f32 v220, v220, v217
  v_mul_f32 v221, v221, v217
  v_accvgpr_write_b32 a68, v218
  v_accvgpr_write_b32 a69, v219
  v_accvgpr_write_b32 a70, v220
  v_accvgpr_write_b32 a71, v221
  v_accvgpr_read_b32 v218, a72
  v_accvgpr_read_b32 v219, a73
  v_accvgpr_read_b32 v220, a74
  v_accvgpr_read_b32 v221, a75
  v_mul_f32 v218, v218, v217
  v_mul_f32 v219, v219, v217
  v_mul_f32 v220, v220, v217
  v_mul_f32 v221, v221, v217
  v_accvgpr_write_b32 a72, v218
  v_accvgpr_write_b32 a73, v219
  v_accvgpr_write_b32 a74, v220
  v_accvgpr_write_b32 a75, v221
  v_accvgpr_read_b32 v218, a76
  v_accvgpr_read_b32 v219, a77
  v_accvgpr_read_b32 v220, a78
  v_accvgpr_read_b32 v221, a79
  v_mul_f32 v218, v218, v217
  v_mul_f32 v219, v219, v217
  v_mul_f32 v220, v220, v217
  v_mul_f32 v221, v221, v217
  v_accvgpr_write_b32 a76, v218
  v_accvgpr_write_b32 a77, v219
  v_accvgpr_write_b32 a78, v220
  v_accvgpr_write_b32 a79, v221
  v_accvgpr_read_b32 v218, a80
  v_accvgpr_read_b32 v219, a81
  v_accvgpr_read_b32 v220, a82
  v_accvgpr_read_b32 v221, a83
  v_mul_f32 v218, v218, v217
  v_mul_f32 v219, v219, v217
  v_mul_f32 v220, v220, v217
  v_mul_f32 v221, v221, v217
  v_accvgpr_write_b32 a80, v218
  v_accvgpr_write_b32 a81, v219
  v_accvgpr_write_b32 a82, v220
  v_accvgpr_write_b32 a83, v221
  v_accvgpr_read_b32 v218, a84
  v_accvgpr_read_b32 v219, a85
  v_accvgpr_read_b32 v220, a86
  v_accvgpr_read_b32 v221, a87
  v_mul_f32 v218, v218, v217
  v_mul_f32 v219, v219, v217
  v_mul_f32 v220, v220, v217
  v_mul_f32 v221, v221, v217
  v_accvgpr_write_b32 a84, v218
  v_accvgpr_write_b32 a85, v219
  v_accvgpr_write_b32 a86, v220
  v_accvgpr_write_b32 a87, v221
  v_accvgpr_read_b32 v218, a88
  v_accvgpr_read_b32 v219, a89
  v_accvgpr_read_b32 v220, a90
  v_accvgpr_read_b32 v221, a91
  v_mul_f32 v218, v218, v217
  v_mul_f32 v219, v219, v217
  v_mul_f32 v220, v220, v217
  v_mul_f32 v221, v221, v217
  v_accvgpr_write_b32 a88, v218
  v_accvgpr_write_b32 a89, v219
  v_accvgpr_write_b32 a90, v220
  v_accvgpr_write_b32 a91, v221
  v_accvgpr_read_b32 v218, a92
  v_accvgpr_read_b32 v219, a93
  v_accvgpr_read_b32 v220, a94
  v_accvgpr_read_b32 v221, a95
  v_mul_f32 v218, v218, v217
  v_mul_f32 v219, v219, v217
  v_mul_f32 v220, v220, v217
  v_mul_f32 v221, v221, v217
  v_accvgpr_write_b32 a92, v218
  v_accvgpr_write_b32 a93, v219
  v_accvgpr_write_b32 a94, v220
  v_accvgpr_write_b32 a95, v221
  v_accvgpr_read_b32 v218, a96
  v_accvgpr_read_b32 v219, a97
  v_accvgpr_read_b32 v220, a98
  v_accvgpr_read_b32 v221, a99
  v_mul_f32 v218, v218, v217
  v_mul_f32 v219, v219, v217
  v_mul_f32 v220, v220, v217
  v_mul_f32 v221, v221, v217
  v_accvgpr_write_b32 a96, v218
  v_accvgpr_write_b32 a97, v219
  v_accvgpr_write_b32 a98, v220
  v_accvgpr_write_b32 a99, v221
  v_accvgpr_read_b32 v218, a100
  v_accvgpr_read_b32 v219, a101
  v_accvgpr_read_b32 v220, a102
  v_accvgpr_read_b32 v221, a103
  v_mul_f32 v218, v218, v217
  v_mul_f32 v219, v219, v217
  v_mul_f32 v220, v220, v217
  v_mul_f32 v221, v221, v217
  v_accvgpr_write_b32 a100, v218
  v_accvgpr_write_b32 a101, v219
  v_accvgpr_write_b32 a102, v220
  v_accvgpr_write_b32 a103, v221
  v_accvgpr_read_b32 v218, a104
  v_accvgpr_read_b32 v219, a105
  v_accvgpr_read_b32 v220, a106
  v_accvgpr_read_b32 v221, a107
  v_mul_f32 v218, v218, v217
  v_mul_f32 v219, v219, v217
  v_mul_f32 v220, v220, v217
  v_mul_f32 v221, v221, v217
  v_accvgpr_write_b32 a104, v218
  v_accvgpr_write_b32 a105, v219
  v_accvgpr_write_b32 a106, v220
  v_accvgpr_write_b32 a107, v221
  v_accvgpr_read_b32 v218, a108
  v_accvgpr_read_b32 v219, a109
  v_accvgpr_read_b32 v220, a110
  v_accvgpr_read_b32 v221, a111
  v_mul_f32 v218, v218, v217
  v_mul_f32 v219, v219, v217
  v_mul_f32 v220, v220, v217
  v_mul_f32 v221, v221, v217
  v_accvgpr_write_b32 a108, v218
  v_accvgpr_write_b32 a109, v219
  v_accvgpr_write_b32 a110, v220
  v_accvgpr_write_b32 a111, v221
  v_accvgpr_read_b32 v218, a112
  v_accvgpr_read_b32 v219, a113
  v_accvgpr_read_b32 v220, a114
  v_accvgpr_read_b32 v221, a115
  v_mul_f32 v218, v218, v217
  v_mul_f32 v219, v219, v217
  v_mul_f32 v220, v220, v217
  v_mul_f32 v221, v221, v217
  v_accvgpr_write_b32 a112, v218
  v_accvgpr_write_b32 a113, v219
  v_accvgpr_write_b32 a114, v220
  v_accvgpr_write_b32 a115, v221
  v_accvgpr_read_b32 v218, a116
  v_accvgpr_read_b32 v219, a117
  v_accvgpr_read_b32 v220, a118
  v_accvgpr_read_b32 v221, a119
  v_mul_f32 v218, v218, v217
  v_mul_f32 v219, v219, v217
  v_mul_f32 v220, v220, v217
  v_mul_f32 v221, v221, v217
  v_accvgpr_write_b32 a116, v218
  v_accvgpr_write_b32 a117, v219
  v_accvgpr_write_b32 a118, v220
  v_accvgpr_write_b32 a119, v221
  v_accvgpr_read_b32 v218, a120
  v_accvgpr_read_b32 v219, a121
  v_accvgpr_read_b32 v220, a122
  v_accvgpr_read_b32 v221, a123
  v_mul_f32 v218, v218, v217
  v_mul_f32 v219, v219, v217
  v_mul_f32 v220, v220, v217
  v_mul_f32 v221, v221, v217
  v_accvgpr_write_b32 a120, v218
  v_accvgpr_write_b32 a121, v219
  v_accvgpr_write_b32 a122, v220
  v_accvgpr_write_b32 a123, v221
  v_accvgpr_read_b32 v218, a124
  v_accvgpr_read_b32 v219, a125
  v_accvgpr_read_b32 v220, a126
  v_accvgpr_read_b32 v221, a127
  v_mul_f32 v218, v218, v217
  v_mul_f32 v219, v219, v217
  v_mul_f32 v220, v220, v217
  v_mul_f32 v221, v221, v217
  v_accvgpr_write_b32 a124, v218
  v_accvgpr_write_b32 a125, v219
  v_accvgpr_write_b32 a126, v220
  v_accvgpr_write_b32 a127, v221
  v_sub_f32 v144, v144, v216
  v_sub_f32 v145, v145, v216
  v_sub_f32 v146, v146, v216
  v_sub_f32 v147, v147, v216
  v_sub_f32 v148, v148, v216
  v_sub_f32 v149, v149, v216
  v_sub_f32 v150, v150, v216
  v_sub_f32 v151, v151, v216
  v_sub_f32 v152, v152, v216
  v_sub_f32 v153, v153, v216
  v_sub_f32 v154, v154, v216
  v_sub_f32 v155, v155, v216
  v_sub_f32 v156, v156, v216
  v_sub_f32 v157, v157, v216
  v_sub_f32 v158, v158, v216
  v_sub_f32 v159, v159, v216
  v_exp_f32 v144, v144
  v_exp_f32 v145, v145
  v_exp_f32 v146, v146
  v_exp_f32 v147, v147
  v_exp_f32 v148, v148
  v_exp_f32 v149, v149
  v_exp_f32 v150, v150
  v_exp_f32 v151, v151
  v_exp_f32 v152, v152
  v_exp_f32 v153, v153
  v_exp_f32 v154, v154
  v_exp_f32 v155, v155
  v_exp_f32 v156, v156
  v_exp_f32 v157, v157
  v_exp_f32 v158, v158
  v_exp_f32 v159, v159
  v_add_f32 v28, v144, v145
  v_add_f32 v28, v28, v146
  v_add_f32 v28, v28, v147
  v_add_f32 v28, v28, v148
  v_add_f32 v28, v28, v149
  v_add_f32 v28, v28, v150
  v_add_f32 v28, v28, v151
  v_add_f32 v28, v28, v152
  v_add_f32 v28, v28, v153
  v_add_f32 v28, v28, v154
  v_add_f32 v28, v28, v155
  v_add_f32 v28, v28, v156
  v_add_f32 v28, v28, v157
  v_add_f32 v28, v28, v158
  v_add_f32 v28, v28, v159
  v_cvt_pk_bf16_f32 v200, v144, v145
  v_cvt_pk_bf16_f32 v201, v146, v147
  v_cvt_pk_bf16_f32 v202, v148, v149
  v_cvt_pk_bf16_f32 v203, v150, v151
  v_cvt_pk_bf16_f32 v204, v152, v153
  v_cvt_pk_bf16_f32 v205, v154, v155
  v_cvt_pk_bf16_f32 v206, v156, v157
  v_cvt_pk_bf16_f32 v207, v158, v159
  s_nop 7
  s_setpc_b64 s[44:45]
L1_slowb1f:
  s_nop 15
  v_max3_f32 v216, v144, v145, v146
  v_max3_f32 v216, v216, v147, v148
  v_max3_f32 v216, v216, v149, v150
  v_max3_f32 v216, v216, v151, v152
  v_max3_f32 v216, v216, v153, v154
  v_max3_f32 v216, v216, v155, v156
  v_max3_f32 v216, v216, v157, v158
  v_max_f32 v216, v216, v159
  v_mov_b32 v217, v216
  s_nop 1
  v_permlane32_swap_b32 v216, v217
  v_max_f32 v216, v216, v217
  v_sub_f32 v176, v176, v216
  v_mov_b32 v177, v176
  v_mov_b32 v178, v176
  v_mov_b32 v179, v176
  v_mov_b32 v180, v176
  v_mov_b32 v181, v176
  v_mov_b32 v182, v176
  v_mov_b32 v183, v176
  v_mov_b32 v184, v176
  v_mov_b32 v185, v176
  v_mov_b32 v186, v176
  v_mov_b32 v187, v176
  v_mov_b32 v188, v176
  v_mov_b32 v189, v176
  v_mov_b32 v190, v176
  v_mov_b32 v191, v176
  v_sub_f32 v144, v144, v216
  v_sub_f32 v145, v145, v216
  v_sub_f32 v146, v146, v216
  v_sub_f32 v147, v147, v216
  v_sub_f32 v148, v148, v216
  v_sub_f32 v149, v149, v216
  v_sub_f32 v150, v150, v216
  v_sub_f32 v151, v151, v216
  v_sub_f32 v152, v152, v216
  v_sub_f32 v153, v153, v216
  v_sub_f32 v154, v154, v216
  v_sub_f32 v155, v155, v216
  v_sub_f32 v156, v156, v216
  v_sub_f32 v157, v157, v216
  v_sub_f32 v158, v158, v216
  v_sub_f32 v159, v159, v216
  v_exp_f32 v144, v144
  v_exp_f32 v145, v145
  v_exp_f32 v146, v146
  v_exp_f32 v147, v147
  v_exp_f32 v148, v148
  v_exp_f32 v149, v149
  v_exp_f32 v150, v150
  v_exp_f32 v151, v151
  v_exp_f32 v152, v152
  v_exp_f32 v153, v153
  v_exp_f32 v154, v154
  v_exp_f32 v155, v155
  v_exp_f32 v156, v156
  v_exp_f32 v157, v157
  v_exp_f32 v158, v158
  v_exp_f32 v159, v159
  v_add_f32 v28, v144, v145
  v_add_f32 v28, v28, v146
  v_add_f32 v28, v28, v147
  v_add_f32 v28, v28, v148
  v_add_f32 v28, v28, v149
  v_add_f32 v28, v28, v150
  v_add_f32 v28, v28, v151
  v_add_f32 v28, v28, v152
  v_add_f32 v28, v28, v153
  v_add_f32 v28, v28, v154
  v_add_f32 v28, v28, v155
  v_add_f32 v28, v28, v156
  v_add_f32 v28, v28, v157
  v_add_f32 v28, v28, v158
  v_add_f32 v28, v28, v159
  v_cvt_pk_bf16_f32 v200, v144, v145
  v_cvt_pk_bf16_f32 v201, v146, v147
  v_cvt_pk_bf16_f32 v202, v148, v149
  v_cvt_pk_bf16_f32 v203, v150, v151
  v_cvt_pk_bf16_f32 v204, v152, v153
  v_cvt_pk_bf16_f32 v205, v154, v155
  v_cvt_pk_bf16_f32 v206, v156, v157
  v_cvt_pk_bf16_f32 v207, v158, v159
  s_nop 7
  s_setpc_b64 s[44:45]
L_spin0:
  s_mov_b32 s42, 0
L_spin0_l:
  buffer_load_dword v4, v25, s[72:75], 0 offen offset:0 sc1
  s_waitcnt vmcnt(0)
  v_cmp_gt_u32 vcc, 16, v4
  s_nop 4
  s_cbranch_vccz L_spin0_ret
  s_add_u32 s42, s42, 1
  s_cmp_lt_u32 s42, 20000
  s_cbranch_scc1 L_spin0_l
  s_branch L_spin0_ret
L_spin1:
  s_mov_b32 s42, 0
L_spin1_l:
  buffer_load_dword v4, v3, s[72:75], 0 offen offset:4 sc1
  s_waitcnt vmcnt(0)
  v_cmp_gt_u32 vcc, 16, v4
  s_nop 4
  s_cbranch_vccz L_spin1_ret
  s_add_u32 s42, s42, 1
  s_cmp_lt_u32 s42, 20000
  s_cbranch_scc1 L_spin1_l
  s_branch L_spin1_ret
L1_notile:
  s_waitcnt vmcnt(0)
  s_barrier
  s_cmp_eq_u32 s24, 0
  s_cbranch_scc0 L1_fin
  s_mov_b64 exec, 1
  buffer_atomic_add v7, off, s[72:75], s41 offset:4
  s_waitcnt vmcnt(0)
  s_mov_b64 exec, -1
L1_fin:
  s_branch L1_end
CP_end:
.section .rodata,"a"
.p2align 6
.amdhsa_kernel mha_kernel
  .amdhsa_next_free_vgpr 512
  .amdhsa_next_free_sgpr 102
  .amdhsa_accum_offset 256
  .amdhsa_group_segment_fixed_size 0
  .amdhsa_kernarg_size 104
  .amdhsa_user_sgpr_count 2
  .amdhsa_user_sgpr_kernarg_segment_ptr 1
  .amdhsa_system_sgpr_workgroup_id_x 1
.end_amdhsa_kernel
```
